```python
import torch

def _softmax(x, axis=-1):
    return torch.softmax(x, dim=axis)
def _gelu(x):
    return torch.nn.functional.gelu(x, approximate="tanh")
def _silu(x):
    return torch.nn.functional.silu(x)
def _sigmoid(x):
    return torch.sigmoid(x)
def _layernorm(x, axis=-1, eps=1e-5):
    m = x.mean(dim=axis, keepdim=True)
    v = x.var(dim=axis, keepdim=True, unbiased=False)
    return (x - m) / torch.sqrt(v + eps)
def _scatter_add(tgt, idx, src, axis=0):
    return tgt.clone().index_add_(axis, idx, src)
def _segment_sum(src, seg, n):
    out = torch.zeros((n,) + src.shape[1:], dtype=src.dtype)
    return out.index_add_(0, seg, src)
def _pad(x, pw):
    flat = tuple(v for pair in reversed(pw) for v in pair)
    return torch.nn.functional.pad(x, flat)

kernel_name = 'gated_mix__mha_block__mixer_s_mlp__prompt'

def setup_inputs():

    _w = (lambda a: (lambda t: t.to(torch.bfloat16) if t.is_floating_point() else t)(torch.as_tensor(a)))
    def _A_setup():
        B, S, D, H = 1, 2048, 576, 32
        return {
            "x": _w((lambda *s: torch.randn(*s, dtype=torch.bfloat16) * 0.05)(B, S, D)),
            "wqkv": _w((lambda *s: torch.randn(*s, dtype=torch.bfloat16) * 1.6)(D, 3 * D)),
            "wo": _w((lambda *s: torch.randn(*s, dtype=torch.bfloat16) * 0.1)(D, D)),
        }
    _A_in = _A_setup()

    def _B_setup():
        B, S, D, F = 1, 2048, 576, 4608
        return {
            "x":  _w((lambda *s: torch.randn(*s, dtype=torch.bfloat16) * 0.05)(B, S, D)),
            "w1": _w((lambda *s: torch.randn(*s, dtype=torch.bfloat16) * 3.2)(D, D) * (D ** -0.5)),
            "w2": _w((lambda *s: torch.randn(*s, dtype=torch.bfloat16) * 3.2)(D, D) * (D ** -0.5)),
            "w3": _w((lambda *s: torch.randn(*s, dtype=torch.bfloat16) * 3.2)(D, F) * (D ** -0.5)),
            "w4": _w((lambda *s: torch.randn(*s, dtype=torch.bfloat16) * 3.2)(F, D) * (F ** -0.5)),
        }
    _B_in = _B_setup()

    return {
        "A_x": _A_in["x"],
        "A_wqkv": _A_in["wqkv"],
        "A_wo": _A_in["wo"],
        "B_x": _B_in["x"],
        "B_w1": _B_in["w1"],
        "B_w2": _B_in["w2"],
        "B_w3": _B_in["w3"],
        "B_w4": _B_in["w4"],
        "gate_w": _w((lambda *s: torch.randn(*s, dtype=torch.bfloat16) * 0.05)(576) * 16.0),
    }

def reference(A_x, A_wqkv, A_wo, B_x, B_w1, B_w2, B_w3, B_w4, gate_w):
    def _A_ref(x, wqkv, wo):
        B, S, D = x.shape
        H = 32
        Dh = D // H
        qkv = (lambda x, *d: x.permute(*d))((x @ wqkv).reshape(B, S, 3, H, Dh), 2, 0, 3, 1, 4)
        q, k, v = qkv[0], qkv[1], qkv[2]
        scores = torch.einsum("bhqd,bhkd->bhqk", q, k) * (Dh ** -0.5)
        p = _softmax(scores, axis=-1)
        o = torch.einsum("bhqk,bhkd->bhqd", p, v)
        return (lambda x, *d: x.permute(*d))(o, 0, 2, 1, 3).reshape(B, S, D) @ wo

    def _B_ref(x, w1, w2, w3, w4):
        B, S, D = x.shape
        h = _gelu(_layernorm(x, axis=-1) @ w1)
        c = D // 4
        g0 = _pad(h[:, :, 0*c:1*c], ((0, 0), (1, 0), (0, 0)))[:, :S, :]
        g1 = _pad(h[:, :, 1*c:2*c], ((0, 0), (0, 1), (0, 0)))[:, 1:, :]
        g2 = _pad(h[:, :, 2*c:3*c], ((0, 0), (2, 0), (0, 0)))[:, :S, :]
        g3 = _pad(h[:, :, 3*c:   ], ((0, 0), (0, 2), (0, 0)))[:, 2:, :]
        hs = torch.concatenate([g0, g1, g2, g3], axis=-1) @ w2
        x1 = x + hs
        h2 = _gelu(_layernorm(x1, axis=-1) @ w3) @ w4
        return x1 + h2

    x = A_x
    g = _sigmoid((x * gate_w).sum(-1, keepdims=True))
    a = _A_ref(x, A_wqkv, A_wo)
    b = _B_ref(x, B_w1, B_w2, B_w3, B_w4)
    return g * a + (1 - g) * b
```

```asm
; @launch grid=(256,1,1) block=(256,1,1) lds=163840
.amdgcn_target "amdgcn-amd-amdhsa--gfx950"
.text
.globl gated_mix__mha_block__mixer_s_mlp__prompt_kernel
.p2align 8
.type gated_mix__mha_block__mixer_s_mlp__prompt_kernel,@function
gated_mix__mha_block__mixer_s_mlp__prompt_kernel:
L_cs:
  s_load_dword s3, s[0:1], 0
  s_load_dword s3, s[0:1], 64
  s_cmp_ge_u32 s2, 256
  s_cbranch_scc1 L_exit
  s_and_b32 s4, s2, 7
  s_lshr_b32 s5, s2, 4
  s_cmp_ge_u32 s2, 24
  s_cbranch_scc1 L_nocpf
  s_getpc_b64 s[8:9]
L_cs0:
  s_add_u32 s8, s8, L_cs-L_cs0
  s_addc_u32 s9, s9, (L_cs-L_cs0)>>32
  s_mov_b32 s10, L_exit-L_cs
  s_mov_b32 s11, 131072
  s_and_b32 s6, s2, 24
  s_lshl_b32 s6, s6, 12
  v_lshlrev_b32 v1, 7, v0
  buffer_load_dword v255, v1, s[8:11], s6 offen
L_nocpf:
  s_lshr_b32 s7, s5, 1
  s_and_b32 s6, s4, 1
  s_lshl_b32 s6, s6, 3
  s_and_b32 s8, s4, 6
  s_add_u32 s6, s6, s8
  s_and_b32 s8, s5, 1
  s_add_u32 s6, s6, s8
  s_bitcmp1_b32 s2, 3
  s_cbranch_scc1 L_teamA
  s_load_dwordx2 s[36:37], s[0:1], 0
  s_load_dwordx4 s[32:35], s[0:1], 32
  s_load_dwordx8 s[24:31], s[0:1], 64
  s_load_dwordx4 s[48:51], s[0:1], 48
  v_lshrrev_b32 v7, 6, v0
  v_and_b32 v9, 63, v0
  v_readfirstlane_b32 s43, v7
  s_lshl_b32 s54, s6, 2
  s_add_u32 s54, s54, s43
  s_mul_i32 s68, s7, 9
  s_lshr_b32 s68, s68, 1
  s_movk_i32 s44, 6554
  s_movk_i32 s45, 1152
  v_add_u32 v240, 0, v9
  v_mul_u32_u24 v241, s44, v240
  v_lshrrev_b32 v241, 16, v241
  v_mul_u32_u24 v242, 10, v241
  v_sub_u32 v242, v240, v242
  v_lshlrev_b32 v242, 4, v242
  v_and_b32 v243, 1, v241
  v_bfe_u32 v244, v241, 1, 2
  v_lshl_or_b32 v243, v243, 2, v244
  v_and_b32 v244, 24, v241
  v_or_b32 v243, v243, v244
  v_mad_u32_u24 v200, v243, s45, v242
  v_add_u32 v240, 64, v9
  v_mul_u32_u24 v241, s44, v240
  v_lshrrev_b32 v241, 16, v241
  v_mul_u32_u24 v242, 10, v241
  v_sub_u32 v242, v240, v242
  v_lshlrev_b32 v242, 4, v242
  v_and_b32 v243, 1, v241
  v_bfe_u32 v244, v241, 1, 2
  v_lshl_or_b32 v243, v243, 2, v244
  v_and_b32 v244, 24, v241
  v_or_b32 v243, v243, v244
  v_mad_u32_u24 v201, v243, s45, v242
  v_subrev_u32 v201, 1024, v201
  v_add_u32 v240, 128, v9
  v_mul_u32_u24 v241, s44, v240
  v_lshrrev_b32 v241, 16, v241
  v_mul_u32_u24 v242, 10, v241
  v_sub_u32 v242, v240, v242
  v_lshlrev_b32 v242, 4, v242
  v_and_b32 v243, 1, v241
  v_bfe_u32 v244, v241, 1, 2
  v_lshl_or_b32 v243, v243, 2, v244
  v_and_b32 v244, 24, v241
  v_or_b32 v243, v243, v244
  v_mad_u32_u24 v202, v243, s45, v242
  v_subrev_u32 v202, 2048, v202
  v_add_u32 v240, 192, v9
  v_mul_u32_u24 v241, s44, v240
  v_lshrrev_b32 v241, 16, v241
  v_mul_u32_u24 v242, 10, v241
  v_sub_u32 v242, v240, v242
  v_lshlrev_b32 v242, 4, v242
  v_and_b32 v243, 1, v241
  v_bfe_u32 v244, v241, 1, 2
  v_lshl_or_b32 v243, v243, 2, v244
  v_and_b32 v244, 24, v241
  v_or_b32 v243, v243, v244
  v_mad_u32_u24 v203, v243, s45, v242
  v_subrev_u32 v203, 3072, v203
  v_add_u32 v240, 256, v9
  v_mul_u32_u24 v241, s44, v240
  v_lshrrev_b32 v241, 16, v241
  v_mul_u32_u24 v242, 10, v241
  v_sub_u32 v242, v240, v242
  v_lshlrev_b32 v242, 4, v242
  v_and_b32 v243, 1, v241
  v_bfe_u32 v244, v241, 1, 2
  v_lshl_or_b32 v243, v243, 2, v244
  v_and_b32 v244, 24, v241
  v_or_b32 v243, v243, v244
  v_mad_u32_u24 v204, v243, s45, v242
  s_mul_i32 s69, s43, 36864
  s_lshl_b32 s44, s68, 5
  s_add_u32 s69, s69, s44
  s_mul_i32 s70, s43, 5120
  s_add_u32 s72, s70, 81920
  s_cmp_lt_u32 s43, 2
  s_cselect_b32 s72, s72, 196608
  v_lshrrev_b32 v240, 3, v9
  v_and_b32 v241, 7, v9
  v_lshrrev_b32 v242, 4, v9
  v_xor_b32 v241, v241, v242
  v_lshlrev_b32 v241, 4, v241
  s_movk_i32 s44, 1152
  v_mad_u32_u24 v210, v240, s44, v241
  v_xor_b32 v241, 64, v210
  v_add_u32 v211, 8192, v241
  v_add_u32 v212, 16384, v210
  v_add_u32 v213, 24576, v241
  s_mul_i32 s71, s54, 36864
  s_lshl_b32 s73, s43, 12
  s_add_u32 s73, s73, 98304
  s_add_u32 s44, s6, s7
  s_and_b32 s44, s44, 1
  s_add_u32 s75, s71, 1152
  s_mul_i32 s45, s44, 294912
  s_add_u32 s69, s69, s45
  s_lshl_b32 s44, s44, 9
  s_add_u32 s71, s71, s44
  v_lshlrev_b32 v245, 1, v0
  v_add_u32 v245, s44, v245
  v_add_u32 v252, 512, v245
  v_subrev_u32 v240, 1152, v252
  v_min_u32 v252, v252, v240
  v_add_u32 v253, 1024, v245
  v_subrev_u32 v240, 1152, v253
  v_min_u32 v253, v253, v240
  v_bfe_u32 v240, v9, 2, 2
  v_lshrrev_b32 v241, 5, v9
  v_lshlrev_b32 v241, 3, v241
  v_lshl_add_u32 v240, v240, 1, v241
  v_mul_u32_u24 v242, 160, v240
  v_bfe_u32 v243, v9, 4, 1
  v_lshl_add_u32 v242, v243, 5, v242
  v_and_b32 v244, 3, v9
  v_lshl_add_u32 v205, v244, 3, v242
  v_add_u32 v206, 61440, v205
  v_cmp_eq_u32 vcc, 1, v243
  v_lshlrev_b32 v240, 3, v240
  v_add_u32 v240, 92160, v240
  v_add_u32 v241, 128, v205
  v_cndmask_b32 v207, v241, v240, vcc
  v_mov_b32 v240, 160
  v_cndmask_b32 v240, v240, 8, vcc
  v_mad_u32_u24 v208, v240, 1, v207
  v_lshlrev_b32 v209, 4, v240
  s_min_u32 s44, s43, 2
  s_lshl_b32 s44, s44, 6
  v_add_u32 v224, s44, v205
  v_add_u32 v225, s44, v206
  v_and_b32 v240, 31, v9
  v_lshrrev_b32 v217, 5, v9
  v_bfe_u32 v242, v9, 1, 3
  v_xor_b32 v242, v242, v217
  v_lshlrev_b32 v242, 4, v242
  v_lshl_add_u32 v242, v240, 7, v242
  v_add_u32 v220, s73, v242
  v_xor_b32 v221, 32, v220
  v_xor_b32 v222, 64, v220
  v_xor_b32 v223, 96, v220
  v_mov_b32 v64, 1065369472
  v_mov_b32 v65, 1065369472
  v_mov_b32 v66, 1065369472
  v_mov_b32 v67, 1065369472
  s_mov_b32 s58, 663552
  s_mov_b32 s59, 131072
  s_mov_b32 s66, 2359296
  s_mov_b32 s67, 131072
  s_mov_b32 s62, 1152
  s_mov_b32 s63, 131072
  s_waitcnt lgkmcnt(0)
  s_mov_b32 s56, s32
  s_mov_b32 s57, s33
  s_mov_b32 s64, s36
  s_mov_b32 s65, s37
  s_mov_b32 s60, s24
  s_mov_b32 s61, s25
  buffer_load_ushort v246, v245, s[60:63], 0 offen
  buffer_load_ushort v248, v252, s[60:63], 0 offen
  buffer_load_ushort v250, v253, s[60:63], 0 offen
  s_add_u32 m0, s70, 0
  s_nop 0
  buffer_load_dwordx4 v200, s[56:59], s69 offen offset:0 lds
  buffer_load_dwordx4 v201, s[56:59], s69 offen offset:1024 lds
  buffer_load_dwordx4 v202, s[56:59], s69 offen offset:2048 lds
  buffer_load_dwordx4 v203, s[56:59], s69 offen offset:3072 lds
  s_add_u32 m0, s70, 4096
  s_nop 0
  buffer_load_dwordx4 v204, s[56:59], s69 offen offset:0 lds
  s_add_u32 s69, s69, 147456
  s_sub_u32 s53, s69, 663552
  s_cselect_b32 s69, s69, s53
  s_add_u32 m0, s73, 0
  s_nop 0
  buffer_load_dwordx4 v210, s[64:67], s71 offen offset:0 lds
  buffer_load_dwordx4 v211, s[64:67], s71 offen offset:1024 lds
  buffer_load_dwordx4 v212, s[64:67], s71 offen offset:2048 lds
  buffer_load_dwordx4 v213, s[64:67], s71 offen offset:3072 lds
  s_add_u32 s71, s71, 128
  s_sub_u32 s53, s71, 1152
  s_cmp_eq_u32 s71, s75
  s_cselect_b32 s71, s53, s71
  s_add_u32 m0, s73, 16384
  s_nop 0
  buffer_load_dwordx4 v210, s[64:67], s71 offen offset:0 lds
  buffer_load_dwordx4 v211, s[64:67], s71 offen offset:1024 lds
  buffer_load_dwordx4 v212, s[64:67], s71 offen offset:2048 lds
  buffer_load_dwordx4 v213, s[64:67], s71 offen offset:3072 lds
  s_add_u32 s71, s71, 128
  s_sub_u32 s53, s71, 1152
  s_cmp_eq_u32 s71, s75
  s_cselect_b32 s71, s53, s71
  s_mov_b32 s20, s28
  s_mov_b32 s21, s29
  s_mov_b32 s22, 256
  s_mov_b32 s23, 131072
  s_mov_b32 s16, s30
  s_mov_b32 s17, s31
  s_mov_b32 s18, 48234496
  s_mov_b32 s19, 131072
  s_mov_b32 s60, s34
  s_mov_b32 s61, s35
  s_mov_b32 s62, 663552
  v_mov_b32 v227, 0
  s_or_b32 s44, s2, s43
  s_cmp_lg_u32 s44, 0
  s_cbranch_scc1 L_b1_nn
  s_memrealtime s[44:45]
  s_waitcnt lgkmcnt(0)
  s_or_b32 s44, s44, 1
  v_mov_b32 v226, s44
  buffer_store_dword v226, v227, s[20:23], 0 offen sc1
  s_waitcnt vmcnt(0)
L_b1_nn:
  s_lshr_b32 s44, s2, 4
  s_mul_i32 s44, s44, 324
  v_add_u32 v240, s44, v0
  v_lshlrev_b32 v164, 7, v240
  v_add_u32 v240, 32768, v164
  v_mov_b32 v241, 2146435072
  v_cmp_gt_u32 vcc, 68, v0
  s_nop 1
  v_cndmask_b32 v165, v241, v240, vcc
  v_and_b32 v240, 248, v0
  v_and_b32 v241, 3, v0
  v_lshl_or_b32 v240, v241, 1, v240
  v_bfe_u32 v241, v0, 2, 1
  v_or_b32 v240, v240, v241
  v_lshlrev_b32 v240, 3, v240
  v_add_u32 v240, 92160, v240
  v_mov_b32 v241, 16256
  s_waitcnt vmcnt(15)
  v_lshl_or_b32 v246, v246, 16, v241
  v_mov_b32 v247, 0
  s_waitcnt vmcnt(14)
  v_lshl_or_b32 v248, v248, 16, v241
  v_mov_b32 v249, 0
  s_waitcnt vmcnt(13)
  v_lshl_or_b32 v250, v250, 16, v241
  v_mov_b32 v251, 0
  ds_write_b64 v240, v[246:247]
  ds_write_b64 v240, v[248:249] offset:2048
  s_cmp_lg_u32 s43, 0
  s_cbranch_scc1 L_b1_ax
  ds_write_b64 v240, v[250:251] offset:4096
L_b1_ax:
  s_waitcnt lgkmcnt(0)
  s_waitcnt vmcnt(4)
  s_barrier
  ds_read_b128 v[48:51], v220 offset:0
  ds_read_b64_tr_b16 v[16:17], v205 offset:0
  ds_read_b64_tr_b16 v[18:19], v205 offset:160
  ds_read_b64_tr_b16 v[20:21], v205 offset:64
  ds_read_b64_tr_b16 v[22:23], v205 offset:224
  ds_read_b64_tr_b16 v[24:25], v207
  ds_read_b64_tr_b16 v[26:27], v208
  v_add_u32 v207, v207, v209
  v_add_u32 v208, v208, v209
  ds_read_b64_tr_b16 v[28:29], v224 offset:0
  ds_read_b64_tr_b16 v[30:31], v224 offset:160
  ds_read_b128 v[52:55], v221 offset:0
  ds_read_b64_tr_b16 v[32:33], v205 offset:2560
  ds_read_b64_tr_b16 v[34:35], v205 offset:2720
  s_waitcnt lgkmcnt(7)
  v_mfma_f32_32x32x16_bf16 v[96:111], v[16:19], v[48:51], 0
  s_add_u32 m0, s70, 20480
  ds_read_b64_tr_b16 v[36:37], v205 offset:2624
  ds_read_b64_tr_b16 v[38:39], v205 offset:2784
  buffer_load_dwordx4 v200, s[56:59], s69 offen offset:0 lds
  v_bfe_u32 v6, v9, 2, 2
  v_lshrrev_b32 v7, 5, v9
  v_mfma_f32_32x32x16_bf16 v[112:127], v[20:23], v[48:51], 0
  s_waitcnt lgkmcnt(7)
  v_lshl_add_u32 v6, v6, 1, v7
  v_mul_u32_u24 v8, 160, v6
  v_bfe_u32 v10, v9, 4, 1
  v_lshl_add_u32 v8, v10, 5, v8
  v_and_b32 v14, 3, v9
  v_lshl_add_u32 v160, v14, 3, v8
  v_mfma_f32_32x32x16_bf16 v[80:95], v[48:51], v[48:51], 0
  ds_read_b64_tr_b16 v[40:41], v207
  ds_read_b64_tr_b16 v[42:43], v208
  v_add_u32 v207, v207, v209
  v_add_u32 v208, v208, v209
  v_add_u32 v161, 61440, v160
  v_mfma_f32_32x32x16_bf16 v[128:143], v[24:27], v[48:51], 0
  s_waitcnt lgkmcnt(4)
  ds_read_b64_tr_b16 v[44:45], v224 offset:2560
  ds_read_b64_tr_b16 v[46:47], v224 offset:2720
  buffer_load_dwordx4 v201, s[56:59], s69 offen offset:1024 lds
  v_cmp_eq_u32 vcc, 1, v10
  v_lshlrev_b32 v6, 3, v6
  v_mfma_f32_32x32x16_bf16 v[144:159], v[28:31], v[64:67], 0
  ds_read_b128 v[56:59], v222 offset:0
  ds_read_b64_tr_b16 v[16:17], v205 offset:5120
  ds_read_b64_tr_b16 v[18:19], v205 offset:5280
  v_add_u32 v6, 92160, v6
  v_add_u32 v7, 128, v160
  v_mfma_f32_32x32x16_bf16 v[96:111], v[32:35], v[52:55], v[96:111]
  s_waitcnt lgkmcnt(7)
  ds_read_b64_tr_b16 v[20:21], v205 offset:5184
  ds_read_b64_tr_b16 v[22:23], v205 offset:5344
  v_cndmask_b32 v162, v7, v6, vcc
  v_mov_b32 v6, 160
  v_cndmask_b32 v6, v6, 8, vcc
  v_mfma_f32_32x32x16_bf16 v[112:127], v[36:39], v[52:55], v[112:127]
  buffer_load_dwordx4 v202, s[56:59], s69 offen offset:2048 lds
  v_mad_u32_u24 v163, v6, 8, v162
  v_lshlrev_b32 v219, 4, v6
  v_and_b32 v14, 31, v9
  s_lshl_b32 s46, s54, 5
  v_add_u32 v10, s46, v14
  v_mfma_f32_32x32x16_bf16 v[80:95], v[52:55], v[52:55], v[80:95]
  s_waitcnt lgkmcnt(5)
  ds_read_b64_tr_b16 v[24:25], v207
  ds_read_b64_tr_b16 v[26:27], v208
  v_add_u32 v207, v207, v209
  v_add_u32 v208, v208, v209
  v_lshlrev_b32 v215, 2, v10
  v_mfma_f32_32x32x16_bf16 v[128:143], v[40:43], v[52:55], v[128:143]
  s_mov_b32 s47, 36864
  ds_read_b64_tr_b16 v[28:29], v224 offset:5120
  ds_read_b64_tr_b16 v[30:31], v224 offset:5280
  v_subrev_u32 v6, 1, v10
  v_lshrrev_b32 v7, 5, v6
  v_min_u32 v7, 64, v7
  v_mfma_f32_32x32x16_bf16 v[144:159], v[44:47], v[64:67], v[144:159]
  s_waitcnt lgkmcnt(4)
  ds_read_b128 v[60:63], v223 offset:0
  ds_read_b64_tr_b16 v[32:33], v205 offset:7680
  ds_read_b64_tr_b16 v[34:35], v205 offset:7840
  buffer_load_dwordx4 v203, s[56:59], s69 offen offset:3072 lds
  v_and_b32 v8, 31, v6
  v_mfma_f32_32x32x16_bf16 v[96:111], v[16:19], v[56:59], v[96:111]
  ds_read_b64_tr_b16 v[36:37], v205 offset:7744
  ds_read_b64_tr_b16 v[38:39], v205 offset:7904
  v_lshl_add_u32 v8, v217, 5, v8
  v_lshlrev_b32 v8, 4, v8
  v_mad_u32_u24 v232, v7, s47, v8
  v_mfma_f32_32x32x16_bf16 v[112:127], v[20:23], v[56:59], v[112:127]
  s_waitcnt lgkmcnt(7)
  v_add_u32 v6, 1, v10
  v_lshrrev_b32 v7, 5, v6
  v_min_u32 v7, 64, v7
  v_and_b32 v8, 31, v6
  v_lshl_add_u32 v8, v217, 5, v8
  v_lshlrev_b32 v8, 4, v8
  v_mfma_f32_32x32x16_bf16 v[80:95], v[56:59], v[56:59], v[80:95]
  s_add_u32 m0, s70, 24576
  ds_read_b64_tr_b16 v[40:41], v207
  ds_read_b64_tr_b16 v[42:43], v208
  buffer_load_dwordx4 v204, s[56:59], s69 offen offset:0 lds
  s_add_u32 s69, s69, 147456
  s_sub_u32 s53, s69, 663552
  s_cselect_b32 s69, s69, s53
  v_add_u32 v207, v207, v209
  v_add_u32 v208, v208, v209
  v_mfma_f32_32x32x16_bf16 v[128:143], v[24:27], v[56:59], v[128:143]
  s_waitcnt lgkmcnt(4)
  ds_read_b64_tr_b16 v[44:45], v224 offset:7680
  ds_read_b64_tr_b16 v[46:47], v224 offset:7840
  v_mad_u32_u24 v234, v7, s47, v8
  v_subrev_u32 v6, 2, v10
  v_lshrrev_b32 v7, 5, v6
  v_mfma_f32_32x32x16_bf16 v[144:159], v[28:31], v[64:67], v[144:159]
  s_add_u32 m0, s73, 32768
  s_waitcnt vmcnt(5)
  ds_read_b128 v[48:51], v220 offset:16384
  ds_read_b64_tr_b16 v[16:17], v205 offset:10240
  ds_read_b64_tr_b16 v[18:19], v205 offset:10400
  v_min_u32 v7, 64, v7
  v_mfma_f32_32x32x16_bf16 v[96:111], v[32:35], v[60:63], v[96:111]
  s_waitcnt lgkmcnt(7)
  ds_read_b64_tr_b16 v[20:21], v205 offset:10304
  ds_read_b64_tr_b16 v[22:23], v205 offset:10464
  buffer_load_dwordx4 v210, s[64:67], s71 offen offset:0 lds
  v_and_b32 v8, 31, v6
  v_lshl_add_u32 v8, v217, 5, v8
  v_mfma_f32_32x32x16_bf16 v[112:127], v[36:39], v[60:63], v[112:127]
  v_lshlrev_b32 v8, 4, v8
  v_mad_u32_u24 v235, v7, s47, v8
  v_add_u32 v6, 2, v10
  v_lshrrev_b32 v7, 5, v6
  v_min_u32 v7, 64, v7
  v_and_b32 v8, 31, v6
  v_mfma_f32_32x32x16_bf16 v[80:95], v[60:63], v[60:63], v[80:95]
  s_waitcnt lgkmcnt(5)
  ds_read_b64_tr_b16 v[24:25], v207
  ds_read_b64_tr_b16 v[26:27], v208
  v_add_u32 v207, v207, v209
  v_add_u32 v208, v208, v209
  v_lshl_add_u32 v8, v217, 5, v8
  v_mfma_f32_32x32x16_bf16 v[128:143], v[40:43], v[60:63], v[128:143]
  ds_read_b64_tr_b16 v[28:29], v224 offset:10240
  ds_read_b64_tr_b16 v[30:31], v224 offset:10400
  buffer_load_dwordx4 v211, s[64:67], s71 offen offset:1024 lds
  v_lshlrev_b32 v8, 4, v8
  v_mad_u32_u24 v230, v7, s47, v8
  v_mfma_f32_32x32x16_bf16 v[144:159], v[44:47], v[64:67], v[144:159]
  s_waitcnt lgkmcnt(4)
  ds_read_b128 v[52:55], v221 offset:16384
  ds_read_b64_tr_b16 v[32:33], v205 offset:12800
  ds_read_b64_tr_b16 v[34:35], v205 offset:12960
  v_and_b32 v6, 24, v14
  v_and_b32 v7, 3, v14
  v_mfma_f32_32x32x16_bf16 v[96:111], v[16:19], v[48:51], v[96:111]
  ds_read_b64_tr_b16 v[36:37], v205 offset:12864
  ds_read_b64_tr_b16 v[38:39], v205 offset:13024
  v_lshl_or_b32 v6, v7, 1, v6
  v_bfe_u32 v7, v14, 2, 1
  v_or_b32 v6, v6, v7
  v_mfma_f32_32x32x16_bf16 v[112:127], v[20:23], v[48:51], v[112:127]
  s_waitcnt lgkmcnt(7)
  buffer_load_dwordx4 v212, s[64:67], s71 offen offset:2048 lds
  v_mul_u32_u24 v6, 160, v6
  v_lshl_add_u32 v214, v217, 3, v6
  s_add_u32 s46, s70, 98304
  v_add_u32 v214, s46, v214
  v_bfe_u32 v6, v9, 3, 2
  v_mfma_f32_32x32x16_bf16 v[80:95], v[48:51], v[48:51], v[80:95]
  ds_read_b64_tr_b16 v[40:41], v207
  ds_read_b64_tr_b16 v[42:43], v208
  v_add_u32 v207, v207, v209
  v_add_u32 v208, v208, v209
  v_min_u32 v6, 2, v6
  v_mfma_f32_32x32x16_bf16 v[128:143], v[24:27], v[48:51], v[128:143]
  s_waitcnt lgkmcnt(4)
  ds_read_b64_tr_b16 v[44:45], v224 offset:12800
  ds_read_b64_tr_b16 v[46:47], v224 offset:12960
  v_add_u32 v6, s6, v6
  v_max_u32 v6, 1, v6
  v_min_u32 v6, 16, v6
  v_mfma_f32_32x32x16_bf16 v[144:159], v[28:31], v[64:67], v[144:159]
  ds_read_b128 v[56:59], v222 offset:16384
  ds_read_b64_tr_b16 v[16:17], v205 offset:15360
  ds_read_b64_tr_b16 v[18:19], v205 offset:15520
  buffer_load_dwordx4 v213, s[64:67], s71 offen offset:3072 lds
  s_add_u32 s71, s71, 128
  s_sub_u32 s53, s71, 1152
  s_cmp_eq_u32 s71, s75
  s_cselect_b32 s71, s53, s71
  v_mfma_f32_32x32x16_bf16 v[96:111], v[32:35], v[52:55], v[96:111]
  s_waitcnt lgkmcnt(7)
  ds_read_b64_tr_b16 v[20:21], v205 offset:15424
  ds_read_b64_tr_b16 v[22:23], v205 offset:15584
  v_subrev_u32 v6, 1, v6
  v_and_b32 v7, 7, v9
  v_lshl_add_u32 v6, v6, 3, v7
  v_mfma_f32_32x32x16_bf16 v[112:127], v[36:39], v[52:55], v[112:127]
  s_add_u32 m0, s73, 49152
  v_lshlrev_b32 v229, 7, v6
  v_lshlrev_b32 v6, 3, v9
  s_mul_i32 s46, s43, 1152
  v_add_u32 v6, s46, v6
  v_add_u32 v254, 92160, v6
  v_add_u32 v228, 14180352, v6
  v_mfma_f32_32x32x16_bf16 v[80:95], v[52:55], v[52:55], v[80:95]
  s_waitcnt lgkmcnt(5)
  ds_read_b64_tr_b16 v[24:25], v207
  ds_read_b64_tr_b16 v[26:27], v208
  buffer_load_dwordx4 v210, s[64:67], s71 offen offset:0 lds
  v_add_u32 v207, v207, v209
  v_add_u32 v208, v208, v209
  v_mfma_f32_32x32x16_bf16 v[128:143], v[40:43], v[52:55], v[128:143]
  ds_read_b64_tr_b16 v[28:29], v224 offset:15360
  ds_read_b64_tr_b16 v[30:31], v224 offset:15520
  v_lshrrev_b32 v11, 3, v9
  v_and_b32 v12, 7, v9
  v_bfe_u32 v13, v9, 4, 1
  v_mfma_f32_32x32x16_bf16 v[144:159], v[44:47], v[64:67], v[144:159]
  s_waitcnt lgkmcnt(4)
  ds_read_b128 v[60:63], v223 offset:16384
  ds_read_b64_tr_b16 v[32:33], v205 offset:17920
  ds_read_b64_tr_b16 v[34:35], v205 offset:18080
  v_lshlrev_b32 v13, 2, v13
  v_xor_b32 v12, v12, v13
  v_mfma_f32_32x32x16_bf16 v[96:111], v[16:19], v[56:59], v[96:111]
  ds_read_b64_tr_b16 v[36:37], v205 offset:17984
  ds_read_b64_tr_b16 v[38:39], v205 offset:18144
  buffer_load_dwordx4 v211, s[64:67], s71 offen offset:1024 lds
  v_lshlrev_b32 v12, 4, v12
  s_mul_i32 s45, s43, 72
  v_mfma_f32_32x32x16_bf16 v[112:127], v[20:23], v[56:59], v[112:127]
  s_waitcnt lgkmcnt(7)
  v_add_u32 v11, s45, v11
  s_movk_i32 s44, 1152
  v_mad_u32_u24 v4, v11, s44, v12
  s_movk_i32 s44, 9216
  v_mad_u32_u24 v3, v11, s44, v12
  s_mul_i32 s44, s7, 1152
  v_mfma_f32_32x32x16_bf16 v[80:95], v[56:59], v[56:59], v[80:95]
  ds_read_b64_tr_b16 v[40:41], v207
  ds_read_b64_tr_b16 v[42:43], v208
  v_add_u32 v207, v207, v209
  v_add_u32 v208, v208, v209
  v_add_u32 v3, s44, v3
  v_mfma_f32_32x32x16_bf16 v[128:143], v[24:27], v[56:59], v[128:143]
  s_waitcnt lgkmcnt(4)
  ds_read_b64_tr_b16 v[44:45], v224 offset:17920
  ds_read_b64_tr_b16 v[46:47], v224 offset:18080
  buffer_load_dwordx4 v212, s[64:67], s71 offen offset:2048 lds
  s_mul_i32 s44, s7, 663552
  v_add_u32 v4, s44, v4
  v_mfma_f32_32x32x16_bf16 v[144:159], v[28:31], v[64:67], v[144:159]
  s_waitcnt vmcnt(3)
  s_barrier
  ds_read_b128 v[48:51], v220 offset:32768
  ds_read_b64_tr_b16 v[16:17], v205 offset:20480
  ds_read_b64_tr_b16 v[18:19], v205 offset:20640
  v_mfma_f32_32x32x16_bf16 v[96:111], v[32:35], v[60:63], v[96:111]
  s_waitcnt lgkmcnt(7)
  ds_read_b64_tr_b16 v[20:21], v205 offset:20544
  ds_read_b64_tr_b16 v[22:23], v205 offset:20704
  v_lshrrev_b32 v11, 5, v9
  v_lshlrev_b32 v0, 9, v11
  v_bfe_u32 v11, v9, 2, 2
  v_mfma_f32_32x32x16_bf16 v[112:127], v[36:39], v[60:63], v[112:127]
  buffer_load_dwordx4 v213, s[64:67], s71 offen offset:3072 lds
  s_add_u32 s71, s71, 128
  s_sub_u32 s53, s71, 1152
  s_cmp_eq_u32 s71, s75
  s_cselect_b32 s71, s53, s71
  v_lshl_add_u32 v0, v11, 7, v0
  v_mfma_f32_32x32x16_bf16 v[80:95], v[60:63], v[60:63], v[80:95]
  s_waitcnt lgkmcnt(5)
  ds_read_b64_tr_b16 v[24:25], v207
  ds_read_b64_tr_b16 v[26:27], v208
  v_add_u32 v207, v207, v209
  v_add_u32 v208, v208, v209
  v_bfe_u32 v11, v9, 3, 1
  v_mfma_f32_32x32x16_bf16 v[128:143], v[40:43], v[60:63], v[128:143]
  s_add_u32 m0, s70, 40960
  ds_read_b64_tr_b16 v[28:29], v224 offset:20480
  ds_read_b64_tr_b16 v[30:31], v224 offset:20640
  v_lshl_add_u32 v0, v11, 6, v0
  v_bfe_u32 v11, v9, 4, 1
  v_lshl_add_u32 v0, v11, 5, v0
  v_mfma_f32_32x32x16_bf16 v[144:159], v[44:47], v[64:67], v[144:159]
  s_waitcnt lgkmcnt(4)
  ds_read_b128 v[52:55], v221 offset:32768
  ds_read_b64_tr_b16 v[32:33], v205 offset:23040
  ds_read_b64_tr_b16 v[34:35], v205 offset:23200
  buffer_load_dwordx4 v200, s[56:59], s69 offen offset:0 lds
  v_and_b32 v11, 3, v9
  v_mfma_f32_32x32x16_bf16 v[96:111], v[16:19], v[48:51], v[96:111]
  ds_read_b64_tr_b16 v[36:37], v205 offset:23104
  ds_read_b64_tr_b16 v[38:39], v205 offset:23264
  v_lshl_add_u32 v0, v11, 3, v0
  s_mul_i32 s42, s43, 9216
  s_mov_b32 s24, 0
  v_mfma_f32_32x32x16_bf16 v[112:127], v[20:23], v[48:51], v[112:127]
  s_waitcnt lgkmcnt(7)
  s_mov_b32 s33, 0
  s_mov_b32 s25, 72704
  s_mov_b32 s34, 8192
  s_mov_b32 s26, 145408
  s_mov_b32 s35, 16384
  s_mov_b32 s27, 218112
  v_mfma_f32_32x32x16_bf16 v[80:95], v[48:51], v[48:51], v[80:95]
  s_mov_b32 s36, 24576
  ds_read_b64_tr_b16 v[40:41], v207
  ds_read_b64_tr_b16 v[42:43], v208
  buffer_load_dwordx4 v201, s[56:59], s69 offen offset:1024 lds
  v_add_u32 v207, v207, v209
  v_add_u32 v208, v208, v209
  v_mfma_f32_32x32x16_bf16 v[128:143], v[24:27], v[48:51], v[128:143]
  s_waitcnt lgkmcnt(4)
  ds_read_b64_tr_b16 v[44:45], v224 offset:23040
  ds_read_b64_tr_b16 v[46:47], v224 offset:23200
  s_mov_b32 s28, 294912
  s_mov_b32 s37, 36864
  s_mov_b32 s29, 367616
  v_mfma_f32_32x32x16_bf16 v[144:159], v[28:31], v[64:67], v[144:159]
  s_mov_b32 s38, 45056
  ds_read_b128 v[56:59], v222 offset:32768
  ds_read_b64_tr_b16 v[16:17], v205 offset:25600
  ds_read_b64_tr_b16 v[18:19], v205 offset:25760
  s_mov_b32 s30, 440320
  s_mov_b32 s39, 53248
  v_mfma_f32_32x32x16_bf16 v[96:111], v[32:35], v[52:55], v[96:111]
  s_waitcnt lgkmcnt(7)
  ds_read_b64_tr_b16 v[20:21], v205 offset:25664
  ds_read_b64_tr_b16 v[22:23], v205 offset:25824
  buffer_load_dwordx4 v202, s[56:59], s69 offen offset:2048 lds
  s_mov_b32 s31, 513024
  s_mov_b32 s40, 61440
  v_mfma_f32_32x32x16_bf16 v[112:127], v[36:39], v[52:55], v[112:127]
  s_mov_b32 s32, 589824
  s_mov_b32 s41, 73728
  s_mov_b32 s8, s48
  s_mov_b32 s9, s49
  s_mov_b32 s10, 5308416
  s_mov_b32 s11, 131072
  s_mov_b32 s12, s50
  v_mfma_f32_32x32x16_bf16 v[80:95], v[52:55], v[52:55], v[80:95]
  s_waitcnt lgkmcnt(5)
  ds_read_b64_tr_b16 v[24:25], v207
  ds_read_b64_tr_b16 v[26:27], v208
  v_add_u32 v207, v207, v209
  v_add_u32 v208, v208, v209
  s_mov_b32 s13, s51
  v_mfma_f32_32x32x16_bf16 v[128:143], v[40:43], v[52:55], v[128:143]
  s_mov_b32 s14, 5308416
  ds_read_b64_tr_b16 v[28:29], v224 offset:25600
  ds_read_b64_tr_b16 v[30:31], v224 offset:25760
  buffer_load_dwordx4 v203, s[56:59], s69 offen offset:3072 lds
  s_mov_b32 s15, 131072
  v_mfma_f32_32x32x16_bf16 v[144:159], v[44:47], v[64:67], v[144:159]
  s_waitcnt lgkmcnt(4)
  ds_read_b128 v[60:63], v223 offset:32768
  ds_read_b64_tr_b16 v[32:33], v205 offset:28160
  ds_read_b64_tr_b16 v[34:35], v205 offset:28320
  v_mfma_f32_32x32x16_bf16 v[96:111], v[16:19], v[56:59], v[96:111]
  ds_read_b64_tr_b16 v[36:37], v205 offset:28224
  ds_read_b64_tr_b16 v[38:39], v205 offset:28384
  v_mfma_f32_32x32x16_bf16 v[112:127], v[20:23], v[56:59], v[112:127]
  s_waitcnt lgkmcnt(7)
  v_mfma_f32_32x32x16_bf16 v[80:95], v[56:59], v[56:59], v[80:95]
  s_add_u32 m0, s70, 45056
  ds_read_b64_tr_b16 v[40:41], v207
  ds_read_b64_tr_b16 v[42:43], v208
  buffer_load_dwordx4 v204, s[56:59], s69 offen offset:0 lds
  s_add_u32 s69, s69, 147456
  s_sub_u32 s53, s69, 663552
  s_cselect_b32 s69, s69, s53
  v_add_u32 v207, v207, v209
  v_add_u32 v208, v208, v209
  v_mfma_f32_32x32x16_bf16 v[128:143], v[24:27], v[56:59], v[128:143]
  s_waitcnt lgkmcnt(4)
  ds_read_b64_tr_b16 v[44:45], v224 offset:28160
  ds_read_b64_tr_b16 v[46:47], v224 offset:28320
  v_mfma_f32_32x32x16_bf16 v[144:159], v[28:31], v[64:67], v[144:159]
  s_add_u32 m0, s73, 0
  s_waitcnt vmcnt(5)
  ds_read_b128 v[48:51], v220 offset:49152
  ds_read_b64_tr_b16 v[16:17], v205 offset:30720
  ds_read_b64_tr_b16 v[18:19], v205 offset:30880
  v_mfma_f32_32x32x16_bf16 v[96:111], v[32:35], v[60:63], v[96:111]
  s_waitcnt lgkmcnt(7)
  ds_read_b64_tr_b16 v[20:21], v205 offset:30784
  ds_read_b64_tr_b16 v[22:23], v205 offset:30944
  buffer_load_dwordx4 v210, s[64:67], s71 offen offset:0 lds
  v_mfma_f32_32x32x16_bf16 v[112:127], v[36:39], v[60:63], v[112:127]
  v_mfma_f32_32x32x16_bf16 v[80:95], v[60:63], v[60:63], v[80:95]
  s_waitcnt lgkmcnt(5)
  ds_read_b64_tr_b16 v[24:25], v207
  ds_read_b64_tr_b16 v[26:27], v208
  v_add_u32 v207, v207, v209
  v_add_u32 v208, v208, v209
  v_mfma_f32_32x32x16_bf16 v[128:143], v[40:43], v[60:63], v[128:143]
  ds_read_b64_tr_b16 v[28:29], v224 offset:30720
  ds_read_b64_tr_b16 v[30:31], v224 offset:30880
  buffer_load_dwordx4 v211, s[64:67], s71 offen offset:1024 lds
  v_mfma_f32_32x32x16_bf16 v[144:159], v[44:47], v[64:67], v[144:159]
  s_waitcnt lgkmcnt(4)
  ds_read_b128 v[52:55], v221 offset:49152
  ds_read_b64_tr_b16 v[32:33], v205 offset:33280
  ds_read_b64_tr_b16 v[34:35], v205 offset:33440
  v_mfma_f32_32x32x16_bf16 v[96:111], v[16:19], v[48:51], v[96:111]
  ds_read_b64_tr_b16 v[36:37], v205 offset:33344
  ds_read_b64_tr_b16 v[38:39], v205 offset:33504
  v_mfma_f32_32x32x16_bf16 v[112:127], v[20:23], v[48:51], v[112:127]
  s_waitcnt lgkmcnt(7)
  buffer_load_dwordx4 v212, s[64:67], s71 offen offset:2048 lds
  v_mfma_f32_32x32x16_bf16 v[80:95], v[48:51], v[48:51], v[80:95]
  ds_read_b64_tr_b16 v[40:41], v207
  ds_read_b64_tr_b16 v[42:43], v208
  v_add_u32 v207, v207, v209
  v_add_u32 v208, v208, v209
  v_mfma_f32_32x32x16_bf16 v[128:143], v[24:27], v[48:51], v[128:143]
  s_waitcnt lgkmcnt(4)
  ds_read_b64_tr_b16 v[44:45], v224 offset:33280
  ds_read_b64_tr_b16 v[46:47], v224 offset:33440
  v_mfma_f32_32x32x16_bf16 v[144:159], v[28:31], v[64:67], v[144:159]
  ds_read_b128 v[56:59], v222 offset:49152
  ds_read_b64_tr_b16 v[16:17], v205 offset:35840
  ds_read_b64_tr_b16 v[18:19], v205 offset:36000
  buffer_load_dwordx4 v213, s[64:67], s71 offen offset:3072 lds
  s_add_u32 s71, s71, 128
  s_sub_u32 s53, s71, 1152
  s_cmp_eq_u32 s71, s75
  s_cselect_b32 s71, s53, s71
  v_mfma_f32_32x32x16_bf16 v[96:111], v[32:35], v[52:55], v[96:111]
  s_waitcnt lgkmcnt(7)
  ds_read_b64_tr_b16 v[20:21], v205 offset:35904
  ds_read_b64_tr_b16 v[22:23], v205 offset:36064
  v_mfma_f32_32x32x16_bf16 v[112:127], v[36:39], v[52:55], v[112:127]
  s_add_u32 m0, s73, 16384
  v_mfma_f32_32x32x16_bf16 v[80:95], v[52:55], v[52:55], v[80:95]
  s_waitcnt lgkmcnt(5)
  ds_read_b64_tr_b16 v[24:25], v207
  ds_read_b64_tr_b16 v[26:27], v208
  buffer_load_dwordx4 v210, s[64:67], s71 offen offset:0 lds
  v_add_u32 v207, v207, v209
  v_add_u32 v208, v208, v209
  v_mfma_f32_32x32x16_bf16 v[128:143], v[40:43], v[52:55], v[128:143]
  ds_read_b64_tr_b16 v[28:29], v224 offset:35840
  ds_read_b64_tr_b16 v[30:31], v224 offset:36000
  v_mfma_f32_32x32x16_bf16 v[144:159], v[44:47], v[64:67], v[144:159]
  s_waitcnt lgkmcnt(4)
  ds_read_b128 v[60:63], v223 offset:49152
  ds_read_b64_tr_b16 v[32:33], v205 offset:38400
  ds_read_b64_tr_b16 v[34:35], v205 offset:38560
  v_mfma_f32_32x32x16_bf16 v[96:111], v[16:19], v[56:59], v[96:111]
  ds_read_b64_tr_b16 v[36:37], v205 offset:38464
  ds_read_b64_tr_b16 v[38:39], v205 offset:38624
  buffer_load_dwordx4 v211, s[64:67], s71 offen offset:1024 lds
  v_mfma_f32_32x32x16_bf16 v[112:127], v[20:23], v[56:59], v[112:127]
  s_waitcnt lgkmcnt(7)
  v_mfma_f32_32x32x16_bf16 v[80:95], v[56:59], v[56:59], v[80:95]
  ds_read_b64_tr_b16 v[40:41], v207
  ds_read_b64_tr_b16 v[42:43], v208
  v_add_u32 v207, v207, v209
  v_add_u32 v208, v208, v209
  v_mfma_f32_32x32x16_bf16 v[128:143], v[24:27], v[56:59], v[128:143]
  s_waitcnt lgkmcnt(4)
  ds_read_b64_tr_b16 v[44:45], v224 offset:38400
  ds_read_b64_tr_b16 v[46:47], v224 offset:38560
  buffer_load_dwordx4 v212, s[64:67], s71 offen offset:2048 lds
  v_mfma_f32_32x32x16_bf16 v[144:159], v[28:31], v[64:67], v[144:159]
  s_waitcnt vmcnt(3)
  s_barrier
  ds_read_b128 v[48:51], v220 offset:0
  ds_read_b64_tr_b16 v[16:17], v205 offset:40960
  ds_read_b64_tr_b16 v[18:19], v205 offset:41120
  v_mfma_f32_32x32x16_bf16 v[96:111], v[32:35], v[60:63], v[96:111]
  s_waitcnt lgkmcnt(7)
  ds_read_b64_tr_b16 v[20:21], v205 offset:41024
  ds_read_b64_tr_b16 v[22:23], v205 offset:41184
  v_mfma_f32_32x32x16_bf16 v[112:127], v[36:39], v[60:63], v[112:127]
  buffer_load_dwordx4 v213, s[64:67], s71 offen offset:3072 lds
  s_add_u32 s71, s71, 128
  s_sub_u32 s53, s71, 1152
  s_cmp_eq_u32 s71, s75
  s_cselect_b32 s71, s53, s71
  v_mfma_f32_32x32x16_bf16 v[80:95], v[60:63], v[60:63], v[80:95]
  s_waitcnt lgkmcnt(5)
  ds_read_b64_tr_b16 v[24:25], v207
  ds_read_b64_tr_b16 v[26:27], v208
  v_add_u32 v207, v207, v209
  v_add_u32 v208, v208, v209
  v_mfma_f32_32x32x16_bf16 v[128:143], v[40:43], v[60:63], v[128:143]
  s_add_u32 m0, s70, 61440
  ds_read_b64_tr_b16 v[28:29], v224 offset:40960
  ds_read_b64_tr_b16 v[30:31], v224 offset:41120
  v_mfma_f32_32x32x16_bf16 v[144:159], v[44:47], v[64:67], v[144:159]
  s_waitcnt lgkmcnt(4)
  ds_read_b128 v[52:55], v221 offset:0
  ds_read_b64_tr_b16 v[32:33], v205 offset:43520
  ds_read_b64_tr_b16 v[34:35], v205 offset:43680
  buffer_load_dwordx4 v200, s[56:59], s69 offen offset:0 lds
  v_mfma_f32_32x32x16_bf16 v[96:111], v[16:19], v[48:51], v[96:111]
  ds_read_b64_tr_b16 v[36:37], v205 offset:43584
  ds_read_b64_tr_b16 v[38:39], v205 offset:43744
  v_mfma_f32_32x32x16_bf16 v[112:127], v[20:23], v[48:51], v[112:127]
  s_waitcnt lgkmcnt(7)
  v_mfma_f32_32x32x16_bf16 v[80:95], v[48:51], v[48:51], v[80:95]
  ds_read_b64_tr_b16 v[40:41], v207
  ds_read_b64_tr_b16 v[42:43], v208
  buffer_load_dwordx4 v201, s[56:59], s69 offen offset:1024 lds
  v_add_u32 v207, v207, v209
  v_add_u32 v208, v208, v209
  v_mfma_f32_32x32x16_bf16 v[128:143], v[24:27], v[48:51], v[128:143]
  s_waitcnt lgkmcnt(4)
  ds_read_b64_tr_b16 v[44:45], v224 offset:43520
  ds_read_b64_tr_b16 v[46:47], v224 offset:43680
  v_mfma_f32_32x32x16_bf16 v[144:159], v[28:31], v[64:67], v[144:159]
  ds_read_b128 v[56:59], v222 offset:0
  ds_read_b64_tr_b16 v[16:17], v205 offset:46080
  ds_read_b64_tr_b16 v[18:19], v205 offset:46240
  v_mfma_f32_32x32x16_bf16 v[96:111], v[32:35], v[52:55], v[96:111]
  s_waitcnt lgkmcnt(7)
  ds_read_b64_tr_b16 v[20:21], v205 offset:46144
  ds_read_b64_tr_b16 v[22:23], v205 offset:46304
  buffer_load_dwordx4 v202, s[56:59], s69 offen offset:2048 lds
  v_mfma_f32_32x32x16_bf16 v[112:127], v[36:39], v[52:55], v[112:127]
  v_mfma_f32_32x32x16_bf16 v[80:95], v[52:55], v[52:55], v[80:95]
  s_waitcnt lgkmcnt(5)
  ds_read_b64_tr_b16 v[24:25], v207
  ds_read_b64_tr_b16 v[26:27], v208
  v_add_u32 v207, v207, v209
  v_add_u32 v208, v208, v209
  v_mfma_f32_32x32x16_bf16 v[128:143], v[40:43], v[52:55], v[128:143]
  ds_read_b64_tr_b16 v[28:29], v224 offset:46080
  ds_read_b64_tr_b16 v[30:31], v224 offset:46240
  buffer_load_dwordx4 v203, s[56:59], s69 offen offset:3072 lds
  v_mfma_f32_32x32x16_bf16 v[144:159], v[44:47], v[64:67], v[144:159]
  s_waitcnt lgkmcnt(4)
  ds_read_b128 v[60:63], v223 offset:0
  ds_read_b64_tr_b16 v[32:33], v205 offset:48640
  ds_read_b64_tr_b16 v[34:35], v205 offset:48800
  v_mfma_f32_32x32x16_bf16 v[96:111], v[16:19], v[56:59], v[96:111]
  s_add_u32 m0, s70, 65536
  ds_read_b64_tr_b16 v[36:37], v205 offset:48704
  ds_read_b64_tr_b16 v[38:39], v205 offset:48864
  v_mfma_f32_32x32x16_bf16 v[112:127], v[20:23], v[56:59], v[112:127]
  s_waitcnt lgkmcnt(7)
  buffer_load_dwordx4 v204, s[56:59], s69 offen offset:0 lds
  s_add_u32 s69, s69, 147456
  s_sub_u32 s53, s69, 663552
  s_cselect_b32 s69, s69, s53
  s_cmp_lt_u32 s72, 163840
  s_cselect_b32 s69, s69, 2146435072
  v_mfma_f32_32x32x16_bf16 v[80:95], v[56:59], v[56:59], v[80:95]
  ds_read_b64_tr_b16 v[40:41], v207
  ds_read_b64_tr_b16 v[42:43], v208
  v_add_u32 v207, v207, v209
  v_add_u32 v208, v208, v209
  v_mfma_f32_32x32x16_bf16 v[128:143], v[24:27], v[56:59], v[128:143]
  s_waitcnt lgkmcnt(4)
  ds_read_b64_tr_b16 v[44:45], v224 offset:48640
  ds_read_b64_tr_b16 v[46:47], v224 offset:48800
  v_mfma_f32_32x32x16_bf16 v[144:159], v[28:31], v[64:67], v[144:159]
  s_add_u32 m0, s73, 32768
  s_waitcnt vmcnt(5)
  ds_read_b128 v[48:51], v220 offset:16384
  ds_read_b64_tr_b16 v[16:17], v205 offset:51200
  ds_read_b64_tr_b16 v[18:19], v205 offset:51360
  buffer_load_dwordx4 v210, s[64:67], s71 offen offset:0 lds
  v_mfma_f32_32x32x16_bf16 v[96:111], v[32:35], v[60:63], v[96:111]
  s_waitcnt lgkmcnt(7)
  ds_read_b64_tr_b16 v[20:21], v205 offset:51264
  ds_read_b64_tr_b16 v[22:23], v205 offset:51424
  v_mfma_f32_32x32x16_bf16 v[112:127], v[36:39], v[60:63], v[112:127]
  v_mfma_f32_32x32x16_bf16 v[80:95], v[60:63], v[60:63], v[80:95]
  s_waitcnt lgkmcnt(5)
  ds_read_b64_tr_b16 v[24:25], v207
  ds_read_b64_tr_b16 v[26:27], v208
  buffer_load_dwordx4 v211, s[64:67], s71 offen offset:1024 lds
  v_add_u32 v207, v207, v209
  v_add_u32 v208, v208, v209
  v_mfma_f32_32x32x16_bf16 v[128:143], v[40:43], v[60:63], v[128:143]
  ds_read_b64_tr_b16 v[28:29], v224 offset:51200
  ds_read_b64_tr_b16 v[30:31], v224 offset:51360
  v_mfma_f32_32x32x16_bf16 v[144:159], v[44:47], v[64:67], v[144:159]
  s_waitcnt lgkmcnt(4)
  ds_read_b128 v[52:55], v221 offset:16384
  ds_read_b64_tr_b16 v[32:33], v205 offset:53760
  ds_read_b64_tr_b16 v[34:35], v205 offset:53920
  v_mfma_f32_32x32x16_bf16 v[96:111], v[16:19], v[48:51], v[96:111]
  ds_read_b64_tr_b16 v[36:37], v205 offset:53824
  ds_read_b64_tr_b16 v[38:39], v205 offset:53984
  v_mfma_f32_32x32x16_bf16 v[112:127], v[20:23], v[48:51], v[112:127]
  s_waitcnt lgkmcnt(7)
  buffer_load_dwordx4 v212, s[64:67], s71 offen offset:2048 lds
  v_mfma_f32_32x32x16_bf16 v[80:95], v[48:51], v[48:51], v[80:95]
  ds_read_b64_tr_b16 v[40:41], v207
  ds_read_b64_tr_b16 v[42:43], v208
  v_add_u32 v207, v207, v209
  v_add_u32 v208, v208, v209
  v_mfma_f32_32x32x16_bf16 v[128:143], v[24:27], v[48:51], v[128:143]
  s_waitcnt lgkmcnt(4)
  ds_read_b64_tr_b16 v[44:45], v224 offset:53760
  ds_read_b64_tr_b16 v[46:47], v224 offset:53920
  v_mfma_f32_32x32x16_bf16 v[144:159], v[28:31], v[64:67], v[144:159]
  ds_read_b128 v[56:59], v222 offset:16384
  ds_read_b64_tr_b16 v[16:17], v205 offset:56320
  ds_read_b64_tr_b16 v[18:19], v205 offset:56480
  buffer_load_dwordx4 v213, s[64:67], s71 offen offset:3072 lds
  s_add_u32 s71, s71, 128
  s_sub_u32 s53, s71, 1152
  s_cmp_eq_u32 s71, s75
  s_cselect_b32 s71, s53, s71
  v_mfma_f32_32x32x16_bf16 v[96:111], v[32:35], v[52:55], v[96:111]
  s_waitcnt lgkmcnt(7)
  ds_read_b64_tr_b16 v[20:21], v205 offset:56384
  ds_read_b64_tr_b16 v[22:23], v205 offset:56544
  v_mfma_f32_32x32x16_bf16 v[112:127], v[36:39], v[52:55], v[112:127]
  s_add_u32 m0, s73, 49152
  v_mfma_f32_32x32x16_bf16 v[80:95], v[52:55], v[52:55], v[80:95]
  s_waitcnt lgkmcnt(5)
  ds_read_b64_tr_b16 v[24:25], v207
  ds_read_b64_tr_b16 v[26:27], v208
  buffer_load_dwordx4 v210, s[64:67], s71 offen offset:0 lds
  v_add_u32 v207, v207, v209
  v_add_u32 v208, v208, v209
  v_mfma_f32_32x32x16_bf16 v[128:143], v[40:43], v[52:55], v[128:143]
  ds_read_b64_tr_b16 v[28:29], v224 offset:56320
  ds_read_b64_tr_b16 v[30:31], v224 offset:56480
  v_mfma_f32_32x32x16_bf16 v[144:159], v[44:47], v[64:67], v[144:159]
  s_waitcnt lgkmcnt(4)
  ds_read_b128 v[60:63], v223 offset:16384
  ds_read_b64_tr_b16 v[32:33], v205 offset:58880
  ds_read_b64_tr_b16 v[34:35], v205 offset:59040
  v_mfma_f32_32x32x16_bf16 v[96:111], v[16:19], v[56:59], v[96:111]
  ds_read_b64_tr_b16 v[36:37], v205 offset:58944
  ds_read_b64_tr_b16 v[38:39], v205 offset:59104
  buffer_load_dwordx4 v211, s[64:67], s71 offen offset:1024 lds
  v_mfma_f32_32x32x16_bf16 v[112:127], v[20:23], v[56:59], v[112:127]
  s_waitcnt lgkmcnt(7)
  v_mfma_f32_32x32x16_bf16 v[80:95], v[56:59], v[56:59], v[80:95]
  ds_read_b64_tr_b16 v[40:41], v207
  ds_read_b64_tr_b16 v[42:43], v208
  v_add_u32 v207, v207, v209
  v_add_u32 v208, v208, v209
  v_mfma_f32_32x32x16_bf16 v[128:143], v[24:27], v[56:59], v[128:143]
  s_waitcnt lgkmcnt(4)
  ds_read_b64_tr_b16 v[44:45], v224 offset:58880
  ds_read_b64_tr_b16 v[46:47], v224 offset:59040
  buffer_load_dwordx4 v212, s[64:67], s71 offen offset:2048 lds
  v_mfma_f32_32x32x16_bf16 v[144:159], v[28:31], v[64:67], v[144:159]
  s_waitcnt vmcnt(3)
  s_barrier
  ds_read_b128 v[48:51], v220 offset:32768
  ds_read_b64_tr_b16 v[16:17], v206 offset:0
  ds_read_b64_tr_b16 v[18:19], v206 offset:160
  v_mfma_f32_32x32x16_bf16 v[96:111], v[32:35], v[60:63], v[96:111]
  s_waitcnt lgkmcnt(7)
  ds_read_b64_tr_b16 v[20:21], v206 offset:64
  ds_read_b64_tr_b16 v[22:23], v206 offset:224
  v_mfma_f32_32x32x16_bf16 v[112:127], v[36:39], v[60:63], v[112:127]
  buffer_load_dwordx4 v213, s[64:67], s71 offen offset:3072 lds
  s_add_u32 s71, s71, 128
  s_sub_u32 s53, s71, 1152
  s_cmp_eq_u32 s71, s75
  s_cselect_b32 s71, s53, s71
  v_mfma_f32_32x32x16_bf16 v[80:95], v[60:63], v[60:63], v[80:95]
  s_waitcnt lgkmcnt(5)
  ds_read_b64_tr_b16 v[24:25], v207
  ds_read_b64_tr_b16 v[26:27], v208
  v_add_u32 v207, v207, v209
  v_add_u32 v208, v208, v209
  v_mfma_f32_32x32x16_bf16 v[128:143], v[40:43], v[60:63], v[128:143]
  s_add_u32 m0, s72, 0
  ds_read_b64_tr_b16 v[28:29], v225 offset:0
  ds_read_b64_tr_b16 v[30:31], v225 offset:160
  v_mfma_f32_32x32x16_bf16 v[144:159], v[44:47], v[64:67], v[144:159]
  s_waitcnt lgkmcnt(4)
  ds_read_b128 v[52:55], v221 offset:32768
  ds_read_b64_tr_b16 v[32:33], v206 offset:2560
  ds_read_b64_tr_b16 v[34:35], v206 offset:2720
  buffer_load_dwordx4 v200, s[56:59], s69 offen offset:0 lds
  v_mfma_f32_32x32x16_bf16 v[96:111], v[16:19], v[48:51], v[96:111]
  ds_read_b64_tr_b16 v[36:37], v206 offset:2624
  ds_read_b64_tr_b16 v[38:39], v206 offset:2784
  v_mfma_f32_32x32x16_bf16 v[112:127], v[20:23], v[48:51], v[112:127]
  s_waitcnt lgkmcnt(7)
  v_mfma_f32_32x32x16_bf16 v[80:95], v[48:51], v[48:51], v[80:95]
  ds_read_b64_tr_b16 v[40:41], v207
  ds_read_b64_tr_b16 v[42:43], v208
  buffer_load_dwordx4 v201, s[56:59], s69 offen offset:1024 lds
  v_add_u32 v207, v207, v209
  v_add_u32 v208, v208, v209
  v_mfma_f32_32x32x16_bf16 v[128:143], v[24:27], v[48:51], v[128:143]
  s_waitcnt lgkmcnt(4)
  ds_read_b64_tr_b16 v[44:45], v225 offset:2560
  ds_read_b64_tr_b16 v[46:47], v225 offset:2720
  v_mfma_f32_32x32x16_bf16 v[144:159], v[28:31], v[64:67], v[144:159]
  ds_read_b128 v[56:59], v222 offset:32768
  ds_read_b64_tr_b16 v[16:17], v206 offset:5120
  ds_read_b64_tr_b16 v[18:19], v206 offset:5280
  v_mfma_f32_32x32x16_bf16 v[96:111], v[32:35], v[52:55], v[96:111]
  s_waitcnt lgkmcnt(7)
  ds_read_b64_tr_b16 v[20:21], v206 offset:5184
  ds_read_b64_tr_b16 v[22:23], v206 offset:5344
  buffer_load_dwordx4 v202, s[56:59], s69 offen offset:2048 lds
  v_mfma_f32_32x32x16_bf16 v[112:127], v[36:39], v[52:55], v[112:127]
  v_mfma_f32_32x32x16_bf16 v[80:95], v[52:55], v[52:55], v[80:95]
  s_waitcnt lgkmcnt(5)
  ds_read_b64_tr_b16 v[24:25], v207
  ds_read_b64_tr_b16 v[26:27], v208
  v_add_u32 v207, v207, v209
  v_add_u32 v208, v208, v209
  v_mfma_f32_32x32x16_bf16 v[128:143], v[40:43], v[52:55], v[128:143]
  ds_read_b64_tr_b16 v[28:29], v225 offset:5120
  ds_read_b64_tr_b16 v[30:31], v225 offset:5280
  buffer_load_dwordx4 v203, s[56:59], s69 offen offset:3072 lds
  v_mfma_f32_32x32x16_bf16 v[144:159], v[44:47], v[64:67], v[144:159]
  s_waitcnt lgkmcnt(4)
  ds_read_b128 v[60:63], v223 offset:32768
  ds_read_b64_tr_b16 v[32:33], v206 offset:7680
  ds_read_b64_tr_b16 v[34:35], v206 offset:7840
  v_mfma_f32_32x32x16_bf16 v[96:111], v[16:19], v[56:59], v[96:111]
  s_add_u32 m0, s72, 4096
  ds_read_b64_tr_b16 v[36:37], v206 offset:7744
  ds_read_b64_tr_b16 v[38:39], v206 offset:7904
  v_mfma_f32_32x32x16_bf16 v[112:127], v[20:23], v[56:59], v[112:127]
  s_waitcnt lgkmcnt(7)
  buffer_load_dwordx4 v204, s[56:59], s69 offen offset:0 lds
  v_mfma_f32_32x32x16_bf16 v[80:95], v[56:59], v[56:59], v[80:95]
  ds_read_b64_tr_b16 v[40:41], v207
  ds_read_b64_tr_b16 v[42:43], v208
  v_add_u32 v207, v207, v209
  v_add_u32 v208, v208, v209
  v_mfma_f32_32x32x16_bf16 v[128:143], v[24:27], v[56:59], v[128:143]
  s_waitcnt lgkmcnt(4)
  ds_read_b64_tr_b16 v[44:45], v225 offset:7680
  ds_read_b64_tr_b16 v[46:47], v225 offset:7840
  v_mfma_f32_32x32x16_bf16 v[144:159], v[28:31], v[64:67], v[144:159]
  s_add_u32 m0, s73, 0
  s_waitcnt vmcnt(5)
  ds_read_b128 v[48:51], v220 offset:49152
  ds_read_b64_tr_b16 v[16:17], v206 offset:10240
  ds_read_b64_tr_b16 v[18:19], v206 offset:10400
  buffer_load_dwordx4 v210, s[64:67], s71 offen offset:0 lds
  v_mfma_f32_32x32x16_bf16 v[96:111], v[32:35], v[60:63], v[96:111]
  s_waitcnt lgkmcnt(7)
  ds_read_b64_tr_b16 v[20:21], v206 offset:10304
  ds_read_b64_tr_b16 v[22:23], v206 offset:10464
  v_mfma_f32_32x32x16_bf16 v[112:127], v[36:39], v[60:63], v[112:127]
  v_mfma_f32_32x32x16_bf16 v[80:95], v[60:63], v[60:63], v[80:95]
  s_waitcnt lgkmcnt(5)
  ds_read_b64_tr_b16 v[24:25], v207
  ds_read_b64_tr_b16 v[26:27], v208
  buffer_load_dwordx4 v211, s[64:67], s71 offen offset:1024 lds
  v_add_u32 v207, v207, v209
  v_add_u32 v208, v208, v209
  v_mfma_f32_32x32x16_bf16 v[128:143], v[40:43], v[60:63], v[128:143]
  ds_read_b64_tr_b16 v[28:29], v225 offset:10240
  ds_read_b64_tr_b16 v[30:31], v225 offset:10400
  v_mfma_f32_32x32x16_bf16 v[144:159], v[44:47], v[64:67], v[144:159]
  s_waitcnt lgkmcnt(4)
  ds_read_b128 v[52:55], v221 offset:49152
  ds_read_b64_tr_b16 v[32:33], v206 offset:12800
  ds_read_b64_tr_b16 v[34:35], v206 offset:12960
  v_mfma_f32_32x32x16_bf16 v[96:111], v[16:19], v[48:51], v[96:111]
  ds_read_b64_tr_b16 v[36:37], v206 offset:12864
  ds_read_b64_tr_b16 v[38:39], v206 offset:13024
  buffer_load_dwordx4 v212, s[64:67], s71 offen offset:2048 lds
  v_mfma_f32_32x32x16_bf16 v[112:127], v[20:23], v[48:51], v[112:127]
  s_waitcnt lgkmcnt(7)
  v_mfma_f32_32x32x16_bf16 v[80:95], v[48:51], v[48:51], v[80:95]
  ds_read_b64_tr_b16 v[40:41], v207
  ds_read_b64_tr_b16 v[42:43], v208
  v_add_u32 v207, v207, v209
  v_add_u32 v208, v208, v209
  v_mfma_f32_32x32x16_bf16 v[128:143], v[24:27], v[48:51], v[128:143]
  s_waitcnt lgkmcnt(4)
  ds_read_b64_tr_b16 v[44:45], v225 offset:12800
  ds_read_b64_tr_b16 v[46:47], v225 offset:12960
  buffer_load_dwordx4 v213, s[64:67], s71 offen offset:3072 lds
  s_add_u32 s71, s71, 128
  s_sub_u32 s53, s71, 1152
  s_cmp_eq_u32 s71, s75
  s_cselect_b32 s71, s53, s71
  v_mfma_f32_32x32x16_bf16 v[144:159], v[28:31], v[64:67], v[144:159]
  ds_read_b128 v[56:59], v222 offset:49152
  ds_read_b64_tr_b16 v[16:17], v206 offset:15360
  ds_read_b64_tr_b16 v[18:19], v206 offset:15520
  v_mfma_f32_32x32x16_bf16 v[96:111], v[32:35], v[52:55], v[96:111]
  s_waitcnt lgkmcnt(7)
  ds_read_b64_tr_b16 v[20:21], v206 offset:15424
  ds_read_b64_tr_b16 v[22:23], v206 offset:15584
  v_mfma_f32_32x32x16_bf16 v[112:127], v[36:39], v[52:55], v[112:127]
  buffer_load_dword v226, v227, s[20:23], 0 offen sc1
  v_mfma_f32_32x32x16_bf16 v[80:95], v[52:55], v[52:55], v[80:95]
  s_waitcnt lgkmcnt(5)
  ds_read_b64_tr_b16 v[24:25], v207
  ds_read_b64_tr_b16 v[26:27], v208
  v_add_u32 v207, v207, v209
  v_add_u32 v208, v208, v209
  v_mfma_f32_32x32x16_bf16 v[128:143], v[40:43], v[52:55], v[128:143]
  ds_read_b64_tr_b16 v[28:29], v225 offset:15360
  ds_read_b64_tr_b16 v[30:31], v225 offset:15520
  v_mfma_f32_32x32x16_bf16 v[144:159], v[44:47], v[64:67], v[144:159]
  s_waitcnt lgkmcnt(4)
  ds_read_b128 v[60:63], v223 offset:49152
  ds_read_b64_tr_b16 v[32:33], v206 offset:17920
  ds_read_b64_tr_b16 v[34:35], v206 offset:18080
  v_mfma_f32_32x32x16_bf16 v[96:111], v[16:19], v[56:59], v[96:111]
  ds_read_b64_tr_b16 v[36:37], v206 offset:17984
  ds_read_b64_tr_b16 v[38:39], v206 offset:18144
  v_mfma_f32_32x32x16_bf16 v[112:127], v[20:23], v[56:59], v[112:127]
  s_waitcnt lgkmcnt(7)
  v_mfma_f32_32x32x16_bf16 v[80:95], v[56:59], v[56:59], v[80:95]
  ds_read_b64_tr_b16 v[40:41], v207
  ds_read_b64_tr_b16 v[42:43], v208
  v_add_u32 v207, v207, v209
  v_add_u32 v208, v208, v209
  v_mfma_f32_32x32x16_bf16 v[128:143], v[24:27], v[56:59], v[128:143]
  s_waitcnt lgkmcnt(4)
  ds_read_b64_tr_b16 v[44:45], v225 offset:17920
  ds_read_b64_tr_b16 v[46:47], v225 offset:18080
  v_mfma_f32_32x32x16_bf16 v[144:159], v[28:31], v[64:67], v[144:159]
  s_waitcnt vmcnt(1)
  s_barrier
  ds_read_b128 v[48:51], v220 offset:0
  ds_read_b64_tr_b16 v[16:17], v206 offset:20480
  ds_read_b64_tr_b16 v[18:19], v206 offset:20640
  v_mfma_f32_32x32x16_bf16 v[96:111], v[32:35], v[60:63], v[96:111]
  s_waitcnt lgkmcnt(7)
  ds_read_b64_tr_b16 v[20:21], v206 offset:20544
  ds_read_b64_tr_b16 v[22:23], v206 offset:20704
  v_mfma_f32_32x32x16_bf16 v[112:127], v[36:39], v[60:63], v[112:127]
  v_mfma_f32_32x32x16_bf16 v[80:95], v[60:63], v[60:63], v[80:95]
  s_waitcnt lgkmcnt(5)
  ds_read_b64_tr_b16 v[24:25], v207
  ds_read_b64_tr_b16 v[26:27], v208
  v_add_u32 v207, v207, v209
  v_add_u32 v208, v208, v209
  v_mfma_f32_32x32x16_bf16 v[128:143], v[40:43], v[60:63], v[128:143]
  ds_read_b64_tr_b16 v[28:29], v225 offset:20480
  ds_read_b64_tr_b16 v[30:31], v225 offset:20640
  v_mfma_f32_32x32x16_bf16 v[144:159], v[44:47], v[64:67], v[144:159]
  s_waitcnt lgkmcnt(4)
  ds_read_b128 v[52:55], v221 offset:0
  ds_read_b64_tr_b16 v[32:33], v206 offset:23040
  ds_read_b64_tr_b16 v[34:35], v206 offset:23200
  v_mfma_f32_32x32x16_bf16 v[96:111], v[16:19], v[48:51], v[96:111]
  ds_read_b64_tr_b16 v[36:37], v206 offset:23104
  ds_read_b64_tr_b16 v[38:39], v206 offset:23264
  v_mfma_f32_32x32x16_bf16 v[112:127], v[20:23], v[48:51], v[112:127]
  s_waitcnt lgkmcnt(7)
  v_mfma_f32_32x32x16_bf16 v[80:95], v[48:51], v[48:51], v[80:95]
  ds_read_b64_tr_b16 v[40:41], v207
  ds_read_b64_tr_b16 v[42:43], v208
  v_add_u32 v207, v207, v209
  v_add_u32 v208, v208, v209
  v_mfma_f32_32x32x16_bf16 v[128:143], v[24:27], v[48:51], v[128:143]
  s_waitcnt lgkmcnt(4)
  ds_read_b64_tr_b16 v[44:45], v225 offset:23040
  ds_read_b64_tr_b16 v[46:47], v225 offset:23200
  v_mfma_f32_32x32x16_bf16 v[144:159], v[28:31], v[64:67], v[144:159]
  ds_read_b128 v[56:59], v222 offset:0
  ds_read_b64_tr_b16 v[16:17], v206 offset:25600
  ds_read_b64_tr_b16 v[18:19], v206 offset:25760
  v_mfma_f32_32x32x16_bf16 v[96:111], v[32:35], v[52:55], v[96:111]
  s_waitcnt lgkmcnt(7)
  ds_read_b64_tr_b16 v[20:21], v206 offset:25664
  ds_read_b64_tr_b16 v[22:23], v206 offset:25824
  v_mfma_f32_32x32x16_bf16 v[112:127], v[36:39], v[52:55], v[112:127]
  v_mfma_f32_32x32x16_bf16 v[80:95], v[52:55], v[52:55], v[80:95]
  s_waitcnt lgkmcnt(5)
  ds_read_b64_tr_b16 v[24:25], v207
  ds_read_b64_tr_b16 v[26:27], v208
  v_add_u32 v207, v207, v209
  v_add_u32 v208, v208, v209
  v_mfma_f32_32x32x16_bf16 v[128:143], v[40:43], v[52:55], v[128:143]
  ds_read_b64_tr_b16 v[28:29], v225 offset:25600
  ds_read_b64_tr_b16 v[30:31], v225 offset:25760
  v_mfma_f32_32x32x16_bf16 v[144:159], v[44:47], v[64:67], v[144:159]
  s_waitcnt lgkmcnt(4)
  ds_read_b128 v[60:63], v223 offset:0
  ds_read_b64_tr_b16 v[32:33], v206 offset:28160
  ds_read_b64_tr_b16 v[34:35], v206 offset:28320
  v_mfma_f32_32x32x16_bf16 v[96:111], v[16:19], v[56:59], v[96:111]
  ds_read_b64_tr_b16 v[36:37], v206 offset:28224
  ds_read_b64_tr_b16 v[38:39], v206 offset:28384
  v_mfma_f32_32x32x16_bf16 v[112:127], v[20:23], v[56:59], v[112:127]
  s_waitcnt lgkmcnt(7)
  v_mfma_f32_32x32x16_bf16 v[80:95], v[56:59], v[56:59], v[80:95]
  ds_read_b64_tr_b16 v[40:41], v207
  ds_read_b64_tr_b16 v[42:43], v208
  v_add_u32 v207, v207, v209
  v_add_u32 v208, v208, v209
  v_mfma_f32_32x32x16_bf16 v[128:143], v[24:27], v[56:59], v[128:143]
  s_waitcnt lgkmcnt(4)
  ds_read_b64_tr_b16 v[44:45], v225 offset:28160
  ds_read_b64_tr_b16 v[46:47], v225 offset:28320
  v_mfma_f32_32x32x16_bf16 v[144:159], v[28:31], v[64:67], v[144:159]
  v_mfma_f32_32x32x16_bf16 v[96:111], v[32:35], v[60:63], v[96:111]
  s_waitcnt lgkmcnt(4)
  v_mfma_f32_32x32x16_bf16 v[112:127], v[36:39], v[60:63], v[112:127]
  v_mfma_f32_32x32x16_bf16 v[80:95], v[60:63], v[60:63], v[80:95]
  s_waitcnt lgkmcnt(0)
  v_mfma_f32_32x32x16_bf16 v[128:143], v[40:43], v[60:63], v[128:143]
  v_mfma_f32_32x32x16_bf16 v[144:159], v[44:47], v[64:67], v[144:159]
  s_min_u32 s44, s43, 2
  s_lshl_b32 s44, s44, 7
  s_add_u32 s44, s44, 96768
  v_lshlrev_b32 v240, 6, v217
  v_add_u32 v241, s44, v240
  v_add_u32 v240, 96768, v240
  s_nop 5
  ds_write_b128 v241, v[144:147] offset:0
  ds_write_b128 v241, v[148:151] offset:16
  ds_write_b128 v241, v[152:155] offset:32
  ds_write_b128 v241, v[156:159] offset:48
  s_waitcnt vmcnt(0)
  s_mov_b32 s44, 1048576
L_b1_non:
  v_readfirstlane_b32 s3, v226
  s_sub_u32 s44, s44, 1
  s_cmp_lg_u32 s3, 0
  s_cbranch_scc1 L_b1_non_d
  s_cmp_eq_u32 s44, 0
  s_cbranch_scc1 L_b1_non_d
  buffer_load_dword v226, v227, s[20:23], 0 offen sc1
  s_waitcnt vmcnt(0)
  s_branch L_b1_non
L_b1_non_d:
  v_bfe_u32 v76, v9, 4, 1
  v_cmp_eq_u32 vcc, 1, v76
  s_nop 1
  v_cndmask_b32 v80, v80, v88, vcc
  v_cndmask_b32 v81, v81, v89, vcc
  v_cndmask_b32 v82, v82, v90, vcc
  v_cndmask_b32 v83, v83, v91, vcc
  v_cndmask_b32 v84, v84, v92, vcc
  v_cndmask_b32 v85, v85, v93, vcc
  v_cndmask_b32 v86, v86, v94, vcc
  v_cndmask_b32 v87, v87, v95, vcc
  v_bfe_u32 v76, v9, 3, 1
  v_cmp_eq_u32 vcc, 1, v76
  s_nop 1
  v_cndmask_b32 v80, v80, v84, vcc
  v_cndmask_b32 v81, v81, v85, vcc
  v_cndmask_b32 v82, v82, v86, vcc
  v_cndmask_b32 v83, v83, v87, vcc
  v_bfe_u32 v76, v9, 1, 1
  v_cmp_eq_u32 vcc, 1, v76
  s_nop 1
  v_cndmask_b32 v80, v80, v82, vcc
  v_cndmask_b32 v81, v81, v83, vcc
  v_bfe_u32 v76, v9, 0, 1
  v_cmp_eq_u32 vcc, 1, v76
  s_nop 1
  v_cndmask_b32 v80, v80, v81, vcc
  v_bfe_u32 v76, v9, 2, 1
  v_cmp_eq_u32 vcc, v76, v217
  s_nop 1
  v_cndmask_b32 v68, 0, v80, vcc
  v_mov_b32 v69, v68
  s_nop 1
  v_permlane32_swap_b32 v68, v69
  v_add_f32 v68, v68, v69
  v_mul_f32 v216, 987991609, v136
  v_mul_f32 v218, 3216550459, v137
  v_exp_f32 v218, v218
  v_mul_f32 v76, v216, v216
  v_mov_b32 v77, 987991609
  v_fma_f32 v76, v68, v77, -v76
  v_add_f32 v218, 1.0, v218
  v_rcp_f32 v218, v218
  v_max_f32 v76, 0, v76
  v_add_f32 v76, 925353388, v76
  v_sqrt_f32 v74, v76
  v_rsq_f32 v77, v76
  s_nop 0
  v_mul_f32 v70, 3222493025, v77
  v_mul_f32 v77, v77, v77
  v_mul_f32 v77, 1027024659, v77
  v_mul_f32 v72, v70, v77
  s_waitcnt lgkmcnt(0)
  s_barrier
  ds_read_b128 v[164:167], v240 offset:0
  ds_read_b128 v[168:171], v240 offset:16
  ds_read_b128 v[172:175], v240 offset:32
  ds_read_b128 v[176:179], v240 offset:48
  ds_read_b128 v[180:183], v240 offset:128
  ds_read_b128 v[184:187], v240 offset:144
  ds_read_b128 v[188:191], v240 offset:160
  ds_read_b128 v[192:195], v240 offset:176
  ds_read_b128 v[196:199], v240 offset:256
  ds_read_b128 v[236:239], v240 offset:272
  s_mul_i32 s68, s7, 9
  s_lshr_b32 s68, s68, 1
  s_movk_i32 s44, 6554
  s_movk_i32 s45, 1152
  s_mul_i32 s69, s43, 36864
  s_lshl_b32 s44, s68, 5
  s_add_u32 s69, s69, s44
  s_mul_i32 s70, s43, 5120
  s_add_u32 s72, s70, 81920
  s_cmp_lt_u32 s43, 2
  s_cselect_b32 s72, s72, 196608
  s_mov_b32 s56, s60
  s_mov_b32 s57, s61
  s_mul_i32 s71, s54, 36864
  s_lshl_b32 s44, s68, 5
  s_add_u32 s71, s71, s44
  buffer_load_dwordx2 v[248:249], v228, s[16:19], 0 offen offset:0 sc1
  buffer_load_dwordx2 v[250:251], v228, s[16:19], 0 offen offset:512 sc1
  buffer_load_dwordx2 v[252:253], v228, s[16:19], 0 offen offset:640 sc1
  v_lshlrev_b32 v241, 4, v9
  s_mul_i32 s46, s54, 36864
  s_lshl_b32 s47, s68, 10
  s_add_u32 s46, s46, s47
  s_add_u32 s46, s46, 7077888
  s_add_u32 s47, s46, 4096
  s_bitcmp1_b32 s7, 0
  s_cselect_b32 s47, s47, 2146435072
  s_waitcnt lgkmcnt(9)
  v_pk_fma_f32 v[96:97], v[164:165], v[216:217], v[96:97] op_sel_hi:[1,0,1] neg_lo:[0,1,0] neg_hi:[0,1,0]
  v_pk_fma_f32 v[98:99], v[166:167], v[216:217], v[98:99] op_sel_hi:[1,0,1] neg_lo:[0,1,0] neg_hi:[0,1,0]
  v_pk_mul_f32 v[48:49], v[96:97], v[96:97]
  v_pk_mul_f32 v[50:51], v[98:99], v[98:99]
  v_pk_fma_f32 v[48:49], v[48:49], v[72:73], v[70:71] op_sel_hi:[1,0,0]
  v_pk_fma_f32 v[50:51], v[50:51], v[72:73], v[70:71] op_sel_hi:[1,0,0]
  v_pk_mul_f32 v[48:49], v[48:49], v[96:97]
  v_pk_mul_f32 v[50:51], v[50:51], v[98:99]
  v_exp_f32 v48, v48
  v_exp_f32 v49, v49
  v_exp_f32 v50, v50
  v_exp_f32 v51, v51
  v_pk_fma_f32 v[48:49], v[48:49], v[74:75], v[74:75] op_sel_hi:[1,0,0]
  v_pk_fma_f32 v[50:51], v[50:51], v[74:75], v[74:75] op_sel_hi:[1,0,0]
  v_rcp_f32 v48, v48
  v_rcp_f32 v49, v49
  v_rcp_f32 v50, v50
  v_rcp_f32 v51, v51
  v_pk_mul_f32 v[48:49], v[48:49], v[96:97]
  v_pk_mul_f32 v[50:51], v[50:51], v[98:99]
  v_cvt_pk_bf16_f32 v16, v48, v49
  v_cvt_pk_bf16_f32 v17, v50, v51
  s_add_u32 m0, s70, 0
  s_nop 0
  buffer_load_dwordx4 v200, s[56:59], s69 offen offset:0 lds
  buffer_load_dwordx4 v201, s[56:59], s69 offen offset:1024 lds
  s_waitcnt lgkmcnt(8)
  v_pk_fma_f32 v[100:101], v[168:169], v[216:217], v[100:101] op_sel_hi:[1,0,1] neg_lo:[0,1,0] neg_hi:[0,1,0]
  v_pk_fma_f32 v[102:103], v[170:171], v[216:217], v[102:103] op_sel_hi:[1,0,1] neg_lo:[0,1,0] neg_hi:[0,1,0]
  v_pk_mul_f32 v[52:53], v[100:101], v[100:101]
  v_pk_mul_f32 v[54:55], v[102:103], v[102:103]
  v_pk_fma_f32 v[52:53], v[52:53], v[72:73], v[70:71] op_sel_hi:[1,0,0]
  v_pk_fma_f32 v[54:55], v[54:55], v[72:73], v[70:71] op_sel_hi:[1,0,0]
  v_pk_mul_f32 v[52:53], v[52:53], v[100:101]
  v_pk_mul_f32 v[54:55], v[54:55], v[102:103]
  v_exp_f32 v52, v52
  v_exp_f32 v53, v53
  v_exp_f32 v54, v54
  v_exp_f32 v55, v55
  v_pk_fma_f32 v[52:53], v[52:53], v[74:75], v[74:75] op_sel_hi:[1,0,0]
  v_pk_fma_f32 v[54:55], v[54:55], v[74:75], v[74:75] op_sel_hi:[1,0,0]
  v_rcp_f32 v52, v52
  v_rcp_f32 v53, v53
  v_rcp_f32 v54, v54
  v_rcp_f32 v55, v55
  v_pk_mul_f32 v[52:53], v[52:53], v[100:101]
  v_pk_mul_f32 v[54:55], v[54:55], v[102:103]
  v_cvt_pk_bf16_f32 v18, v52, v53
  v_cvt_pk_bf16_f32 v19, v54, v55
  buffer_load_dwordx4 v202, s[56:59], s69 offen offset:2048 lds
  buffer_load_dwordx4 v203, s[56:59], s69 offen offset:3072 lds
  buffer_store_dwordx4 v[16:19], v241, s[16:19], s46 offen offset:0 sc1
  s_waitcnt lgkmcnt(7)
  v_pk_fma_f32 v[104:105], v[172:173], v[216:217], v[104:105] op_sel_hi:[1,0,1] neg_lo:[0,1,0] neg_hi:[0,1,0]
  v_pk_fma_f32 v[106:107], v[174:175], v[216:217], v[106:107] op_sel_hi:[1,0,1] neg_lo:[0,1,0] neg_hi:[0,1,0]
  v_pk_mul_f32 v[48:49], v[104:105], v[104:105]
  v_pk_mul_f32 v[50:51], v[106:107], v[106:107]
  v_pk_fma_f32 v[48:49], v[48:49], v[72:73], v[70:71] op_sel_hi:[1,0,0]
  v_pk_fma_f32 v[50:51], v[50:51], v[72:73], v[70:71] op_sel_hi:[1,0,0]
  v_pk_mul_f32 v[48:49], v[48:49], v[104:105]
  v_pk_mul_f32 v[50:51], v[50:51], v[106:107]
  v_exp_f32 v48, v48
  v_exp_f32 v49, v49
  v_exp_f32 v50, v50
  v_exp_f32 v51, v51
  v_pk_fma_f32 v[48:49], v[48:49], v[74:75], v[74:75] op_sel_hi:[1,0,0]
  v_pk_fma_f32 v[50:51], v[50:51], v[74:75], v[74:75] op_sel_hi:[1,0,0]
  v_rcp_f32 v48, v48
  v_rcp_f32 v49, v49
  v_rcp_f32 v50, v50
  v_rcp_f32 v51, v51
  v_pk_mul_f32 v[48:49], v[48:49], v[104:105]
  v_pk_mul_f32 v[50:51], v[50:51], v[106:107]
  v_cvt_pk_bf16_f32 v20, v48, v49
  v_cvt_pk_bf16_f32 v21, v50, v51
  s_add_u32 m0, s70, 4096
  s_nop 0
  buffer_load_dwordx4 v204, s[56:59], s69 offen offset:0 lds
  s_add_u32 s69, s69, 147456
  s_add_u32 m0, s70, 20480
  s_nop 0
  buffer_load_dwordx4 v200, s[56:59], s69 offen offset:0 lds
  s_waitcnt lgkmcnt(6)
  v_pk_fma_f32 v[108:109], v[176:177], v[216:217], v[108:109] op_sel_hi:[1,0,1] neg_lo:[0,1,0] neg_hi:[0,1,0]
  v_pk_fma_f32 v[110:111], v[178:179], v[216:217], v[110:111] op_sel_hi:[1,0,1] neg_lo:[0,1,0] neg_hi:[0,1,0]
  v_pk_mul_f32 v[52:53], v[108:109], v[108:109]
  v_pk_mul_f32 v[54:55], v[110:111], v[110:111]
  v_pk_fma_f32 v[52:53], v[52:53], v[72:73], v[70:71] op_sel_hi:[1,0,0]
  v_pk_fma_f32 v[54:55], v[54:55], v[72:73], v[70:71] op_sel_hi:[1,0,0]
  v_pk_mul_f32 v[52:53], v[52:53], v[108:109]
  v_pk_mul_f32 v[54:55], v[54:55], v[110:111]
  v_exp_f32 v52, v52
  v_exp_f32 v53, v53
  v_exp_f32 v54, v54
  v_exp_f32 v55, v55
  v_pk_fma_f32 v[52:53], v[52:53], v[74:75], v[74:75] op_sel_hi:[1,0,0]
  v_pk_fma_f32 v[54:55], v[54:55], v[74:75], v[74:75] op_sel_hi:[1,0,0]
  v_rcp_f32 v52, v52
  v_rcp_f32 v53, v53
  v_rcp_f32 v54, v54
  v_rcp_f32 v55, v55
  v_pk_mul_f32 v[52:53], v[52:53], v[108:109]
  v_pk_mul_f32 v[54:55], v[54:55], v[110:111]
  v_cvt_pk_bf16_f32 v22, v52, v53
  v_cvt_pk_bf16_f32 v23, v54, v55
  buffer_load_dwordx4 v201, s[56:59], s69 offen offset:1024 lds
  buffer_load_dwordx4 v202, s[56:59], s69 offen offset:2048 lds
  buffer_store_dwordx4 v[20:23], v241, s[16:19], s46 offen offset:1024 sc1
  s_waitcnt lgkmcnt(5)
  v_pk_fma_f32 v[112:113], v[180:181], v[216:217], v[112:113] op_sel_hi:[1,0,1] neg_lo:[0,1,0] neg_hi:[0,1,0]
  v_pk_fma_f32 v[114:115], v[182:183], v[216:217], v[114:115] op_sel_hi:[1,0,1] neg_lo:[0,1,0] neg_hi:[0,1,0]
  v_pk_mul_f32 v[48:49], v[112:113], v[112:113]
  v_pk_mul_f32 v[50:51], v[114:115], v[114:115]
  v_pk_fma_f32 v[48:49], v[48:49], v[72:73], v[70:71] op_sel_hi:[1,0,0]
  v_pk_fma_f32 v[50:51], v[50:51], v[72:73], v[70:71] op_sel_hi:[1,0,0]
  v_pk_mul_f32 v[48:49], v[48:49], v[112:113]
  v_pk_mul_f32 v[50:51], v[50:51], v[114:115]
  v_exp_f32 v48, v48
  v_exp_f32 v49, v49
  v_exp_f32 v50, v50
  v_exp_f32 v51, v51
  v_pk_fma_f32 v[48:49], v[48:49], v[74:75], v[74:75] op_sel_hi:[1,0,0]
  v_pk_fma_f32 v[50:51], v[50:51], v[74:75], v[74:75] op_sel_hi:[1,0,0]
  v_rcp_f32 v48, v48
  v_rcp_f32 v49, v49
  v_rcp_f32 v50, v50
  v_rcp_f32 v51, v51
  v_pk_mul_f32 v[48:49], v[48:49], v[112:113]
  v_pk_mul_f32 v[50:51], v[50:51], v[114:115]
  v_cvt_pk_bf16_f32 v24, v48, v49
  v_cvt_pk_bf16_f32 v25, v50, v51
  buffer_load_dwordx4 v203, s[56:59], s69 offen offset:3072 lds
  s_add_u32 m0, s70, 24576
  s_nop 0
  buffer_load_dwordx4 v204, s[56:59], s69 offen offset:0 lds
  s_add_u32 s69, s69, 147456
  s_waitcnt lgkmcnt(4)
  v_pk_fma_f32 v[116:117], v[184:185], v[216:217], v[116:117] op_sel_hi:[1,0,1] neg_lo:[0,1,0] neg_hi:[0,1,0]
  v_pk_fma_f32 v[118:119], v[186:187], v[216:217], v[118:119] op_sel_hi:[1,0,1] neg_lo:[0,1,0] neg_hi:[0,1,0]
  v_pk_mul_f32 v[52:53], v[116:117], v[116:117]
  v_pk_mul_f32 v[54:55], v[118:119], v[118:119]
  v_pk_fma_f32 v[52:53], v[52:53], v[72:73], v[70:71] op_sel_hi:[1,0,0]
  v_pk_fma_f32 v[54:55], v[54:55], v[72:73], v[70:71] op_sel_hi:[1,0,0]
  v_pk_mul_f32 v[52:53], v[52:53], v[116:117]
  v_pk_mul_f32 v[54:55], v[54:55], v[118:119]
  v_exp_f32 v52, v52
  v_exp_f32 v53, v53
  v_exp_f32 v54, v54
  v_exp_f32 v55, v55
  v_pk_fma_f32 v[52:53], v[52:53], v[74:75], v[74:75] op_sel_hi:[1,0,0]
  v_pk_fma_f32 v[54:55], v[54:55], v[74:75], v[74:75] op_sel_hi:[1,0,0]
  v_rcp_f32 v52, v52
  v_rcp_f32 v53, v53
  v_rcp_f32 v54, v54
  v_rcp_f32 v55, v55
  v_pk_mul_f32 v[52:53], v[52:53], v[116:117]
  v_pk_mul_f32 v[54:55], v[54:55], v[118:119]
  v_cvt_pk_bf16_f32 v26, v52, v53
  v_cvt_pk_bf16_f32 v27, v54, v55
  s_add_u32 m0, s70, 40960
  s_nop 0
  buffer_load_dwordx4 v200, s[56:59], s69 offen offset:0 lds
  buffer_load_dwordx4 v201, s[56:59], s69 offen offset:1024 lds
  buffer_store_dwordx4 v[24:27], v241, s[16:19], s46 offen offset:2048 sc1
  s_waitcnt lgkmcnt(3)
  v_pk_fma_f32 v[120:121], v[188:189], v[216:217], v[120:121] op_sel_hi:[1,0,1] neg_lo:[0,1,0] neg_hi:[0,1,0]
  v_pk_fma_f32 v[122:123], v[190:191], v[216:217], v[122:123] op_sel_hi:[1,0,1] neg_lo:[0,1,0] neg_hi:[0,1,0]
  v_pk_mul_f32 v[48:49], v[120:121], v[120:121]
  v_pk_mul_f32 v[50:51], v[122:123], v[122:123]
  v_pk_fma_f32 v[48:49], v[48:49], v[72:73], v[70:71] op_sel_hi:[1,0,0]
  v_pk_fma_f32 v[50:51], v[50:51], v[72:73], v[70:71] op_sel_hi:[1,0,0]
  v_pk_mul_f32 v[48:49], v[48:49], v[120:121]
  v_pk_mul_f32 v[50:51], v[50:51], v[122:123]
  v_exp_f32 v48, v48
  v_exp_f32 v49, v49
  v_exp_f32 v50, v50
  v_exp_f32 v51, v51
  v_pk_fma_f32 v[48:49], v[48:49], v[74:75], v[74:75] op_sel_hi:[1,0,0]
  v_pk_fma_f32 v[50:51], v[50:51], v[74:75], v[74:75] op_sel_hi:[1,0,0]
  v_rcp_f32 v48, v48
  v_rcp_f32 v49, v49
  v_rcp_f32 v50, v50
  v_rcp_f32 v51, v51
  v_pk_mul_f32 v[48:49], v[48:49], v[120:121]
  v_pk_mul_f32 v[50:51], v[50:51], v[122:123]
  v_cvt_pk_bf16_f32 v28, v48, v49
  v_cvt_pk_bf16_f32 v29, v50, v51
  buffer_load_dwordx4 v202, s[56:59], s69 offen offset:2048 lds
  buffer_load_dwordx4 v203, s[56:59], s69 offen offset:3072 lds
  s_waitcnt lgkmcnt(2)
  v_pk_fma_f32 v[124:125], v[192:193], v[216:217], v[124:125] op_sel_hi:[1,0,1] neg_lo:[0,1,0] neg_hi:[0,1,0]
  v_pk_fma_f32 v[126:127], v[194:195], v[216:217], v[126:127] op_sel_hi:[1,0,1] neg_lo:[0,1,0] neg_hi:[0,1,0]
  v_pk_mul_f32 v[52:53], v[124:125], v[124:125]
  v_pk_mul_f32 v[54:55], v[126:127], v[126:127]
  v_pk_fma_f32 v[52:53], v[52:53], v[72:73], v[70:71] op_sel_hi:[1,0,0]
  v_pk_fma_f32 v[54:55], v[54:55], v[72:73], v[70:71] op_sel_hi:[1,0,0]
  v_pk_mul_f32 v[52:53], v[52:53], v[124:125]
  v_pk_mul_f32 v[54:55], v[54:55], v[126:127]
  v_exp_f32 v52, v52
  v_exp_f32 v53, v53
  v_exp_f32 v54, v54
  v_exp_f32 v55, v55
  v_pk_fma_f32 v[52:53], v[52:53], v[74:75], v[74:75] op_sel_hi:[1,0,0]
  v_pk_fma_f32 v[54:55], v[54:55], v[74:75], v[74:75] op_sel_hi:[1,0,0]
  v_rcp_f32 v52, v52
  v_rcp_f32 v53, v53
  v_rcp_f32 v54, v54
  v_rcp_f32 v55, v55
  v_pk_mul_f32 v[52:53], v[52:53], v[124:125]
  v_pk_mul_f32 v[54:55], v[54:55], v[126:127]
  v_cvt_pk_bf16_f32 v30, v52, v53
  v_cvt_pk_bf16_f32 v31, v54, v55
  s_add_u32 m0, s70, 45056
  s_nop 0
  buffer_load_dwordx4 v204, s[56:59], s69 offen offset:0 lds
  s_add_u32 s69, s69, 147456
  s_add_u32 m0, s70, 61440
  s_nop 0
  buffer_load_dwordx4 v200, s[56:59], s69 offen offset:0 lds
  buffer_store_dwordx4 v[28:31], v241, s[16:19], s46 offen offset:3072 sc1
  s_waitcnt lgkmcnt(1)
  v_pk_fma_f32 v[128:129], v[196:197], v[216:217], v[128:129] op_sel_hi:[1,0,1] neg_lo:[0,1,0] neg_hi:[0,1,0]
  v_pk_fma_f32 v[130:131], v[198:199], v[216:217], v[130:131] op_sel_hi:[1,0,1] neg_lo:[0,1,0] neg_hi:[0,1,0]
  v_pk_mul_f32 v[48:49], v[128:129], v[128:129]
  v_pk_mul_f32 v[50:51], v[130:131], v[130:131]
  v_pk_fma_f32 v[48:49], v[48:49], v[72:73], v[70:71] op_sel_hi:[1,0,0]
  v_pk_fma_f32 v[50:51], v[50:51], v[72:73], v[70:71] op_sel_hi:[1,0,0]
  v_pk_mul_f32 v[48:49], v[48:49], v[128:129]
  v_pk_mul_f32 v[50:51], v[50:51], v[130:131]
  v_exp_f32 v48, v48
  v_exp_f32 v49, v49
  v_exp_f32 v50, v50
  v_exp_f32 v51, v51
  v_pk_fma_f32 v[48:49], v[48:49], v[74:75], v[74:75] op_sel_hi:[1,0,0]
  v_pk_fma_f32 v[50:51], v[50:51], v[74:75], v[74:75] op_sel_hi:[1,0,0]
  v_rcp_f32 v48, v48
  v_rcp_f32 v49, v49
  v_rcp_f32 v50, v50
  v_rcp_f32 v51, v51
  v_pk_mul_f32 v[48:49], v[48:49], v[128:129]
  v_pk_mul_f32 v[50:51], v[50:51], v[130:131]
  v_cvt_pk_bf16_f32 v32, v48, v49
  v_cvt_pk_bf16_f32 v33, v50, v51
  buffer_load_dwordx4 v201, s[56:59], s69 offen offset:1024 lds
  buffer_load_dwordx4 v202, s[56:59], s69 offen offset:2048 lds
  s_waitcnt lgkmcnt(0)
  v_pk_fma_f32 v[132:133], v[236:237], v[216:217], v[132:133] op_sel_hi:[1,0,1] neg_lo:[0,1,0] neg_hi:[0,1,0]
  v_pk_fma_f32 v[134:135], v[238:239], v[216:217], v[134:135] op_sel_hi:[1,0,1] neg_lo:[0,1,0] neg_hi:[0,1,0]
  v_pk_mul_f32 v[52:53], v[132:133], v[132:133]
  v_pk_mul_f32 v[54:55], v[134:135], v[134:135]
  v_pk_fma_f32 v[52:53], v[52:53], v[72:73], v[70:71] op_sel_hi:[1,0,0]
  v_pk_fma_f32 v[54:55], v[54:55], v[72:73], v[70:71] op_sel_hi:[1,0,0]
  v_pk_mul_f32 v[52:53], v[52:53], v[132:133]
  v_pk_mul_f32 v[54:55], v[54:55], v[134:135]
  v_exp_f32 v52, v52
  v_exp_f32 v53, v53
  v_exp_f32 v54, v54
  v_exp_f32 v55, v55
  v_pk_fma_f32 v[52:53], v[52:53], v[74:75], v[74:75] op_sel_hi:[1,0,0]
  v_pk_fma_f32 v[54:55], v[54:55], v[74:75], v[74:75] op_sel_hi:[1,0,0]
  v_rcp_f32 v52, v52
  v_rcp_f32 v53, v53
  v_rcp_f32 v54, v54
  v_rcp_f32 v55, v55
  v_pk_mul_f32 v[52:53], v[52:53], v[132:133]
  v_pk_mul_f32 v[54:55], v[54:55], v[134:135]
  v_cvt_pk_bf16_f32 v34, v52, v53
  v_cvt_pk_bf16_f32 v35, v54, v55
  buffer_load_dwordx4 v203, s[56:59], s69 offen offset:3072 lds
  s_add_u32 m0, s70, 65536
  s_nop 0
  buffer_load_dwordx4 v204, s[56:59], s69 offen offset:0 lds
  s_add_u32 s69, s69, 147456
  buffer_store_dwordx4 v[32:35], v241, s[16:19], s47 offen sc1
  s_add_u32 m0, s72, 0
  s_nop 0
  buffer_load_dwordx4 v200, s[56:59], s69 offen offset:0 lds
  buffer_load_dwordx4 v201, s[56:59], s69 offen offset:1024 lds
  buffer_load_dwordx4 v202, s[56:59], s69 offen offset:2048 lds
  buffer_load_dwordx4 v203, s[56:59], s69 offen offset:3072 lds
  s_add_u32 m0, s72, 4096
  s_nop 0
  buffer_load_dwordx4 v204, s[56:59], s69 offen offset:0 lds
  s_lshl_b32 s46, s6, 3
  s_add_u32 s46, s46, s7
  s_lshl_b32 s46, s46, 7
  s_add_u32 s46, s46, 14368768
  s_waitcnt vmcnt(5)
  s_barrier
  s_cmp_lg_u32 s43, 0
  s_cbranch_scc1 L_b1_sf
  v_mov_b32 v246, s3
  v_mov_b32 v247, 0
  s_mov_b64 exec, 1
  buffer_store_dword v246, v247, s[16:19], s46 offen sc1
  s_mov_b64 exec, -1
L_b1_sf:
  s_bitcmp1_b32 s7, 0
  s_cselect_b32 s44, 39, 31
  v_min_u32 v246, s44, v9
  v_lshlrev_b32 v246, 7, v246
  s_mul_i32 s46, s54, 36864
  s_lshl_b32 s47, s68, 10
  s_add_u32 s46, s46, s47
  s_add_u32 s46, s46, 7077888
  buffer_load_dword v14, v246, s[16:19], s46 offen sc1
  s_add_u32 m0, s70, 98304
  s_nop 0
  buffer_load_dwordx4 v200, s[64:67], s71 offen offset:0 lds
  buffer_load_dwordx4 v201, s[64:67], s71 offen offset:1024 lds
  buffer_load_dwordx4 v202, s[64:67], s71 offen offset:2048 lds
  buffer_load_dwordx4 v203, s[64:67], s71 offen offset:3072 lds
  s_add_u32 m0, s70, 102400
  s_nop 0
  buffer_load_dwordx4 v204, s[64:67], s71 offen offset:0 lds
  s_add_u32 s60, s16, 7077888
  s_addc_u32 s61, s17, 0
  s_mov_b32 s62, 2359296
  s_mov_b32 s44, 1048576
L_w2_gr:
  v_cmp_ne_u32 vcc, s3, v249
  v_cmp_ne_u32 s[74:75], s3, v251
  s_or_b64 vcc, vcc, s[74:75]
  v_cmp_ne_u32 s[74:75], s3, v253
  s_or_b64 vcc, vcc, s[74:75]
  s_cbranch_scc0 L_w2_gd
  s_sub_u32 s44, s44, 1
  s_cmp_eq_u32 s44, 0
  s_cbranch_scc1 L_w2_gd
  buffer_load_dwordx2 v[248:249], v228, s[16:19], 0 offen offset:0 sc1
  buffer_load_dwordx2 v[250:251], v228, s[16:19], 0 offen offset:512 sc1
  buffer_load_dwordx2 v[252:253], v228, s[16:19], 0 offen offset:640 sc1
  s_waitcnt vmcnt(0)
  s_branch L_w2_gr
L_w2_gd:
  ds_write_b64 v254, v[248:249] offset:0
  ds_write_b64 v254, v[250:251] offset:512
  ds_write_b64 v254, v[252:253] offset:640
  s_waitcnt vmcnt(0)
  s_mov_b32 s71, 0
  ds_read2_b64 v[164:167], v214 offset0:0 offset1:2
  ds_read2_b64 v[168:171], v214 offset0:4 offset1:6
  ds_read2_b64 v[172:175], v214 offset0:8 offset1:10
  ds_read2_b64 v[176:179], v214 offset0:12 offset1:14
  ds_read2_b64 v[180:183], v214 offset0:16 offset1:18
  s_waitcnt lgkmcnt(0)
  s_mov_b32 s44, 14368768
  s_cmp_lg_u32 s43, 0
  s_cbranch_scc1 L_w2_w0_d
  s_mov_b32 s45, 1048576
L_w2_w0:
  buffer_load_dword v243, v229, s[16:19], s44 offen sc1
  s_sub_u32 s45, s45, 1
  s_waitcnt vmcnt(0)
  v_cmp_ne_u32 vcc, s3, v243
  s_cmp_eq_u32 s45, 0
  s_cbranch_scc1 L_w2_w0_d
  s_cmp_lg_u64 vcc, 0
  s_cbranch_scc1 L_w2_w0
L_w2_w0_d:
  s_barrier
  buffer_load_dwordx4 a[0:3], v232, s[60:63], s71 offen offset:0 sc1
  buffer_load_dwordx4 a[4:7], v232, s[60:63], s71 offen offset:1024 sc1
  buffer_load_dwordx4 a[8:11], v232, s[60:63], s71 offen offset:2048 sc1
  buffer_load_dwordx4 a[12:15], v232, s[60:63], s71 offen offset:3072 sc1
  s_add_u32 s71, s71, 4096
  buffer_load_dwordx4 a[16:19], v232, s[60:63], s71 offen offset:0 sc1
  buffer_load_dwordx4 a[20:23], v232, s[60:63], s71 offen offset:1024 sc1
  buffer_load_dwordx4 a[24:27], v232, s[60:63], s71 offen offset:2048 sc1
  buffer_load_dwordx4 a[28:31], v232, s[60:63], s71 offen offset:3072 sc1
  s_add_u32 s71, s71, 4096
  buffer_load_dwordx4 a[32:35], v232, s[60:63], s71 offen offset:0 sc1
  buffer_load_dwordx4 a[36:39], v234, s[60:63], s71 offen offset:1024 sc1
  ds_read_b64_tr_b16 v[16:17], v160 offset:0
  ds_read_b64_tr_b16 v[18:19], v160 offset:1280
  ds_read_b64_tr_b16 v[20:21], v160 offset:64
  ds_read_b64_tr_b16 v[22:23], v160 offset:1344
  ds_read_b64_tr_b16 v[24:25], v162
  ds_read_b64_tr_b16 v[26:27], v163
  v_add_u32 v162, v162, v219
  v_add_u32 v163, v163, v219
  ds_read_b64_tr_b16 v[28:29], v160 offset:2560
  ds_read_b64_tr_b16 v[30:31], v160 offset:3840
  ds_read_b64_tr_b16 v[32:33], v160 offset:2624
  ds_read_b64_tr_b16 v[34:35], v160 offset:3904
  ds_read_b64_tr_b16 v[36:37], v162
  ds_read_b64_tr_b16 v[38:39], v163
  v_add_u32 v162, v162, v219
  v_add_u32 v163, v163, v219
  s_waitcnt vmcnt(9) lgkmcnt(8)
  v_mfma_f32_32x32x16_bf16 v[96:111], v[16:19], a[0:3], 0
  ds_read_b64_tr_b16 v[40:41], v160 offset:5120
  ds_read_b64_tr_b16 v[42:43], v160 offset:6400
  buffer_load_dwordx4 a[40:43], v234, s[60:63], s71 offen offset:2048 sc1
  v_mfma_f32_32x32x16_bf16 v[112:127], v[20:23], a[0:3], 0
  s_waitcnt vmcnt(9) lgkmcnt(6)
  ds_read_b64_tr_b16 v[44:45], v160 offset:5184
  ds_read_b64_tr_b16 v[46:47], v160 offset:6464
  v_mfma_f32_32x32x16_bf16 v[128:143], v[24:27], a[0:3], 0
  ds_read_b64_tr_b16 v[16:17], v162
  ds_read_b64_tr_b16 v[18:19], v163
  buffer_load_dwordx4 a[44:47], v234, s[60:63], s71 offen offset:3072 sc1
  s_add_u32 s71, s71, 4096
  v_add_u32 v162, v162, v219
  v_add_u32 v163, v163, v219
  v_mfma_f32_32x32x16_bf16 v[96:111], v[28:31], a[4:7], v[96:111]
  s_waitcnt lgkmcnt(6)
  ds_read_b64_tr_b16 v[20:21], v160 offset:7680
  ds_read_b64_tr_b16 v[22:23], v160 offset:8960
  v_mfma_f32_32x32x16_bf16 v[112:127], v[32:35], a[4:7], v[112:127]
  ds_read_b64_tr_b16 v[24:25], v160 offset:7744
  ds_read_b64_tr_b16 v[26:27], v160 offset:9024
  v_mfma_f32_32x32x16_bf16 v[128:143], v[36:39], a[4:7], v[128:143]
  s_waitcnt vmcnt(9) lgkmcnt(6)
  ds_read_b64_tr_b16 v[28:29], v162
  ds_read_b64_tr_b16 v[30:31], v163
  buffer_load_dwordx4 a[48:51], v234, s[60:63], s71 offen offset:0 sc1
  v_add_u32 v162, v162, v219
  v_add_u32 v163, v163, v219
  v_mfma_f32_32x32x16_bf16 v[96:111], v[40:43], a[8:11], v[96:111]
  ds_read_b64_tr_b16 v[32:33], v160 offset:10240
  ds_read_b64_tr_b16 v[34:35], v160 offset:11520
  v_mfma_f32_32x32x16_bf16 v[112:127], v[44:47], a[8:11], v[112:127]
  s_waitcnt vmcnt(9) lgkmcnt(6)
  ds_read_b64_tr_b16 v[36:37], v160 offset:10304
  ds_read_b64_tr_b16 v[38:39], v160 offset:11584
  buffer_load_dwordx4 a[52:55], v234, s[60:63], s71 offen offset:1024 sc1
  v_mfma_f32_32x32x16_bf16 v[128:143], v[16:19], a[8:11], v[128:143]
  ds_read_b64_tr_b16 v[40:41], v162
  ds_read_b64_tr_b16 v[42:43], v163
  v_add_u32 v162, v162, v219
  v_add_u32 v163, v163, v219
  v_mfma_f32_32x32x16_bf16 v[96:111], v[20:23], a[12:15], v[96:111]
  s_waitcnt lgkmcnt(6)
  ds_read_b64_tr_b16 v[44:45], v160 offset:12800
  ds_read_b64_tr_b16 v[46:47], v160 offset:14080
  v_mfma_f32_32x32x16_bf16 v[112:127], v[24:27], a[12:15], v[112:127]
  ds_read_b64_tr_b16 v[16:17], v160 offset:12864
  ds_read_b64_tr_b16 v[18:19], v160 offset:14144
  buffer_load_dwordx4 a[56:59], v234, s[60:63], s71 offen offset:2048 sc1
  v_mfma_f32_32x32x16_bf16 v[128:143], v[28:31], a[12:15], v[128:143]
  s_waitcnt vmcnt(10) lgkmcnt(6)
  ds_read_b64_tr_b16 v[20:21], v162
  ds_read_b64_tr_b16 v[22:23], v163
  v_add_u32 v162, v162, v219
  v_add_u32 v163, v163, v219
  v_mfma_f32_32x32x16_bf16 v[96:111], v[32:35], a[16:19], v[96:111]
  ds_read_b64_tr_b16 v[24:25], v160 offset:15360
  ds_read_b64_tr_b16 v[26:27], v160 offset:16640
  buffer_load_dwordx4 a[60:63], v234, s[60:63], s71 offen offset:3072 sc1
  s_add_u32 s71, s71, 4096
  v_mfma_f32_32x32x16_bf16 v[112:127], v[36:39], a[16:19], v[112:127]
  s_waitcnt vmcnt(10) lgkmcnt(6)
  ds_read_b64_tr_b16 v[28:29], v160 offset:15424
  ds_read_b64_tr_b16 v[30:31], v160 offset:16704
  v_mfma_f32_32x32x16_bf16 v[128:143], v[40:43], a[16:19], v[128:143]
  ds_read_b64_tr_b16 v[32:33], v162
  ds_read_b64_tr_b16 v[34:35], v163
  v_add_u32 v162, v162, v219
  v_add_u32 v163, v163, v219
  v_mfma_f32_32x32x16_bf16 v[96:111], v[44:47], a[20:23], v[96:111]
  s_waitcnt lgkmcnt(6)
  ds_read_b64_tr_b16 v[36:37], v160 offset:17920
  ds_read_b64_tr_b16 v[38:39], v160 offset:19200
  buffer_load_dwordx4 a[64:67], v234, s[60:63], s71 offen offset:0 sc1
  v_mfma_f32_32x32x16_bf16 v[112:127], v[16:19], a[20:23], v[112:127]
  ds_read_b64_tr_b16 v[40:41], v160 offset:17984
  ds_read_b64_tr_b16 v[42:43], v160 offset:19264
  v_mfma_f32_32x32x16_bf16 v[128:143], v[20:23], a[20:23], v[128:143]
  s_waitcnt vmcnt(10) lgkmcnt(6)
  ds_read_b64_tr_b16 v[44:45], v162
  ds_read_b64_tr_b16 v[46:47], v163
  buffer_load_dwordx4 a[68:71], v234, s[60:63], s71 offen offset:1024 sc1
  v_add_u32 v162, v162, v219
  v_add_u32 v163, v163, v219
  v_mfma_f32_32x32x16_bf16 v[96:111], v[24:27], a[24:27], v[96:111]
  ds_read_b64_tr_b16 v[16:17], v160 offset:20480
  ds_read_b64_tr_b16 v[18:19], v160 offset:21760
  v_mfma_f32_32x32x16_bf16 v[112:127], v[28:31], a[24:27], v[112:127]
  s_waitcnt vmcnt(10) lgkmcnt(6)
  ds_read_b64_tr_b16 v[20:21], v160 offset:20544
  ds_read_b64_tr_b16 v[22:23], v160 offset:21824
  v_mfma_f32_32x32x16_bf16 v[128:143], v[32:35], a[24:27], v[128:143]
  ds_read_b64_tr_b16 v[24:25], v162
  ds_read_b64_tr_b16 v[26:27], v163
  buffer_load_dwordx4 a[72:75], v235, s[60:63], s71 offen offset:2048 sc1
  v_add_u32 v162, v162, v219
  v_add_u32 v163, v163, v219
  v_mfma_f32_32x32x16_bf16 v[96:111], v[36:39], a[28:31], v[96:111]
  s_waitcnt lgkmcnt(6)
  ds_read_b64_tr_b16 v[28:29], v160 offset:23040
  ds_read_b64_tr_b16 v[30:31], v160 offset:24320
  v_mfma_f32_32x32x16_bf16 v[112:127], v[40:43], a[28:31], v[112:127]
  ds_read_b64_tr_b16 v[32:33], v160 offset:23104
  ds_read_b64_tr_b16 v[34:35], v160 offset:24384
  buffer_load_dwordx4 a[76:79], v235, s[60:63], s71 offen offset:3072 sc1
  s_add_u32 s71, s71, 4096
  v_mfma_f32_32x32x16_bf16 v[128:143], v[44:47], a[28:31], v[128:143]
  s_waitcnt vmcnt(11) lgkmcnt(6)
  ds_read_b64_tr_b16 v[36:37], v162
  ds_read_b64_tr_b16 v[38:39], v163
  v_add_u32 v162, v162, v219
  v_add_u32 v163, v163, v219
  v_mfma_f32_32x32x16_bf16 v[96:111], v[16:19], a[32:35], v[96:111]
  ds_read_b64_tr_b16 v[40:41], v160 offset:25600
  ds_read_b64_tr_b16 v[42:43], v160 offset:26880
  v_mfma_f32_32x32x16_bf16 v[112:127], v[20:23], a[32:35], v[112:127]
  s_waitcnt vmcnt(10) lgkmcnt(6)
  ds_read_b64_tr_b16 v[44:45], v160 offset:25664
  ds_read_b64_tr_b16 v[46:47], v160 offset:26944
  buffer_load_dwordx4 a[80:83], v235, s[60:63], s71 offen offset:0 sc1
  v_mfma_f32_32x32x16_bf16 v[128:143], v[24:27], a[32:35], v[128:143]
  ds_read_b64_tr_b16 v[16:17], v162
  ds_read_b64_tr_b16 v[18:19], v163
  v_add_u32 v162, v162, v219
  v_add_u32 v163, v163, v219
  v_mfma_f32_32x32x16_bf16 v[96:111], v[28:31], a[36:39], v[96:111]
  s_waitcnt lgkmcnt(6)
  ds_read_b64_tr_b16 v[20:21], v160 offset:28160
  ds_read_b64_tr_b16 v[22:23], v160 offset:29440
  buffer_load_dwordx4 a[84:87], v235, s[60:63], s71 offen offset:1024 sc1
  v_mfma_f32_32x32x16_bf16 v[112:127], v[32:35], a[36:39], v[112:127]
  ds_read_b64_tr_b16 v[24:25], v160 offset:28224
  ds_read_b64_tr_b16 v[26:27], v160 offset:29504
  v_mfma_f32_32x32x16_bf16 v[128:143], v[36:39], a[36:39], v[128:143]
  s_waitcnt vmcnt(11) lgkmcnt(6)
  ds_read_b64_tr_b16 v[28:29], v162
  ds_read_b64_tr_b16 v[30:31], v163
  v_add_u32 v162, v162, v219
  v_add_u32 v163, v163, v219
  v_mfma_f32_32x32x16_bf16 v[96:111], v[40:43], a[40:43], v[96:111]
  ds_read_b64_tr_b16 v[32:33], v160 offset:30720
  ds_read_b64_tr_b16 v[34:35], v160 offset:32000
  buffer_load_dwordx4 a[88:91], v235, s[60:63], s71 offen offset:2048 sc1
  v_mfma_f32_32x32x16_bf16 v[112:127], v[44:47], a[40:43], v[112:127]
  s_waitcnt vmcnt(11) lgkmcnt(6)
  ds_read_b64_tr_b16 v[36:37], v160 offset:30784
  ds_read_b64_tr_b16 v[38:39], v160 offset:32064
  v_mfma_f32_32x32x16_bf16 v[128:143], v[16:19], a[40:43], v[128:143]
  ds_read_b64_tr_b16 v[40:41], v162
  ds_read_b64_tr_b16 v[42:43], v163
  buffer_load_dwordx4 a[92:95], v235, s[60:63], s71 offen offset:3072 sc1
  s_add_u32 s71, s71, 4096
  v_add_u32 v162, v162, v219
  v_add_u32 v163, v163, v219
  v_mfma_f32_32x32x16_bf16 v[96:111], v[20:23], a[44:47], v[96:111]
  s_waitcnt lgkmcnt(6)
  ds_read_b64_tr_b16 v[44:45], v160 offset:33280
  ds_read_b64_tr_b16 v[46:47], v160 offset:34560
  v_mfma_f32_32x32x16_bf16 v[112:127], v[24:27], a[44:47], v[112:127]
  ds_read_b64_tr_b16 v[16:17], v160 offset:33344
  ds_read_b64_tr_b16 v[18:19], v160 offset:34624
  v_mfma_f32_32x32x16_bf16 v[128:143], v[28:31], a[44:47], v[128:143]
  s_waitcnt vmcnt(11) lgkmcnt(6)
  ds_read_b64_tr_b16 v[20:21], v162
  ds_read_b64_tr_b16 v[22:23], v163
  buffer_load_dwordx4 a[96:99], v235, s[60:63], s71 offen offset:0 sc1
  v_add_u32 v162, v162, v219
  v_add_u32 v163, v163, v219
  v_mfma_f32_32x32x16_bf16 v[96:111], v[32:35], a[48:51], v[96:111]
  ds_read_b64_tr_b16 v[24:25], v160 offset:35840
  ds_read_b64_tr_b16 v[26:27], v160 offset:37120
  v_mfma_f32_32x32x16_bf16 v[112:127], v[36:39], a[48:51], v[112:127]
  s_waitcnt vmcnt(11) lgkmcnt(6)
  ds_read_b64_tr_b16 v[28:29], v160 offset:35904
  ds_read_b64_tr_b16 v[30:31], v160 offset:37184
  buffer_load_dwordx4 a[100:103], v235, s[60:63], s71 offen offset:1024 sc1
  v_mfma_f32_32x32x16_bf16 v[128:143], v[40:43], a[48:51], v[128:143]
  ds_read_b64_tr_b16 v[32:33], v162
  ds_read_b64_tr_b16 v[34:35], v163
  v_add_u32 v162, v162, v219
  v_add_u32 v163, v163, v219
  v_mfma_f32_32x32x16_bf16 v[96:111], v[44:47], a[52:55], v[96:111]
  s_waitcnt lgkmcnt(6)
  ds_read_b64_tr_b16 v[36:37], v160 offset:38400
  ds_read_b64_tr_b16 v[38:39], v160 offset:39680
  v_mfma_f32_32x32x16_bf16 v[112:127], v[16:19], a[52:55], v[112:127]
  ds_read_b64_tr_b16 v[40:41], v160 offset:38464
  ds_read_b64_tr_b16 v[42:43], v160 offset:39744
  buffer_load_dwordx4 a[104:107], v235, s[60:63], s71 offen offset:2048 sc1
  v_mfma_f32_32x32x16_bf16 v[128:143], v[20:23], a[52:55], v[128:143]
  s_waitcnt vmcnt(12) lgkmcnt(6)
  ds_read_b64_tr_b16 v[44:45], v162
  ds_read_b64_tr_b16 v[46:47], v163
  v_add_u32 v162, v162, v219
  v_add_u32 v163, v163, v219
  v_mfma_f32_32x32x16_bf16 v[96:111], v[24:27], a[56:59], v[96:111]
  ds_read_b64_tr_b16 v[16:17], v160 offset:40960
  ds_read_b64_tr_b16 v[18:19], v160 offset:42240
  buffer_load_dwordx4 a[108:111], v230, s[60:63], s71 offen offset:3072 sc1
  s_add_u32 s71, s71, 4096
  v_mfma_f32_32x32x16_bf16 v[112:127], v[28:31], a[56:59], v[112:127]
  s_waitcnt vmcnt(12) lgkmcnt(6)
  ds_read_b64_tr_b16 v[20:21], v160 offset:41024
  ds_read_b64_tr_b16 v[22:23], v160 offset:42304
  v_mfma_f32_32x32x16_bf16 v[128:143], v[32:35], a[56:59], v[128:143]
  ds_read_b64_tr_b16 v[24:25], v162
  ds_read_b64_tr_b16 v[26:27], v163
  v_add_u32 v162, v162, v219
  v_add_u32 v163, v163, v219
  v_mfma_f32_32x32x16_bf16 v[96:111], v[36:39], a[60:63], v[96:111]
  s_waitcnt lgkmcnt(6)
  ds_read_b64_tr_b16 v[28:29], v160 offset:43520
  ds_read_b64_tr_b16 v[30:31], v160 offset:44800
  buffer_load_dwordx4 a[112:115], v230, s[60:63], s71 offen offset:0 sc1
  v_mfma_f32_32x32x16_bf16 v[112:127], v[40:43], a[60:63], v[112:127]
  ds_read_b64_tr_b16 v[32:33], v160 offset:43584
  ds_read_b64_tr_b16 v[34:35], v160 offset:44864
  v_mfma_f32_32x32x16_bf16 v[128:143], v[44:47], a[60:63], v[128:143]
  s_waitcnt vmcnt(12) lgkmcnt(6)
  ds_read_b64_tr_b16 v[36:37], v162
  ds_read_b64_tr_b16 v[38:39], v163
  buffer_load_dwordx4 a[116:119], v230, s[60:63], s71 offen offset:1024 sc1
  v_add_u32 v162, v162, v219
  v_add_u32 v163, v163, v219
  v_mfma_f32_32x32x16_bf16 v[96:111], v[16:19], a[64:67], v[96:111]
  ds_read_b64_tr_b16 v[40:41], v160 offset:46080
  ds_read_b64_tr_b16 v[42:43], v160 offset:47360
  v_mfma_f32_32x32x16_bf16 v[112:127], v[20:23], a[64:67], v[112:127]
  s_waitcnt vmcnt(12) lgkmcnt(6)
  ds_read_b64_tr_b16 v[44:45], v160 offset:46144
  ds_read_b64_tr_b16 v[46:47], v160 offset:47424
  v_mfma_f32_32x32x16_bf16 v[128:143], v[24:27], a[64:67], v[128:143]
  ds_read_b64_tr_b16 v[16:17], v162
  ds_read_b64_tr_b16 v[18:19], v163
  buffer_load_dwordx4 a[120:123], v230, s[60:63], s71 offen offset:2048 sc1
  v_add_u32 v162, v162, v219
  v_add_u32 v163, v163, v219
  v_mfma_f32_32x32x16_bf16 v[96:111], v[28:31], a[68:71], v[96:111]
  s_waitcnt lgkmcnt(6)
  ds_read_b64_tr_b16 v[20:21], v160 offset:48640
  ds_read_b64_tr_b16 v[22:23], v160 offset:49920
  v_mfma_f32_32x32x16_bf16 v[112:127], v[32:35], a[68:71], v[112:127]
  ds_read_b64_tr_b16 v[24:25], v160 offset:48704
  ds_read_b64_tr_b16 v[26:27], v160 offset:49984
  buffer_load_dwordx4 a[124:127], v230, s[60:63], s71 offen offset:3072 sc1
  s_add_u32 s71, s71, 4096
  v_mfma_f32_32x32x16_bf16 v[128:143], v[36:39], a[68:71], v[128:143]
  s_waitcnt vmcnt(13) lgkmcnt(6)
  ds_read_b64_tr_b16 v[28:29], v162
  ds_read_b64_tr_b16 v[30:31], v163
  v_add_u32 v162, v162, v219
  v_add_u32 v163, v163, v219
  v_mfma_f32_32x32x16_bf16 v[96:111], v[40:43], a[72:75], v[96:111]
  ds_read_b64_tr_b16 v[32:33], v160 offset:51200
  ds_read_b64_tr_b16 v[34:35], v160 offset:52480
  v_mfma_f32_32x32x16_bf16 v[112:127], v[44:47], a[72:75], v[112:127]
  s_waitcnt vmcnt(12) lgkmcnt(6)
  ds_read_b64_tr_b16 v[36:37], v160 offset:51264
  ds_read_b64_tr_b16 v[38:39], v160 offset:52544
  buffer_load_dwordx4 a[128:131], v230, s[60:63], s71 offen offset:0 sc1
  v_mfma_f32_32x32x16_bf16 v[128:143], v[16:19], a[72:75], v[128:143]
  ds_read_b64_tr_b16 v[40:41], v162
  ds_read_b64_tr_b16 v[42:43], v163
  v_add_u32 v162, v162, v219
  v_add_u32 v163, v163, v219
  v_mfma_f32_32x32x16_bf16 v[96:111], v[20:23], a[76:79], v[96:111]
  s_waitcnt lgkmcnt(6)
  ds_read_b64_tr_b16 v[44:45], v160 offset:53760
  ds_read_b64_tr_b16 v[46:47], v160 offset:55040
  buffer_load_dwordx4 a[132:135], v230, s[60:63], s71 offen offset:1024 sc1
  v_mfma_f32_32x32x16_bf16 v[112:127], v[24:27], a[76:79], v[112:127]
  ds_read_b64_tr_b16 v[16:17], v160 offset:53824
  ds_read_b64_tr_b16 v[18:19], v160 offset:55104
  v_mfma_f32_32x32x16_bf16 v[128:143], v[28:31], a[76:79], v[128:143]
  s_waitcnt vmcnt(13) lgkmcnt(6)
  ds_read_b64_tr_b16 v[20:21], v162
  ds_read_b64_tr_b16 v[22:23], v163
  v_add_u32 v162, v162, v219
  v_add_u32 v163, v163, v219
  v_mfma_f32_32x32x16_bf16 v[96:111], v[32:35], a[80:83], v[96:111]
  ds_read_b64_tr_b16 v[24:25], v160 offset:56320
  ds_read_b64_tr_b16 v[26:27], v160 offset:57600
  buffer_load_dwordx4 a[136:139], v230, s[60:63], s71 offen offset:2048 sc1
  v_mfma_f32_32x32x16_bf16 v[112:127], v[36:39], a[80:83], v[112:127]
  s_waitcnt vmcnt(13) lgkmcnt(6)
  ds_read_b64_tr_b16 v[28:29], v160 offset:56384
  ds_read_b64_tr_b16 v[30:31], v160 offset:57664
  v_mfma_f32_32x32x16_bf16 v[128:143], v[40:43], a[80:83], v[128:143]
  ds_read_b64_tr_b16 v[32:33], v162
  ds_read_b64_tr_b16 v[34:35], v163
  buffer_load_dwordx4 a[140:143], v230, s[60:63], s71 offen offset:3072 sc1
  s_add_u32 s71, s71, 4096
  v_add_u32 v162, v162, v219
  v_add_u32 v163, v163, v219
  v_mfma_f32_32x32x16_bf16 v[96:111], v[44:47], a[84:87], v[96:111]
  s_waitcnt lgkmcnt(6)
  ds_read_b64_tr_b16 v[36:37], v160 offset:58880
  ds_read_b64_tr_b16 v[38:39], v160 offset:60160
  v_mfma_f32_32x32x16_bf16 v[112:127], v[16:19], a[84:87], v[112:127]
  s_add_u32 m0, s42, 110592
  ds_read_b64_tr_b16 v[40:41], v160 offset:58944
  ds_read_b64_tr_b16 v[42:43], v160 offset:60224
  v_mfma_f32_32x32x16_bf16 v[128:143], v[20:23], a[84:87], v[128:143]
  s_waitcnt vmcnt(13) lgkmcnt(6)
  ds_read_b64_tr_b16 v[44:45], v162
  ds_read_b64_tr_b16 v[46:47], v163
  buffer_load_dwordx4 v3, s[8:11], s24 offen offset:0 lds
  v_add_u32 v162, v162, v219
  v_add_u32 v163, v163, v219
  v_mfma_f32_32x32x16_bf16 v[96:111], v[24:27], a[88:91], v[96:111]
  ds_read_b64_tr_b16 v[16:17], v161 offset:0
  ds_read_b64_tr_b16 v[18:19], v161 offset:1280
  v_mfma_f32_32x32x16_bf16 v[112:127], v[28:31], a[88:91], v[112:127]
  s_waitcnt vmcnt(13) lgkmcnt(6)
  ds_read_b64_tr_b16 v[20:21], v161 offset:64
  ds_read_b64_tr_b16 v[22:23], v161 offset:1344
  buffer_load_dwordx4 v3, s[8:11], s25 offen offset:1024 lds
  v_mfma_f32_32x32x16_bf16 v[128:143], v[32:35], a[88:91], v[128:143]
  ds_read_b64_tr_b16 v[24:25], v162
  ds_read_b64_tr_b16 v[26:27], v163
  v_add_u32 v162, v162, v219
  v_add_u32 v163, v163, v219
  v_mfma_f32_32x32x16_bf16 v[96:111], v[36:39], a[92:95], v[96:111]
  s_waitcnt lgkmcnt(6)
  ds_read_b64_tr_b16 v[28:29], v161 offset:2560
  ds_read_b64_tr_b16 v[30:31], v161 offset:3840
  v_mfma_f32_32x32x16_bf16 v[112:127], v[40:43], a[92:95], v[112:127]
  ds_read_b64_tr_b16 v[32:33], v161 offset:2624
  ds_read_b64_tr_b16 v[34:35], v161 offset:3904
  buffer_load_dwordx4 v3, s[8:11], s26 offen offset:2048 lds
  v_mfma_f32_32x32x16_bf16 v[128:143], v[44:47], a[92:95], v[128:143]
  s_waitcnt vmcnt(14) lgkmcnt(6)
  ds_read_b64_tr_b16 v[36:37], v162
  ds_read_b64_tr_b16 v[38:39], v163
  v_add_u32 v162, v162, v219
  v_add_u32 v163, v163, v219
  v_mfma_f32_32x32x16_bf16 v[96:111], v[16:19], a[96:99], v[96:111]
  ds_read_b64_tr_b16 v[40:41], v161 offset:5120
  ds_read_b64_tr_b16 v[42:43], v161 offset:6400
  buffer_load_dwordx4 v3, s[8:11], s27 offen offset:3072 lds
  v_mfma_f32_32x32x16_bf16 v[112:127], v[20:23], a[96:99], v[112:127]
  s_waitcnt vmcnt(14) lgkmcnt(6)
  ds_read_b64_tr_b16 v[44:45], v161 offset:5184
  ds_read_b64_tr_b16 v[46:47], v161 offset:6464
  v_mfma_f32_32x32x16_bf16 v[128:143], v[24:27], a[96:99], v[128:143]
  s_add_u32 m0, s42, 114688
  ds_read_b64_tr_b16 v[16:17], v162
  ds_read_b64_tr_b16 v[18:19], v163
  v_add_u32 v162, v162, v219
  v_add_u32 v163, v163, v219
  v_mfma_f32_32x32x16_bf16 v[96:111], v[28:31], a[100:103], v[96:111]
  s_waitcnt lgkmcnt(6)
  ds_read_b64_tr_b16 v[20:21], v161 offset:7680
  ds_read_b64_tr_b16 v[22:23], v161 offset:8960
  buffer_load_dwordx4 v3, s[8:11], s28 offen offset:0 lds
  v_mfma_f32_32x32x16_bf16 v[112:127], v[32:35], a[100:103], v[112:127]
  ds_read_b64_tr_b16 v[24:25], v161 offset:7744
  ds_read_b64_tr_b16 v[26:27], v161 offset:9024
  v_mfma_f32_32x32x16_bf16 v[128:143], v[36:39], a[100:103], v[128:143]
  s_waitcnt vmcnt(14) lgkmcnt(6)
  ds_read_b64_tr_b16 v[28:29], v162
  ds_read_b64_tr_b16 v[30:31], v163
  buffer_load_dwordx4 v3, s[8:11], s29 offen offset:1024 lds
  v_add_u32 v162, v162, v219
  v_add_u32 v163, v163, v219
  v_mfma_f32_32x32x16_bf16 v[96:111], v[40:43], a[104:107], v[96:111]
  ds_read_b64_tr_b16 v[32:33], v161 offset:10240
  ds_read_b64_tr_b16 v[34:35], v161 offset:11520
  v_mfma_f32_32x32x16_bf16 v[112:127], v[44:47], a[104:107], v[112:127]
  s_waitcnt vmcnt(14) lgkmcnt(6)
  ds_read_b64_tr_b16 v[36:37], v161 offset:10304
  ds_read_b64_tr_b16 v[38:39], v161 offset:11584
  v_mfma_f32_32x32x16_bf16 v[128:143], v[16:19], a[104:107], v[128:143]
  ds_read_b64_tr_b16 v[40:41], v162
  ds_read_b64_tr_b16 v[42:43], v163
  buffer_load_dwordx4 v3, s[8:11], s30 offen offset:2048 lds
  v_add_u32 v162, v162, v219
  v_add_u32 v163, v163, v219
  v_mfma_f32_32x32x16_bf16 v[96:111], v[20:23], a[108:111], v[96:111]
  s_waitcnt lgkmcnt(6)
  ds_read_b64_tr_b16 v[44:45], v161 offset:12800
  ds_read_b64_tr_b16 v[46:47], v161 offset:14080
  v_mfma_f32_32x32x16_bf16 v[112:127], v[24:27], a[108:111], v[112:127]
  ds_read_b64_tr_b16 v[16:17], v161 offset:12864
  ds_read_b64_tr_b16 v[18:19], v161 offset:14144
  buffer_load_dwordx4 v3, s[8:11], s31 offen offset:3072 lds
  v_mfma_f32_32x32x16_bf16 v[128:143], v[28:31], a[108:111], v[128:143]
  s_waitcnt vmcnt(15) lgkmcnt(6)
  ds_read_b64_tr_b16 v[20:21], v162
  ds_read_b64_tr_b16 v[22:23], v163
  v_add_u32 v162, v162, v219
  v_add_u32 v163, v163, v219
  v_mfma_f32_32x32x16_bf16 v[96:111], v[32:35], a[112:115], v[96:111]
  s_add_u32 m0, s42, 118784
  ds_read_b64_tr_b16 v[24:25], v161 offset:15360
  ds_read_b64_tr_b16 v[26:27], v161 offset:16640
  v_mfma_f32_32x32x16_bf16 v[112:127], v[36:39], a[112:115], v[112:127]
  s_waitcnt vmcnt(14) lgkmcnt(6)
  ds_read_b64_tr_b16 v[28:29], v161 offset:15424
  ds_read_b64_tr_b16 v[30:31], v161 offset:16704
  buffer_load_dwordx4 v3, s[8:11], s32 offen offset:0 lds
  v_mfma_f32_32x32x16_bf16 v[128:143], v[40:43], a[112:115], v[128:143]
  ds_read_b64_tr_b16 v[32:33], v162
  ds_read_b64_tr_b16 v[34:35], v163
  v_add_u32 v162, v162, v219
  v_add_u32 v163, v163, v219
  v_mfma_f32_32x32x16_bf16 v[96:111], v[44:47], a[116:119], v[96:111]
  s_waitcnt lgkmcnt(6)
  ds_read_b64_tr_b16 v[36:37], v161 offset:17920
  ds_read_b64_tr_b16 v[38:39], v161 offset:19200
  v_add_u32 v3, 2654208, v3
  v_mfma_f32_32x32x16_bf16 v[112:127], v[16:19], a[116:119], v[112:127]
  ds_read_b64_tr_b16 v[40:41], v161 offset:17984
  ds_read_b64_tr_b16 v[42:43], v161 offset:19264
  v_mfma_f32_32x32x16_bf16 v[128:143], v[20:23], a[116:119], v[128:143]
  s_waitcnt vmcnt(14) lgkmcnt(6)
  ds_read_b64_tr_b16 v[44:45], v162
  ds_read_b64_tr_b16 v[46:47], v163
  v_add_u32 v162, v162, v219
  v_add_u32 v163, v163, v219
  v_mfma_f32_32x32x16_bf16 v[96:111], v[24:27], a[120:123], v[96:111]
  ds_read_b64_tr_b16 v[16:17], v161 offset:20480
  ds_read_b64_tr_b16 v[18:19], v161 offset:21760
  v_mfma_f32_32x32x16_bf16 v[112:127], v[28:31], a[120:123], v[112:127]
  s_waitcnt vmcnt(13) lgkmcnt(6)
  ds_read_b64_tr_b16 v[20:21], v161 offset:20544
  ds_read_b64_tr_b16 v[22:23], v161 offset:21824
  v_mfma_f32_32x32x16_bf16 v[128:143], v[32:35], a[120:123], v[128:143]
  ds_read_b64_tr_b16 v[24:25], v162
  ds_read_b64_tr_b16 v[26:27], v163
  v_add_u32 v162, v162, v219
  v_add_u32 v163, v163, v219
  v_mfma_f32_32x32x16_bf16 v[96:111], v[36:39], a[124:127], v[96:111]
  s_waitcnt lgkmcnt(6)
  ds_read_b64_tr_b16 v[28:29], v161 offset:23040
  ds_read_b64_tr_b16 v[30:31], v161 offset:24320
  v_mfma_f32_32x32x16_bf16 v[112:127], v[40:43], a[124:127], v[112:127]
  ds_read_b64_tr_b16 v[32:33], v161 offset:23104
  ds_read_b64_tr_b16 v[34:35], v161 offset:24384
  v_mfma_f32_32x32x16_bf16 v[128:143], v[44:47], a[124:127], v[128:143]
  s_waitcnt vmcnt(12) lgkmcnt(6)
  ds_read_b64_tr_b16 v[36:37], v162
  ds_read_b64_tr_b16 v[38:39], v163
  v_add_u32 v162, v162, v219
  v_add_u32 v163, v163, v219
  v_mfma_f32_32x32x16_bf16 v[96:111], v[16:19], a[128:131], v[96:111]
  ds_read_b64_tr_b16 v[40:41], v161 offset:25600
  ds_read_b64_tr_b16 v[42:43], v161 offset:26880
  v_mfma_f32_32x32x16_bf16 v[112:127], v[20:23], a[128:131], v[112:127]
  s_waitcnt vmcnt(11) lgkmcnt(6)
  ds_read_b64_tr_b16 v[44:45], v161 offset:25664
  ds_read_b64_tr_b16 v[46:47], v161 offset:26944
  v_mfma_f32_32x32x16_bf16 v[128:143], v[24:27], a[128:131], v[128:143]
  ds_read_b64_tr_b16 v[16:17], v162
  ds_read_b64_tr_b16 v[18:19], v163
  v_add_u32 v162, v162, v219
  v_add_u32 v163, v163, v219
  v_mfma_f32_32x32x16_bf16 v[96:111], v[28:31], a[132:135], v[96:111]
  s_waitcnt lgkmcnt(6)
  ds_read_b64_tr_b16 v[20:21], v161 offset:28160
  ds_read_b64_tr_b16 v[22:23], v161 offset:29440
  v_mfma_f32_32x32x16_bf16 v[112:127], v[32:35], a[132:135], v[112:127]
  ds_read_b64_tr_b16 v[24:25], v161 offset:28224
  ds_read_b64_tr_b16 v[26:27], v161 offset:29504
  v_mfma_f32_32x32x16_bf16 v[128:143], v[36:39], a[132:135], v[128:143]
  s_waitcnt vmcnt(10) lgkmcnt(6)
  ds_read_b64_tr_b16 v[28:29], v162
  ds_read_b64_tr_b16 v[30:31], v163
  v_add_u32 v162, v162, v219
  v_add_u32 v163, v163, v219
  v_mfma_f32_32x32x16_bf16 v[96:111], v[40:43], a[136:139], v[96:111]
  v_mfma_f32_32x32x16_bf16 v[112:127], v[44:47], a[136:139], v[112:127]
  s_waitcnt vmcnt(9) lgkmcnt(4)
  v_mfma_f32_32x32x16_bf16 v[128:143], v[16:19], a[136:139], v[128:143]
  v_mfma_f32_32x32x16_bf16 v[96:111], v[20:23], a[140:143], v[96:111]
  s_waitcnt lgkmcnt(0)
  v_mfma_f32_32x32x16_bf16 v[112:127], v[24:27], a[140:143], v[112:127]
  v_mfma_f32_32x32x16_bf16 v[128:143], v[28:31], a[140:143], v[128:143]
  s_barrier
  s_nop 10
  v_add_f32 v216, v216, v136
  v_add_f32 v216, v216, v137
  v_lshlrev_b32 v240, 4, v9
  s_mul_i32 s44, s54, 36864
  s_lshl_b32 s45, s68, 10
  s_add_u32 s44, s44, s45
  s_add_u32 s44, s44, 9437184
  s_add_u32 s45, s44, 4096
  s_bitcmp1_b32 s7, 0
  s_cselect_b32 s45, s45, 2146435072
  s_cselect_b32 s46, 1065353216, 0
  v_mov_b32 v244, 0
  v_mov_b32 v245, 0
  v_mov_b32 v246, 0
  v_mov_b32 v247, 0
  v_lshlrev_b32 v248, 16, v180
  v_and_b32 v249, 4294901760, v180
  v_pk_add_f32 v[128:129], v[128:129], v[216:217] op_sel_hi:[1,0] neg_lo:[0,1] neg_hi:[0,1]
  v_pk_add_f32 v[128:129], v[128:129], v[248:249]
  v_pk_fma_f32 v[246:247], v[128:129], v[128:129], v[246:247]
  v_cvt_pk_bf16_f32 v180, v128, v129
  s_add_u32 m0, s42, 0
  s_nop 0
  buffer_load_dwordx4 v3, s[8:11], s24 offen offset:0 lds
  v_lshlrev_b32 v242, 16, v181
  v_and_b32 v243, 4294901760, v181
  v_pk_add_f32 v[130:131], v[130:131], v[216:217] op_sel_hi:[1,0] neg_lo:[0,1] neg_hi:[0,1]
  v_pk_add_f32 v[130:131], v[130:131], v[242:243]
  v_pk_fma_f32 v[246:247], v[130:131], v[130:131], v[246:247]
  v_cvt_pk_bf16_f32 v181, v130, v131
  v_lshlrev_b32 v248, 16, v182
  v_and_b32 v249, 4294901760, v182
  v_pk_add_f32 v[132:133], v[132:133], v[216:217] op_sel_hi:[1,0] neg_lo:[0,1] neg_hi:[0,1]
  v_pk_add_f32 v[132:133], v[132:133], v[248:249]
  v_pk_fma_f32 v[246:247], v[132:133], v[132:133], v[246:247]
  v_cvt_pk_bf16_f32 v182, v132, v133
  buffer_load_dwordx4 v3, s[8:11], s25 offen offset:1024 lds
  v_lshlrev_b32 v242, 16, v183
  v_and_b32 v243, 4294901760, v183
  v_pk_add_f32 v[134:135], v[134:135], v[216:217] op_sel_hi:[1,0] neg_lo:[0,1] neg_hi:[0,1]
  v_pk_add_f32 v[134:135], v[134:135], v[242:243]
  v_pk_fma_f32 v[246:247], v[134:135], v[134:135], v[246:247]
  v_cvt_pk_bf16_f32 v183, v134, v135
  buffer_store_dwordx4 v[180:183], v240, s[16:19], s45 offen sc1
  v_lshlrev_b32 v248, 16, v164
  v_and_b32 v249, 4294901760, v164
  v_pk_add_f32 v[96:97], v[96:97], v[216:217] op_sel_hi:[1,0] neg_lo:[0,1] neg_hi:[0,1]
  v_pk_add_f32 v[96:97], v[96:97], v[248:249]
  v_pk_fma_f32 v[244:245], v[96:97], v[96:97], v[244:245]
  v_cvt_pk_bf16_f32 v164, v96, v97
  buffer_load_dwordx4 v3, s[8:11], s26 offen offset:2048 lds
  v_lshlrev_b32 v242, 16, v165
  v_and_b32 v243, 4294901760, v165
  v_pk_add_f32 v[98:99], v[98:99], v[216:217] op_sel_hi:[1,0] neg_lo:[0,1] neg_hi:[0,1]
  v_pk_add_f32 v[98:99], v[98:99], v[242:243]
  v_pk_fma_f32 v[244:245], v[98:99], v[98:99], v[244:245]
  v_cvt_pk_bf16_f32 v165, v98, v99
  v_lshlrev_b32 v248, 16, v166
  v_and_b32 v249, 4294901760, v166
  v_pk_add_f32 v[100:101], v[100:101], v[216:217] op_sel_hi:[1,0] neg_lo:[0,1] neg_hi:[0,1]
  v_pk_add_f32 v[100:101], v[100:101], v[248:249]
  v_pk_fma_f32 v[244:245], v[100:101], v[100:101], v[244:245]
  v_cvt_pk_bf16_f32 v166, v100, v101
  buffer_load_dwordx4 v3, s[8:11], s27 offen offset:3072 lds
  v_lshlrev_b32 v242, 16, v167
  v_and_b32 v243, 4294901760, v167
  v_pk_add_f32 v[102:103], v[102:103], v[216:217] op_sel_hi:[1,0] neg_lo:[0,1] neg_hi:[0,1]
  v_pk_add_f32 v[102:103], v[102:103], v[242:243]
  v_pk_fma_f32 v[244:245], v[102:103], v[102:103], v[244:245]
  v_cvt_pk_bf16_f32 v167, v102, v103
  buffer_store_dwordx4 v[164:167], v240, s[16:19], s44 offen offset:0 sc1
  v_lshlrev_b32 v248, 16, v168
  v_and_b32 v249, 4294901760, v168
  v_pk_add_f32 v[104:105], v[104:105], v[216:217] op_sel_hi:[1,0] neg_lo:[0,1] neg_hi:[0,1]
  v_pk_add_f32 v[104:105], v[104:105], v[248:249]
  v_pk_fma_f32 v[244:245], v[104:105], v[104:105], v[244:245]
  v_cvt_pk_bf16_f32 v168, v104, v105
  s_add_u32 m0, s42, 4096
  s_nop 0
  buffer_load_dwordx4 v3, s[8:11], s28 offen offset:0 lds
  v_lshlrev_b32 v242, 16, v169
  v_and_b32 v243, 4294901760, v169
  v_pk_add_f32 v[106:107], v[106:107], v[216:217] op_sel_hi:[1,0] neg_lo:[0,1] neg_hi:[0,1]
  v_pk_add_f32 v[106:107], v[106:107], v[242:243]
  v_pk_fma_f32 v[244:245], v[106:107], v[106:107], v[244:245]
  v_cvt_pk_bf16_f32 v169, v106, v107
  v_lshlrev_b32 v248, 16, v170
  v_and_b32 v249, 4294901760, v170
  v_pk_add_f32 v[108:109], v[108:109], v[216:217] op_sel_hi:[1,0] neg_lo:[0,1] neg_hi:[0,1]
  v_pk_add_f32 v[108:109], v[108:109], v[248:249]
  v_pk_fma_f32 v[244:245], v[108:109], v[108:109], v[244:245]
  v_cvt_pk_bf16_f32 v170, v108, v109
  buffer_load_dwordx4 v3, s[8:11], s29 offen offset:1024 lds
  v_lshlrev_b32 v242, 16, v171
  v_and_b32 v243, 4294901760, v171
  v_pk_add_f32 v[110:111], v[110:111], v[216:217] op_sel_hi:[1,0] neg_lo:[0,1] neg_hi:[0,1]
  v_pk_add_f32 v[110:111], v[110:111], v[242:243]
  v_pk_fma_f32 v[244:245], v[110:111], v[110:111], v[244:245]
  v_cvt_pk_bf16_f32 v171, v110, v111
  buffer_store_dwordx4 v[168:171], v240, s[16:19], s44 offen offset:1024 sc1
  v_lshlrev_b32 v248, 16, v172
  v_and_b32 v249, 4294901760, v172
  v_pk_add_f32 v[112:113], v[112:113], v[216:217] op_sel_hi:[1,0] neg_lo:[0,1] neg_hi:[0,1]
  v_pk_add_f32 v[112:113], v[112:113], v[248:249]
  v_pk_fma_f32 v[244:245], v[112:113], v[112:113], v[244:245]
  v_cvt_pk_bf16_f32 v172, v112, v113
  buffer_load_dwordx4 v3, s[8:11], s30 offen offset:2048 lds
  v_lshlrev_b32 v242, 16, v173
  v_and_b32 v243, 4294901760, v173
  v_pk_add_f32 v[114:115], v[114:115], v[216:217] op_sel_hi:[1,0] neg_lo:[0,1] neg_hi:[0,1]
  v_pk_add_f32 v[114:115], v[114:115], v[242:243]
  v_pk_fma_f32 v[244:245], v[114:115], v[114:115], v[244:245]
  v_cvt_pk_bf16_f32 v173, v114, v115
  v_lshlrev_b32 v248, 16, v174
  v_and_b32 v249, 4294901760, v174
  v_pk_add_f32 v[116:117], v[116:117], v[216:217] op_sel_hi:[1,0] neg_lo:[0,1] neg_hi:[0,1]
  v_pk_add_f32 v[116:117], v[116:117], v[248:249]
  v_pk_fma_f32 v[244:245], v[116:117], v[116:117], v[244:245]
  v_cvt_pk_bf16_f32 v174, v116, v117
  buffer_load_dwordx4 v3, s[8:11], s31 offen offset:3072 lds
  v_lshlrev_b32 v242, 16, v175
  v_and_b32 v243, 4294901760, v175
  v_pk_add_f32 v[118:119], v[118:119], v[216:217] op_sel_hi:[1,0] neg_lo:[0,1] neg_hi:[0,1]
  v_pk_add_f32 v[118:119], v[118:119], v[242:243]
  v_pk_fma_f32 v[244:245], v[118:119], v[118:119], v[244:245]
  v_cvt_pk_bf16_f32 v175, v118, v119
  buffer_store_dwordx4 v[172:175], v240, s[16:19], s44 offen offset:2048 sc1
  v_lshlrev_b32 v248, 16, v176
  v_and_b32 v249, 4294901760, v176
  v_pk_add_f32 v[120:121], v[120:121], v[216:217] op_sel_hi:[1,0] neg_lo:[0,1] neg_hi:[0,1]
  v_pk_add_f32 v[120:121], v[120:121], v[248:249]
  v_pk_fma_f32 v[244:245], v[120:121], v[120:121], v[244:245]
  v_cvt_pk_bf16_f32 v176, v120, v121
  s_add_u32 m0, s42, 8192
  s_nop 0
  buffer_load_dwordx4 v3, s[8:11], s32 offen offset:0 lds
  v_lshlrev_b32 v242, 16, v177
  v_and_b32 v243, 4294901760, v177
  v_pk_add_f32 v[122:123], v[122:123], v[216:217] op_sel_hi:[1,0] neg_lo:[0,1] neg_hi:[0,1]
  v_pk_add_f32 v[122:123], v[122:123], v[242:243]
  v_pk_fma_f32 v[244:245], v[122:123], v[122:123], v[244:245]
  v_cvt_pk_bf16_f32 v177, v122, v123
  v_lshlrev_b32 v248, 16, v178
  v_and_b32 v249, 4294901760, v178
  v_pk_add_f32 v[124:125], v[124:125], v[216:217] op_sel_hi:[1,0] neg_lo:[0,1] neg_hi:[0,1]
  v_pk_add_f32 v[124:125], v[124:125], v[248:249]
  v_pk_fma_f32 v[244:245], v[124:125], v[124:125], v[244:245]
  v_cvt_pk_bf16_f32 v178, v124, v125
  v_subrev_u32 v3, 2654080, v3
  v_lshlrev_b32 v242, 16, v179
  v_and_b32 v243, 4294901760, v179
  v_pk_add_f32 v[126:127], v[126:127], v[216:217] op_sel_hi:[1,0] neg_lo:[0,1] neg_hi:[0,1]
  v_pk_add_f32 v[126:127], v[126:127], v[242:243]
  v_pk_fma_f32 v[244:245], v[126:127], v[126:127], v[244:245]
  v_cvt_pk_bf16_f32 v179, v126, v127
  buffer_store_dwordx4 v[176:179], v240, s[16:19], s44 offen offset:3072 sc1
  v_add_f32 v244, v244, v245
  v_add_f32 v246, v246, v247
  v_fmac_f32 v244, s46, v246
  v_mov_b32 v245, v244
  s_nop 1
  v_permlane32_swap_b32 v244, v245
  v_add_f32 v244, v244, v245
  s_lshl_b32 s45, s7, 13
  s_add_u32 s45, s45, 14188544
  buffer_store_dword v244, v215, s[16:19], s45 offen sc1
  s_cmp_eq_u32 s7, 0
  s_mov_b32 s45, 2146435072
  s_cselect_b32 s45, 14163968, s45
  buffer_store_dword v218, v215, s[16:19], s45 offen sc1
  s_add_u32 s45, s45, 8192
  buffer_store_dword v216, v215, s[16:19], s45 offen sc1
  s_add_u32 m0, s42, 36864
  s_nop 0
  buffer_load_dwordx4 v3, s[8:11], s24 offen offset:0 lds
  buffer_load_dwordx4 v3, s[8:11], s25 offen offset:1024 lds
  buffer_load_dwordx4 v3, s[8:11], s26 offen offset:2048 lds
  buffer_load_dwordx4 v3, s[8:11], s27 offen offset:3072 lds
  s_add_u32 m0, s42, 40960
  s_nop 0
  buffer_load_dwordx4 v3, s[8:11], s28 offen offset:0 lds
  buffer_load_dwordx4 v3, s[8:11], s29 offen offset:1024 lds
  buffer_load_dwordx4 v3, s[8:11], s30 offen offset:2048 lds
  buffer_load_dwordx4 v3, s[8:11], s31 offen offset:3072 lds
  s_add_u32 m0, s42, 45056
  s_nop 0
  buffer_load_dwordx4 v3, s[8:11], s32 offen offset:0 lds
  v_add_u32 v3, 2654208, v3
  s_lshl_b32 s44, s6, 3
  s_add_u32 s44, s44, s7
  s_lshl_b32 s44, s44, 7
  s_add_u32 s44, s44, 14385152
  s_waitcnt vmcnt(9)
  s_barrier
  s_cmp_lg_u32 s43, 0
  s_cbranch_scc1 L_w2_sf
  v_mov_b32 v12, s3
  v_mov_b32 v13, 0
  s_mov_b64 exec, 1
  buffer_store_dword v12, v13, s[16:19], s44 offen sc1
  s_mov_b64 exec, -1
L_w2_sf:
  s_bitcmp1_b32 s7, 0
  s_cselect_b32 s44, 39, 31
  v_min_u32 v12, s44, v9
  v_lshlrev_b32 v12, 7, v12
  s_mul_i32 s44, s54, 36864
  s_lshl_b32 s45, s68, 10
  s_add_u32 s44, s44, s45
  s_add_u32 s44, s44, 9437184
  buffer_load_dword v14, v12, s[16:19], s44 offen sc1
  s_mul_i32 s44, s54, 36864
  s_mul_i32 s52, s7, 2359296
  s_add_u32 s52, s52, s44
  s_add_u32 s52, s52, 14680064
  s_add_u32 s47, s44, 9437184
  v_lshlrev_b32 v7, 4, v9
  v_add_u32 v1, 110592, v0
  v_xor_b32 v5, 64, v1
  s_lshl_b32 s44, s6, 10
  s_add_u32 s44, s44, 14385152
  v_and_b32 v12, 7, v9
  v_lshlrev_b32 v12, 7, v12
  v_and_b32 v15, 31, v9
  v_lshlrev_b32 v15, 2, v15
  s_waitcnt vmcnt(0) lgkmcnt(0)
  s_cmp_lg_u32 s43, 0
  s_cbranch_scc1 L_w2_wf_d
  s_mov_b32 s45, 1048576
L_w2_wf:
  buffer_load_dword v13, v12, s[16:19], s44 offen sc1
  s_sub_u32 s45, s45, 1
  s_waitcnt vmcnt(0)
  v_cmp_ne_u32 vcc, s3, v13
  s_cmp_eq_u32 s45, 0
  s_cbranch_scc1 L_w2_wf_d
  s_cmp_lg_u64 vcc, 0
  s_cbranch_scc1 L_w2_wf
L_w2_wf_d:
  s_barrier
  buffer_load_dwordx4 a[0:3], v7, s[16:19], s47 offen offset:0 sc1
  buffer_load_dwordx4 a[4:7], v7, s[16:19], s47 offen offset:1024 sc1
  buffer_load_dwordx4 a[8:11], v7, s[16:19], s47 offen offset:2048 sc1
  buffer_load_dwordx4 a[12:15], v7, s[16:19], s47 offen offset:3072 sc1
  s_add_u32 s47, s47, 4096
  buffer_load_dwordx4 a[16:19], v7, s[16:19], s47 offen offset:0 sc1
  buffer_load_dwordx4 a[20:23], v7, s[16:19], s47 offen offset:1024 sc1
  buffer_load_dwordx4 a[24:27], v7, s[16:19], s47 offen offset:2048 sc1
  buffer_load_dwordx4 a[28:31], v7, s[16:19], s47 offen offset:3072 sc1
  s_add_u32 s47, s47, 4096
  buffer_load_dwordx4 a[32:35], v7, s[16:19], s47 offen offset:0 sc1
  buffer_load_dwordx4 a[36:39], v7, s[16:19], s47 offen offset:1024 sc1
  s_lshl_b32 s44, s54, 7
  s_add_u32 s44, s44, 14188544
  ds_read_b64_tr_b16 v[16:17], v1 offset:0
  ds_read_b64_tr_b16 v[18:19], v1 offset:1024
  ds_read_b64_tr_b16 v[20:21], v5 offset:0
  ds_read_b64_tr_b16 v[22:23], v5 offset:1024
  ds_read_b64_tr_b16 v[24:25], v1 offset:2048
  ds_read_b64_tr_b16 v[26:27], v1 offset:3072
  ds_read_b64_tr_b16 v[28:29], v5 offset:2048
  ds_read_b64_tr_b16 v[30:31], v5 offset:3072
  ds_read_b64_tr_b16 v[32:33], v1 offset:4096
  ds_read_b64_tr_b16 v[34:35], v1 offset:5120
  ds_read_b64_tr_b16 v[36:37], v5 offset:4096
  ds_read_b64_tr_b16 v[38:39], v5 offset:5120
  s_waitcnt lgkmcnt(8)
  s_waitcnt vmcnt(9)
  v_mfma_f32_32x32x16_bf16 v[48:63], v[16:19], a[0:3], 0
  ds_read_b64_tr_b16 v[40:41], v1 offset:6144
  ds_read_b64_tr_b16 v[42:43], v1 offset:7168
  buffer_load_dwordx4 a[40:43], v7, s[16:19], s47 offen offset:2048 sc1
  v_mfma_f32_32x32x16_bf16 v[64:79], v[20:23], a[0:3], 0
  s_waitcnt lgkmcnt(6)
  ds_read_b64_tr_b16 v[44:45], v5 offset:6144
  ds_read_b64_tr_b16 v[46:47], v5 offset:7168
  buffer_load_dwordx4 a[44:47], v7, s[16:19], s47 offen offset:3072 sc1
  s_add_u32 s47, s47, 4096
  s_waitcnt vmcnt(10)
  v_mfma_f32_32x32x16_bf16 v[48:63], v[24:27], a[4:7], v[48:63]
  ds_read_b64_tr_b16 v[16:17], v1 offset:8192
  ds_read_b64_tr_b16 v[18:19], v1 offset:9216
  v_mfma_f32_32x32x16_bf16 v[64:79], v[28:31], a[4:7], v[64:79]
  s_waitcnt lgkmcnt(6)
  ds_read_b64_tr_b16 v[20:21], v5 offset:8192
  ds_read_b64_tr_b16 v[22:23], v5 offset:9216
  buffer_load_dwordx4 a[48:51], v7, s[16:19], s47 offen offset:0 sc1
  s_waitcnt vmcnt(10)
  v_mfma_f32_32x32x16_bf16 v[48:63], v[32:35], a[8:11], v[48:63]
  ds_read_b64_tr_b16 v[24:25], v1 offset:10240
  ds_read_b64_tr_b16 v[26:27], v1 offset:11264
  v_mfma_f32_32x32x16_bf16 v[64:79], v[36:39], a[8:11], v[64:79]
  s_waitcnt lgkmcnt(6)
  ds_read_b64_tr_b16 v[28:29], v5 offset:10240
  ds_read_b64_tr_b16 v[30:31], v5 offset:11264
  buffer_load_dwordx4 a[52:55], v7, s[16:19], s47 offen offset:1024 sc1
  s_waitcnt vmcnt(10)
  v_mfma_f32_32x32x16_bf16 v[48:63], v[40:43], a[12:15], v[48:63]
  ds_read_b64_tr_b16 v[32:33], v1 offset:12288
  ds_read_b64_tr_b16 v[34:35], v1 offset:13312
  v_mfma_f32_32x32x16_bf16 v[64:79], v[44:47], a[12:15], v[64:79]
  s_waitcnt lgkmcnt(6)
  ds_read_b64_tr_b16 v[36:37], v5 offset:12288
  ds_read_b64_tr_b16 v[38:39], v5 offset:13312
  buffer_load_dwordx4 a[56:59], v7, s[16:19], s47 offen offset:2048 sc1
  s_waitcnt vmcnt(10)
  v_mfma_f32_32x32x16_bf16 v[48:63], v[16:19], a[16:19], v[48:63]
  ds_read_b64_tr_b16 v[40:41], v1 offset:14336
  ds_read_b64_tr_b16 v[42:43], v1 offset:15360
  v_mfma_f32_32x32x16_bf16 v[64:79], v[20:23], a[16:19], v[64:79]
  s_waitcnt lgkmcnt(6)
  ds_read_b64_tr_b16 v[44:45], v5 offset:14336
  ds_read_b64_tr_b16 v[46:47], v5 offset:15360
  buffer_load_dwordx4 a[60:63], v7, s[16:19], s47 offen offset:3072 sc1
  s_add_u32 s47, s47, 4096
  s_waitcnt vmcnt(10)
  v_mfma_f32_32x32x16_bf16 v[48:63], v[24:27], a[20:23], v[48:63]
  ds_read_b64_tr_b16 v[16:17], v1 offset:16384
  ds_read_b64_tr_b16 v[18:19], v1 offset:17408
  buffer_load_dwordx4 a[64:67], v7, s[16:19], s47 offen offset:0 sc1
  v_mfma_f32_32x32x16_bf16 v[64:79], v[28:31], a[20:23], v[64:79]
  s_waitcnt lgkmcnt(6)
  ds_read_b64_tr_b16 v[20:21], v5 offset:16384
  ds_read_b64_tr_b16 v[22:23], v5 offset:17408
  s_waitcnt vmcnt(10)
  v_mfma_f32_32x32x16_bf16 v[48:63], v[32:35], a[24:27], v[48:63]
  ds_read_b64_tr_b16 v[24:25], v1 offset:18432
  ds_read_b64_tr_b16 v[26:27], v1 offset:19456
  buffer_load_dwordx4 a[68:71], v7, s[16:19], s47 offen offset:1024 sc1
  v_mfma_f32_32x32x16_bf16 v[64:79], v[36:39], a[24:27], v[64:79]
  s_waitcnt lgkmcnt(6)
  ds_read_b64_tr_b16 v[28:29], v5 offset:18432
  ds_read_b64_tr_b16 v[30:31], v5 offset:19456
  s_waitcnt vmcnt(10)
  v_mfma_f32_32x32x16_bf16 v[48:63], v[40:43], a[28:31], v[48:63]
  ds_read_b64_tr_b16 v[32:33], v1 offset:20480
  ds_read_b64_tr_b16 v[34:35], v1 offset:21504
  buffer_load_dwordx4 a[72:75], v7, s[16:19], s47 offen offset:2048 sc1
  v_mfma_f32_32x32x16_bf16 v[64:79], v[44:47], a[28:31], v[64:79]
  s_waitcnt lgkmcnt(6)
  ds_read_b64_tr_b16 v[36:37], v5 offset:20480
  ds_read_b64_tr_b16 v[38:39], v5 offset:21504
  s_waitcnt vmcnt(10)
  v_mfma_f32_32x32x16_bf16 v[48:63], v[16:19], a[32:35], v[48:63]
  ds_read_b64_tr_b16 v[40:41], v1 offset:22528
  ds_read_b64_tr_b16 v[42:43], v1 offset:23552
  buffer_load_dwordx4 a[76:79], v7, s[16:19], s47 offen offset:3072 sc1
  s_add_u32 s47, s47, 4096
  v_mfma_f32_32x32x16_bf16 v[64:79], v[20:23], a[32:35], v[64:79]
  s_waitcnt lgkmcnt(6)
  ds_read_b64_tr_b16 v[44:45], v5 offset:22528
  ds_read_b64_tr_b16 v[46:47], v5 offset:23552
  s_waitcnt vmcnt(10)
  v_mfma_f32_32x32x16_bf16 v[48:63], v[24:27], a[36:39], v[48:63]
  ds_read_b64_tr_b16 v[16:17], v1 offset:24576
  ds_read_b64_tr_b16 v[18:19], v1 offset:25600
  buffer_load_dwordx4 a[80:83], v7, s[16:19], s47 offen offset:0 sc1
  v_mfma_f32_32x32x16_bf16 v[64:79], v[28:31], a[36:39], v[64:79]
  s_waitcnt lgkmcnt(6)
  ds_read_b64_tr_b16 v[20:21], v5 offset:24576
  ds_read_b64_tr_b16 v[22:23], v5 offset:25600
  buffer_load_dwordx4 a[84:87], v7, s[16:19], s47 offen offset:1024 sc1
  s_waitcnt vmcnt(11)
  v_mfma_f32_32x32x16_bf16 v[48:63], v[32:35], a[40:43], v[48:63]
  ds_read_b64_tr_b16 v[24:25], v1 offset:26624
  ds_read_b64_tr_b16 v[26:27], v1 offset:27648
  v_mfma_f32_32x32x16_bf16 v[64:79], v[36:39], a[40:43], v[64:79]
  s_waitcnt lgkmcnt(6)
  ds_read_b64_tr_b16 v[28:29], v5 offset:26624
  ds_read_b64_tr_b16 v[30:31], v5 offset:27648
  buffer_load_dwordx4 a[88:91], v7, s[16:19], s47 offen offset:2048 sc1
  s_waitcnt vmcnt(11)
  v_mfma_f32_32x32x16_bf16 v[48:63], v[40:43], a[44:47], v[48:63]
  ds_read_b64_tr_b16 v[32:33], v1 offset:28672
  ds_read_b64_tr_b16 v[34:35], v1 offset:29696
  v_mfma_f32_32x32x16_bf16 v[64:79], v[44:47], a[44:47], v[64:79]
  s_waitcnt lgkmcnt(6)
  ds_read_b64_tr_b16 v[36:37], v5 offset:28672
  ds_read_b64_tr_b16 v[38:39], v5 offset:29696
  buffer_load_dwordx4 a[92:95], v7, s[16:19], s47 offen offset:3072 sc1
  s_add_u32 s47, s47, 4096
  s_waitcnt vmcnt(11)
  v_mfma_f32_32x32x16_bf16 v[48:63], v[16:19], a[48:51], v[48:63]
  ds_read_b64_tr_b16 v[40:41], v1 offset:30720
  ds_read_b64_tr_b16 v[42:43], v1 offset:31744
  v_mfma_f32_32x32x16_bf16 v[64:79], v[20:23], a[48:51], v[64:79]
  s_waitcnt lgkmcnt(6)
  ds_read_b64_tr_b16 v[44:45], v5 offset:30720
  ds_read_b64_tr_b16 v[46:47], v5 offset:31744
  buffer_load_dwordx4 a[96:99], v7, s[16:19], s47 offen offset:0 sc1
  s_waitcnt vmcnt(11)
  v_mfma_f32_32x32x16_bf16 v[48:63], v[24:27], a[52:55], v[48:63]
  ds_read_b64_tr_b16 v[16:17], v1 offset:32768
  ds_read_b64_tr_b16 v[18:19], v1 offset:33792
  v_mfma_f32_32x32x16_bf16 v[64:79], v[28:31], a[52:55], v[64:79]
  s_waitcnt lgkmcnt(6)
  ds_read_b64_tr_b16 v[20:21], v5 offset:32768
  ds_read_b64_tr_b16 v[22:23], v5 offset:33792
  buffer_load_dwordx4 a[100:103], v7, s[16:19], s47 offen offset:1024 sc1
  s_waitcnt vmcnt(11)
  v_mfma_f32_32x32x16_bf16 v[48:63], v[32:35], a[56:59], v[48:63]
  ds_read_b64_tr_b16 v[24:25], v1 offset:34816
  ds_read_b64_tr_b16 v[26:27], v1 offset:35840
  buffer_load_dwordx4 a[104:107], v7, s[16:19], s47 offen offset:2048 sc1
  v_mfma_f32_32x32x16_bf16 v[64:79], v[36:39], a[56:59], v[64:79]
  s_waitcnt lgkmcnt(6)
  ds_read_b64_tr_b16 v[28:29], v5 offset:34816
  ds_read_b64_tr_b16 v[30:31], v5 offset:35840
  v_add_u32 v2, 0, v0
  v_xor_b32 v11, 64, v2
  s_waitcnt vmcnt(11)
  v_mfma_f32_32x32x16_bf16 v[48:63], v[40:43], a[60:63], v[48:63]
  buffer_load_dwordx4 a[108:111], v7, s[16:19], s47 offen offset:3072 sc1
  s_add_u32 s47, s47, 4096
  v_mfma_f32_32x32x16_bf16 v[64:79], v[44:47], a[60:63], v[64:79]
  s_waitcnt vmcnt(63) lgkmcnt(0)
  s_barrier
  ds_read_b64_tr_b16 v[32:33], v2 offset:0
  ds_read_b64_tr_b16 v[34:35], v2 offset:1024
  ds_read_b64_tr_b16 v[36:37], v11 offset:0
  ds_read_b64_tr_b16 v[38:39], v11 offset:1024
  s_waitcnt vmcnt(11)
  v_mfma_f32_32x32x16_bf16 v[48:63], v[16:19], a[64:67], v[48:63]
  ds_read_b64_tr_b16 v[40:41], v2 offset:2048
  ds_read_b64_tr_b16 v[42:43], v2 offset:3072
  buffer_load_dwordx4 a[112:115], v7, s[16:19], s47 offen offset:0 sc1
  v_mfma_f32_32x32x16_bf16 v[64:79], v[20:23], a[64:67], v[64:79]
  s_waitcnt lgkmcnt(6)
  ds_read_b64_tr_b16 v[44:45], v11 offset:2048
  ds_read_b64_tr_b16 v[46:47], v11 offset:3072
  s_waitcnt vmcnt(11)
  v_mfma_f32_32x32x16_bf16 v[48:63], v[24:27], a[68:71], v[48:63]
  ds_read_b64_tr_b16 v[16:17], v2 offset:4096
  ds_read_b64_tr_b16 v[18:19], v2 offset:5120
  buffer_load_dwordx4 a[116:119], v7, s[16:19], s47 offen offset:1024 sc1
  v_mfma_f32_32x32x16_bf16 v[64:79], v[28:31], a[68:71], v[64:79]
  s_waitcnt lgkmcnt(6)
  ds_read_b64_tr_b16 v[20:21], v11 offset:4096
  ds_read_b64_tr_b16 v[22:23], v11 offset:5120
  s_waitcnt vmcnt(11)
  v_mfma_f32_32x32x16_bf16 v[48:63], v[32:35], a[72:75], v[48:63]
  ds_read_b64_tr_b16 v[24:25], v2 offset:6144
  ds_read_b64_tr_b16 v[26:27], v2 offset:7168
  buffer_load_dwordx4 a[120:123], v7, s[16:19], s47 offen offset:2048 sc1
  v_mfma_f32_32x32x16_bf16 v[64:79], v[36:39], a[72:75], v[64:79]
  s_waitcnt lgkmcnt(6)
  ds_read_b64_tr_b16 v[28:29], v11 offset:6144
  ds_read_b64_tr_b16 v[30:31], v11 offset:7168
  buffer_load_dwordx4 a[124:127], v7, s[16:19], s47 offen offset:3072 sc1
  s_add_u32 s47, s47, 4096
  s_waitcnt vmcnt(12)
  v_mfma_f32_32x32x16_bf16 v[48:63], v[40:43], a[76:79], v[48:63]
  ds_read_b64_tr_b16 v[32:33], v2 offset:8192
  ds_read_b64_tr_b16 v[34:35], v2 offset:9216
  buffer_load_dwordx4 a[128:131], v7, s[16:19], s47 offen offset:0 sc1
  v_mfma_f32_32x32x16_bf16 v[64:79], v[44:47], a[76:79], v[64:79]
  s_waitcnt lgkmcnt(6)
  ds_read_b64_tr_b16 v[36:37], v11 offset:8192
  ds_read_b64_tr_b16 v[38:39], v11 offset:9216
  buffer_load_dwordx4 a[132:135], v7, s[16:19], s47 offen offset:1024 sc1
  s_waitcnt vmcnt(13)
  v_mfma_f32_32x32x16_bf16 v[48:63], v[16:19], a[80:83], v[48:63]
  ds_read_b64_tr_b16 v[40:41], v2 offset:10240
  ds_read_b64_tr_b16 v[42:43], v2 offset:11264
  buffer_load_dwordx4 a[136:139], v7, s[16:19], s47 offen offset:2048 sc1
  v_mfma_f32_32x32x16_bf16 v[64:79], v[20:23], a[80:83], v[64:79]
  s_waitcnt lgkmcnt(6)
  ds_read_b64_tr_b16 v[44:45], v11 offset:10240
  ds_read_b64_tr_b16 v[46:47], v11 offset:11264
  buffer_load_dwordx4 a[140:143], v7, s[16:19], s47 offen offset:3072 sc1
  s_add_u32 s47, s47, 4096
  s_waitcnt vmcnt(14)
  v_mfma_f32_32x32x16_bf16 v[48:63], v[24:27], a[84:87], v[48:63]
  ds_read_b64_tr_b16 v[16:17], v2 offset:12288
  ds_read_b64_tr_b16 v[18:19], v2 offset:13312
  buffer_load_dword v240, v15, s[16:19], s44 offen sc1
  s_add_u32 s44, s44, 8192
  v_mfma_f32_32x32x16_bf16 v[64:79], v[28:31], a[84:87], v[64:79]
  s_waitcnt lgkmcnt(6)
  ds_read_b64_tr_b16 v[20:21], v11 offset:12288
  ds_read_b64_tr_b16 v[22:23], v11 offset:13312
  buffer_load_dword v241, v15, s[16:19], s44 offen sc1
  s_add_u32 s44, s44, 8192
  s_waitcnt vmcnt(15)
  v_mfma_f32_32x32x16_bf16 v[48:63], v[32:35], a[88:91], v[48:63]
  ds_read_b64_tr_b16 v[24:25], v2 offset:14336
  ds_read_b64_tr_b16 v[26:27], v2 offset:15360
  buffer_load_dword v242, v15, s[16:19], s44 offen sc1
  s_add_u32 s44, s44, 8192
  v_mfma_f32_32x32x16_bf16 v[64:79], v[36:39], a[88:91], v[64:79]
  s_waitcnt lgkmcnt(6)
  ds_read_b64_tr_b16 v[28:29], v11 offset:14336
  ds_read_b64_tr_b16 v[30:31], v11 offset:15360
  buffer_load_dword v243, v15, s[16:19], s44 offen sc1
  s_add_u32 s44, s44, 8192
  s_waitcnt vmcnt(16)
  v_mfma_f32_32x32x16_bf16 v[48:63], v[40:43], a[92:95], v[48:63]
  ds_read_b64_tr_b16 v[32:33], v2 offset:16384
  ds_read_b64_tr_b16 v[34:35], v2 offset:17408
  buffer_load_dword v244, v15, s[16:19], s44 offen sc1
  s_add_u32 s44, s44, 8192
  v_mfma_f32_32x32x16_bf16 v[64:79], v[44:47], a[92:95], v[64:79]
  s_waitcnt lgkmcnt(6)
  ds_read_b64_tr_b16 v[36:37], v11 offset:16384
  ds_read_b64_tr_b16 v[38:39], v11 offset:17408
  buffer_load_dword v245, v15, s[16:19], s44 offen sc1
  s_add_u32 s44, s44, 8192
  s_waitcnt vmcnt(17)
  v_mfma_f32_32x32x16_bf16 v[48:63], v[16:19], a[96:99], v[48:63]
  ds_read_b64_tr_b16 v[40:41], v2 offset:18432
  ds_read_b64_tr_b16 v[42:43], v2 offset:19456
  buffer_load_dword v246, v15, s[16:19], s44 offen sc1
  s_add_u32 s44, s44, 8192
  v_mfma_f32_32x32x16_bf16 v[64:79], v[20:23], a[96:99], v[64:79]
  s_waitcnt lgkmcnt(6)
  ds_read_b64_tr_b16 v[44:45], v11 offset:18432
  ds_read_b64_tr_b16 v[46:47], v11 offset:19456
  buffer_load_dword v247, v15, s[16:19], s44 offen sc1
  s_add_u32 s44, s44, 8192
  s_waitcnt vmcnt(18)
  v_mfma_f32_32x32x16_bf16 v[48:63], v[24:27], a[100:103], v[48:63]
  s_add_u32 m0, s42, 73728
  ds_read_b64_tr_b16 v[16:17], v2 offset:20480
  ds_read_b64_tr_b16 v[18:19], v2 offset:21504
  buffer_load_dwordx4 v3, s[8:11], s24 offen offset:0 lds
  v_mfma_f32_32x32x16_bf16 v[64:79], v[28:31], a[100:103], v[64:79]
  s_waitcnt lgkmcnt(6)
  ds_read_b64_tr_b16 v[20:21], v11 offset:20480
  ds_read_b64_tr_b16 v[22:23], v11 offset:21504
  buffer_load_dwordx4 v3, s[8:11], s25 offen offset:1024 lds
  s_waitcnt vmcnt(19)
  v_mfma_f32_32x32x16_bf16 v[48:63], v[32:35], a[104:107], v[48:63]
  ds_read_b64_tr_b16 v[24:25], v2 offset:22528
  ds_read_b64_tr_b16 v[26:27], v2 offset:23552
  buffer_load_dwordx4 v3, s[8:11], s26 offen offset:2048 lds
  v_mfma_f32_32x32x16_bf16 v[64:79], v[36:39], a[104:107], v[64:79]
  s_waitcnt lgkmcnt(6)
  ds_read_b64_tr_b16 v[28:29], v11 offset:22528
  ds_read_b64_tr_b16 v[30:31], v11 offset:23552
  s_waitcnt vmcnt(19)
  v_mfma_f32_32x32x16_bf16 v[48:63], v[40:43], a[108:111], v[48:63]
  ds_read_b64_tr_b16 v[32:33], v2 offset:24576
  ds_read_b64_tr_b16 v[34:35], v2 offset:25600
  buffer_load_dwordx4 v3, s[8:11], s27 offen offset:3072 lds
  v_mfma_f32_32x32x16_bf16 v[64:79], v[44:47], a[108:111], v[64:79]
  s_waitcnt lgkmcnt(6)
  ds_read_b64_tr_b16 v[36:37], v11 offset:24576
  ds_read_b64_tr_b16 v[38:39], v11 offset:25600
  s_add_u32 m0, s42, 77824
  s_nop 0
  buffer_load_dwordx4 v3, s[8:11], s28 offen offset:0 lds
  s_waitcnt vmcnt(20)
  v_mfma_f32_32x32x16_bf16 v[48:63], v[16:19], a[112:115], v[48:63]
  ds_read_b64_tr_b16 v[40:41], v2 offset:26624
  ds_read_b64_tr_b16 v[42:43], v2 offset:27648
  buffer_load_dwordx4 v3, s[8:11], s29 offen offset:1024 lds
  v_mfma_f32_32x32x16_bf16 v[64:79], v[20:23], a[112:115], v[64:79]
  s_waitcnt lgkmcnt(6)
  ds_read_b64_tr_b16 v[44:45], v11 offset:26624
  ds_read_b64_tr_b16 v[46:47], v11 offset:27648
  buffer_load_dwordx4 v3, s[8:11], s30 offen offset:2048 lds
  s_waitcnt vmcnt(21)
  v_mfma_f32_32x32x16_bf16 v[48:63], v[24:27], a[116:119], v[48:63]
  ds_read_b64_tr_b16 v[16:17], v2 offset:28672
  ds_read_b64_tr_b16 v[18:19], v2 offset:29696
  buffer_load_dwordx4 v3, s[8:11], s31 offen offset:3072 lds
  v_mfma_f32_32x32x16_bf16 v[64:79], v[28:31], a[116:119], v[64:79]
  s_waitcnt lgkmcnt(6)
  ds_read_b64_tr_b16 v[20:21], v11 offset:28672
  ds_read_b64_tr_b16 v[22:23], v11 offset:29696
  s_add_u32 m0, s42, 81920
  s_nop 0
  buffer_load_dwordx4 v3, s[8:11], s32 offen offset:0 lds
  s_waitcnt vmcnt(22)
  v_mfma_f32_32x32x16_bf16 v[48:63], v[32:35], a[120:123], v[48:63]
  ds_read_b64_tr_b16 v[24:25], v2 offset:30720
  ds_read_b64_tr_b16 v[26:27], v2 offset:31744
  v_subrev_u32 v3, 2654080, v3
  v_mfma_f32_32x32x16_bf16 v[64:79], v[36:39], a[120:123], v[64:79]
  s_waitcnt lgkmcnt(6)
  ds_read_b64_tr_b16 v[28:29], v11 offset:30720
  ds_read_b64_tr_b16 v[30:31], v11 offset:31744
  s_add_u32 m0, s42, 110592
  s_nop 0
  buffer_load_dwordx4 v3, s[8:11], s24 offen offset:0 lds
  s_waitcnt vmcnt(22)
  v_mfma_f32_32x32x16_bf16 v[48:63], v[40:43], a[124:127], v[48:63]
  ds_read_b64_tr_b16 v[32:33], v2 offset:32768
  ds_read_b64_tr_b16 v[34:35], v2 offset:33792
  buffer_load_dwordx4 v3, s[8:11], s25 offen offset:1024 lds
  v_mfma_f32_32x32x16_bf16 v[64:79], v[44:47], a[124:127], v[64:79]
  s_waitcnt lgkmcnt(6)
  ds_read_b64_tr_b16 v[36:37], v11 offset:32768
  ds_read_b64_tr_b16 v[38:39], v11 offset:33792
  buffer_load_dwordx4 v3, s[8:11], s26 offen offset:2048 lds
  s_waitcnt vmcnt(23)
  v_mfma_f32_32x32x16_bf16 v[48:63], v[16:19], a[128:131], v[48:63]
  ds_read_b64_tr_b16 v[40:41], v2 offset:34816
  ds_read_b64_tr_b16 v[42:43], v2 offset:35840
  buffer_load_dwordx4 v3, s[8:11], s27 offen offset:3072 lds
  v_mfma_f32_32x32x16_bf16 v[64:79], v[20:23], a[128:131], v[64:79]
  s_waitcnt lgkmcnt(6)
  ds_read_b64_tr_b16 v[44:45], v11 offset:34816
  ds_read_b64_tr_b16 v[46:47], v11 offset:35840
  s_add_u32 m0, s42, 114688
  s_nop 0
  buffer_load_dwordx4 v3, s[8:11], s28 offen offset:0 lds
  v_add_u32 v1, 36864, v0
  v_xor_b32 v5, 64, v1
  s_waitcnt vmcnt(24)
  v_mfma_f32_32x32x16_bf16 v[48:63], v[24:27], a[132:135], v[48:63]
  buffer_load_dwordx4 v3, s[8:11], s29 offen offset:1024 lds
  s_waitcnt vmcnt(21)
  v_add_f32 v240, v240, v241
  s_waitcnt vmcnt(20)
  v_add_f32 v240, v240, v242
  s_waitcnt vmcnt(19)
  v_add_f32 v240, v240, v243
  s_waitcnt vmcnt(18)
  v_add_f32 v240, v240, v244
  s_waitcnt vmcnt(17)
  v_add_f32 v240, v240, v245
  v_mfma_f32_32x32x16_bf16 v[64:79], v[28:31], a[132:135], v[64:79]
  s_waitcnt vmcnt(63) lgkmcnt(0)
  s_barrier
  ds_read_b64_tr_b16 v[16:17], v1 offset:0
  ds_read_b64_tr_b16 v[18:19], v1 offset:1024
  ds_read_b64_tr_b16 v[20:21], v5 offset:0
  ds_read_b64_tr_b16 v[22:23], v5 offset:1024
  buffer_load_dwordx4 v3, s[8:11], s30 offen offset:2048 lds
  v_mfma_f32_32x32x16_bf16 v[48:63], v[32:35], a[136:139], v[48:63]
  ds_read_b64_tr_b16 v[24:25], v1 offset:2048
  ds_read_b64_tr_b16 v[26:27], v1 offset:3072
  buffer_load_dwordx4 v3, s[8:11], s31 offen offset:3072 lds
  s_waitcnt vmcnt(18)
  v_add_f32 v240, v240, v246
  s_waitcnt vmcnt(17)
  v_add_f32 v240, v240, v247
  v_mfma_f32_32x32x16_bf16 v[64:79], v[36:39], a[136:139], v[64:79]
  s_waitcnt lgkmcnt(6)
  ds_read_b64_tr_b16 v[28:29], v5 offset:2048
  ds_read_b64_tr_b16 v[30:31], v5 offset:3072
  s_add_u32 m0, s42, 118784
  s_nop 0
  buffer_load_dwordx4 v3, s[8:11], s32 offen offset:0 lds
  v_mov_b32 v241, 925353388
  v_mfma_f32_32x32x16_bf16 v[48:63], v[40:43], a[140:143], v[48:63]
  ds_read_b64_tr_b16 v[32:33], v1 offset:4096
  ds_read_b64_tr_b16 v[34:35], v1 offset:5120
  v_add_u32 v3, 2654208, v3
  v_fmac_f32 v241, 987991609, v240
  v_sqrt_f32 v10, v241
  v_rsq_f32 v242, v241
  v_mfma_f32_32x32x16_bf16 v[64:79], v[44:47], a[140:143], v[64:79]
  s_waitcnt lgkmcnt(6)
  ds_read_b64_tr_b16 v[36:37], v5 offset:4096
  ds_read_b64_tr_b16 v[38:39], v5 offset:5120
  v_mov_b32 v244, 1027024659
  v_mul_f32 v6, 3222493025, v242
  v_mul_f32 v243, v242, v242
  v_mul_f32 v243, v244, v243
  v_mul_f32 v8, v6, v243
  v_mfma_f32_32x32x16_bf16 v[80:95], v[16:19], a[0:3], 0
  ds_read_b64_tr_b16 v[40:41], v1 offset:6144
  ds_read_b64_tr_b16 v[42:43], v1 offset:7168
  v_mfma_f32_32x32x16_bf16 v[96:111], v[20:23], a[0:3], 0
  s_waitcnt lgkmcnt(6)
  ds_read_b64_tr_b16 v[44:45], v5 offset:6144
  ds_read_b64_tr_b16 v[46:47], v5 offset:7168
  v_mfma_f32_32x32x16_bf16 v[80:95], v[24:27], a[4:7], v[80:95]
  s_add_u32 m0, s42, 0
  ds_read_b64_tr_b16 v[16:17], v1 offset:8192
  ds_read_b64_tr_b16 v[18:19], v1 offset:9216
  buffer_load_dwordx4 v3, s[8:11], s24 offen offset:0 lds
  v_mul_f32 v12, v48, v48
  v_mul_f32 v13, v49, v49
  v_mfma_f32_32x32x16_bf16 v[96:111], v[28:31], a[4:7], v[96:111]
  s_waitcnt lgkmcnt(6)
  ds_read_b64_tr_b16 v[20:21], v5 offset:8192
  ds_read_b64_tr_b16 v[22:23], v5 offset:9216
  v_fma_f32 v12, v12, v8, v6
  v_fma_f32 v13, v13, v8, v6
  v_mul_f32 v12, v12, v48
  v_mul_f32 v13, v13, v49
  v_exp_f32 v12, v12
  v_mfma_f32_32x32x16_bf16 v[80:95], v[32:35], a[8:11], v[80:95]
  ds_read_b64_tr_b16 v[24:25], v1 offset:10240
  ds_read_b64_tr_b16 v[26:27], v1 offset:11264
  v_exp_f32 v13, v13
  v_fma_f32 v12, v12, v10, v10
  v_mfma_f32_32x32x16_bf16 v[96:111], v[36:39], a[8:11], v[96:111]
  s_waitcnt lgkmcnt(6)
  ds_read_b64_tr_b16 v[28:29], v5 offset:10240
  ds_read_b64_tr_b16 v[30:31], v5 offset:11264
  buffer_load_dwordx4 v3, s[8:11], s25 offen offset:1024 lds
  v_fma_f32 v13, v13, v10, v10
  v_rcp_f32 v12, v12
  v_rcp_f32 v13, v13
  v_mfma_f32_32x32x16_bf16 v[80:95], v[40:43], a[12:15], v[80:95]
  ds_read_b64_tr_b16 v[32:33], v1 offset:12288
  ds_read_b64_tr_b16 v[34:35], v1 offset:13312
  v_mul_f32 v12, v12, v48
  v_mul_f32 v13, v13, v49
  v_cvt_pk_bf16_f32 v112, v12, v13
  v_mul_f32 v14, v50, v50
  v_mul_f32 v15, v51, v51
  v_mfma_f32_32x32x16_bf16 v[96:111], v[44:47], a[12:15], v[96:111]
  s_waitcnt lgkmcnt(6)
  ds_read_b64_tr_b16 v[36:37], v5 offset:12288
  ds_read_b64_tr_b16 v[38:39], v5 offset:13312
  v_fma_f32 v14, v14, v8, v6
  v_fma_f32 v15, v15, v8, v6
  v_mul_f32 v14, v14, v50
  v_mul_f32 v15, v15, v51
  v_mfma_f32_32x32x16_bf16 v[80:95], v[16:19], a[16:19], v[80:95]
  ds_read_b64_tr_b16 v[40:41], v1 offset:14336
  ds_read_b64_tr_b16 v[42:43], v1 offset:15360
  buffer_load_dwordx4 v3, s[8:11], s26 offen offset:2048 lds
  v_exp_f32 v14, v14
  v_exp_f32 v15, v15
  v_fma_f32 v14, v14, v10, v10
  v_mfma_f32_32x32x16_bf16 v[96:111], v[20:23], a[16:19], v[96:111]
  s_waitcnt lgkmcnt(6)
  ds_read_b64_tr_b16 v[44:45], v5 offset:14336
  ds_read_b64_tr_b16 v[46:47], v5 offset:15360
  v_fma_f32 v15, v15, v10, v10
  v_rcp_f32 v14, v14
  v_rcp_f32 v15, v15
  v_mfma_f32_32x32x16_bf16 v[80:95], v[24:27], a[20:23], v[80:95]
  ds_read_b64_tr_b16 v[16:17], v1 offset:16384
  ds_read_b64_tr_b16 v[18:19], v1 offset:17408
  v_mul_f32 v14, v14, v50
  v_mul_f32 v15, v15, v51
  v_cvt_pk_bf16_f32 v113, v14, v15
  v_mul_f32 v12, v52, v52
  v_mfma_f32_32x32x16_bf16 v[96:111], v[28:31], a[20:23], v[96:111]
  s_waitcnt lgkmcnt(6)
  ds_read_b64_tr_b16 v[20:21], v5 offset:16384
  ds_read_b64_tr_b16 v[22:23], v5 offset:17408
  buffer_load_dwordx4 v3, s[8:11], s27 offen offset:3072 lds
  v_mul_f32 v13, v53, v53
  v_fma_f32 v12, v12, v8, v6
  v_fma_f32 v13, v13, v8, v6
  v_mul_f32 v12, v12, v52
  v_mul_f32 v13, v13, v53
  v_mfma_f32_32x32x16_bf16 v[80:95], v[32:35], a[24:27], v[80:95]
  ds_read_b64_tr_b16 v[24:25], v1 offset:18432
  ds_read_b64_tr_b16 v[26:27], v1 offset:19456
  v_exp_f32 v12, v12
  v_exp_f32 v13, v13
  v_mfma_f32_32x32x16_bf16 v[96:111], v[36:39], a[24:27], v[96:111]
  s_waitcnt lgkmcnt(6)
  ds_read_b64_tr_b16 v[28:29], v5 offset:18432
  ds_read_b64_tr_b16 v[30:31], v5 offset:19456
  v_fma_f32 v12, v12, v10, v10
  v_fma_f32 v13, v13, v10, v10
  v_rcp_f32 v12, v12
  v_rcp_f32 v13, v13
  v_mfma_f32_32x32x16_bf16 v[80:95], v[40:43], a[28:31], v[80:95]
  s_add_u32 m0, s42, 4096
  ds_read_b64_tr_b16 v[32:33], v1 offset:20480
  ds_read_b64_tr_b16 v[34:35], v1 offset:21504
  buffer_load_dwordx4 v3, s[8:11], s28 offen offset:0 lds
  v_mul_f32 v12, v12, v52
  v_mul_f32 v13, v13, v53
  v_cvt_pk_bf16_f32 v114, v12, v13
  v_mfma_f32_32x32x16_bf16 v[96:111], v[44:47], a[28:31], v[96:111]
  s_waitcnt lgkmcnt(6)
  ds_read_b64_tr_b16 v[36:37], v5 offset:20480
  ds_read_b64_tr_b16 v[38:39], v5 offset:21504
  v_mul_f32 v14, v54, v54
  v_mul_f32 v15, v55, v55
  v_fma_f32 v14, v14, v8, v6
  v_fma_f32 v15, v15, v8, v6
  v_mul_f32 v14, v14, v54
  v_mfma_f32_32x32x16_bf16 v[80:95], v[16:19], a[32:35], v[80:95]
  ds_read_b64_tr_b16 v[40:41], v1 offset:22528
  ds_read_b64_tr_b16 v[42:43], v1 offset:23552
  v_mul_f32 v15, v15, v55
  v_exp_f32 v14, v14
  v_exp_f32 v15, v15
  v_mfma_f32_32x32x16_bf16 v[96:111], v[20:23], a[32:35], v[96:111]
  s_waitcnt lgkmcnt(6)
  ds_read_b64_tr_b16 v[44:45], v5 offset:22528
  ds_read_b64_tr_b16 v[46:47], v5 offset:23552
  buffer_load_dwordx4 v3, s[8:11], s29 offen offset:1024 lds
  v_fma_f32 v14, v14, v10, v10
  v_fma_f32 v15, v15, v10, v10
  v_rcp_f32 v14, v14
  v_mfma_f32_32x32x16_bf16 v[80:95], v[24:27], a[36:39], v[80:95]
  ds_read_b64_tr_b16 v[16:17], v1 offset:24576
  ds_read_b64_tr_b16 v[18:19], v1 offset:25600
  v_rcp_f32 v15, v15
  v_mul_f32 v14, v14, v54
  v_mul_f32 v15, v15, v55
  v_cvt_pk_bf16_f32 v115, v14, v15
  v_mfma_f32_32x32x16_bf16 v[96:111], v[28:31], a[36:39], v[96:111]
  s_waitcnt lgkmcnt(6)
  ds_read_b64_tr_b16 v[20:21], v5 offset:24576
  ds_read_b64_tr_b16 v[22:23], v5 offset:25600
  v_mul_f32 v12, v56, v56
  v_mul_f32 v13, v57, v57
  v_fma_f32 v12, v12, v8, v6
  v_fma_f32 v13, v13, v8, v6
  v_mfma_f32_32x32x16_bf16 v[80:95], v[32:35], a[40:43], v[80:95]
  ds_read_b64_tr_b16 v[24:25], v1 offset:26624
  ds_read_b64_tr_b16 v[26:27], v1 offset:27648
  buffer_load_dwordx4 v3, s[8:11], s30 offen offset:2048 lds
  v_mul_f32 v12, v12, v56
  v_mul_f32 v13, v13, v57
  v_exp_f32 v12, v12
  v_exp_f32 v13, v13
  v_mfma_f32_32x32x16_bf16 v[96:111], v[36:39], a[40:43], v[96:111]
  s_waitcnt lgkmcnt(6)
  ds_read_b64_tr_b16 v[28:29], v5 offset:26624
  ds_read_b64_tr_b16 v[30:31], v5 offset:27648
  v_fma_f32 v12, v12, v10, v10
  v_fma_f32 v13, v13, v10, v10
  v_rcp_f32 v12, v12
  v_mfma_f32_32x32x16_bf16 v[80:95], v[40:43], a[44:47], v[80:95]
  ds_read_b64_tr_b16 v[32:33], v1 offset:28672
  ds_read_b64_tr_b16 v[34:35], v1 offset:29696
  v_rcp_f32 v13, v13
  v_mul_f32 v12, v12, v56
  v_mul_f32 v13, v13, v57
  v_mfma_f32_32x32x16_bf16 v[96:111], v[44:47], a[44:47], v[96:111]
  s_waitcnt lgkmcnt(6)
  ds_read_b64_tr_b16 v[36:37], v5 offset:28672
  ds_read_b64_tr_b16 v[38:39], v5 offset:29696
  buffer_load_dwordx4 v3, s[8:11], s31 offen offset:3072 lds
  v_cvt_pk_bf16_f32 v116, v12, v13
  v_mul_f32 v14, v58, v58
  v_mul_f32 v15, v59, v59
  v_fma_f32 v14, v14, v8, v6
  v_fma_f32 v15, v15, v8, v6
  v_mfma_f32_32x32x16_bf16 v[80:95], v[16:19], a[48:51], v[80:95]
  ds_read_b64_tr_b16 v[40:41], v1 offset:30720
  ds_read_b64_tr_b16 v[42:43], v1 offset:31744
  v_mul_f32 v14, v14, v58
  v_mul_f32 v15, v15, v59
  v_exp_f32 v14, v14
  v_mfma_f32_32x32x16_bf16 v[96:111], v[20:23], a[48:51], v[96:111]
  s_waitcnt lgkmcnt(6)
  ds_read_b64_tr_b16 v[44:45], v5 offset:30720
  ds_read_b64_tr_b16 v[46:47], v5 offset:31744
  v_exp_f32 v15, v15
  v_fma_f32 v14, v14, v10, v10
  v_fma_f32 v15, v15, v10, v10
  v_rcp_f32 v14, v14
  v_mfma_f32_32x32x16_bf16 v[80:95], v[24:27], a[52:55], v[80:95]
  s_add_u32 m0, s42, 8192
  ds_read_b64_tr_b16 v[16:17], v1 offset:32768
  ds_read_b64_tr_b16 v[18:19], v1 offset:33792
  buffer_load_dwordx4 v3, s[8:11], s32 offen offset:0 lds
  v_rcp_f32 v15, v15
  v_mul_f32 v14, v14, v58
  v_mul_f32 v15, v15, v59
  v_mfma_f32_32x32x16_bf16 v[96:111], v[28:31], a[52:55], v[96:111]
  s_waitcnt lgkmcnt(6)
  ds_read_b64_tr_b16 v[20:21], v5 offset:32768
  ds_read_b64_tr_b16 v[22:23], v5 offset:33792
  v_cvt_pk_bf16_f32 v117, v14, v15
  v_mul_f32 v12, v60, v60
  v_mul_f32 v13, v61, v61
  v_fma_f32 v12, v12, v8, v6
  v_mfma_f32_32x32x16_bf16 v[80:95], v[32:35], a[56:59], v[80:95]
  ds_read_b64_tr_b16 v[24:25], v1 offset:34816
  ds_read_b64_tr_b16 v[26:27], v1 offset:35840
  v_fma_f32 v13, v13, v8, v6
  v_mul_f32 v12, v12, v60
  v_mul_f32 v13, v13, v61
  v_exp_f32 v12, v12
  v_mfma_f32_32x32x16_bf16 v[96:111], v[36:39], a[56:59], v[96:111]
  s_waitcnt lgkmcnt(6)
  ds_read_b64_tr_b16 v[28:29], v5 offset:34816
  ds_read_b64_tr_b16 v[30:31], v5 offset:35840
  v_subrev_u32 v3, 2654080, v3
  v_add_u32 v2, 73728, v0
  v_xor_b32 v11, 64, v2
  v_exp_f32 v13, v13
  v_fma_f32 v12, v12, v10, v10
  v_fma_f32 v13, v13, v10, v10
  v_mfma_f32_32x32x16_bf16 v[80:95], v[40:43], a[60:63], v[80:95]
  v_rcp_f32 v12, v12
  v_rcp_f32 v13, v13
  v_mul_f32 v12, v12, v60
  v_mul_f32 v13, v13, v61
  v_mfma_f32_32x32x16_bf16 v[96:111], v[44:47], a[60:63], v[96:111]
  s_waitcnt vmcnt(18) lgkmcnt(0)
  s_barrier
  ds_read_b64_tr_b16 v[32:33], v2 offset:0
  ds_read_b64_tr_b16 v[34:35], v2 offset:1024
  ds_read_b64_tr_b16 v[36:37], v11 offset:0
  ds_read_b64_tr_b16 v[38:39], v11 offset:1024
  v_cvt_pk_bf16_f32 v118, v12, v13
  v_mul_f32 v14, v62, v62
  v_mul_f32 v15, v63, v63
  v_fma_f32 v14, v14, v8, v6
  v_mfma_f32_32x32x16_bf16 v[80:95], v[16:19], a[64:67], v[80:95]
  ds_read_b64_tr_b16 v[40:41], v2 offset:2048
  ds_read_b64_tr_b16 v[42:43], v2 offset:3072
  v_fma_f32 v15, v15, v8, v6
  v_mul_f32 v14, v14, v62
  v_mul_f32 v15, v15, v63
  v_exp_f32 v14, v14
  v_mfma_f32_32x32x16_bf16 v[96:111], v[20:23], a[64:67], v[96:111]
  s_waitcnt lgkmcnt(6)
  ds_read_b64_tr_b16 v[44:45], v11 offset:2048
  ds_read_b64_tr_b16 v[46:47], v11 offset:3072
  v_exp_f32 v15, v15
  v_fma_f32 v14, v14, v10, v10
  v_fma_f32 v15, v15, v10, v10
  v_mfma_f32_32x32x16_bf16 v[80:95], v[24:27], a[68:71], v[80:95]
  ds_read_b64_tr_b16 v[16:17], v2 offset:4096
  ds_read_b64_tr_b16 v[18:19], v2 offset:5120
  v_rcp_f32 v14, v14
  v_rcp_f32 v15, v15
  v_mul_f32 v14, v14, v62
  v_mul_f32 v15, v15, v63
  v_cvt_pk_bf16_f32 v119, v14, v15
  v_mfma_f32_32x32x16_bf16 v[96:111], v[28:31], a[68:71], v[96:111]
  s_waitcnt lgkmcnt(6)
  ds_read_b64_tr_b16 v[20:21], v11 offset:4096
  ds_read_b64_tr_b16 v[22:23], v11 offset:5120
  v_mfma_f32_32x32x16_bf16 v[80:95], v[32:35], a[72:75], v[80:95]
  ds_read_b64_tr_b16 v[24:25], v2 offset:6144
  ds_read_b64_tr_b16 v[26:27], v2 offset:7168
  v_mfma_f32_32x32x16_bf16 v[96:111], v[36:39], a[72:75], v[96:111]
  s_waitcnt lgkmcnt(6)
  ds_read_b64_tr_b16 v[28:29], v11 offset:6144
  ds_read_b64_tr_b16 v[30:31], v11 offset:7168
  v_mfma_f32_32x32x16_bf16 v[80:95], v[40:43], a[76:79], v[80:95]
  s_add_u32 m0, s42, 36864
  ds_read_b64_tr_b16 v[32:33], v2 offset:8192
  ds_read_b64_tr_b16 v[34:35], v2 offset:9216
  buffer_load_dwordx4 v3, s[8:11], s24 offen offset:0 lds
  v_mul_f32 v12, v64, v64
  v_mul_f32 v13, v65, v65
  v_mfma_f32_32x32x16_bf16 v[96:111], v[44:47], a[76:79], v[96:111]
  s_waitcnt lgkmcnt(6)
  ds_read_b64_tr_b16 v[36:37], v11 offset:8192
  ds_read_b64_tr_b16 v[38:39], v11 offset:9216
  v_fma_f32 v12, v12, v8, v6
  v_fma_f32 v13, v13, v8, v6
  v_mul_f32 v12, v12, v64
  v_mul_f32 v13, v13, v65
  v_exp_f32 v12, v12
  v_mfma_f32_32x32x16_bf16 v[80:95], v[16:19], a[80:83], v[80:95]
  ds_read_b64_tr_b16 v[40:41], v2 offset:10240
  ds_read_b64_tr_b16 v[42:43], v2 offset:11264
  v_exp_f32 v13, v13
  v_fma_f32 v12, v12, v10, v10
  v_mfma_f32_32x32x16_bf16 v[96:111], v[20:23], a[80:83], v[96:111]
  s_waitcnt lgkmcnt(6)
  ds_read_b64_tr_b16 v[44:45], v11 offset:10240
  ds_read_b64_tr_b16 v[46:47], v11 offset:11264
  buffer_load_dwordx4 v3, s[8:11], s25 offen offset:1024 lds
  v_fma_f32 v13, v13, v10, v10
  v_rcp_f32 v12, v12
  v_rcp_f32 v13, v13
  v_mfma_f32_32x32x16_bf16 v[80:95], v[24:27], a[84:87], v[80:95]
  ds_read_b64_tr_b16 v[16:17], v2 offset:12288
  ds_read_b64_tr_b16 v[18:19], v2 offset:13312
  v_mul_f32 v12, v12, v64
  v_mul_f32 v13, v13, v65
  v_cvt_pk_bf16_f32 v120, v12, v13
  v_mul_f32 v14, v66, v66
  v_mul_f32 v15, v67, v67
  v_mfma_f32_32x32x16_bf16 v[96:111], v[28:31], a[84:87], v[96:111]
  s_waitcnt lgkmcnt(6)
  ds_read_b64_tr_b16 v[20:21], v11 offset:12288
  ds_read_b64_tr_b16 v[22:23], v11 offset:13312
  v_fma_f32 v14, v14, v8, v6
  v_fma_f32 v15, v15, v8, v6
  v_mul_f32 v14, v14, v66
  v_mul_f32 v15, v15, v67
  v_mfma_f32_32x32x16_bf16 v[80:95], v[32:35], a[88:91], v[80:95]
  ds_read_b64_tr_b16 v[24:25], v2 offset:14336
  ds_read_b64_tr_b16 v[26:27], v2 offset:15360
  buffer_load_dwordx4 v3, s[8:11], s26 offen offset:2048 lds
  v_exp_f32 v14, v14
  v_exp_f32 v15, v15
  v_fma_f32 v14, v14, v10, v10
  v_mfma_f32_32x32x16_bf16 v[96:111], v[36:39], a[88:91], v[96:111]
  s_waitcnt lgkmcnt(6)
  ds_read_b64_tr_b16 v[28:29], v11 offset:14336
  ds_read_b64_tr_b16 v[30:31], v11 offset:15360
  v_fma_f32 v15, v15, v10, v10
  v_rcp_f32 v14, v14
  v_rcp_f32 v15, v15
  v_mfma_f32_32x32x16_bf16 v[80:95], v[40:43], a[92:95], v[80:95]
  ds_read_b64_tr_b16 v[32:33], v2 offset:16384
  ds_read_b64_tr_b16 v[34:35], v2 offset:17408
  v_mul_f32 v14, v14, v66
  v_mul_f32 v15, v15, v67
  v_cvt_pk_bf16_f32 v121, v14, v15
  v_mul_f32 v12, v68, v68
  v_mfma_f32_32x32x16_bf16 v[96:111], v[44:47], a[92:95], v[96:111]
  s_waitcnt lgkmcnt(6)
  ds_read_b64_tr_b16 v[36:37], v11 offset:16384
  ds_read_b64_tr_b16 v[38:39], v11 offset:17408
  buffer_load_dwordx4 v3, s[8:11], s27 offen offset:3072 lds
  v_mul_f32 v13, v69, v69
  v_fma_f32 v12, v12, v8, v6
  v_fma_f32 v13, v13, v8, v6
  v_mul_f32 v12, v12, v68
  v_mul_f32 v13, v13, v69
  v_mfma_f32_32x32x16_bf16 v[80:95], v[16:19], a[96:99], v[80:95]
  ds_read_b64_tr_b16 v[40:41], v2 offset:18432
  ds_read_b64_tr_b16 v[42:43], v2 offset:19456
  v_exp_f32 v12, v12
  v_exp_f32 v13, v13
  v_mfma_f32_32x32x16_bf16 v[96:111], v[20:23], a[96:99], v[96:111]
  s_waitcnt lgkmcnt(6)
  ds_read_b64_tr_b16 v[44:45], v11 offset:18432
  ds_read_b64_tr_b16 v[46:47], v11 offset:19456
  v_fma_f32 v12, v12, v10, v10
  v_fma_f32 v13, v13, v10, v10
  v_rcp_f32 v12, v12
  v_rcp_f32 v13, v13
  v_mfma_f32_32x32x16_bf16 v[80:95], v[24:27], a[100:103], v[80:95]
  s_add_u32 m0, s42, 40960
  ds_read_b64_tr_b16 v[16:17], v2 offset:20480
  ds_read_b64_tr_b16 v[18:19], v2 offset:21504
  buffer_load_dwordx4 v3, s[8:11], s28 offen offset:0 lds
  v_mul_f32 v12, v12, v68
  v_mul_f32 v13, v13, v69
  v_cvt_pk_bf16_f32 v122, v12, v13
  v_mfma_f32_32x32x16_bf16 v[96:111], v[28:31], a[100:103], v[96:111]
  s_waitcnt lgkmcnt(6)
  ds_read_b64_tr_b16 v[20:21], v11 offset:20480
  ds_read_b64_tr_b16 v[22:23], v11 offset:21504
  v_mul_f32 v14, v70, v70
  v_mul_f32 v15, v71, v71
  v_fma_f32 v14, v14, v8, v6
  v_fma_f32 v15, v15, v8, v6
  v_mul_f32 v14, v14, v70
  v_mfma_f32_32x32x16_bf16 v[80:95], v[32:35], a[104:107], v[80:95]
  ds_read_b64_tr_b16 v[24:25], v2 offset:22528
  ds_read_b64_tr_b16 v[26:27], v2 offset:23552
  v_mul_f32 v15, v15, v71
  v_exp_f32 v14, v14
  v_exp_f32 v15, v15
  v_mfma_f32_32x32x16_bf16 v[96:111], v[36:39], a[104:107], v[96:111]
  s_waitcnt lgkmcnt(6)
  ds_read_b64_tr_b16 v[28:29], v11 offset:22528
  ds_read_b64_tr_b16 v[30:31], v11 offset:23552
  buffer_load_dwordx4 v3, s[8:11], s29 offen offset:1024 lds
  v_fma_f32 v14, v14, v10, v10
  v_fma_f32 v15, v15, v10, v10
  v_rcp_f32 v14, v14
  v_mfma_f32_32x32x16_bf16 v[80:95], v[40:43], a[108:111], v[80:95]
  ds_read_b64_tr_b16 v[32:33], v2 offset:24576
  ds_read_b64_tr_b16 v[34:35], v2 offset:25600
  v_rcp_f32 v15, v15
  v_mul_f32 v14, v14, v70
  v_mul_f32 v15, v15, v71
  v_cvt_pk_bf16_f32 v123, v14, v15
  v_mfma_f32_32x32x16_bf16 v[96:111], v[44:47], a[108:111], v[96:111]
  s_waitcnt lgkmcnt(6)
  ds_read_b64_tr_b16 v[36:37], v11 offset:24576
  ds_read_b64_tr_b16 v[38:39], v11 offset:25600
  v_mul_f32 v12, v72, v72
  v_mul_f32 v13, v73, v73
  v_fma_f32 v12, v12, v8, v6
  v_fma_f32 v13, v13, v8, v6
  v_mfma_f32_32x32x16_bf16 v[80:95], v[16:19], a[112:115], v[80:95]
  ds_read_b64_tr_b16 v[40:41], v2 offset:26624
  ds_read_b64_tr_b16 v[42:43], v2 offset:27648
  buffer_load_dwordx4 v3, s[8:11], s30 offen offset:2048 lds
  v_mul_f32 v12, v12, v72
  v_mul_f32 v13, v13, v73
  v_exp_f32 v12, v12
  v_exp_f32 v13, v13
  v_mfma_f32_32x32x16_bf16 v[96:111], v[20:23], a[112:115], v[96:111]
  s_waitcnt lgkmcnt(6)
  ds_read_b64_tr_b16 v[44:45], v11 offset:26624
  ds_read_b64_tr_b16 v[46:47], v11 offset:27648
  v_fma_f32 v12, v12, v10, v10
  v_fma_f32 v13, v13, v10, v10
  v_rcp_f32 v12, v12
  v_mfma_f32_32x32x16_bf16 v[80:95], v[24:27], a[116:119], v[80:95]
  ds_read_b64_tr_b16 v[16:17], v2 offset:28672
  ds_read_b64_tr_b16 v[18:19], v2 offset:29696
  v_rcp_f32 v13, v13
  v_mul_f32 v12, v12, v72
  v_mul_f32 v13, v13, v73
  v_mfma_f32_32x32x16_bf16 v[96:111], v[28:31], a[116:119], v[96:111]
  s_waitcnt lgkmcnt(6)
  ds_read_b64_tr_b16 v[20:21], v11 offset:28672
  ds_read_b64_tr_b16 v[22:23], v11 offset:29696
  buffer_load_dwordx4 v3, s[8:11], s31 offen offset:3072 lds
  v_cvt_pk_bf16_f32 v124, v12, v13
  v_mul_f32 v14, v74, v74
  v_mul_f32 v15, v75, v75
  v_fma_f32 v14, v14, v8, v6
  v_fma_f32 v15, v15, v8, v6
  v_mfma_f32_32x32x16_bf16 v[80:95], v[32:35], a[120:123], v[80:95]
  ds_read_b64_tr_b16 v[24:25], v2 offset:30720
  ds_read_b64_tr_b16 v[26:27], v2 offset:31744
  v_mul_f32 v14, v14, v74
  v_mul_f32 v15, v15, v75
  v_exp_f32 v14, v14
  v_mfma_f32_32x32x16_bf16 v[96:111], v[36:39], a[120:123], v[96:111]
  s_waitcnt lgkmcnt(6)
  ds_read_b64_tr_b16 v[28:29], v11 offset:30720
  ds_read_b64_tr_b16 v[30:31], v11 offset:31744
  v_exp_f32 v15, v15
  v_fma_f32 v14, v14, v10, v10
  v_fma_f32 v15, v15, v10, v10
  v_rcp_f32 v14, v14
  v_mfma_f32_32x32x16_bf16 v[80:95], v[40:43], a[124:127], v[80:95]
  s_add_u32 m0, s42, 45056
  ds_read_b64_tr_b16 v[32:33], v2 offset:32768
  ds_read_b64_tr_b16 v[34:35], v2 offset:33792
  buffer_load_dwordx4 v3, s[8:11], s32 offen offset:0 lds
  v_rcp_f32 v15, v15
  v_mul_f32 v14, v14, v74
  v_mul_f32 v15, v15, v75
  v_mfma_f32_32x32x16_bf16 v[96:111], v[44:47], a[124:127], v[96:111]
  s_waitcnt lgkmcnt(6)
  ds_read_b64_tr_b16 v[36:37], v11 offset:32768
  ds_read_b64_tr_b16 v[38:39], v11 offset:33792
  v_cvt_pk_bf16_f32 v125, v14, v15
  v_mul_f32 v12, v76, v76
  v_mul_f32 v13, v77, v77
  v_fma_f32 v12, v12, v8, v6
  v_mfma_f32_32x32x16_bf16 v[80:95], v[16:19], a[128:131], v[80:95]
  ds_read_b64_tr_b16 v[40:41], v2 offset:34816
  ds_read_b64_tr_b16 v[42:43], v2 offset:35840
  v_fma_f32 v13, v13, v8, v6
  v_mul_f32 v12, v12, v76
  v_mul_f32 v13, v13, v77
  v_exp_f32 v12, v12
  v_mfma_f32_32x32x16_bf16 v[96:111], v[20:23], a[128:131], v[96:111]
  s_waitcnt lgkmcnt(6)
  ds_read_b64_tr_b16 v[44:45], v11 offset:34816
  ds_read_b64_tr_b16 v[46:47], v11 offset:35840
  v_add_u32 v3, 2654208, v3
  v_add_u32 v1, 110592, v0
  v_xor_b32 v5, 64, v1
  v_exp_f32 v13, v13
  v_fma_f32 v12, v12, v10, v10
  v_fma_f32 v13, v13, v10, v10
  v_mfma_f32_32x32x16_bf16 v[80:95], v[24:27], a[132:135], v[80:95]
  v_rcp_f32 v12, v12
  v_rcp_f32 v13, v13
  v_mul_f32 v12, v12, v76
  v_mul_f32 v13, v13, v77
  v_mfma_f32_32x32x16_bf16 v[96:111], v[28:31], a[132:135], v[96:111]
  s_waitcnt vmcnt(18) lgkmcnt(0)
  s_barrier
  ds_read_b64_tr_b16 v[16:17], v1 offset:0
  ds_read_b64_tr_b16 v[18:19], v1 offset:1024
  ds_read_b64_tr_b16 v[20:21], v5 offset:0
  ds_read_b64_tr_b16 v[22:23], v5 offset:1024
  v_cvt_pk_bf16_f32 v126, v12, v13
  v_mul_f32 v14, v78, v78
  v_mul_f32 v15, v79, v79
  v_fma_f32 v14, v14, v8, v6
  v_mfma_f32_32x32x16_bf16 v[80:95], v[32:35], a[136:139], v[80:95]
  ds_read_b64_tr_b16 v[24:25], v1 offset:2048
  ds_read_b64_tr_b16 v[26:27], v1 offset:3072
  v_fma_f32 v15, v15, v8, v6
  v_mul_f32 v14, v14, v78
  v_mul_f32 v15, v15, v79
  v_exp_f32 v14, v14
  v_mfma_f32_32x32x16_bf16 v[96:111], v[36:39], a[136:139], v[96:111]
  s_waitcnt lgkmcnt(6)
  ds_read_b64_tr_b16 v[28:29], v5 offset:2048
  ds_read_b64_tr_b16 v[30:31], v5 offset:3072
  v_exp_f32 v15, v15
  v_fma_f32 v14, v14, v10, v10
  v_fma_f32 v15, v15, v10, v10
  v_mfma_f32_32x32x16_bf16 v[80:95], v[40:43], a[140:143], v[80:95]
  ds_read_b64_tr_b16 v[32:33], v1 offset:4096
  ds_read_b64_tr_b16 v[34:35], v1 offset:5120
  v_rcp_f32 v14, v14
  v_rcp_f32 v15, v15
  v_mul_f32 v14, v14, v78
  v_mul_f32 v15, v15, v79
  v_cvt_pk_bf16_f32 v127, v14, v15
  v_mfma_f32_32x32x16_bf16 v[96:111], v[44:47], a[140:143], v[96:111]
  s_waitcnt lgkmcnt(6)
  ds_read_b64_tr_b16 v[36:37], v5 offset:4096
  ds_read_b64_tr_b16 v[38:39], v5 offset:5120
  v_mfma_f32_32x32x16_bf16 v[48:63], v[16:19], a[0:3], 0
  ds_read_b64_tr_b16 v[40:41], v1 offset:6144
  ds_read_b64_tr_b16 v[42:43], v1 offset:7168
  v_mfma_f32_32x32x16_bf16 v[64:79], v[20:23], a[0:3], 0
  s_waitcnt lgkmcnt(6)
  ds_read_b64_tr_b16 v[44:45], v5 offset:6144
  ds_read_b64_tr_b16 v[46:47], v5 offset:7168
  v_mfma_f32_32x32x16_bf16 v[48:63], v[24:27], a[4:7], v[48:63]
  s_add_u32 m0, s42, 73728
  ds_read_b64_tr_b16 v[16:17], v1 offset:8192
  ds_read_b64_tr_b16 v[18:19], v1 offset:9216
  buffer_load_dwordx4 v3, s[8:11], s24 offen offset:0 lds
  v_mul_f32 v12, v80, v80
  v_mul_f32 v13, v81, v81
  v_mfma_f32_32x32x16_bf16 v[64:79], v[28:31], a[4:7], v[64:79]
  s_waitcnt lgkmcnt(6)
  ds_read_b64_tr_b16 v[20:21], v5 offset:8192
  ds_read_b64_tr_b16 v[22:23], v5 offset:9216
  v_fma_f32 v12, v12, v8, v6
  v_fma_f32 v13, v13, v8, v6
  v_mul_f32 v12, v12, v80
  v_mul_f32 v13, v13, v81
  v_exp_f32 v12, v12
  v_mfma_f32_32x32x16_bf16 v[48:63], v[32:35], a[8:11], v[48:63]
  ds_read_b64_tr_b16 v[24:25], v1 offset:10240
  ds_read_b64_tr_b16 v[26:27], v1 offset:11264
  v_exp_f32 v13, v13
  v_fma_f32 v12, v12, v10, v10
  v_mfma_f32_32x32x16_bf16 v[64:79], v[36:39], a[8:11], v[64:79]
  s_waitcnt lgkmcnt(6)
  ds_read_b64_tr_b16 v[28:29], v5 offset:10240
  ds_read_b64_tr_b16 v[30:31], v5 offset:11264
  buffer_load_dwordx4 v3, s[8:11], s25 offen offset:1024 lds
  v_fma_f32 v13, v13, v10, v10
  v_rcp_f32 v12, v12
  v_rcp_f32 v13, v13
  v_mfma_f32_32x32x16_bf16 v[48:63], v[40:43], a[12:15], v[48:63]
  ds_read_b64_tr_b16 v[32:33], v1 offset:12288
  ds_read_b64_tr_b16 v[34:35], v1 offset:13312
  v_mul_f32 v12, v12, v80
  v_mul_f32 v13, v13, v81
  v_cvt_pk_bf16_f32 v128, v12, v13
  v_mul_f32 v14, v82, v82
  v_mul_f32 v15, v83, v83
  v_mfma_f32_32x32x16_bf16 v[64:79], v[44:47], a[12:15], v[64:79]
  s_waitcnt lgkmcnt(6)
  ds_read_b64_tr_b16 v[36:37], v5 offset:12288
  ds_read_b64_tr_b16 v[38:39], v5 offset:13312
  v_fma_f32 v14, v14, v8, v6
  v_fma_f32 v15, v15, v8, v6
  v_mul_f32 v14, v14, v82
  v_mul_f32 v15, v15, v83
  v_mfma_f32_32x32x16_bf16 v[48:63], v[16:19], a[16:19], v[48:63]
  ds_read_b64_tr_b16 v[40:41], v1 offset:14336
  ds_read_b64_tr_b16 v[42:43], v1 offset:15360
  buffer_load_dwordx4 v3, s[8:11], s26 offen offset:2048 lds
  v_exp_f32 v14, v14
  v_exp_f32 v15, v15
  v_fma_f32 v14, v14, v10, v10
  v_mfma_f32_32x32x16_bf16 v[64:79], v[20:23], a[16:19], v[64:79]
  s_waitcnt lgkmcnt(6)
  ds_read_b64_tr_b16 v[44:45], v5 offset:14336
  ds_read_b64_tr_b16 v[46:47], v5 offset:15360
  v_fma_f32 v15, v15, v10, v10
  v_rcp_f32 v14, v14
  v_rcp_f32 v15, v15
  v_mfma_f32_32x32x16_bf16 v[48:63], v[24:27], a[20:23], v[48:63]
  ds_read_b64_tr_b16 v[16:17], v1 offset:16384
  ds_read_b64_tr_b16 v[18:19], v1 offset:17408
  v_mul_f32 v14, v14, v82
  v_mul_f32 v15, v15, v83
  v_cvt_pk_bf16_f32 v129, v14, v15
  v_mul_f32 v12, v84, v84
  v_mfma_f32_32x32x16_bf16 v[64:79], v[28:31], a[20:23], v[64:79]
  s_waitcnt lgkmcnt(6)
  ds_read_b64_tr_b16 v[20:21], v5 offset:16384
  ds_read_b64_tr_b16 v[22:23], v5 offset:17408
  buffer_load_dwordx4 v3, s[8:11], s27 offen offset:3072 lds
  v_mul_f32 v13, v85, v85
  v_fma_f32 v12, v12, v8, v6
  v_fma_f32 v13, v13, v8, v6
  v_mul_f32 v12, v12, v84
  v_mul_f32 v13, v13, v85
  v_mfma_f32_32x32x16_bf16 v[48:63], v[32:35], a[24:27], v[48:63]
  ds_read_b64_tr_b16 v[24:25], v1 offset:18432
  ds_read_b64_tr_b16 v[26:27], v1 offset:19456
  v_exp_f32 v12, v12
  v_exp_f32 v13, v13
  v_mfma_f32_32x32x16_bf16 v[64:79], v[36:39], a[24:27], v[64:79]
  s_waitcnt lgkmcnt(6)
  ds_read_b64_tr_b16 v[28:29], v5 offset:18432
  ds_read_b64_tr_b16 v[30:31], v5 offset:19456
  v_fma_f32 v12, v12, v10, v10
  v_fma_f32 v13, v13, v10, v10
  v_rcp_f32 v12, v12
  v_rcp_f32 v13, v13
  v_mfma_f32_32x32x16_bf16 v[48:63], v[40:43], a[28:31], v[48:63]
  s_add_u32 m0, s42, 77824
  ds_read_b64_tr_b16 v[32:33], v1 offset:20480
  ds_read_b64_tr_b16 v[34:35], v1 offset:21504
  buffer_load_dwordx4 v3, s[8:11], s28 offen offset:0 lds
  v_mul_f32 v12, v12, v84
  v_mul_f32 v13, v13, v85
  v_cvt_pk_bf16_f32 v130, v12, v13
  v_mfma_f32_32x32x16_bf16 v[64:79], v[44:47], a[28:31], v[64:79]
  s_waitcnt lgkmcnt(6)
  ds_read_b64_tr_b16 v[36:37], v5 offset:20480
  ds_read_b64_tr_b16 v[38:39], v5 offset:21504
  v_mul_f32 v14, v86, v86
  v_mul_f32 v15, v87, v87
  v_fma_f32 v14, v14, v8, v6
  v_fma_f32 v15, v15, v8, v6
  v_mul_f32 v14, v14, v86
  v_mfma_f32_32x32x16_bf16 v[48:63], v[16:19], a[32:35], v[48:63]
  ds_read_b64_tr_b16 v[40:41], v1 offset:22528
  ds_read_b64_tr_b16 v[42:43], v1 offset:23552
  v_mul_f32 v15, v15, v87
  v_exp_f32 v14, v14
  v_exp_f32 v15, v15
  v_mfma_f32_32x32x16_bf16 v[64:79], v[20:23], a[32:35], v[64:79]
  s_waitcnt lgkmcnt(6)
  ds_read_b64_tr_b16 v[44:45], v5 offset:22528
  ds_read_b64_tr_b16 v[46:47], v5 offset:23552
  buffer_load_dwordx4 v3, s[8:11], s29 offen offset:1024 lds
  v_fma_f32 v14, v14, v10, v10
  v_fma_f32 v15, v15, v10, v10
  v_rcp_f32 v14, v14
  v_mfma_f32_32x32x16_bf16 v[48:63], v[24:27], a[36:39], v[48:63]
  ds_read_b64_tr_b16 v[16:17], v1 offset:24576
  ds_read_b64_tr_b16 v[18:19], v1 offset:25600
  v_rcp_f32 v15, v15
  v_mul_f32 v14, v14, v86
  v_mul_f32 v15, v15, v87
  v_cvt_pk_bf16_f32 v131, v14, v15
  v_mfma_f32_32x32x16_bf16 v[64:79], v[28:31], a[36:39], v[64:79]
  s_waitcnt lgkmcnt(6)
  ds_read_b64_tr_b16 v[20:21], v5 offset:24576
  ds_read_b64_tr_b16 v[22:23], v5 offset:25600
  v_mul_f32 v12, v88, v88
  v_mul_f32 v13, v89, v89
  v_fma_f32 v12, v12, v8, v6
  v_fma_f32 v13, v13, v8, v6
  v_mfma_f32_32x32x16_bf16 v[48:63], v[32:35], a[40:43], v[48:63]
  ds_read_b64_tr_b16 v[24:25], v1 offset:26624
  ds_read_b64_tr_b16 v[26:27], v1 offset:27648
  buffer_load_dwordx4 v3, s[8:11], s30 offen offset:2048 lds
  v_mul_f32 v12, v12, v88
  v_mul_f32 v13, v13, v89
  v_exp_f32 v12, v12
  v_exp_f32 v13, v13
  v_mfma_f32_32x32x16_bf16 v[64:79], v[36:39], a[40:43], v[64:79]
  s_waitcnt lgkmcnt(6)
  ds_read_b64_tr_b16 v[28:29], v5 offset:26624
  ds_read_b64_tr_b16 v[30:31], v5 offset:27648
  v_fma_f32 v12, v12, v10, v10
  v_fma_f32 v13, v13, v10, v10
  v_rcp_f32 v12, v12
  v_mfma_f32_32x32x16_bf16 v[48:63], v[40:43], a[44:47], v[48:63]
  ds_read_b64_tr_b16 v[32:33], v1 offset:28672
  ds_read_b64_tr_b16 v[34:35], v1 offset:29696
  v_rcp_f32 v13, v13
  v_mul_f32 v12, v12, v88
  v_mul_f32 v13, v13, v89
  v_mfma_f32_32x32x16_bf16 v[64:79], v[44:47], a[44:47], v[64:79]
  s_waitcnt lgkmcnt(6)
  ds_read_b64_tr_b16 v[36:37], v5 offset:28672
  ds_read_b64_tr_b16 v[38:39], v5 offset:29696
  buffer_load_dwordx4 v3, s[8:11], s31 offen offset:3072 lds
  v_cvt_pk_bf16_f32 v132, v12, v13
  v_mul_f32 v14, v90, v90
  v_mul_f32 v15, v91, v91
  v_fma_f32 v14, v14, v8, v6
  v_fma_f32 v15, v15, v8, v6
  v_mfma_f32_32x32x16_bf16 v[48:63], v[16:19], a[48:51], v[48:63]
  ds_read_b64_tr_b16 v[40:41], v1 offset:30720
  ds_read_b64_tr_b16 v[42:43], v1 offset:31744
  v_mul_f32 v14, v14, v90
  v_mul_f32 v15, v15, v91
  v_exp_f32 v14, v14
  v_mfma_f32_32x32x16_bf16 v[64:79], v[20:23], a[48:51], v[64:79]
  s_waitcnt lgkmcnt(6)
  ds_read_b64_tr_b16 v[44:45], v5 offset:30720
  ds_read_b64_tr_b16 v[46:47], v5 offset:31744
  v_exp_f32 v15, v15
  v_fma_f32 v14, v14, v10, v10
  v_fma_f32 v15, v15, v10, v10
  v_rcp_f32 v14, v14
  v_mfma_f32_32x32x16_bf16 v[48:63], v[24:27], a[52:55], v[48:63]
  s_add_u32 m0, s42, 81920
  ds_read_b64_tr_b16 v[16:17], v1 offset:32768
  ds_read_b64_tr_b16 v[18:19], v1 offset:33792
  buffer_load_dwordx4 v3, s[8:11], s32 offen offset:0 lds
  v_rcp_f32 v15, v15
  v_mul_f32 v14, v14, v90
  v_mul_f32 v15, v15, v91
  v_mfma_f32_32x32x16_bf16 v[64:79], v[28:31], a[52:55], v[64:79]
  s_waitcnt lgkmcnt(6)
  ds_read_b64_tr_b16 v[20:21], v5 offset:32768
  ds_read_b64_tr_b16 v[22:23], v5 offset:33792
  v_cvt_pk_bf16_f32 v133, v14, v15
  v_mul_f32 v12, v92, v92
  v_mul_f32 v13, v93, v93
  v_fma_f32 v12, v12, v8, v6
  v_mfma_f32_32x32x16_bf16 v[48:63], v[32:35], a[56:59], v[48:63]
  ds_read_b64_tr_b16 v[24:25], v1 offset:34816
  ds_read_b64_tr_b16 v[26:27], v1 offset:35840
  v_fma_f32 v13, v13, v8, v6
  v_mul_f32 v12, v12, v92
  v_mul_f32 v13, v13, v93
  v_exp_f32 v12, v12
  v_mfma_f32_32x32x16_bf16 v[64:79], v[36:39], a[56:59], v[64:79]
  s_waitcnt lgkmcnt(6)
  ds_read_b64_tr_b16 v[28:29], v5 offset:34816
  ds_read_b64_tr_b16 v[30:31], v5 offset:35840
  v_subrev_u32 v3, 2654080, v3
  v_add_u32 v2, 0, v0
  v_xor_b32 v11, 64, v2
  v_exp_f32 v13, v13
  v_fma_f32 v12, v12, v10, v10
  v_fma_f32 v13, v13, v10, v10
  v_mfma_f32_32x32x16_bf16 v[48:63], v[40:43], a[60:63], v[48:63]
  v_rcp_f32 v12, v12
  v_rcp_f32 v13, v13
  v_mul_f32 v12, v12, v92
  v_mul_f32 v13, v13, v93
  v_mfma_f32_32x32x16_bf16 v[64:79], v[44:47], a[60:63], v[64:79]
  s_waitcnt vmcnt(18) lgkmcnt(0)
  s_barrier
  ds_read_b64_tr_b16 v[32:33], v2 offset:0
  ds_read_b64_tr_b16 v[34:35], v2 offset:1024
  ds_read_b64_tr_b16 v[36:37], v11 offset:0
  ds_read_b64_tr_b16 v[38:39], v11 offset:1024
  v_cvt_pk_bf16_f32 v134, v12, v13
  v_mul_f32 v14, v94, v94
  v_mul_f32 v15, v95, v95
  v_fma_f32 v14, v14, v8, v6
  v_mfma_f32_32x32x16_bf16 v[48:63], v[16:19], a[64:67], v[48:63]
  ds_read_b64_tr_b16 v[40:41], v2 offset:2048
  ds_read_b64_tr_b16 v[42:43], v2 offset:3072
  v_fma_f32 v15, v15, v8, v6
  v_mul_f32 v14, v14, v94
  v_mul_f32 v15, v15, v95
  v_exp_f32 v14, v14
  v_mfma_f32_32x32x16_bf16 v[64:79], v[20:23], a[64:67], v[64:79]
  s_waitcnt lgkmcnt(6)
  ds_read_b64_tr_b16 v[44:45], v11 offset:2048
  ds_read_b64_tr_b16 v[46:47], v11 offset:3072
  v_exp_f32 v15, v15
  v_fma_f32 v14, v14, v10, v10
  v_fma_f32 v15, v15, v10, v10
  v_mfma_f32_32x32x16_bf16 v[48:63], v[24:27], a[68:71], v[48:63]
  ds_read_b64_tr_b16 v[16:17], v2 offset:4096
  ds_read_b64_tr_b16 v[18:19], v2 offset:5120
  v_rcp_f32 v14, v14
  v_rcp_f32 v15, v15
  v_mul_f32 v14, v14, v94
  v_mul_f32 v15, v15, v95
  v_cvt_pk_bf16_f32 v135, v14, v15
  v_mfma_f32_32x32x16_bf16 v[64:79], v[28:31], a[68:71], v[64:79]
  s_waitcnt lgkmcnt(6)
  ds_read_b64_tr_b16 v[20:21], v11 offset:4096
  ds_read_b64_tr_b16 v[22:23], v11 offset:5120
  v_mfma_f32_32x32x16_bf16 v[48:63], v[32:35], a[72:75], v[48:63]
  ds_read_b64_tr_b16 v[24:25], v2 offset:6144
  ds_read_b64_tr_b16 v[26:27], v2 offset:7168
  v_mfma_f32_32x32x16_bf16 v[64:79], v[36:39], a[72:75], v[64:79]
  s_waitcnt lgkmcnt(6)
  ds_read_b64_tr_b16 v[28:29], v11 offset:6144
  ds_read_b64_tr_b16 v[30:31], v11 offset:7168
  v_mfma_f32_32x32x16_bf16 v[48:63], v[40:43], a[76:79], v[48:63]
  s_add_u32 m0, s42, 110592
  ds_read_b64_tr_b16 v[32:33], v2 offset:8192
  ds_read_b64_tr_b16 v[34:35], v2 offset:9216
  buffer_load_dwordx4 v3, s[8:11], s24 offen offset:0 lds
  v_mul_f32 v12, v96, v96
  v_mul_f32 v13, v97, v97
  v_mfma_f32_32x32x16_bf16 v[64:79], v[44:47], a[76:79], v[64:79]
  s_waitcnt lgkmcnt(6)
  ds_read_b64_tr_b16 v[36:37], v11 offset:8192
  ds_read_b64_tr_b16 v[38:39], v11 offset:9216
  v_fma_f32 v12, v12, v8, v6
  v_fma_f32 v13, v13, v8, v6
  v_mul_f32 v12, v12, v96
  v_mul_f32 v13, v13, v97
  v_exp_f32 v12, v12
  v_mfma_f32_32x32x16_bf16 v[48:63], v[16:19], a[80:83], v[48:63]
  ds_read_b64_tr_b16 v[40:41], v2 offset:10240
  ds_read_b64_tr_b16 v[42:43], v2 offset:11264
  v_exp_f32 v13, v13
  v_fma_f32 v12, v12, v10, v10
  v_mfma_f32_32x32x16_bf16 v[64:79], v[20:23], a[80:83], v[64:79]
  s_waitcnt lgkmcnt(6)
  ds_read_b64_tr_b16 v[44:45], v11 offset:10240
  ds_read_b64_tr_b16 v[46:47], v11 offset:11264
  buffer_load_dwordx4 v3, s[8:11], s25 offen offset:1024 lds
  v_fma_f32 v13, v13, v10, v10
  v_rcp_f32 v12, v12
  v_rcp_f32 v13, v13
  v_mfma_f32_32x32x16_bf16 v[48:63], v[24:27], a[84:87], v[48:63]
  ds_read_b64_tr_b16 v[16:17], v2 offset:12288
  ds_read_b64_tr_b16 v[18:19], v2 offset:13312
  v_mul_f32 v12, v12, v96
  v_mul_f32 v13, v13, v97
  v_cvt_pk_bf16_f32 v136, v12, v13
  v_mul_f32 v14, v98, v98
  v_mul_f32 v15, v99, v99
  v_mfma_f32_32x32x16_bf16 v[64:79], v[28:31], a[84:87], v[64:79]
  s_waitcnt lgkmcnt(6)
  ds_read_b64_tr_b16 v[20:21], v11 offset:12288
  ds_read_b64_tr_b16 v[22:23], v11 offset:13312
  v_fma_f32 v14, v14, v8, v6
  v_fma_f32 v15, v15, v8, v6
  v_mul_f32 v14, v14, v98
  v_mul_f32 v15, v15, v99
  v_mfma_f32_32x32x16_bf16 v[48:63], v[32:35], a[88:91], v[48:63]
  ds_read_b64_tr_b16 v[24:25], v2 offset:14336
  ds_read_b64_tr_b16 v[26:27], v2 offset:15360
  buffer_load_dwordx4 v3, s[8:11], s26 offen offset:2048 lds
  v_exp_f32 v14, v14
  v_exp_f32 v15, v15
  v_fma_f32 v14, v14, v10, v10
  v_mfma_f32_32x32x16_bf16 v[64:79], v[36:39], a[88:91], v[64:79]
  s_waitcnt lgkmcnt(6)
  ds_read_b64_tr_b16 v[28:29], v11 offset:14336
  ds_read_b64_tr_b16 v[30:31], v11 offset:15360
  v_fma_f32 v15, v15, v10, v10
  v_rcp_f32 v14, v14
  v_rcp_f32 v15, v15
  v_mfma_f32_32x32x16_bf16 v[48:63], v[40:43], a[92:95], v[48:63]
  ds_read_b64_tr_b16 v[32:33], v2 offset:16384
  ds_read_b64_tr_b16 v[34:35], v2 offset:17408
  v_mul_f32 v14, v14, v98
  v_mul_f32 v15, v15, v99
  v_cvt_pk_bf16_f32 v137, v14, v15
  v_mul_f32 v12, v100, v100
  v_mfma_f32_32x32x16_bf16 v[64:79], v[44:47], a[92:95], v[64:79]
  s_waitcnt lgkmcnt(6)
  ds_read_b64_tr_b16 v[36:37], v11 offset:16384
  ds_read_b64_tr_b16 v[38:39], v11 offset:17408
  buffer_load_dwordx4 v3, s[8:11], s27 offen offset:3072 lds
  v_mul_f32 v13, v101, v101
  v_fma_f32 v12, v12, v8, v6
  v_fma_f32 v13, v13, v8, v6
  v_mul_f32 v12, v12, v100
  v_mul_f32 v13, v13, v101
  v_mfma_f32_32x32x16_bf16 v[48:63], v[16:19], a[96:99], v[48:63]
  ds_read_b64_tr_b16 v[40:41], v2 offset:18432
  ds_read_b64_tr_b16 v[42:43], v2 offset:19456
  v_exp_f32 v12, v12
  v_exp_f32 v13, v13
  v_mfma_f32_32x32x16_bf16 v[64:79], v[20:23], a[96:99], v[64:79]
  s_waitcnt lgkmcnt(6)
  ds_read_b64_tr_b16 v[44:45], v11 offset:18432
  ds_read_b64_tr_b16 v[46:47], v11 offset:19456
  v_fma_f32 v12, v12, v10, v10
  v_fma_f32 v13, v13, v10, v10
  v_rcp_f32 v12, v12
  v_rcp_f32 v13, v13
  v_mfma_f32_32x32x16_bf16 v[48:63], v[24:27], a[100:103], v[48:63]
  s_add_u32 m0, s42, 114688
  ds_read_b64_tr_b16 v[16:17], v2 offset:20480
  ds_read_b64_tr_b16 v[18:19], v2 offset:21504
  buffer_load_dwordx4 v3, s[8:11], s28 offen offset:0 lds
  v_mul_f32 v12, v12, v100
  v_mul_f32 v13, v13, v101
  v_cvt_pk_bf16_f32 v138, v12, v13
  v_mfma_f32_32x32x16_bf16 v[64:79], v[28:31], a[100:103], v[64:79]
  s_waitcnt lgkmcnt(6)
  ds_read_b64_tr_b16 v[20:21], v11 offset:20480
  ds_read_b64_tr_b16 v[22:23], v11 offset:21504
  v_mul_f32 v14, v102, v102
  v_mul_f32 v15, v103, v103
  v_fma_f32 v14, v14, v8, v6
  v_fma_f32 v15, v15, v8, v6
  v_mul_f32 v14, v14, v102
  v_mfma_f32_32x32x16_bf16 v[48:63], v[32:35], a[104:107], v[48:63]
  ds_read_b64_tr_b16 v[24:25], v2 offset:22528
  ds_read_b64_tr_b16 v[26:27], v2 offset:23552
  v_mul_f32 v15, v15, v103
  v_exp_f32 v14, v14
  v_exp_f32 v15, v15
  v_mfma_f32_32x32x16_bf16 v[64:79], v[36:39], a[104:107], v[64:79]
  s_waitcnt lgkmcnt(6)
  ds_read_b64_tr_b16 v[28:29], v11 offset:22528
  ds_read_b64_tr_b16 v[30:31], v11 offset:23552
  buffer_load_dwordx4 v3, s[8:11], s29 offen offset:1024 lds
  v_fma_f32 v14, v14, v10, v10
  v_fma_f32 v15, v15, v10, v10
  v_rcp_f32 v14, v14
  v_mfma_f32_32x32x16_bf16 v[48:63], v[40:43], a[108:111], v[48:63]
  ds_read_b64_tr_b16 v[32:33], v2 offset:24576
  ds_read_b64_tr_b16 v[34:35], v2 offset:25600
  v_rcp_f32 v15, v15
  v_mul_f32 v14, v14, v102
  v_mul_f32 v15, v15, v103
  v_cvt_pk_bf16_f32 v139, v14, v15
  v_mfma_f32_32x32x16_bf16 v[64:79], v[44:47], a[108:111], v[64:79]
  s_waitcnt lgkmcnt(6)
  ds_read_b64_tr_b16 v[36:37], v11 offset:24576
  ds_read_b64_tr_b16 v[38:39], v11 offset:25600
  v_mul_f32 v12, v104, v104
  v_mul_f32 v13, v105, v105
  v_fma_f32 v12, v12, v8, v6
  v_fma_f32 v13, v13, v8, v6
  v_mfma_f32_32x32x16_bf16 v[48:63], v[16:19], a[112:115], v[48:63]
  ds_read_b64_tr_b16 v[40:41], v2 offset:26624
  ds_read_b64_tr_b16 v[42:43], v2 offset:27648
  buffer_load_dwordx4 v3, s[8:11], s30 offen offset:2048 lds
  v_mul_f32 v12, v12, v104
  v_mul_f32 v13, v13, v105
  v_exp_f32 v12, v12
  v_exp_f32 v13, v13
  v_mfma_f32_32x32x16_bf16 v[64:79], v[20:23], a[112:115], v[64:79]
  s_waitcnt lgkmcnt(6)
  ds_read_b64_tr_b16 v[44:45], v11 offset:26624
  ds_read_b64_tr_b16 v[46:47], v11 offset:27648
  v_fma_f32 v12, v12, v10, v10
  v_fma_f32 v13, v13, v10, v10
  v_rcp_f32 v12, v12
  v_mfma_f32_32x32x16_bf16 v[48:63], v[24:27], a[116:119], v[48:63]
  ds_read_b64_tr_b16 v[16:17], v2 offset:28672
  ds_read_b64_tr_b16 v[18:19], v2 offset:29696
  v_rcp_f32 v13, v13
  v_mul_f32 v12, v12, v104
  v_mul_f32 v13, v13, v105
  v_mfma_f32_32x32x16_bf16 v[64:79], v[28:31], a[116:119], v[64:79]
  s_waitcnt lgkmcnt(6)
  ds_read_b64_tr_b16 v[20:21], v11 offset:28672
  ds_read_b64_tr_b16 v[22:23], v11 offset:29696
  buffer_load_dwordx4 v3, s[8:11], s31 offen offset:3072 lds
  v_cvt_pk_bf16_f32 v140, v12, v13
  v_mul_f32 v14, v106, v106
  v_mul_f32 v15, v107, v107
  v_fma_f32 v14, v14, v8, v6
  v_fma_f32 v15, v15, v8, v6
  v_mfma_f32_32x32x16_bf16 v[48:63], v[32:35], a[120:123], v[48:63]
  ds_read_b64_tr_b16 v[24:25], v2 offset:30720
  ds_read_b64_tr_b16 v[26:27], v2 offset:31744
  v_mul_f32 v14, v14, v106
  v_mul_f32 v15, v15, v107
  v_exp_f32 v14, v14
  v_mfma_f32_32x32x16_bf16 v[64:79], v[36:39], a[120:123], v[64:79]
  s_waitcnt lgkmcnt(6)
  ds_read_b64_tr_b16 v[28:29], v11 offset:30720
  ds_read_b64_tr_b16 v[30:31], v11 offset:31744
  v_exp_f32 v15, v15
  v_fma_f32 v14, v14, v10, v10
  v_fma_f32 v15, v15, v10, v10
  v_rcp_f32 v14, v14
  v_mfma_f32_32x32x16_bf16 v[48:63], v[40:43], a[124:127], v[48:63]
  s_add_u32 m0, s42, 118784
  ds_read_b64_tr_b16 v[32:33], v2 offset:32768
  ds_read_b64_tr_b16 v[34:35], v2 offset:33792
  buffer_load_dwordx4 v3, s[8:11], s32 offen offset:0 lds
  v_rcp_f32 v15, v15
  v_mul_f32 v14, v14, v106
  v_mul_f32 v15, v15, v107
  v_mfma_f32_32x32x16_bf16 v[64:79], v[44:47], a[124:127], v[64:79]
  s_waitcnt lgkmcnt(6)
  ds_read_b64_tr_b16 v[36:37], v11 offset:32768
  ds_read_b64_tr_b16 v[38:39], v11 offset:33792
  v_cvt_pk_bf16_f32 v141, v14, v15
  v_mul_f32 v12, v108, v108
  v_mul_f32 v13, v109, v109
  v_fma_f32 v12, v12, v8, v6
  v_mfma_f32_32x32x16_bf16 v[48:63], v[16:19], a[128:131], v[48:63]
  ds_read_b64_tr_b16 v[40:41], v2 offset:34816
  ds_read_b64_tr_b16 v[42:43], v2 offset:35840
  v_fma_f32 v13, v13, v8, v6
  v_mul_f32 v12, v12, v108
  v_mul_f32 v13, v13, v109
  v_exp_f32 v12, v12
  v_mfma_f32_32x32x16_bf16 v[64:79], v[20:23], a[128:131], v[64:79]
  s_waitcnt lgkmcnt(6)
  ds_read_b64_tr_b16 v[44:45], v11 offset:34816
  ds_read_b64_tr_b16 v[46:47], v11 offset:35840
  v_add_u32 v3, 2654208, v3
  v_add_u32 v1, 36864, v0
  v_xor_b32 v5, 64, v1
  v_exp_f32 v13, v13
  v_fma_f32 v12, v12, v10, v10
  v_fma_f32 v13, v13, v10, v10
  v_mfma_f32_32x32x16_bf16 v[48:63], v[24:27], a[132:135], v[48:63]
  v_rcp_f32 v12, v12
  v_rcp_f32 v13, v13
  v_mul_f32 v12, v12, v108
  v_mul_f32 v13, v13, v109
  v_mfma_f32_32x32x16_bf16 v[64:79], v[28:31], a[132:135], v[64:79]
  s_waitcnt vmcnt(18) lgkmcnt(0)
  s_barrier
  ds_read_b64_tr_b16 v[16:17], v1 offset:0
  ds_read_b64_tr_b16 v[18:19], v1 offset:1024
  ds_read_b64_tr_b16 v[20:21], v5 offset:0
  ds_read_b64_tr_b16 v[22:23], v5 offset:1024
  v_cvt_pk_bf16_f32 v142, v12, v13
  v_mul_f32 v14, v110, v110
  v_mul_f32 v15, v111, v111
  v_fma_f32 v14, v14, v8, v6
  v_mfma_f32_32x32x16_bf16 v[48:63], v[32:35], a[136:139], v[48:63]
  ds_read_b64_tr_b16 v[24:25], v1 offset:2048
  ds_read_b64_tr_b16 v[26:27], v1 offset:3072
  v_fma_f32 v15, v15, v8, v6
  v_mul_f32 v14, v14, v110
  v_mul_f32 v15, v15, v111
  v_exp_f32 v14, v14
  v_mfma_f32_32x32x16_bf16 v[64:79], v[36:39], a[136:139], v[64:79]
  s_waitcnt lgkmcnt(6)
  ds_read_b64_tr_b16 v[28:29], v5 offset:2048
  ds_read_b64_tr_b16 v[30:31], v5 offset:3072
  v_exp_f32 v15, v15
  v_fma_f32 v14, v14, v10, v10
  v_fma_f32 v15, v15, v10, v10
  v_mfma_f32_32x32x16_bf16 v[48:63], v[40:43], a[140:143], v[48:63]
  ds_read_b64_tr_b16 v[32:33], v1 offset:4096
  ds_read_b64_tr_b16 v[34:35], v1 offset:5120
  v_rcp_f32 v14, v14
  v_rcp_f32 v15, v15
  v_mul_f32 v14, v14, v110
  v_mul_f32 v15, v15, v111
  v_cvt_pk_bf16_f32 v143, v14, v15
  v_mfma_f32_32x32x16_bf16 v[64:79], v[44:47], a[140:143], v[64:79]
  s_waitcnt lgkmcnt(6)
  ds_read_b64_tr_b16 v[36:37], v5 offset:4096
  ds_read_b64_tr_b16 v[38:39], v5 offset:5120
  v_mfma_f32_32x32x16_bf16 v[80:95], v[16:19], a[0:3], 0
  ds_read_b64_tr_b16 v[40:41], v1 offset:6144
  ds_read_b64_tr_b16 v[42:43], v1 offset:7168
  v_mfma_f32_32x32x16_bf16 v[96:111], v[20:23], a[0:3], 0
  s_waitcnt lgkmcnt(6)
  ds_read_b64_tr_b16 v[44:45], v5 offset:6144
  ds_read_b64_tr_b16 v[46:47], v5 offset:7168
  v_mfma_f32_32x32x16_bf16 v[80:95], v[24:27], a[4:7], v[80:95]
  s_add_u32 m0, s42, 0
  ds_read_b64_tr_b16 v[16:17], v1 offset:8192
  ds_read_b64_tr_b16 v[18:19], v1 offset:9216
  buffer_load_dwordx4 v3, s[8:11], s24 offen offset:0 lds
  v_mul_f32 v12, v48, v48
  v_mul_f32 v13, v49, v49
  v_mfma_f32_32x32x16_bf16 v[96:111], v[28:31], a[4:7], v[96:111]
  s_waitcnt lgkmcnt(6)
  ds_read_b64_tr_b16 v[20:21], v5 offset:8192
  ds_read_b64_tr_b16 v[22:23], v5 offset:9216
  v_fma_f32 v12, v12, v8, v6
  v_fma_f32 v13, v13, v8, v6
  v_mul_f32 v12, v12, v48
  v_mul_f32 v13, v13, v49
  v_exp_f32 v12, v12
  v_mfma_f32_32x32x16_bf16 v[80:95], v[32:35], a[8:11], v[80:95]
  ds_read_b64_tr_b16 v[24:25], v1 offset:10240
  ds_read_b64_tr_b16 v[26:27], v1 offset:11264
  v_exp_f32 v13, v13
  v_fma_f32 v12, v12, v10, v10
  v_mfma_f32_32x32x16_bf16 v[96:111], v[36:39], a[8:11], v[96:111]
  s_waitcnt lgkmcnt(6)
  ds_read_b64_tr_b16 v[28:29], v5 offset:10240
  ds_read_b64_tr_b16 v[30:31], v5 offset:11264
  buffer_load_dwordx4 v3, s[8:11], s25 offen offset:1024 lds
  v_fma_f32 v13, v13, v10, v10
  v_rcp_f32 v12, v12
  v_rcp_f32 v13, v13
  v_mfma_f32_32x32x16_bf16 v[80:95], v[40:43], a[12:15], v[80:95]
  ds_read_b64_tr_b16 v[32:33], v1 offset:12288
  ds_read_b64_tr_b16 v[34:35], v1 offset:13312
  v_mul_f32 v12, v12, v48
  v_mul_f32 v13, v13, v49
  v_cvt_pk_bf16_f32 v144, v12, v13
  v_mul_f32 v14, v50, v50
  v_mul_f32 v15, v51, v51
  v_mfma_f32_32x32x16_bf16 v[96:111], v[44:47], a[12:15], v[96:111]
  s_waitcnt lgkmcnt(6)
  ds_read_b64_tr_b16 v[36:37], v5 offset:12288
  ds_read_b64_tr_b16 v[38:39], v5 offset:13312
  v_fma_f32 v14, v14, v8, v6
  v_fma_f32 v15, v15, v8, v6
  v_mul_f32 v14, v14, v50
  v_mul_f32 v15, v15, v51
  v_mfma_f32_32x32x16_bf16 v[80:95], v[16:19], a[16:19], v[80:95]
  ds_read_b64_tr_b16 v[40:41], v1 offset:14336
  ds_read_b64_tr_b16 v[42:43], v1 offset:15360
  buffer_load_dwordx4 v3, s[8:11], s26 offen offset:2048 lds
  v_exp_f32 v14, v14
  v_exp_f32 v15, v15
  v_fma_f32 v14, v14, v10, v10
  v_mfma_f32_32x32x16_bf16 v[96:111], v[20:23], a[16:19], v[96:111]
  s_waitcnt lgkmcnt(6)
  ds_read_b64_tr_b16 v[44:45], v5 offset:14336
  ds_read_b64_tr_b16 v[46:47], v5 offset:15360
  v_fma_f32 v15, v15, v10, v10
  v_rcp_f32 v14, v14
  v_rcp_f32 v15, v15
  v_mfma_f32_32x32x16_bf16 v[80:95], v[24:27], a[20:23], v[80:95]
  ds_read_b64_tr_b16 v[16:17], v1 offset:16384
  ds_read_b64_tr_b16 v[18:19], v1 offset:17408
  v_mul_f32 v14, v14, v50
  v_mul_f32 v15, v15, v51
  v_cvt_pk_bf16_f32 v145, v14, v15
  v_mul_f32 v12, v52, v52
  v_mfma_f32_32x32x16_bf16 v[96:111], v[28:31], a[20:23], v[96:111]
  s_waitcnt lgkmcnt(6)
  ds_read_b64_tr_b16 v[20:21], v5 offset:16384
  ds_read_b64_tr_b16 v[22:23], v5 offset:17408
  buffer_load_dwordx4 v3, s[8:11], s27 offen offset:3072 lds
  v_mul_f32 v13, v53, v53
  v_fma_f32 v12, v12, v8, v6
  v_fma_f32 v13, v13, v8, v6
  v_mul_f32 v12, v12, v52
  v_mul_f32 v13, v13, v53
  v_mfma_f32_32x32x16_bf16 v[80:95], v[32:35], a[24:27], v[80:95]
  ds_read_b64_tr_b16 v[24:25], v1 offset:18432
  ds_read_b64_tr_b16 v[26:27], v1 offset:19456
  v_exp_f32 v12, v12
  v_exp_f32 v13, v13
  v_mfma_f32_32x32x16_bf16 v[96:111], v[36:39], a[24:27], v[96:111]
  s_waitcnt lgkmcnt(6)
  ds_read_b64_tr_b16 v[28:29], v5 offset:18432
  ds_read_b64_tr_b16 v[30:31], v5 offset:19456
  v_fma_f32 v12, v12, v10, v10
  v_fma_f32 v13, v13, v10, v10
  v_rcp_f32 v12, v12
  v_rcp_f32 v13, v13
  v_mfma_f32_32x32x16_bf16 v[80:95], v[40:43], a[28:31], v[80:95]
  s_add_u32 m0, s42, 4096
  ds_read_b64_tr_b16 v[32:33], v1 offset:20480
  ds_read_b64_tr_b16 v[34:35], v1 offset:21504
  buffer_load_dwordx4 v3, s[8:11], s28 offen offset:0 lds
  v_mul_f32 v12, v12, v52
  v_mul_f32 v13, v13, v53
  v_cvt_pk_bf16_f32 v146, v12, v13
  v_mfma_f32_32x32x16_bf16 v[96:111], v[44:47], a[28:31], v[96:111]
  s_waitcnt lgkmcnt(6)
  ds_read_b64_tr_b16 v[36:37], v5 offset:20480
  ds_read_b64_tr_b16 v[38:39], v5 offset:21504
  v_mul_f32 v14, v54, v54
  v_mul_f32 v15, v55, v55
  v_fma_f32 v14, v14, v8, v6
  v_fma_f32 v15, v15, v8, v6
  v_mul_f32 v14, v14, v54
  v_mfma_f32_32x32x16_bf16 v[80:95], v[16:19], a[32:35], v[80:95]
  ds_read_b64_tr_b16 v[40:41], v1 offset:22528
  ds_read_b64_tr_b16 v[42:43], v1 offset:23552
  v_mul_f32 v15, v15, v55
  v_exp_f32 v14, v14
  v_exp_f32 v15, v15
  v_mfma_f32_32x32x16_bf16 v[96:111], v[20:23], a[32:35], v[96:111]
  s_waitcnt lgkmcnt(6)
  ds_read_b64_tr_b16 v[44:45], v5 offset:22528
  ds_read_b64_tr_b16 v[46:47], v5 offset:23552
  buffer_load_dwordx4 v3, s[8:11], s29 offen offset:1024 lds
  v_fma_f32 v14, v14, v10, v10
  v_fma_f32 v15, v15, v10, v10
  v_rcp_f32 v14, v14
  v_mfma_f32_32x32x16_bf16 v[80:95], v[24:27], a[36:39], v[80:95]
  ds_read_b64_tr_b16 v[16:17], v1 offset:24576
  ds_read_b64_tr_b16 v[18:19], v1 offset:25600
  v_rcp_f32 v15, v15
  v_mul_f32 v14, v14, v54
  v_mul_f32 v15, v15, v55
  v_cvt_pk_bf16_f32 v147, v14, v15
  v_mfma_f32_32x32x16_bf16 v[96:111], v[28:31], a[36:39], v[96:111]
  s_waitcnt lgkmcnt(6)
  ds_read_b64_tr_b16 v[20:21], v5 offset:24576
  ds_read_b64_tr_b16 v[22:23], v5 offset:25600
  v_mul_f32 v12, v56, v56
  v_mul_f32 v13, v57, v57
  v_fma_f32 v12, v12, v8, v6
  v_fma_f32 v13, v13, v8, v6
  v_mfma_f32_32x32x16_bf16 v[80:95], v[32:35], a[40:43], v[80:95]
  ds_read_b64_tr_b16 v[24:25], v1 offset:26624
  ds_read_b64_tr_b16 v[26:27], v1 offset:27648
  buffer_load_dwordx4 v3, s[8:11], s30 offen offset:2048 lds
  v_mul_f32 v12, v12, v56
  v_mul_f32 v13, v13, v57
  v_exp_f32 v12, v12
  v_exp_f32 v13, v13
  v_mfma_f32_32x32x16_bf16 v[96:111], v[36:39], a[40:43], v[96:111]
  s_waitcnt lgkmcnt(6)
  ds_read_b64_tr_b16 v[28:29], v5 offset:26624
  ds_read_b64_tr_b16 v[30:31], v5 offset:27648
  v_fma_f32 v12, v12, v10, v10
  v_fma_f32 v13, v13, v10, v10
  v_rcp_f32 v12, v12
  v_mfma_f32_32x32x16_bf16 v[80:95], v[40:43], a[44:47], v[80:95]
  ds_read_b64_tr_b16 v[32:33], v1 offset:28672
  ds_read_b64_tr_b16 v[34:35], v1 offset:29696
  v_rcp_f32 v13, v13
  v_mul_f32 v12, v12, v56
  v_mul_f32 v13, v13, v57
  v_mfma_f32_32x32x16_bf16 v[96:111], v[44:47], a[44:47], v[96:111]
  s_waitcnt lgkmcnt(6)
  ds_read_b64_tr_b16 v[36:37], v5 offset:28672
  ds_read_b64_tr_b16 v[38:39], v5 offset:29696
  buffer_load_dwordx4 v3, s[8:11], s31 offen offset:3072 lds
  v_cvt_pk_bf16_f32 v148, v12, v13
  v_mul_f32 v14, v58, v58
  v_mul_f32 v15, v59, v59
  v_fma_f32 v14, v14, v8, v6
  v_fma_f32 v15, v15, v8, v6
  v_mfma_f32_32x32x16_bf16 v[80:95], v[16:19], a[48:51], v[80:95]
  ds_read_b64_tr_b16 v[40:41], v1 offset:30720
  ds_read_b64_tr_b16 v[42:43], v1 offset:31744
  v_mul_f32 v14, v14, v58
  v_mul_f32 v15, v15, v59
  v_exp_f32 v14, v14
  v_mfma_f32_32x32x16_bf16 v[96:111], v[20:23], a[48:51], v[96:111]
  s_waitcnt lgkmcnt(6)
  ds_read_b64_tr_b16 v[44:45], v5 offset:30720
  ds_read_b64_tr_b16 v[46:47], v5 offset:31744
  v_exp_f32 v15, v15
  v_fma_f32 v14, v14, v10, v10
  v_fma_f32 v15, v15, v10, v10
  v_rcp_f32 v14, v14
  v_mfma_f32_32x32x16_bf16 v[80:95], v[24:27], a[52:55], v[80:95]
  s_add_u32 m0, s42, 8192
  ds_read_b64_tr_b16 v[16:17], v1 offset:32768
  ds_read_b64_tr_b16 v[18:19], v1 offset:33792
  buffer_load_dwordx4 v3, s[8:11], s32 offen offset:0 lds
  v_rcp_f32 v15, v15
  v_mul_f32 v14, v14, v58
  v_mul_f32 v15, v15, v59
  v_mfma_f32_32x32x16_bf16 v[96:111], v[28:31], a[52:55], v[96:111]
  s_waitcnt lgkmcnt(6)
  ds_read_b64_tr_b16 v[20:21], v5 offset:32768
  ds_read_b64_tr_b16 v[22:23], v5 offset:33792
  v_cvt_pk_bf16_f32 v149, v14, v15
  v_mul_f32 v12, v60, v60
  v_mul_f32 v13, v61, v61
  v_fma_f32 v12, v12, v8, v6
  v_mfma_f32_32x32x16_bf16 v[80:95], v[32:35], a[56:59], v[80:95]
  ds_read_b64_tr_b16 v[24:25], v1 offset:34816
  ds_read_b64_tr_b16 v[26:27], v1 offset:35840
  v_fma_f32 v13, v13, v8, v6
  v_mul_f32 v12, v12, v60
  v_mul_f32 v13, v13, v61
  v_exp_f32 v12, v12
  v_mfma_f32_32x32x16_bf16 v[96:111], v[36:39], a[56:59], v[96:111]
  s_waitcnt lgkmcnt(6)
  ds_read_b64_tr_b16 v[28:29], v5 offset:34816
  ds_read_b64_tr_b16 v[30:31], v5 offset:35840
  v_subrev_u32 v3, 2654080, v3
  v_add_u32 v2, 73728, v0
  v_xor_b32 v11, 64, v2
  v_exp_f32 v13, v13
  v_fma_f32 v12, v12, v10, v10
  v_fma_f32 v13, v13, v10, v10
  v_mfma_f32_32x32x16_bf16 v[80:95], v[40:43], a[60:63], v[80:95]
  v_rcp_f32 v12, v12
  v_rcp_f32 v13, v13
  v_mul_f32 v12, v12, v60
  v_mul_f32 v13, v13, v61
  v_mfma_f32_32x32x16_bf16 v[96:111], v[44:47], a[60:63], v[96:111]
  s_waitcnt vmcnt(18) lgkmcnt(0)
  s_barrier
  ds_read_b64_tr_b16 v[32:33], v2 offset:0
  ds_read_b64_tr_b16 v[34:35], v2 offset:1024
  ds_read_b64_tr_b16 v[36:37], v11 offset:0
  ds_read_b64_tr_b16 v[38:39], v11 offset:1024
  v_cvt_pk_bf16_f32 v150, v12, v13
  v_mul_f32 v14, v62, v62
  v_mul_f32 v15, v63, v63
  v_fma_f32 v14, v14, v8, v6
  v_mfma_f32_32x32x16_bf16 v[80:95], v[16:19], a[64:67], v[80:95]
  ds_read_b64_tr_b16 v[40:41], v2 offset:2048
  ds_read_b64_tr_b16 v[42:43], v2 offset:3072
  v_fma_f32 v15, v15, v8, v6
  v_mul_f32 v14, v14, v62
  v_mul_f32 v15, v15, v63
  v_exp_f32 v14, v14
  v_mfma_f32_32x32x16_bf16 v[96:111], v[20:23], a[64:67], v[96:111]
  s_waitcnt lgkmcnt(6)
  ds_read_b64_tr_b16 v[44:45], v11 offset:2048
  ds_read_b64_tr_b16 v[46:47], v11 offset:3072
  v_exp_f32 v15, v15
  v_fma_f32 v14, v14, v10, v10
  v_fma_f32 v15, v15, v10, v10
  v_mfma_f32_32x32x16_bf16 v[80:95], v[24:27], a[68:71], v[80:95]
  ds_read_b64_tr_b16 v[16:17], v2 offset:4096
  ds_read_b64_tr_b16 v[18:19], v2 offset:5120
  v_rcp_f32 v14, v14
  v_rcp_f32 v15, v15
  v_mul_f32 v14, v14, v62
  v_mul_f32 v15, v15, v63
  v_cvt_pk_bf16_f32 v151, v14, v15
  v_mfma_f32_32x32x16_bf16 v[96:111], v[28:31], a[68:71], v[96:111]
  s_waitcnt lgkmcnt(6)
  ds_read_b64_tr_b16 v[20:21], v11 offset:4096
  ds_read_b64_tr_b16 v[22:23], v11 offset:5120
  v_mfma_f32_32x32x16_bf16 v[80:95], v[32:35], a[72:75], v[80:95]
  ds_read_b64_tr_b16 v[24:25], v2 offset:6144
  ds_read_b64_tr_b16 v[26:27], v2 offset:7168
  v_mfma_f32_32x32x16_bf16 v[96:111], v[36:39], a[72:75], v[96:111]
  s_waitcnt lgkmcnt(6)
  ds_read_b64_tr_b16 v[28:29], v11 offset:6144
  ds_read_b64_tr_b16 v[30:31], v11 offset:7168
  v_mfma_f32_32x32x16_bf16 v[80:95], v[40:43], a[76:79], v[80:95]
  s_add_u32 m0, s42, 36864
  ds_read_b64_tr_b16 v[32:33], v2 offset:8192
  ds_read_b64_tr_b16 v[34:35], v2 offset:9216
  buffer_load_dwordx4 v3, s[8:11], s24 offen offset:0 lds
  v_mul_f32 v12, v64, v64
  v_mul_f32 v13, v65, v65
  v_mfma_f32_32x32x16_bf16 v[96:111], v[44:47], a[76:79], v[96:111]
  s_waitcnt lgkmcnt(6)
  ds_read_b64_tr_b16 v[36:37], v11 offset:8192
  ds_read_b64_tr_b16 v[38:39], v11 offset:9216
  v_fma_f32 v12, v12, v8, v6
  v_fma_f32 v13, v13, v8, v6
  v_mul_f32 v12, v12, v64
  v_mul_f32 v13, v13, v65
  v_exp_f32 v12, v12
  v_mfma_f32_32x32x16_bf16 v[80:95], v[16:19], a[80:83], v[80:95]
  ds_read_b64_tr_b16 v[40:41], v2 offset:10240
  ds_read_b64_tr_b16 v[42:43], v2 offset:11264
  v_exp_f32 v13, v13
  v_fma_f32 v12, v12, v10, v10
  v_mfma_f32_32x32x16_bf16 v[96:111], v[20:23], a[80:83], v[96:111]
  s_waitcnt lgkmcnt(6)
  ds_read_b64_tr_b16 v[44:45], v11 offset:10240
  ds_read_b64_tr_b16 v[46:47], v11 offset:11264
  buffer_load_dwordx4 v3, s[8:11], s25 offen offset:1024 lds
  v_fma_f32 v13, v13, v10, v10
  v_rcp_f32 v12, v12
  v_rcp_f32 v13, v13
  v_mfma_f32_32x32x16_bf16 v[80:95], v[24:27], a[84:87], v[80:95]
  ds_read_b64_tr_b16 v[16:17], v2 offset:12288
  ds_read_b64_tr_b16 v[18:19], v2 offset:13312
  v_mul_f32 v12, v12, v64
  v_mul_f32 v13, v13, v65
  v_cvt_pk_bf16_f32 v152, v12, v13
  v_mul_f32 v14, v66, v66
  v_mul_f32 v15, v67, v67
  v_mfma_f32_32x32x16_bf16 v[96:111], v[28:31], a[84:87], v[96:111]
  s_waitcnt lgkmcnt(6)
  ds_read_b64_tr_b16 v[20:21], v11 offset:12288
  ds_read_b64_tr_b16 v[22:23], v11 offset:13312
  v_fma_f32 v14, v14, v8, v6
  v_fma_f32 v15, v15, v8, v6
  v_mul_f32 v14, v14, v66
  v_mul_f32 v15, v15, v67
  v_mfma_f32_32x32x16_bf16 v[80:95], v[32:35], a[88:91], v[80:95]
  ds_read_b64_tr_b16 v[24:25], v2 offset:14336
  ds_read_b64_tr_b16 v[26:27], v2 offset:15360
  buffer_load_dwordx4 v3, s[8:11], s26 offen offset:2048 lds
  v_exp_f32 v14, v14
  v_exp_f32 v15, v15
  v_fma_f32 v14, v14, v10, v10
  v_mfma_f32_32x32x16_bf16 v[96:111], v[36:39], a[88:91], v[96:111]
  s_waitcnt lgkmcnt(6)
  ds_read_b64_tr_b16 v[28:29], v11 offset:14336
  ds_read_b64_tr_b16 v[30:31], v11 offset:15360
  v_fma_f32 v15, v15, v10, v10
  v_rcp_f32 v14, v14
  v_rcp_f32 v15, v15
  v_mfma_f32_32x32x16_bf16 v[80:95], v[40:43], a[92:95], v[80:95]
  ds_read_b64_tr_b16 v[32:33], v2 offset:16384
  ds_read_b64_tr_b16 v[34:35], v2 offset:17408
  v_mul_f32 v14, v14, v66
  v_mul_f32 v15, v15, v67
  v_cvt_pk_bf16_f32 v153, v14, v15
  v_mul_f32 v12, v68, v68
  v_mfma_f32_32x32x16_bf16 v[96:111], v[44:47], a[92:95], v[96:111]
  s_waitcnt lgkmcnt(6)
  ds_read_b64_tr_b16 v[36:37], v11 offset:16384
  ds_read_b64_tr_b16 v[38:39], v11 offset:17408
  buffer_load_dwordx4 v3, s[8:11], s27 offen offset:3072 lds
  v_mul_f32 v13, v69, v69
  v_fma_f32 v12, v12, v8, v6
  v_fma_f32 v13, v13, v8, v6
  v_mul_f32 v12, v12, v68
  v_mul_f32 v13, v13, v69
  v_mfma_f32_32x32x16_bf16 v[80:95], v[16:19], a[96:99], v[80:95]
  ds_read_b64_tr_b16 v[40:41], v2 offset:18432
  ds_read_b64_tr_b16 v[42:43], v2 offset:19456
  v_exp_f32 v12, v12
  v_exp_f32 v13, v13
  v_mfma_f32_32x32x16_bf16 v[96:111], v[20:23], a[96:99], v[96:111]
  s_waitcnt lgkmcnt(6)
  ds_read_b64_tr_b16 v[44:45], v11 offset:18432
  ds_read_b64_tr_b16 v[46:47], v11 offset:19456
  v_fma_f32 v12, v12, v10, v10
  v_fma_f32 v13, v13, v10, v10
  v_rcp_f32 v12, v12
  v_rcp_f32 v13, v13
  v_mfma_f32_32x32x16_bf16 v[80:95], v[24:27], a[100:103], v[80:95]
  s_add_u32 m0, s42, 40960
  ds_read_b64_tr_b16 v[16:17], v2 offset:20480
  ds_read_b64_tr_b16 v[18:19], v2 offset:21504
  buffer_load_dwordx4 v3, s[8:11], s28 offen offset:0 lds
  v_mul_f32 v12, v12, v68
  v_mul_f32 v13, v13, v69
  v_cvt_pk_bf16_f32 v154, v12, v13
  v_mfma_f32_32x32x16_bf16 v[96:111], v[28:31], a[100:103], v[96:111]
  s_waitcnt lgkmcnt(6)
  ds_read_b64_tr_b16 v[20:21], v11 offset:20480
  ds_read_b64_tr_b16 v[22:23], v11 offset:21504
  v_mul_f32 v14, v70, v70
  v_mul_f32 v15, v71, v71
  v_fma_f32 v14, v14, v8, v6
  v_fma_f32 v15, v15, v8, v6
  v_mul_f32 v14, v14, v70
  v_mfma_f32_32x32x16_bf16 v[80:95], v[32:35], a[104:107], v[80:95]
  ds_read_b64_tr_b16 v[24:25], v2 offset:22528
  ds_read_b64_tr_b16 v[26:27], v2 offset:23552
  v_mul_f32 v15, v15, v71
  v_exp_f32 v14, v14
  v_exp_f32 v15, v15
  v_mfma_f32_32x32x16_bf16 v[96:111], v[36:39], a[104:107], v[96:111]
  s_waitcnt lgkmcnt(6)
  ds_read_b64_tr_b16 v[28:29], v11 offset:22528
  ds_read_b64_tr_b16 v[30:31], v11 offset:23552
  buffer_load_dwordx4 v3, s[8:11], s29 offen offset:1024 lds
  v_fma_f32 v14, v14, v10, v10
  v_fma_f32 v15, v15, v10, v10
  v_rcp_f32 v14, v14
  v_mfma_f32_32x32x16_bf16 v[80:95], v[40:43], a[108:111], v[80:95]
  ds_read_b64_tr_b16 v[32:33], v2 offset:24576
  ds_read_b64_tr_b16 v[34:35], v2 offset:25600
  v_rcp_f32 v15, v15
  v_mul_f32 v14, v14, v70
  v_mul_f32 v15, v15, v71
  v_cvt_pk_bf16_f32 v155, v14, v15
  v_mfma_f32_32x32x16_bf16 v[96:111], v[44:47], a[108:111], v[96:111]
  s_waitcnt lgkmcnt(6)
  ds_read_b64_tr_b16 v[36:37], v11 offset:24576
  ds_read_b64_tr_b16 v[38:39], v11 offset:25600
  v_mul_f32 v12, v72, v72
  v_mul_f32 v13, v73, v73
  v_fma_f32 v12, v12, v8, v6
  v_fma_f32 v13, v13, v8, v6
  v_mfma_f32_32x32x16_bf16 v[80:95], v[16:19], a[112:115], v[80:95]
  ds_read_b64_tr_b16 v[40:41], v2 offset:26624
  ds_read_b64_tr_b16 v[42:43], v2 offset:27648
  buffer_load_dwordx4 v3, s[8:11], s30 offen offset:2048 lds
  v_mul_f32 v12, v12, v72
  v_mul_f32 v13, v13, v73
  v_exp_f32 v12, v12
  v_exp_f32 v13, v13
  v_mfma_f32_32x32x16_bf16 v[96:111], v[20:23], a[112:115], v[96:111]
  s_waitcnt lgkmcnt(6)
  ds_read_b64_tr_b16 v[44:45], v11 offset:26624
  ds_read_b64_tr_b16 v[46:47], v11 offset:27648
  v_fma_f32 v12, v12, v10, v10
  v_fma_f32 v13, v13, v10, v10
  v_rcp_f32 v12, v12
  v_mfma_f32_32x32x16_bf16 v[80:95], v[24:27], a[116:119], v[80:95]
  ds_read_b64_tr_b16 v[16:17], v2 offset:28672
  ds_read_b64_tr_b16 v[18:19], v2 offset:29696
  v_rcp_f32 v13, v13
  v_mul_f32 v12, v12, v72
  v_mul_f32 v13, v13, v73
  v_mfma_f32_32x32x16_bf16 v[96:111], v[28:31], a[116:119], v[96:111]
  s_waitcnt lgkmcnt(6)
  ds_read_b64_tr_b16 v[20:21], v11 offset:28672
  ds_read_b64_tr_b16 v[22:23], v11 offset:29696
  buffer_load_dwordx4 v3, s[8:11], s31 offen offset:3072 lds
  v_cvt_pk_bf16_f32 v156, v12, v13
  v_mul_f32 v14, v74, v74
  v_mul_f32 v15, v75, v75
  v_fma_f32 v14, v14, v8, v6
  v_fma_f32 v15, v15, v8, v6
  v_mfma_f32_32x32x16_bf16 v[80:95], v[32:35], a[120:123], v[80:95]
  ds_read_b64_tr_b16 v[24:25], v2 offset:30720
  ds_read_b64_tr_b16 v[26:27], v2 offset:31744
  v_mul_f32 v14, v14, v74
  v_mul_f32 v15, v15, v75
  v_exp_f32 v14, v14
  v_mfma_f32_32x32x16_bf16 v[96:111], v[36:39], a[120:123], v[96:111]
  s_waitcnt lgkmcnt(6)
  ds_read_b64_tr_b16 v[28:29], v11 offset:30720
  ds_read_b64_tr_b16 v[30:31], v11 offset:31744
  v_exp_f32 v15, v15
  v_fma_f32 v14, v14, v10, v10
  v_fma_f32 v15, v15, v10, v10
  v_rcp_f32 v14, v14
  v_mfma_f32_32x32x16_bf16 v[80:95], v[40:43], a[124:127], v[80:95]
  s_add_u32 m0, s42, 45056
  ds_read_b64_tr_b16 v[32:33], v2 offset:32768
  ds_read_b64_tr_b16 v[34:35], v2 offset:33792
  buffer_load_dwordx4 v3, s[8:11], s32 offen offset:0 lds
  v_rcp_f32 v15, v15
  v_mul_f32 v14, v14, v74
  v_mul_f32 v15, v15, v75
  v_mfma_f32_32x32x16_bf16 v[96:111], v[44:47], a[124:127], v[96:111]
  s_waitcnt lgkmcnt(6)
  ds_read_b64_tr_b16 v[36:37], v11 offset:32768
  ds_read_b64_tr_b16 v[38:39], v11 offset:33792
  v_cvt_pk_bf16_f32 v157, v14, v15
  v_mul_f32 v12, v76, v76
  v_mul_f32 v13, v77, v77
  v_fma_f32 v12, v12, v8, v6
  v_mfma_f32_32x32x16_bf16 v[80:95], v[16:19], a[128:131], v[80:95]
  ds_read_b64_tr_b16 v[40:41], v2 offset:34816
  ds_read_b64_tr_b16 v[42:43], v2 offset:35840
  v_fma_f32 v13, v13, v8, v6
  v_mul_f32 v12, v12, v76
  v_mul_f32 v13, v13, v77
  v_exp_f32 v12, v12
  v_mfma_f32_32x32x16_bf16 v[96:111], v[20:23], a[128:131], v[96:111]
  s_waitcnt lgkmcnt(6)
  ds_read_b64_tr_b16 v[44:45], v11 offset:34816
  ds_read_b64_tr_b16 v[46:47], v11 offset:35840
  v_add_u32 v3, 2654208, v3
  v_add_u32 v1, 110592, v0
  v_xor_b32 v5, 64, v1
  v_exp_f32 v13, v13
  v_fma_f32 v12, v12, v10, v10
  v_fma_f32 v13, v13, v10, v10
  v_mfma_f32_32x32x16_bf16 v[80:95], v[24:27], a[132:135], v[80:95]
  v_rcp_f32 v12, v12
  v_rcp_f32 v13, v13
  v_mul_f32 v12, v12, v76
  v_mul_f32 v13, v13, v77
  v_mfma_f32_32x32x16_bf16 v[96:111], v[28:31], a[132:135], v[96:111]
  s_waitcnt vmcnt(18) lgkmcnt(0)
  s_barrier
  ds_read_b64_tr_b16 v[16:17], v1 offset:0
  ds_read_b64_tr_b16 v[18:19], v1 offset:1024
  ds_read_b64_tr_b16 v[20:21], v5 offset:0
  ds_read_b64_tr_b16 v[22:23], v5 offset:1024
  v_cvt_pk_bf16_f32 v158, v12, v13
  v_mul_f32 v14, v78, v78
  v_mul_f32 v15, v79, v79
  v_fma_f32 v14, v14, v8, v6
  v_mfma_f32_32x32x16_bf16 v[80:95], v[32:35], a[136:139], v[80:95]
  ds_read_b64_tr_b16 v[24:25], v1 offset:2048
  ds_read_b64_tr_b16 v[26:27], v1 offset:3072
  v_fma_f32 v15, v15, v8, v6
  v_mul_f32 v14, v14, v78
  v_mul_f32 v15, v15, v79
  v_exp_f32 v14, v14
  v_mfma_f32_32x32x16_bf16 v[96:111], v[36:39], a[136:139], v[96:111]
  s_waitcnt lgkmcnt(6)
  ds_read_b64_tr_b16 v[28:29], v5 offset:2048
  ds_read_b64_tr_b16 v[30:31], v5 offset:3072
  v_exp_f32 v15, v15
  v_fma_f32 v14, v14, v10, v10
  v_fma_f32 v15, v15, v10, v10
  v_mfma_f32_32x32x16_bf16 v[80:95], v[40:43], a[140:143], v[80:95]
  ds_read_b64_tr_b16 v[32:33], v1 offset:4096
  ds_read_b64_tr_b16 v[34:35], v1 offset:5120
  v_rcp_f32 v14, v14
  v_rcp_f32 v15, v15
  v_mul_f32 v14, v14, v78
  v_mul_f32 v15, v15, v79
  v_cvt_pk_bf16_f32 v159, v14, v15
  v_mfma_f32_32x32x16_bf16 v[96:111], v[44:47], a[140:143], v[96:111]
  s_waitcnt lgkmcnt(6)
  ds_read_b64_tr_b16 v[36:37], v5 offset:4096
  ds_read_b64_tr_b16 v[38:39], v5 offset:5120
  v_mfma_f32_32x32x16_bf16 v[48:63], v[16:19], a[0:3], 0
  ds_read_b64_tr_b16 v[40:41], v1 offset:6144
  ds_read_b64_tr_b16 v[42:43], v1 offset:7168
  v_mfma_f32_32x32x16_bf16 v[64:79], v[20:23], a[0:3], 0
  s_waitcnt lgkmcnt(6)
  ds_read_b64_tr_b16 v[44:45], v5 offset:6144
  ds_read_b64_tr_b16 v[46:47], v5 offset:7168
  v_mfma_f32_32x32x16_bf16 v[48:63], v[24:27], a[4:7], v[48:63]
  s_add_u32 m0, s42, 73728
  ds_read_b64_tr_b16 v[16:17], v1 offset:8192
  ds_read_b64_tr_b16 v[18:19], v1 offset:9216
  buffer_load_dwordx4 v3, s[8:11], s24 offen offset:0 lds
  v_mul_f32 v12, v80, v80
  v_mul_f32 v13, v81, v81
  v_mfma_f32_32x32x16_bf16 v[64:79], v[28:31], a[4:7], v[64:79]
  s_waitcnt lgkmcnt(6)
  ds_read_b64_tr_b16 v[20:21], v5 offset:8192
  ds_read_b64_tr_b16 v[22:23], v5 offset:9216
  v_fma_f32 v12, v12, v8, v6
  v_fma_f32 v13, v13, v8, v6
  v_mul_f32 v12, v12, v80
  v_mul_f32 v13, v13, v81
  v_exp_f32 v12, v12
  v_mfma_f32_32x32x16_bf16 v[48:63], v[32:35], a[8:11], v[48:63]
  ds_read_b64_tr_b16 v[24:25], v1 offset:10240
  ds_read_b64_tr_b16 v[26:27], v1 offset:11264
  v_exp_f32 v13, v13
  v_fma_f32 v12, v12, v10, v10
  v_mfma_f32_32x32x16_bf16 v[64:79], v[36:39], a[8:11], v[64:79]
  s_waitcnt lgkmcnt(6)
  ds_read_b64_tr_b16 v[28:29], v5 offset:10240
  ds_read_b64_tr_b16 v[30:31], v5 offset:11264
  buffer_load_dwordx4 v3, s[8:11], s25 offen offset:1024 lds
  v_fma_f32 v13, v13, v10, v10
  v_rcp_f32 v12, v12
  v_rcp_f32 v13, v13
  v_mfma_f32_32x32x16_bf16 v[48:63], v[40:43], a[12:15], v[48:63]
  ds_read_b64_tr_b16 v[32:33], v1 offset:12288
  ds_read_b64_tr_b16 v[34:35], v1 offset:13312
  v_mul_f32 v12, v12, v80
  v_mul_f32 v13, v13, v81
  v_cvt_pk_bf16_f32 v160, v12, v13
  v_mul_f32 v14, v82, v82
  v_mul_f32 v15, v83, v83
  v_mfma_f32_32x32x16_bf16 v[64:79], v[44:47], a[12:15], v[64:79]
  s_waitcnt lgkmcnt(6)
  ds_read_b64_tr_b16 v[36:37], v5 offset:12288
  ds_read_b64_tr_b16 v[38:39], v5 offset:13312
  v_fma_f32 v14, v14, v8, v6
  v_fma_f32 v15, v15, v8, v6
  v_mul_f32 v14, v14, v82
  v_mul_f32 v15, v15, v83
  v_mfma_f32_32x32x16_bf16 v[48:63], v[16:19], a[16:19], v[48:63]
  ds_read_b64_tr_b16 v[40:41], v1 offset:14336
  ds_read_b64_tr_b16 v[42:43], v1 offset:15360
  buffer_load_dwordx4 v3, s[8:11], s26 offen offset:2048 lds
  v_exp_f32 v14, v14
  v_exp_f32 v15, v15
  v_fma_f32 v14, v14, v10, v10
  v_mfma_f32_32x32x16_bf16 v[64:79], v[20:23], a[16:19], v[64:79]
  s_waitcnt lgkmcnt(6)
  ds_read_b64_tr_b16 v[44:45], v5 offset:14336
  ds_read_b64_tr_b16 v[46:47], v5 offset:15360
  v_fma_f32 v15, v15, v10, v10
  v_rcp_f32 v14, v14
  v_rcp_f32 v15, v15
  v_mfma_f32_32x32x16_bf16 v[48:63], v[24:27], a[20:23], v[48:63]
  ds_read_b64_tr_b16 v[16:17], v1 offset:16384
  ds_read_b64_tr_b16 v[18:19], v1 offset:17408
  v_mul_f32 v14, v14, v82
  v_mul_f32 v15, v15, v83
  v_cvt_pk_bf16_f32 v161, v14, v15
  v_mul_f32 v12, v84, v84
  v_mfma_f32_32x32x16_bf16 v[64:79], v[28:31], a[20:23], v[64:79]
  s_waitcnt lgkmcnt(6)
  ds_read_b64_tr_b16 v[20:21], v5 offset:16384
  ds_read_b64_tr_b16 v[22:23], v5 offset:17408
  buffer_load_dwordx4 v3, s[8:11], s27 offen offset:3072 lds
  v_mul_f32 v13, v85, v85
  v_fma_f32 v12, v12, v8, v6
  v_fma_f32 v13, v13, v8, v6
  v_mul_f32 v12, v12, v84
  v_mul_f32 v13, v13, v85
  v_mfma_f32_32x32x16_bf16 v[48:63], v[32:35], a[24:27], v[48:63]
  ds_read_b64_tr_b16 v[24:25], v1 offset:18432
  ds_read_b64_tr_b16 v[26:27], v1 offset:19456
  v_exp_f32 v12, v12
  v_exp_f32 v13, v13
  v_mfma_f32_32x32x16_bf16 v[64:79], v[36:39], a[24:27], v[64:79]
  s_waitcnt lgkmcnt(6)
  ds_read_b64_tr_b16 v[28:29], v5 offset:18432
  ds_read_b64_tr_b16 v[30:31], v5 offset:19456
  v_fma_f32 v12, v12, v10, v10
  v_fma_f32 v13, v13, v10, v10
  v_rcp_f32 v12, v12
  v_rcp_f32 v13, v13
  v_mfma_f32_32x32x16_bf16 v[48:63], v[40:43], a[28:31], v[48:63]
  s_add_u32 m0, s42, 77824
  ds_read_b64_tr_b16 v[32:33], v1 offset:20480
  ds_read_b64_tr_b16 v[34:35], v1 offset:21504
  buffer_load_dwordx4 v3, s[8:11], s28 offen offset:0 lds
  v_mul_f32 v12, v12, v84
  v_mul_f32 v13, v13, v85
  v_cvt_pk_bf16_f32 v162, v12, v13
  v_mfma_f32_32x32x16_bf16 v[64:79], v[44:47], a[28:31], v[64:79]
  s_waitcnt lgkmcnt(6)
  ds_read_b64_tr_b16 v[36:37], v5 offset:20480
  ds_read_b64_tr_b16 v[38:39], v5 offset:21504
  v_mul_f32 v14, v86, v86
  v_mul_f32 v15, v87, v87
  v_fma_f32 v14, v14, v8, v6
  v_fma_f32 v15, v15, v8, v6
  v_mul_f32 v14, v14, v86
  v_mfma_f32_32x32x16_bf16 v[48:63], v[16:19], a[32:35], v[48:63]
  ds_read_b64_tr_b16 v[40:41], v1 offset:22528
  ds_read_b64_tr_b16 v[42:43], v1 offset:23552
  v_mul_f32 v15, v15, v87
  v_exp_f32 v14, v14
  v_exp_f32 v15, v15
  v_mfma_f32_32x32x16_bf16 v[64:79], v[20:23], a[32:35], v[64:79]
  s_waitcnt lgkmcnt(6)
  ds_read_b64_tr_b16 v[44:45], v5 offset:22528
  ds_read_b64_tr_b16 v[46:47], v5 offset:23552
  buffer_load_dwordx4 v3, s[8:11], s29 offen offset:1024 lds
  v_fma_f32 v14, v14, v10, v10
  v_fma_f32 v15, v15, v10, v10
  v_rcp_f32 v14, v14
  v_mfma_f32_32x32x16_bf16 v[48:63], v[24:27], a[36:39], v[48:63]
  ds_read_b64_tr_b16 v[16:17], v1 offset:24576
  ds_read_b64_tr_b16 v[18:19], v1 offset:25600
  v_rcp_f32 v15, v15
  v_mul_f32 v14, v14, v86
  v_mul_f32 v15, v15, v87
  v_cvt_pk_bf16_f32 v163, v14, v15
  v_mfma_f32_32x32x16_bf16 v[64:79], v[28:31], a[36:39], v[64:79]
  s_waitcnt lgkmcnt(6)
  ds_read_b64_tr_b16 v[20:21], v5 offset:24576
  ds_read_b64_tr_b16 v[22:23], v5 offset:25600
  v_mul_f32 v12, v88, v88
  v_mul_f32 v13, v89, v89
  v_fma_f32 v12, v12, v8, v6
  v_fma_f32 v13, v13, v8, v6
  v_mfma_f32_32x32x16_bf16 v[48:63], v[32:35], a[40:43], v[48:63]
  ds_read_b64_tr_b16 v[24:25], v1 offset:26624
  ds_read_b64_tr_b16 v[26:27], v1 offset:27648
  buffer_load_dwordx4 v3, s[8:11], s30 offen offset:2048 lds
  v_mul_f32 v12, v12, v88
  v_mul_f32 v13, v13, v89
  v_exp_f32 v12, v12
  v_exp_f32 v13, v13
  v_mfma_f32_32x32x16_bf16 v[64:79], v[36:39], a[40:43], v[64:79]
  s_waitcnt lgkmcnt(6)
  ds_read_b64_tr_b16 v[28:29], v5 offset:26624
  ds_read_b64_tr_b16 v[30:31], v5 offset:27648
  v_fma_f32 v12, v12, v10, v10
  v_fma_f32 v13, v13, v10, v10
  v_rcp_f32 v12, v12
  v_mfma_f32_32x32x16_bf16 v[48:63], v[40:43], a[44:47], v[48:63]
  ds_read_b64_tr_b16 v[32:33], v1 offset:28672
  ds_read_b64_tr_b16 v[34:35], v1 offset:29696
  v_rcp_f32 v13, v13
  v_mul_f32 v12, v12, v88
  v_mul_f32 v13, v13, v89
  v_mfma_f32_32x32x16_bf16 v[64:79], v[44:47], a[44:47], v[64:79]
  s_waitcnt lgkmcnt(6)
  ds_read_b64_tr_b16 v[36:37], v5 offset:28672
  ds_read_b64_tr_b16 v[38:39], v5 offset:29696
  buffer_load_dwordx4 v3, s[8:11], s31 offen offset:3072 lds
  v_cvt_pk_bf16_f32 v164, v12, v13
  v_mul_f32 v14, v90, v90
  v_mul_f32 v15, v91, v91
  v_fma_f32 v14, v14, v8, v6
  v_fma_f32 v15, v15, v8, v6
  v_mfma_f32_32x32x16_bf16 v[48:63], v[16:19], a[48:51], v[48:63]
  ds_read_b64_tr_b16 v[40:41], v1 offset:30720
  ds_read_b64_tr_b16 v[42:43], v1 offset:31744
  v_mul_f32 v14, v14, v90
  v_mul_f32 v15, v15, v91
  v_exp_f32 v14, v14
  v_mfma_f32_32x32x16_bf16 v[64:79], v[20:23], a[48:51], v[64:79]
  s_waitcnt lgkmcnt(6)
  ds_read_b64_tr_b16 v[44:45], v5 offset:30720
  ds_read_b64_tr_b16 v[46:47], v5 offset:31744
  v_exp_f32 v15, v15
  v_fma_f32 v14, v14, v10, v10
  v_fma_f32 v15, v15, v10, v10
  v_rcp_f32 v14, v14
  v_mfma_f32_32x32x16_bf16 v[48:63], v[24:27], a[52:55], v[48:63]
  s_add_u32 m0, s42, 81920
  ds_read_b64_tr_b16 v[16:17], v1 offset:32768
  ds_read_b64_tr_b16 v[18:19], v1 offset:33792
  buffer_load_dwordx4 v3, s[8:11], s32 offen offset:0 lds
  v_rcp_f32 v15, v15
  v_mul_f32 v14, v14, v90
  v_mul_f32 v15, v15, v91
  v_mfma_f32_32x32x16_bf16 v[64:79], v[28:31], a[52:55], v[64:79]
  s_waitcnt lgkmcnt(6)
  ds_read_b64_tr_b16 v[20:21], v5 offset:32768
  ds_read_b64_tr_b16 v[22:23], v5 offset:33792
  v_cvt_pk_bf16_f32 v165, v14, v15
  v_mul_f32 v12, v92, v92
  v_mul_f32 v13, v93, v93
  v_fma_f32 v12, v12, v8, v6
  v_mfma_f32_32x32x16_bf16 v[48:63], v[32:35], a[56:59], v[48:63]
  ds_read_b64_tr_b16 v[24:25], v1 offset:34816
  ds_read_b64_tr_b16 v[26:27], v1 offset:35840
  v_fma_f32 v13, v13, v8, v6
  v_mul_f32 v12, v12, v92
  v_mul_f32 v13, v13, v93
  v_exp_f32 v12, v12
  v_mfma_f32_32x32x16_bf16 v[64:79], v[36:39], a[56:59], v[64:79]
  s_waitcnt lgkmcnt(6)
  ds_read_b64_tr_b16 v[28:29], v5 offset:34816
  ds_read_b64_tr_b16 v[30:31], v5 offset:35840
  v_subrev_u32 v3, 2654080, v3
  v_add_u32 v2, 0, v0
  v_xor_b32 v11, 64, v2
  v_exp_f32 v13, v13
  v_fma_f32 v12, v12, v10, v10
  v_fma_f32 v13, v13, v10, v10
  v_mfma_f32_32x32x16_bf16 v[48:63], v[40:43], a[60:63], v[48:63]
  v_rcp_f32 v12, v12
  v_rcp_f32 v13, v13
  v_mul_f32 v12, v12, v92
  v_mul_f32 v13, v13, v93
  v_mfma_f32_32x32x16_bf16 v[64:79], v[44:47], a[60:63], v[64:79]
  s_waitcnt vmcnt(18) lgkmcnt(0)
  s_barrier
  ds_read_b64_tr_b16 v[32:33], v2 offset:0
  ds_read_b64_tr_b16 v[34:35], v2 offset:1024
  ds_read_b64_tr_b16 v[36:37], v11 offset:0
  ds_read_b64_tr_b16 v[38:39], v11 offset:1024
  v_cvt_pk_bf16_f32 v166, v12, v13
  v_mul_f32 v14, v94, v94
  v_mul_f32 v15, v95, v95
  v_fma_f32 v14, v14, v8, v6
  v_mfma_f32_32x32x16_bf16 v[48:63], v[16:19], a[64:67], v[48:63]
  ds_read_b64_tr_b16 v[40:41], v2 offset:2048
  ds_read_b64_tr_b16 v[42:43], v2 offset:3072
  v_fma_f32 v15, v15, v8, v6
  v_mul_f32 v14, v14, v94
  v_mul_f32 v15, v15, v95
  v_exp_f32 v14, v14
  v_mfma_f32_32x32x16_bf16 v[64:79], v[20:23], a[64:67], v[64:79]
  s_waitcnt lgkmcnt(6)
  ds_read_b64_tr_b16 v[44:45], v11 offset:2048
  ds_read_b64_tr_b16 v[46:47], v11 offset:3072
  v_exp_f32 v15, v15
  v_fma_f32 v14, v14, v10, v10
  v_fma_f32 v15, v15, v10, v10
  v_mfma_f32_32x32x16_bf16 v[48:63], v[24:27], a[68:71], v[48:63]
  ds_read_b64_tr_b16 v[16:17], v2 offset:4096
  ds_read_b64_tr_b16 v[18:19], v2 offset:5120
  v_rcp_f32 v14, v14
  v_rcp_f32 v15, v15
  v_mul_f32 v14, v14, v94
  v_mul_f32 v15, v15, v95
  v_cvt_pk_bf16_f32 v167, v14, v15
  v_mfma_f32_32x32x16_bf16 v[64:79], v[28:31], a[68:71], v[64:79]
  s_waitcnt lgkmcnt(6)
  ds_read_b64_tr_b16 v[20:21], v11 offset:4096
  ds_read_b64_tr_b16 v[22:23], v11 offset:5120
  v_mfma_f32_32x32x16_bf16 v[48:63], v[32:35], a[72:75], v[48:63]
  ds_read_b64_tr_b16 v[24:25], v2 offset:6144
  ds_read_b64_tr_b16 v[26:27], v2 offset:7168
  v_mfma_f32_32x32x16_bf16 v[64:79], v[36:39], a[72:75], v[64:79]
  s_waitcnt lgkmcnt(6)
  ds_read_b64_tr_b16 v[28:29], v11 offset:6144
  ds_read_b64_tr_b16 v[30:31], v11 offset:7168
  v_mfma_f32_32x32x16_bf16 v[48:63], v[40:43], a[76:79], v[48:63]
  s_add_u32 m0, s42, 110592
  ds_read_b64_tr_b16 v[32:33], v2 offset:8192
  ds_read_b64_tr_b16 v[34:35], v2 offset:9216
  buffer_load_dwordx4 v3, s[8:11], s24 offen offset:0 lds
  v_mul_f32 v12, v96, v96
  v_mul_f32 v13, v97, v97
  v_mfma_f32_32x32x16_bf16 v[64:79], v[44:47], a[76:79], v[64:79]
  s_waitcnt lgkmcnt(6)
  ds_read_b64_tr_b16 v[36:37], v11 offset:8192
  ds_read_b64_tr_b16 v[38:39], v11 offset:9216
  v_fma_f32 v12, v12, v8, v6
  v_fma_f32 v13, v13, v8, v6
  v_mul_f32 v12, v12, v96
  v_mul_f32 v13, v13, v97
  v_exp_f32 v12, v12
  v_mfma_f32_32x32x16_bf16 v[48:63], v[16:19], a[80:83], v[48:63]
  ds_read_b64_tr_b16 v[40:41], v2 offset:10240
  ds_read_b64_tr_b16 v[42:43], v2 offset:11264
  v_exp_f32 v13, v13
  v_fma_f32 v12, v12, v10, v10
  v_mfma_f32_32x32x16_bf16 v[64:79], v[20:23], a[80:83], v[64:79]
  s_waitcnt lgkmcnt(6)
  ds_read_b64_tr_b16 v[44:45], v11 offset:10240
  ds_read_b64_tr_b16 v[46:47], v11 offset:11264
  buffer_load_dwordx4 v3, s[8:11], s25 offen offset:1024 lds
  v_fma_f32 v13, v13, v10, v10
  v_rcp_f32 v12, v12
  v_rcp_f32 v13, v13
  v_mfma_f32_32x32x16_bf16 v[48:63], v[24:27], a[84:87], v[48:63]
  ds_read_b64_tr_b16 v[16:17], v2 offset:12288
  ds_read_b64_tr_b16 v[18:19], v2 offset:13312
  v_mul_f32 v12, v12, v96
  v_mul_f32 v13, v13, v97
  v_cvt_pk_bf16_f32 v168, v12, v13
  v_mul_f32 v14, v98, v98
  v_mul_f32 v15, v99, v99
  v_mfma_f32_32x32x16_bf16 v[64:79], v[28:31], a[84:87], v[64:79]
  s_waitcnt lgkmcnt(6)
  ds_read_b64_tr_b16 v[20:21], v11 offset:12288
  ds_read_b64_tr_b16 v[22:23], v11 offset:13312
  v_fma_f32 v14, v14, v8, v6
  v_fma_f32 v15, v15, v8, v6
  v_mul_f32 v14, v14, v98
  v_mul_f32 v15, v15, v99
  v_mfma_f32_32x32x16_bf16 v[48:63], v[32:35], a[88:91], v[48:63]
  ds_read_b64_tr_b16 v[24:25], v2 offset:14336
  ds_read_b64_tr_b16 v[26:27], v2 offset:15360
  buffer_load_dwordx4 v3, s[8:11], s26 offen offset:2048 lds
  v_exp_f32 v14, v14
  v_exp_f32 v15, v15
  v_fma_f32 v14, v14, v10, v10
  v_mfma_f32_32x32x16_bf16 v[64:79], v[36:39], a[88:91], v[64:79]
  s_waitcnt lgkmcnt(6)
  ds_read_b64_tr_b16 v[28:29], v11 offset:14336
  ds_read_b64_tr_b16 v[30:31], v11 offset:15360
  v_fma_f32 v15, v15, v10, v10
  v_rcp_f32 v14, v14
  v_rcp_f32 v15, v15
  v_mfma_f32_32x32x16_bf16 v[48:63], v[40:43], a[92:95], v[48:63]
  ds_read_b64_tr_b16 v[32:33], v2 offset:16384
  ds_read_b64_tr_b16 v[34:35], v2 offset:17408
  v_mul_f32 v14, v14, v98
  v_mul_f32 v15, v15, v99
  v_cvt_pk_bf16_f32 v169, v14, v15
  v_mul_f32 v12, v100, v100
  v_mfma_f32_32x32x16_bf16 v[64:79], v[44:47], a[92:95], v[64:79]
  s_waitcnt lgkmcnt(6)
  ds_read_b64_tr_b16 v[36:37], v11 offset:16384
  ds_read_b64_tr_b16 v[38:39], v11 offset:17408
  buffer_load_dwordx4 v3, s[8:11], s27 offen offset:3072 lds
  v_mul_f32 v13, v101, v101
  v_fma_f32 v12, v12, v8, v6
  v_fma_f32 v13, v13, v8, v6
  v_mul_f32 v12, v12, v100
  v_mul_f32 v13, v13, v101
  v_mfma_f32_32x32x16_bf16 v[48:63], v[16:19], a[96:99], v[48:63]
  ds_read_b64_tr_b16 v[40:41], v2 offset:18432
  ds_read_b64_tr_b16 v[42:43], v2 offset:19456
  v_exp_f32 v12, v12
  v_exp_f32 v13, v13
  v_mfma_f32_32x32x16_bf16 v[64:79], v[20:23], a[96:99], v[64:79]
  s_waitcnt lgkmcnt(6)
  ds_read_b64_tr_b16 v[44:45], v11 offset:18432
  ds_read_b64_tr_b16 v[46:47], v11 offset:19456
  v_fma_f32 v12, v12, v10, v10
  v_fma_f32 v13, v13, v10, v10
  v_rcp_f32 v12, v12
  v_rcp_f32 v13, v13
  v_mfma_f32_32x32x16_bf16 v[48:63], v[24:27], a[100:103], v[48:63]
  s_add_u32 m0, s42, 114688
  ds_read_b64_tr_b16 v[16:17], v2 offset:20480
  ds_read_b64_tr_b16 v[18:19], v2 offset:21504
  buffer_load_dwordx4 v3, s[8:11], s28 offen offset:0 lds
  v_mul_f32 v12, v12, v100
  v_mul_f32 v13, v13, v101
  v_cvt_pk_bf16_f32 v170, v12, v13
  v_mfma_f32_32x32x16_bf16 v[64:79], v[28:31], a[100:103], v[64:79]
  s_waitcnt lgkmcnt(6)
  ds_read_b64_tr_b16 v[20:21], v11 offset:20480
  ds_read_b64_tr_b16 v[22:23], v11 offset:21504
  v_mul_f32 v14, v102, v102
  v_mul_f32 v15, v103, v103
  v_fma_f32 v14, v14, v8, v6
  v_fma_f32 v15, v15, v8, v6
  v_mul_f32 v14, v14, v102
  v_mfma_f32_32x32x16_bf16 v[48:63], v[32:35], a[104:107], v[48:63]
  ds_read_b64_tr_b16 v[24:25], v2 offset:22528
  ds_read_b64_tr_b16 v[26:27], v2 offset:23552
  v_mul_f32 v15, v15, v103
  v_exp_f32 v14, v14
  v_exp_f32 v15, v15
  v_mfma_f32_32x32x16_bf16 v[64:79], v[36:39], a[104:107], v[64:79]
  s_waitcnt lgkmcnt(6)
  ds_read_b64_tr_b16 v[28:29], v11 offset:22528
  ds_read_b64_tr_b16 v[30:31], v11 offset:23552
  buffer_load_dwordx4 v3, s[8:11], s29 offen offset:1024 lds
  v_fma_f32 v14, v14, v10, v10
  v_fma_f32 v15, v15, v10, v10
  v_rcp_f32 v14, v14
  v_mfma_f32_32x32x16_bf16 v[48:63], v[40:43], a[108:111], v[48:63]
  ds_read_b64_tr_b16 v[32:33], v2 offset:24576
  ds_read_b64_tr_b16 v[34:35], v2 offset:25600
  v_rcp_f32 v15, v15
  v_mul_f32 v14, v14, v102
  v_mul_f32 v15, v15, v103
  v_cvt_pk_bf16_f32 v171, v14, v15
  v_mfma_f32_32x32x16_bf16 v[64:79], v[44:47], a[108:111], v[64:79]
  s_waitcnt lgkmcnt(6)
  ds_read_b64_tr_b16 v[36:37], v11 offset:24576
  ds_read_b64_tr_b16 v[38:39], v11 offset:25600
  v_mul_f32 v12, v104, v104
  v_mul_f32 v13, v105, v105
  v_fma_f32 v12, v12, v8, v6
  v_fma_f32 v13, v13, v8, v6
  v_mfma_f32_32x32x16_bf16 v[48:63], v[16:19], a[112:115], v[48:63]
  ds_read_b64_tr_b16 v[40:41], v2 offset:26624
  ds_read_b64_tr_b16 v[42:43], v2 offset:27648
  buffer_load_dwordx4 v3, s[8:11], s30 offen offset:2048 lds
  v_mul_f32 v12, v12, v104
  v_mul_f32 v13, v13, v105
  v_exp_f32 v12, v12
  v_exp_f32 v13, v13
  v_mfma_f32_32x32x16_bf16 v[64:79], v[20:23], a[112:115], v[64:79]
  s_waitcnt lgkmcnt(6)
  ds_read_b64_tr_b16 v[44:45], v11 offset:26624
  ds_read_b64_tr_b16 v[46:47], v11 offset:27648
  v_fma_f32 v12, v12, v10, v10
  v_fma_f32 v13, v13, v10, v10
  v_rcp_f32 v12, v12
  v_mfma_f32_32x32x16_bf16 v[48:63], v[24:27], a[116:119], v[48:63]
  ds_read_b64_tr_b16 v[16:17], v2 offset:28672
  ds_read_b64_tr_b16 v[18:19], v2 offset:29696
  v_rcp_f32 v13, v13
  v_mul_f32 v12, v12, v104
  v_mul_f32 v13, v13, v105
  v_mfma_f32_32x32x16_bf16 v[64:79], v[28:31], a[116:119], v[64:79]
  s_waitcnt lgkmcnt(6)
  ds_read_b64_tr_b16 v[20:21], v11 offset:28672
  ds_read_b64_tr_b16 v[22:23], v11 offset:29696
  buffer_load_dwordx4 v3, s[8:11], s31 offen offset:3072 lds
  v_cvt_pk_bf16_f32 v172, v12, v13
  v_mul_f32 v14, v106, v106
  v_mul_f32 v15, v107, v107
  v_fma_f32 v14, v14, v8, v6
  v_fma_f32 v15, v15, v8, v6
  v_mfma_f32_32x32x16_bf16 v[48:63], v[32:35], a[120:123], v[48:63]
  ds_read_b64_tr_b16 v[24:25], v2 offset:30720
  ds_read_b64_tr_b16 v[26:27], v2 offset:31744
  v_mul_f32 v14, v14, v106
  v_mul_f32 v15, v15, v107
  v_exp_f32 v14, v14
  v_mfma_f32_32x32x16_bf16 v[64:79], v[36:39], a[120:123], v[64:79]
  s_waitcnt lgkmcnt(6)
  ds_read_b64_tr_b16 v[28:29], v11 offset:30720
  ds_read_b64_tr_b16 v[30:31], v11 offset:31744
  v_exp_f32 v15, v15
  v_fma_f32 v14, v14, v10, v10
  v_fma_f32 v15, v15, v10, v10
  v_rcp_f32 v14, v14
  v_mfma_f32_32x32x16_bf16 v[48:63], v[40:43], a[124:127], v[48:63]
  s_add_u32 m0, s42, 118784
  ds_read_b64_tr_b16 v[32:33], v2 offset:32768
  ds_read_b64_tr_b16 v[34:35], v2 offset:33792
  buffer_load_dwordx4 v3, s[8:11], s32 offen offset:0 lds
  v_rcp_f32 v15, v15
  v_mul_f32 v14, v14, v106
  v_mul_f32 v15, v15, v107
  v_mfma_f32_32x32x16_bf16 v[64:79], v[44:47], a[124:127], v[64:79]
  s_waitcnt lgkmcnt(6)
  ds_read_b64_tr_b16 v[36:37], v11 offset:32768
  ds_read_b64_tr_b16 v[38:39], v11 offset:33792
  v_cvt_pk_bf16_f32 v173, v14, v15
  v_mul_f32 v12, v108, v108
  v_mul_f32 v13, v109, v109
  v_fma_f32 v12, v12, v8, v6
  v_mfma_f32_32x32x16_bf16 v[48:63], v[16:19], a[128:131], v[48:63]
  ds_read_b64_tr_b16 v[40:41], v2 offset:34816
  ds_read_b64_tr_b16 v[42:43], v2 offset:35840
  v_fma_f32 v13, v13, v8, v6
  v_mul_f32 v12, v12, v108
  v_mul_f32 v13, v13, v109
  v_exp_f32 v12, v12
  v_mfma_f32_32x32x16_bf16 v[64:79], v[20:23], a[128:131], v[64:79]
  s_waitcnt lgkmcnt(6)
  ds_read_b64_tr_b16 v[44:45], v11 offset:34816
  ds_read_b64_tr_b16 v[46:47], v11 offset:35840
  v_add_u32 v3, 2654208, v3
  v_add_u32 v1, 36864, v0
  v_xor_b32 v5, 64, v1
  v_exp_f32 v13, v13
  v_fma_f32 v12, v12, v10, v10
  v_fma_f32 v13, v13, v10, v10
  v_mfma_f32_32x32x16_bf16 v[48:63], v[24:27], a[132:135], v[48:63]
  v_rcp_f32 v12, v12
  v_rcp_f32 v13, v13
  v_mul_f32 v12, v12, v108
  v_mul_f32 v13, v13, v109
  v_mfma_f32_32x32x16_bf16 v[64:79], v[28:31], a[132:135], v[64:79]
  s_waitcnt vmcnt(18) lgkmcnt(0)
  s_barrier
  ds_read_b64_tr_b16 v[16:17], v1 offset:0
  ds_read_b64_tr_b16 v[18:19], v1 offset:1024
  ds_read_b64_tr_b16 v[20:21], v5 offset:0
  ds_read_b64_tr_b16 v[22:23], v5 offset:1024
  v_cvt_pk_bf16_f32 v174, v12, v13
  v_mul_f32 v14, v110, v110
  v_mul_f32 v15, v111, v111
  v_fma_f32 v14, v14, v8, v6
  v_mfma_f32_32x32x16_bf16 v[48:63], v[32:35], a[136:139], v[48:63]
  ds_read_b64_tr_b16 v[24:25], v1 offset:2048
  ds_read_b64_tr_b16 v[26:27], v1 offset:3072
  v_fma_f32 v15, v15, v8, v6
  v_mul_f32 v14, v14, v110
  v_mul_f32 v15, v15, v111
  v_exp_f32 v14, v14
  v_mfma_f32_32x32x16_bf16 v[64:79], v[36:39], a[136:139], v[64:79]
  s_waitcnt lgkmcnt(6)
  ds_read_b64_tr_b16 v[28:29], v5 offset:2048
  ds_read_b64_tr_b16 v[30:31], v5 offset:3072
  v_exp_f32 v15, v15
  v_fma_f32 v14, v14, v10, v10
  v_fma_f32 v15, v15, v10, v10
  v_mfma_f32_32x32x16_bf16 v[48:63], v[40:43], a[140:143], v[48:63]
  ds_read_b64_tr_b16 v[32:33], v1 offset:4096
  ds_read_b64_tr_b16 v[34:35], v1 offset:5120
  v_rcp_f32 v14, v14
  v_rcp_f32 v15, v15
  v_mul_f32 v14, v14, v110
  v_mul_f32 v15, v15, v111
  v_cvt_pk_bf16_f32 v175, v14, v15
  v_mfma_f32_32x32x16_bf16 v[64:79], v[44:47], a[140:143], v[64:79]
  s_waitcnt lgkmcnt(6)
  ds_read_b64_tr_b16 v[36:37], v5 offset:4096
  ds_read_b64_tr_b16 v[38:39], v5 offset:5120
  v_mfma_f32_32x32x16_bf16 v[80:95], v[16:19], a[0:3], 0
  ds_read_b64_tr_b16 v[40:41], v1 offset:6144
  ds_read_b64_tr_b16 v[42:43], v1 offset:7168
  v_mfma_f32_32x32x16_bf16 v[96:111], v[20:23], a[0:3], 0
  s_waitcnt lgkmcnt(6)
  ds_read_b64_tr_b16 v[44:45], v5 offset:6144
  ds_read_b64_tr_b16 v[46:47], v5 offset:7168
  v_mfma_f32_32x32x16_bf16 v[80:95], v[24:27], a[4:7], v[80:95]
  s_add_u32 m0, s42, 0
  ds_read_b64_tr_b16 v[16:17], v1 offset:8192
  ds_read_b64_tr_b16 v[18:19], v1 offset:9216
  buffer_load_dwordx4 v3, s[8:11], s24 offen offset:0 lds
  v_mul_f32 v12, v48, v48
  v_mul_f32 v13, v49, v49
  v_mfma_f32_32x32x16_bf16 v[96:111], v[28:31], a[4:7], v[96:111]
  s_waitcnt lgkmcnt(6)
  ds_read_b64_tr_b16 v[20:21], v5 offset:8192
  ds_read_b64_tr_b16 v[22:23], v5 offset:9216
  v_fma_f32 v12, v12, v8, v6
  v_fma_f32 v13, v13, v8, v6
  v_mul_f32 v12, v12, v48
  v_mul_f32 v13, v13, v49
  v_exp_f32 v12, v12
  v_mfma_f32_32x32x16_bf16 v[80:95], v[32:35], a[8:11], v[80:95]
  ds_read_b64_tr_b16 v[24:25], v1 offset:10240
  ds_read_b64_tr_b16 v[26:27], v1 offset:11264
  v_exp_f32 v13, v13
  v_fma_f32 v12, v12, v10, v10
  v_mfma_f32_32x32x16_bf16 v[96:111], v[36:39], a[8:11], v[96:111]
  s_waitcnt lgkmcnt(6)
  ds_read_b64_tr_b16 v[28:29], v5 offset:10240
  ds_read_b64_tr_b16 v[30:31], v5 offset:11264
  buffer_load_dwordx4 v3, s[8:11], s25 offen offset:1024 lds
  v_fma_f32 v13, v13, v10, v10
  v_rcp_f32 v12, v12
  v_rcp_f32 v13, v13
  v_mfma_f32_32x32x16_bf16 v[80:95], v[40:43], a[12:15], v[80:95]
  ds_read_b64_tr_b16 v[32:33], v1 offset:12288
  ds_read_b64_tr_b16 v[34:35], v1 offset:13312
  v_mul_f32 v12, v12, v48
  v_mul_f32 v13, v13, v49
  v_cvt_pk_bf16_f32 v176, v12, v13
  v_mul_f32 v14, v50, v50
  v_mul_f32 v15, v51, v51
  v_mfma_f32_32x32x16_bf16 v[96:111], v[44:47], a[12:15], v[96:111]
  s_waitcnt lgkmcnt(6)
  ds_read_b64_tr_b16 v[36:37], v5 offset:12288
  ds_read_b64_tr_b16 v[38:39], v5 offset:13312
  v_fma_f32 v14, v14, v8, v6
  v_fma_f32 v15, v15, v8, v6
  v_mul_f32 v14, v14, v50
  v_mul_f32 v15, v15, v51
  v_mfma_f32_32x32x16_bf16 v[80:95], v[16:19], a[16:19], v[80:95]
  ds_read_b64_tr_b16 v[40:41], v1 offset:14336
  ds_read_b64_tr_b16 v[42:43], v1 offset:15360
  buffer_load_dwordx4 v3, s[8:11], s26 offen offset:2048 lds
  v_exp_f32 v14, v14
  v_exp_f32 v15, v15
  v_fma_f32 v14, v14, v10, v10
  v_mfma_f32_32x32x16_bf16 v[96:111], v[20:23], a[16:19], v[96:111]
  s_waitcnt lgkmcnt(6)
  ds_read_b64_tr_b16 v[44:45], v5 offset:14336
  ds_read_b64_tr_b16 v[46:47], v5 offset:15360
  v_fma_f32 v15, v15, v10, v10
  v_rcp_f32 v14, v14
  v_rcp_f32 v15, v15
  v_mfma_f32_32x32x16_bf16 v[80:95], v[24:27], a[20:23], v[80:95]
  ds_read_b64_tr_b16 v[16:17], v1 offset:16384
  ds_read_b64_tr_b16 v[18:19], v1 offset:17408
  v_mul_f32 v14, v14, v50
  v_mul_f32 v15, v15, v51
  v_cvt_pk_bf16_f32 v177, v14, v15
  v_mul_f32 v12, v52, v52
  v_mfma_f32_32x32x16_bf16 v[96:111], v[28:31], a[20:23], v[96:111]
  s_waitcnt lgkmcnt(6)
  ds_read_b64_tr_b16 v[20:21], v5 offset:16384
  ds_read_b64_tr_b16 v[22:23], v5 offset:17408
  buffer_load_dwordx4 v3, s[8:11], s27 offen offset:3072 lds
  v_mul_f32 v13, v53, v53
  v_fma_f32 v12, v12, v8, v6
  v_fma_f32 v13, v13, v8, v6
  v_mul_f32 v12, v12, v52
  v_mul_f32 v13, v13, v53
  v_mfma_f32_32x32x16_bf16 v[80:95], v[32:35], a[24:27], v[80:95]
  ds_read_b64_tr_b16 v[24:25], v1 offset:18432
  ds_read_b64_tr_b16 v[26:27], v1 offset:19456
  v_exp_f32 v12, v12
  v_exp_f32 v13, v13
  v_mfma_f32_32x32x16_bf16 v[96:111], v[36:39], a[24:27], v[96:111]
  s_waitcnt lgkmcnt(6)
  ds_read_b64_tr_b16 v[28:29], v5 offset:18432
  ds_read_b64_tr_b16 v[30:31], v5 offset:19456
  v_fma_f32 v12, v12, v10, v10
  v_fma_f32 v13, v13, v10, v10
  v_rcp_f32 v12, v12
  v_rcp_f32 v13, v13
  v_mfma_f32_32x32x16_bf16 v[80:95], v[40:43], a[28:31], v[80:95]
  s_add_u32 m0, s42, 4096
  ds_read_b64_tr_b16 v[32:33], v1 offset:20480
  ds_read_b64_tr_b16 v[34:35], v1 offset:21504
  buffer_load_dwordx4 v3, s[8:11], s28 offen offset:0 lds
  v_mul_f32 v12, v12, v52
  v_mul_f32 v13, v13, v53
  v_cvt_pk_bf16_f32 v178, v12, v13
  v_mfma_f32_32x32x16_bf16 v[96:111], v[44:47], a[28:31], v[96:111]
  s_waitcnt lgkmcnt(6)
  ds_read_b64_tr_b16 v[36:37], v5 offset:20480
  ds_read_b64_tr_b16 v[38:39], v5 offset:21504
  v_mul_f32 v14, v54, v54
  v_mul_f32 v15, v55, v55
  v_fma_f32 v14, v14, v8, v6
  v_fma_f32 v15, v15, v8, v6
  v_mul_f32 v14, v14, v54
  v_mfma_f32_32x32x16_bf16 v[80:95], v[16:19], a[32:35], v[80:95]
  ds_read_b64_tr_b16 v[40:41], v1 offset:22528
  ds_read_b64_tr_b16 v[42:43], v1 offset:23552
  v_mul_f32 v15, v15, v55
  v_exp_f32 v14, v14
  v_exp_f32 v15, v15
  v_mfma_f32_32x32x16_bf16 v[96:111], v[20:23], a[32:35], v[96:111]
  s_waitcnt lgkmcnt(6)
  ds_read_b64_tr_b16 v[44:45], v5 offset:22528
  ds_read_b64_tr_b16 v[46:47], v5 offset:23552
  buffer_load_dwordx4 v3, s[8:11], s29 offen offset:1024 lds
  v_fma_f32 v14, v14, v10, v10
  v_fma_f32 v15, v15, v10, v10
  v_rcp_f32 v14, v14
  v_mfma_f32_32x32x16_bf16 v[80:95], v[24:27], a[36:39], v[80:95]
  ds_read_b64_tr_b16 v[16:17], v1 offset:24576
  ds_read_b64_tr_b16 v[18:19], v1 offset:25600
  v_rcp_f32 v15, v15
  v_mul_f32 v14, v14, v54
  v_mul_f32 v15, v15, v55
  v_cvt_pk_bf16_f32 v179, v14, v15
  v_mfma_f32_32x32x16_bf16 v[96:111], v[28:31], a[36:39], v[96:111]
  s_waitcnt lgkmcnt(6)
  ds_read_b64_tr_b16 v[20:21], v5 offset:24576
  ds_read_b64_tr_b16 v[22:23], v5 offset:25600
  v_mul_f32 v12, v56, v56
  v_mul_f32 v13, v57, v57
  v_fma_f32 v12, v12, v8, v6
  v_fma_f32 v13, v13, v8, v6
  v_mfma_f32_32x32x16_bf16 v[80:95], v[32:35], a[40:43], v[80:95]
  ds_read_b64_tr_b16 v[24:25], v1 offset:26624
  ds_read_b64_tr_b16 v[26:27], v1 offset:27648
  buffer_load_dwordx4 v3, s[8:11], s30 offen offset:2048 lds
  v_mul_f32 v12, v12, v56
  v_mul_f32 v13, v13, v57
  v_exp_f32 v12, v12
  v_exp_f32 v13, v13
  v_mfma_f32_32x32x16_bf16 v[96:111], v[36:39], a[40:43], v[96:111]
  s_waitcnt lgkmcnt(6)
  ds_read_b64_tr_b16 v[28:29], v5 offset:26624
  ds_read_b64_tr_b16 v[30:31], v5 offset:27648
  v_fma_f32 v12, v12, v10, v10
  v_fma_f32 v13, v13, v10, v10
  v_rcp_f32 v12, v12
  v_mfma_f32_32x32x16_bf16 v[80:95], v[40:43], a[44:47], v[80:95]
  ds_read_b64_tr_b16 v[32:33], v1 offset:28672
  ds_read_b64_tr_b16 v[34:35], v1 offset:29696
  v_rcp_f32 v13, v13
  v_mul_f32 v12, v12, v56
  v_mul_f32 v13, v13, v57
  v_mfma_f32_32x32x16_bf16 v[96:111], v[44:47], a[44:47], v[96:111]
  s_waitcnt lgkmcnt(6)
  ds_read_b64_tr_b16 v[36:37], v5 offset:28672
  ds_read_b64_tr_b16 v[38:39], v5 offset:29696
  buffer_load_dwordx4 v3, s[8:11], s31 offen offset:3072 lds
  v_cvt_pk_bf16_f32 v180, v12, v13
  v_mul_f32 v14, v58, v58
  v_mul_f32 v15, v59, v59
  v_fma_f32 v14, v14, v8, v6
  v_fma_f32 v15, v15, v8, v6
  v_mfma_f32_32x32x16_bf16 v[80:95], v[16:19], a[48:51], v[80:95]
  ds_read_b64_tr_b16 v[40:41], v1 offset:30720
  ds_read_b64_tr_b16 v[42:43], v1 offset:31744
  v_mul_f32 v14, v14, v58
  v_mul_f32 v15, v15, v59
  v_exp_f32 v14, v14
  v_mfma_f32_32x32x16_bf16 v[96:111], v[20:23], a[48:51], v[96:111]
  s_waitcnt lgkmcnt(6)
  ds_read_b64_tr_b16 v[44:45], v5 offset:30720
  ds_read_b64_tr_b16 v[46:47], v5 offset:31744
  v_exp_f32 v15, v15
  v_fma_f32 v14, v14, v10, v10
  v_fma_f32 v15, v15, v10, v10
  v_rcp_f32 v14, v14
  v_mfma_f32_32x32x16_bf16 v[80:95], v[24:27], a[52:55], v[80:95]
  s_add_u32 m0, s42, 8192
  ds_read_b64_tr_b16 v[16:17], v1 offset:32768
  ds_read_b64_tr_b16 v[18:19], v1 offset:33792
  buffer_load_dwordx4 v3, s[8:11], s32 offen offset:0 lds
  v_rcp_f32 v15, v15
  v_mul_f32 v14, v14, v58
  v_mul_f32 v15, v15, v59
  v_mfma_f32_32x32x16_bf16 v[96:111], v[28:31], a[52:55], v[96:111]
  s_waitcnt lgkmcnt(6)
  ds_read_b64_tr_b16 v[20:21], v5 offset:32768
  ds_read_b64_tr_b16 v[22:23], v5 offset:33792
  v_cvt_pk_bf16_f32 v181, v14, v15
  v_mul_f32 v12, v60, v60
  v_mul_f32 v13, v61, v61
  v_fma_f32 v12, v12, v8, v6
  v_mfma_f32_32x32x16_bf16 v[80:95], v[32:35], a[56:59], v[80:95]
  ds_read_b64_tr_b16 v[24:25], v1 offset:34816
  ds_read_b64_tr_b16 v[26:27], v1 offset:35840
  v_fma_f32 v13, v13, v8, v6
  v_mul_f32 v12, v12, v60
  v_mul_f32 v13, v13, v61
  v_exp_f32 v12, v12
  v_mfma_f32_32x32x16_bf16 v[96:111], v[36:39], a[56:59], v[96:111]
  s_waitcnt lgkmcnt(6)
  ds_read_b64_tr_b16 v[28:29], v5 offset:34816
  ds_read_b64_tr_b16 v[30:31], v5 offset:35840
  v_subrev_u32 v3, 2654080, v3
  v_add_u32 v2, 73728, v0
  v_xor_b32 v11, 64, v2
  v_exp_f32 v13, v13
  v_fma_f32 v12, v12, v10, v10
  v_fma_f32 v13, v13, v10, v10
  v_mfma_f32_32x32x16_bf16 v[80:95], v[40:43], a[60:63], v[80:95]
  v_rcp_f32 v12, v12
  v_rcp_f32 v13, v13
  v_mul_f32 v12, v12, v60
  v_mul_f32 v13, v13, v61
  v_mfma_f32_32x32x16_bf16 v[96:111], v[44:47], a[60:63], v[96:111]
  s_waitcnt vmcnt(18) lgkmcnt(0)
  s_barrier
  ds_read_b64_tr_b16 v[32:33], v2 offset:0
  ds_read_b64_tr_b16 v[34:35], v2 offset:1024
  ds_read_b64_tr_b16 v[36:37], v11 offset:0
  ds_read_b64_tr_b16 v[38:39], v11 offset:1024
  v_cvt_pk_bf16_f32 v182, v12, v13
  v_mul_f32 v14, v62, v62
  v_mul_f32 v15, v63, v63
  v_fma_f32 v14, v14, v8, v6
  v_mfma_f32_32x32x16_bf16 v[80:95], v[16:19], a[64:67], v[80:95]
  ds_read_b64_tr_b16 v[40:41], v2 offset:2048
  ds_read_b64_tr_b16 v[42:43], v2 offset:3072
  v_fma_f32 v15, v15, v8, v6
  v_mul_f32 v14, v14, v62
  v_mul_f32 v15, v15, v63
  v_exp_f32 v14, v14
  v_mfma_f32_32x32x16_bf16 v[96:111], v[20:23], a[64:67], v[96:111]
  s_waitcnt lgkmcnt(6)
  ds_read_b64_tr_b16 v[44:45], v11 offset:2048
  ds_read_b64_tr_b16 v[46:47], v11 offset:3072
  v_exp_f32 v15, v15
  v_fma_f32 v14, v14, v10, v10
  v_fma_f32 v15, v15, v10, v10
  v_mfma_f32_32x32x16_bf16 v[80:95], v[24:27], a[68:71], v[80:95]
  ds_read_b64_tr_b16 v[16:17], v2 offset:4096
  ds_read_b64_tr_b16 v[18:19], v2 offset:5120
  v_rcp_f32 v14, v14
  v_rcp_f32 v15, v15
  v_mul_f32 v14, v14, v62
  v_mul_f32 v15, v15, v63
  v_cvt_pk_bf16_f32 v183, v14, v15
  v_mfma_f32_32x32x16_bf16 v[96:111], v[28:31], a[68:71], v[96:111]
  s_waitcnt lgkmcnt(6)
  ds_read_b64_tr_b16 v[20:21], v11 offset:4096
  ds_read_b64_tr_b16 v[22:23], v11 offset:5120
  v_mfma_f32_32x32x16_bf16 v[80:95], v[32:35], a[72:75], v[80:95]
  ds_read_b64_tr_b16 v[24:25], v2 offset:6144
  ds_read_b64_tr_b16 v[26:27], v2 offset:7168
  v_mfma_f32_32x32x16_bf16 v[96:111], v[36:39], a[72:75], v[96:111]
  s_waitcnt lgkmcnt(6)
  ds_read_b64_tr_b16 v[28:29], v11 offset:6144
  ds_read_b64_tr_b16 v[30:31], v11 offset:7168
  v_mfma_f32_32x32x16_bf16 v[80:95], v[40:43], a[76:79], v[80:95]
  s_add_u32 m0, s42, 36864
  ds_read_b64_tr_b16 v[32:33], v2 offset:8192
  ds_read_b64_tr_b16 v[34:35], v2 offset:9216
  buffer_load_dwordx4 v3, s[8:11], s24 offen offset:0 lds
  v_mul_f32 v12, v64, v64
  v_mul_f32 v13, v65, v65
  v_mfma_f32_32x32x16_bf16 v[96:111], v[44:47], a[76:79], v[96:111]
  s_waitcnt lgkmcnt(6)
  ds_read_b64_tr_b16 v[36:37], v11 offset:8192
  ds_read_b64_tr_b16 v[38:39], v11 offset:9216
  v_fma_f32 v12, v12, v8, v6
  v_fma_f32 v13, v13, v8, v6
  v_mul_f32 v12, v12, v64
  v_mul_f32 v13, v13, v65
  v_exp_f32 v12, v12
  v_mfma_f32_32x32x16_bf16 v[80:95], v[16:19], a[80:83], v[80:95]
  ds_read_b64_tr_b16 v[40:41], v2 offset:10240
  ds_read_b64_tr_b16 v[42:43], v2 offset:11264
  v_exp_f32 v13, v13
  v_fma_f32 v12, v12, v10, v10
  v_mfma_f32_32x32x16_bf16 v[96:111], v[20:23], a[80:83], v[96:111]
  s_waitcnt lgkmcnt(6)
  ds_read_b64_tr_b16 v[44:45], v11 offset:10240
  ds_read_b64_tr_b16 v[46:47], v11 offset:11264
  buffer_load_dwordx4 v3, s[8:11], s25 offen offset:1024 lds
  v_fma_f32 v13, v13, v10, v10
  v_rcp_f32 v12, v12
  v_rcp_f32 v13, v13
  v_mfma_f32_32x32x16_bf16 v[80:95], v[24:27], a[84:87], v[80:95]
  ds_read_b64_tr_b16 v[16:17], v2 offset:12288
  ds_read_b64_tr_b16 v[18:19], v2 offset:13312
  v_mul_f32 v12, v12, v64
  v_mul_f32 v13, v13, v65
  v_cvt_pk_bf16_f32 v184, v12, v13
  v_mul_f32 v14, v66, v66
  v_mul_f32 v15, v67, v67
  v_mfma_f32_32x32x16_bf16 v[96:111], v[28:31], a[84:87], v[96:111]
  s_waitcnt lgkmcnt(6)
  ds_read_b64_tr_b16 v[20:21], v11 offset:12288
  ds_read_b64_tr_b16 v[22:23], v11 offset:13312
  v_fma_f32 v14, v14, v8, v6
  v_fma_f32 v15, v15, v8, v6
  v_mul_f32 v14, v14, v66
  v_mul_f32 v15, v15, v67
  v_mfma_f32_32x32x16_bf16 v[80:95], v[32:35], a[88:91], v[80:95]
  ds_read_b64_tr_b16 v[24:25], v2 offset:14336
  ds_read_b64_tr_b16 v[26:27], v2 offset:15360
  buffer_load_dwordx4 v3, s[8:11], s26 offen offset:2048 lds
  v_exp_f32 v14, v14
  v_exp_f32 v15, v15
  v_fma_f32 v14, v14, v10, v10
  v_mfma_f32_32x32x16_bf16 v[96:111], v[36:39], a[88:91], v[96:111]
  s_waitcnt lgkmcnt(6)
  ds_read_b64_tr_b16 v[28:29], v11 offset:14336
  ds_read_b64_tr_b16 v[30:31], v11 offset:15360
  v_fma_f32 v15, v15, v10, v10
  v_rcp_f32 v14, v14
  v_rcp_f32 v15, v15
  v_mfma_f32_32x32x16_bf16 v[80:95], v[40:43], a[92:95], v[80:95]
  ds_read_b64_tr_b16 v[32:33], v2 offset:16384
  ds_read_b64_tr_b16 v[34:35], v2 offset:17408
  v_mul_f32 v14, v14, v66
  v_mul_f32 v15, v15, v67
  v_cvt_pk_bf16_f32 v185, v14, v15
  v_mul_f32 v12, v68, v68
  v_mfma_f32_32x32x16_bf16 v[96:111], v[44:47], a[92:95], v[96:111]
  s_waitcnt lgkmcnt(6)
  ds_read_b64_tr_b16 v[36:37], v11 offset:16384
  ds_read_b64_tr_b16 v[38:39], v11 offset:17408
  buffer_load_dwordx4 v3, s[8:11], s27 offen offset:3072 lds
  v_mul_f32 v13, v69, v69
  v_fma_f32 v12, v12, v8, v6
  v_fma_f32 v13, v13, v8, v6
  v_mul_f32 v12, v12, v68
  v_mul_f32 v13, v13, v69
  v_mfma_f32_32x32x16_bf16 v[80:95], v[16:19], a[96:99], v[80:95]
  ds_read_b64_tr_b16 v[40:41], v2 offset:18432
  ds_read_b64_tr_b16 v[42:43], v2 offset:19456
  v_exp_f32 v12, v12
  v_exp_f32 v13, v13
  v_mfma_f32_32x32x16_bf16 v[96:111], v[20:23], a[96:99], v[96:111]
  s_waitcnt lgkmcnt(6)
  ds_read_b64_tr_b16 v[44:45], v11 offset:18432
  ds_read_b64_tr_b16 v[46:47], v11 offset:19456
  v_fma_f32 v12, v12, v10, v10
  v_fma_f32 v13, v13, v10, v10
  v_rcp_f32 v12, v12
  v_rcp_f32 v13, v13
  v_mfma_f32_32x32x16_bf16 v[80:95], v[24:27], a[100:103], v[80:95]
  s_add_u32 m0, s42, 40960
  ds_read_b64_tr_b16 v[16:17], v2 offset:20480
  ds_read_b64_tr_b16 v[18:19], v2 offset:21504
  buffer_load_dwordx4 v3, s[8:11], s28 offen offset:0 lds
  v_mul_f32 v12, v12, v68
  v_mul_f32 v13, v13, v69
  v_cvt_pk_bf16_f32 v186, v12, v13
  v_mfma_f32_32x32x16_bf16 v[96:111], v[28:31], a[100:103], v[96:111]
  s_waitcnt lgkmcnt(6)
  ds_read_b64_tr_b16 v[20:21], v11 offset:20480
  ds_read_b64_tr_b16 v[22:23], v11 offset:21504
  v_mul_f32 v14, v70, v70
  v_mul_f32 v15, v71, v71
  v_fma_f32 v14, v14, v8, v6
  v_fma_f32 v15, v15, v8, v6
  v_mul_f32 v14, v14, v70
  v_mfma_f32_32x32x16_bf16 v[80:95], v[32:35], a[104:107], v[80:95]
  ds_read_b64_tr_b16 v[24:25], v2 offset:22528
  ds_read_b64_tr_b16 v[26:27], v2 offset:23552
  v_mul_f32 v15, v15, v71
  v_exp_f32 v14, v14
  v_exp_f32 v15, v15
  v_mfma_f32_32x32x16_bf16 v[96:111], v[36:39], a[104:107], v[96:111]
  s_waitcnt lgkmcnt(6)
  ds_read_b64_tr_b16 v[28:29], v11 offset:22528
  ds_read_b64_tr_b16 v[30:31], v11 offset:23552
  buffer_load_dwordx4 v3, s[8:11], s29 offen offset:1024 lds
  v_fma_f32 v14, v14, v10, v10
  v_fma_f32 v15, v15, v10, v10
  v_rcp_f32 v14, v14
  v_mfma_f32_32x32x16_bf16 v[80:95], v[40:43], a[108:111], v[80:95]
  ds_read_b64_tr_b16 v[32:33], v2 offset:24576
  ds_read_b64_tr_b16 v[34:35], v2 offset:25600
  v_rcp_f32 v15, v15
  v_mul_f32 v14, v14, v70
  v_mul_f32 v15, v15, v71
  v_cvt_pk_bf16_f32 v187, v14, v15
  v_mfma_f32_32x32x16_bf16 v[96:111], v[44:47], a[108:111], v[96:111]
  s_waitcnt lgkmcnt(6)
  ds_read_b64_tr_b16 v[36:37], v11 offset:24576
  ds_read_b64_tr_b16 v[38:39], v11 offset:25600
  v_mul_f32 v12, v72, v72
  v_mul_f32 v13, v73, v73
  v_fma_f32 v12, v12, v8, v6
  v_fma_f32 v13, v13, v8, v6
  v_mfma_f32_32x32x16_bf16 v[80:95], v[16:19], a[112:115], v[80:95]
  ds_read_b64_tr_b16 v[40:41], v2 offset:26624
  ds_read_b64_tr_b16 v[42:43], v2 offset:27648
  buffer_load_dwordx4 v3, s[8:11], s30 offen offset:2048 lds
  v_mul_f32 v12, v12, v72
  v_mul_f32 v13, v13, v73
  v_exp_f32 v12, v12
  v_exp_f32 v13, v13
  v_mfma_f32_32x32x16_bf16 v[96:111], v[20:23], a[112:115], v[96:111]
  s_waitcnt lgkmcnt(6)
  ds_read_b64_tr_b16 v[44:45], v11 offset:26624
  ds_read_b64_tr_b16 v[46:47], v11 offset:27648
  v_fma_f32 v12, v12, v10, v10
  v_fma_f32 v13, v13, v10, v10
  v_rcp_f32 v12, v12
  v_mfma_f32_32x32x16_bf16 v[80:95], v[24:27], a[116:119], v[80:95]
  ds_read_b64_tr_b16 v[16:17], v2 offset:28672
  ds_read_b64_tr_b16 v[18:19], v2 offset:29696
  v_rcp_f32 v13, v13
  v_mul_f32 v12, v12, v72
  v_mul_f32 v13, v13, v73
  v_mfma_f32_32x32x16_bf16 v[96:111], v[28:31], a[116:119], v[96:111]
  s_waitcnt lgkmcnt(6)
  ds_read_b64_tr_b16 v[20:21], v11 offset:28672
  ds_read_b64_tr_b16 v[22:23], v11 offset:29696
  buffer_load_dwordx4 v3, s[8:11], s31 offen offset:3072 lds
  v_cvt_pk_bf16_f32 v188, v12, v13
  v_mul_f32 v14, v74, v74
  v_mul_f32 v15, v75, v75
  v_fma_f32 v14, v14, v8, v6
  v_fma_f32 v15, v15, v8, v6
  v_mfma_f32_32x32x16_bf16 v[80:95], v[32:35], a[120:123], v[80:95]
  ds_read_b64_tr_b16 v[24:25], v2 offset:30720
  ds_read_b64_tr_b16 v[26:27], v2 offset:31744
  v_mul_f32 v14, v14, v74
  v_mul_f32 v15, v15, v75
  v_exp_f32 v14, v14
  v_mfma_f32_32x32x16_bf16 v[96:111], v[36:39], a[120:123], v[96:111]
  s_waitcnt lgkmcnt(6)
  ds_read_b64_tr_b16 v[28:29], v11 offset:30720
  ds_read_b64_tr_b16 v[30:31], v11 offset:31744
  v_exp_f32 v15, v15
  v_fma_f32 v14, v14, v10, v10
  v_fma_f32 v15, v15, v10, v10
  v_rcp_f32 v14, v14
  v_mfma_f32_32x32x16_bf16 v[80:95], v[40:43], a[124:127], v[80:95]
  s_add_u32 m0, s42, 45056
  ds_read_b64_tr_b16 v[32:33], v2 offset:32768
  ds_read_b64_tr_b16 v[34:35], v2 offset:33792
  buffer_load_dwordx4 v3, s[8:11], s32 offen offset:0 lds
  v_rcp_f32 v15, v15
  v_mul_f32 v14, v14, v74
  v_mul_f32 v15, v15, v75
  v_mfma_f32_32x32x16_bf16 v[96:111], v[44:47], a[124:127], v[96:111]
  s_waitcnt lgkmcnt(6)
  ds_read_b64_tr_b16 v[36:37], v11 offset:32768
  ds_read_b64_tr_b16 v[38:39], v11 offset:33792
  v_cvt_pk_bf16_f32 v189, v14, v15
  v_mul_f32 v12, v76, v76
  v_mul_f32 v13, v77, v77
  v_fma_f32 v12, v12, v8, v6
  v_mfma_f32_32x32x16_bf16 v[80:95], v[16:19], a[128:131], v[80:95]
  ds_read_b64_tr_b16 v[40:41], v2 offset:34816
  ds_read_b64_tr_b16 v[42:43], v2 offset:35840
  v_fma_f32 v13, v13, v8, v6
  v_mul_f32 v12, v12, v76
  v_mul_f32 v13, v13, v77
  v_exp_f32 v12, v12
  v_mfma_f32_32x32x16_bf16 v[96:111], v[20:23], a[128:131], v[96:111]
  s_waitcnt lgkmcnt(6)
  ds_read_b64_tr_b16 v[44:45], v11 offset:34816
  ds_read_b64_tr_b16 v[46:47], v11 offset:35840
  v_add_u32 v3, 2654208, v3
  v_add_u32 v1, 110592, v0
  v_xor_b32 v5, 64, v1
  v_exp_f32 v13, v13
  v_fma_f32 v12, v12, v10, v10
  v_fma_f32 v13, v13, v10, v10
  v_mfma_f32_32x32x16_bf16 v[80:95], v[24:27], a[132:135], v[80:95]
  v_rcp_f32 v12, v12
  v_rcp_f32 v13, v13
  v_mul_f32 v12, v12, v76
  v_mul_f32 v13, v13, v77
  v_mfma_f32_32x32x16_bf16 v[96:111], v[28:31], a[132:135], v[96:111]
  s_waitcnt vmcnt(18) lgkmcnt(0)
  s_barrier
  ds_read_b64_tr_b16 v[16:17], v1 offset:0
  ds_read_b64_tr_b16 v[18:19], v1 offset:1024
  ds_read_b64_tr_b16 v[20:21], v5 offset:0
  ds_read_b64_tr_b16 v[22:23], v5 offset:1024
  v_cvt_pk_bf16_f32 v190, v12, v13
  v_mul_f32 v14, v78, v78
  v_mul_f32 v15, v79, v79
  v_fma_f32 v14, v14, v8, v6
  v_mfma_f32_32x32x16_bf16 v[80:95], v[32:35], a[136:139], v[80:95]
  ds_read_b64_tr_b16 v[24:25], v1 offset:2048
  ds_read_b64_tr_b16 v[26:27], v1 offset:3072
  v_fma_f32 v15, v15, v8, v6
  v_mul_f32 v14, v14, v78
  v_mul_f32 v15, v15, v79
  v_exp_f32 v14, v14
  v_mfma_f32_32x32x16_bf16 v[96:111], v[36:39], a[136:139], v[96:111]
  s_waitcnt lgkmcnt(6)
  ds_read_b64_tr_b16 v[28:29], v5 offset:2048
  ds_read_b64_tr_b16 v[30:31], v5 offset:3072
  v_exp_f32 v15, v15
  v_fma_f32 v14, v14, v10, v10
  v_fma_f32 v15, v15, v10, v10
  v_mfma_f32_32x32x16_bf16 v[80:95], v[40:43], a[140:143], v[80:95]
  ds_read_b64_tr_b16 v[32:33], v1 offset:4096
  ds_read_b64_tr_b16 v[34:35], v1 offset:5120
  v_rcp_f32 v14, v14
  v_rcp_f32 v15, v15
  v_mul_f32 v14, v14, v78
  v_mul_f32 v15, v15, v79
  v_cvt_pk_bf16_f32 v191, v14, v15
  v_mfma_f32_32x32x16_bf16 v[96:111], v[44:47], a[140:143], v[96:111]
  s_waitcnt lgkmcnt(6)
  ds_read_b64_tr_b16 v[36:37], v5 offset:4096
  ds_read_b64_tr_b16 v[38:39], v5 offset:5120
  v_mfma_f32_32x32x16_bf16 v[48:63], v[16:19], a[0:3], 0
  ds_read_b64_tr_b16 v[40:41], v1 offset:6144
  ds_read_b64_tr_b16 v[42:43], v1 offset:7168
  v_mfma_f32_32x32x16_bf16 v[64:79], v[20:23], a[0:3], 0
  s_waitcnt lgkmcnt(6)
  ds_read_b64_tr_b16 v[44:45], v5 offset:6144
  ds_read_b64_tr_b16 v[46:47], v5 offset:7168
  v_mfma_f32_32x32x16_bf16 v[48:63], v[24:27], a[4:7], v[48:63]
  s_add_u32 m0, s42, 73728
  ds_read_b64_tr_b16 v[16:17], v1 offset:8192
  ds_read_b64_tr_b16 v[18:19], v1 offset:9216
  buffer_load_dwordx4 v3, s[8:11], s24 offen offset:0 lds
  v_mul_f32 v12, v80, v80
  v_mul_f32 v13, v81, v81
  v_mfma_f32_32x32x16_bf16 v[64:79], v[28:31], a[4:7], v[64:79]
  s_waitcnt lgkmcnt(6)
  ds_read_b64_tr_b16 v[20:21], v5 offset:8192
  ds_read_b64_tr_b16 v[22:23], v5 offset:9216
  v_fma_f32 v12, v12, v8, v6
  v_fma_f32 v13, v13, v8, v6
  v_mul_f32 v12, v12, v80
  v_mul_f32 v13, v13, v81
  v_exp_f32 v12, v12
  v_mfma_f32_32x32x16_bf16 v[48:63], v[32:35], a[8:11], v[48:63]
  ds_read_b64_tr_b16 v[24:25], v1 offset:10240
  ds_read_b64_tr_b16 v[26:27], v1 offset:11264
  v_exp_f32 v13, v13
  v_fma_f32 v12, v12, v10, v10
  v_mfma_f32_32x32x16_bf16 v[64:79], v[36:39], a[8:11], v[64:79]
  s_waitcnt lgkmcnt(6)
  ds_read_b64_tr_b16 v[28:29], v5 offset:10240
  ds_read_b64_tr_b16 v[30:31], v5 offset:11264
  buffer_load_dwordx4 v3, s[8:11], s25 offen offset:1024 lds
  v_fma_f32 v13, v13, v10, v10
  v_rcp_f32 v12, v12
  v_rcp_f32 v13, v13
  v_mfma_f32_32x32x16_bf16 v[48:63], v[40:43], a[12:15], v[48:63]
  ds_read_b64_tr_b16 v[32:33], v1 offset:12288
  ds_read_b64_tr_b16 v[34:35], v1 offset:13312
  v_mul_f32 v12, v12, v80
  v_mul_f32 v13, v13, v81
  v_cvt_pk_bf16_f32 v192, v12, v13
  v_mul_f32 v14, v82, v82
  v_mul_f32 v15, v83, v83
  v_mfma_f32_32x32x16_bf16 v[64:79], v[44:47], a[12:15], v[64:79]
  s_waitcnt lgkmcnt(6)
  ds_read_b64_tr_b16 v[36:37], v5 offset:12288
  ds_read_b64_tr_b16 v[38:39], v5 offset:13312
  v_fma_f32 v14, v14, v8, v6
  v_fma_f32 v15, v15, v8, v6
  v_mul_f32 v14, v14, v82
  v_mul_f32 v15, v15, v83
  v_mfma_f32_32x32x16_bf16 v[48:63], v[16:19], a[16:19], v[48:63]
  ds_read_b64_tr_b16 v[40:41], v1 offset:14336
  ds_read_b64_tr_b16 v[42:43], v1 offset:15360
  buffer_load_dwordx4 v3, s[8:11], s26 offen offset:2048 lds
  v_exp_f32 v14, v14
  v_exp_f32 v15, v15
  v_fma_f32 v14, v14, v10, v10
  v_mfma_f32_32x32x16_bf16 v[64:79], v[20:23], a[16:19], v[64:79]
  s_waitcnt lgkmcnt(6)
  ds_read_b64_tr_b16 v[44:45], v5 offset:14336
  ds_read_b64_tr_b16 v[46:47], v5 offset:15360
  v_fma_f32 v15, v15, v10, v10
  v_rcp_f32 v14, v14
  v_rcp_f32 v15, v15
  v_mfma_f32_32x32x16_bf16 v[48:63], v[24:27], a[20:23], v[48:63]
  ds_read_b64_tr_b16 v[16:17], v1 offset:16384
  ds_read_b64_tr_b16 v[18:19], v1 offset:17408
  v_mul_f32 v14, v14, v82
  v_mul_f32 v15, v15, v83
  v_cvt_pk_bf16_f32 v193, v14, v15
  v_mul_f32 v12, v84, v84
  v_mfma_f32_32x32x16_bf16 v[64:79], v[28:31], a[20:23], v[64:79]
  s_waitcnt lgkmcnt(6)
  ds_read_b64_tr_b16 v[20:21], v5 offset:16384
  ds_read_b64_tr_b16 v[22:23], v5 offset:17408
  buffer_load_dwordx4 v3, s[8:11], s27 offen offset:3072 lds
  v_mul_f32 v13, v85, v85
  v_fma_f32 v12, v12, v8, v6
  v_fma_f32 v13, v13, v8, v6
  v_mul_f32 v12, v12, v84
  v_mul_f32 v13, v13, v85
  v_mfma_f32_32x32x16_bf16 v[48:63], v[32:35], a[24:27], v[48:63]
  ds_read_b64_tr_b16 v[24:25], v1 offset:18432
  ds_read_b64_tr_b16 v[26:27], v1 offset:19456
  v_exp_f32 v12, v12
  v_exp_f32 v13, v13
  v_mfma_f32_32x32x16_bf16 v[64:79], v[36:39], a[24:27], v[64:79]
  s_waitcnt lgkmcnt(6)
  ds_read_b64_tr_b16 v[28:29], v5 offset:18432
  ds_read_b64_tr_b16 v[30:31], v5 offset:19456
  v_fma_f32 v12, v12, v10, v10
  v_fma_f32 v13, v13, v10, v10
  v_rcp_f32 v12, v12
  v_rcp_f32 v13, v13
  v_mfma_f32_32x32x16_bf16 v[48:63], v[40:43], a[28:31], v[48:63]
  s_add_u32 m0, s42, 77824
  ds_read_b64_tr_b16 v[32:33], v1 offset:20480
  ds_read_b64_tr_b16 v[34:35], v1 offset:21504
  buffer_load_dwordx4 v3, s[8:11], s28 offen offset:0 lds
  v_mul_f32 v12, v12, v84
  v_mul_f32 v13, v13, v85
  v_cvt_pk_bf16_f32 v194, v12, v13
  v_mfma_f32_32x32x16_bf16 v[64:79], v[44:47], a[28:31], v[64:79]
  s_waitcnt lgkmcnt(6)
  ds_read_b64_tr_b16 v[36:37], v5 offset:20480
  ds_read_b64_tr_b16 v[38:39], v5 offset:21504
  v_mul_f32 v14, v86, v86
  v_mul_f32 v15, v87, v87
  v_fma_f32 v14, v14, v8, v6
  v_fma_f32 v15, v15, v8, v6
  v_mul_f32 v14, v14, v86
  v_mfma_f32_32x32x16_bf16 v[48:63], v[16:19], a[32:35], v[48:63]
  ds_read_b64_tr_b16 v[40:41], v1 offset:22528
  ds_read_b64_tr_b16 v[42:43], v1 offset:23552
  v_mul_f32 v15, v15, v87
  v_exp_f32 v14, v14
  v_exp_f32 v15, v15
  v_mfma_f32_32x32x16_bf16 v[64:79], v[20:23], a[32:35], v[64:79]
  s_waitcnt lgkmcnt(6)
  ds_read_b64_tr_b16 v[44:45], v5 offset:22528
  ds_read_b64_tr_b16 v[46:47], v5 offset:23552
  buffer_load_dwordx4 v3, s[8:11], s29 offen offset:1024 lds
  v_fma_f32 v14, v14, v10, v10
  v_fma_f32 v15, v15, v10, v10
  v_rcp_f32 v14, v14
  v_mfma_f32_32x32x16_bf16 v[48:63], v[24:27], a[36:39], v[48:63]
  ds_read_b64_tr_b16 v[16:17], v1 offset:24576
  ds_read_b64_tr_b16 v[18:19], v1 offset:25600
  v_rcp_f32 v15, v15
  v_mul_f32 v14, v14, v86
  v_mul_f32 v15, v15, v87
  v_cvt_pk_bf16_f32 v195, v14, v15
  v_mfma_f32_32x32x16_bf16 v[64:79], v[28:31], a[36:39], v[64:79]
  s_waitcnt lgkmcnt(6)
  ds_read_b64_tr_b16 v[20:21], v5 offset:24576
  ds_read_b64_tr_b16 v[22:23], v5 offset:25600
  v_mul_f32 v12, v88, v88
  v_mul_f32 v13, v89, v89
  v_fma_f32 v12, v12, v8, v6
  v_fma_f32 v13, v13, v8, v6
  v_mfma_f32_32x32x16_bf16 v[48:63], v[32:35], a[40:43], v[48:63]
  ds_read_b64_tr_b16 v[24:25], v1 offset:26624
  ds_read_b64_tr_b16 v[26:27], v1 offset:27648
  buffer_load_dwordx4 v3, s[8:11], s30 offen offset:2048 lds
  v_mul_f32 v12, v12, v88
  v_mul_f32 v13, v13, v89
  v_exp_f32 v12, v12
  v_exp_f32 v13, v13
  v_mfma_f32_32x32x16_bf16 v[64:79], v[36:39], a[40:43], v[64:79]
  s_waitcnt lgkmcnt(6)
  ds_read_b64_tr_b16 v[28:29], v5 offset:26624
  ds_read_b64_tr_b16 v[30:31], v5 offset:27648
  v_fma_f32 v12, v12, v10, v10
  v_fma_f32 v13, v13, v10, v10
  v_rcp_f32 v12, v12
  v_mfma_f32_32x32x16_bf16 v[48:63], v[40:43], a[44:47], v[48:63]
  ds_read_b64_tr_b16 v[32:33], v1 offset:28672
  ds_read_b64_tr_b16 v[34:35], v1 offset:29696
  v_rcp_f32 v13, v13
  v_mul_f32 v12, v12, v88
  v_mul_f32 v13, v13, v89
  v_mfma_f32_32x32x16_bf16 v[64:79], v[44:47], a[44:47], v[64:79]
  s_waitcnt lgkmcnt(6)
  ds_read_b64_tr_b16 v[36:37], v5 offset:28672
  ds_read_b64_tr_b16 v[38:39], v5 offset:29696
  buffer_load_dwordx4 v3, s[8:11], s31 offen offset:3072 lds
  v_cvt_pk_bf16_f32 v196, v12, v13
  v_mul_f32 v14, v90, v90
  v_mul_f32 v15, v91, v91
  v_fma_f32 v14, v14, v8, v6
  v_fma_f32 v15, v15, v8, v6
  v_mfma_f32_32x32x16_bf16 v[48:63], v[16:19], a[48:51], v[48:63]
  ds_read_b64_tr_b16 v[40:41], v1 offset:30720
  ds_read_b64_tr_b16 v[42:43], v1 offset:31744
  v_mul_f32 v14, v14, v90
  v_mul_f32 v15, v15, v91
  v_exp_f32 v14, v14
  v_mfma_f32_32x32x16_bf16 v[64:79], v[20:23], a[48:51], v[64:79]
  s_waitcnt lgkmcnt(6)
  ds_read_b64_tr_b16 v[44:45], v5 offset:30720
  ds_read_b64_tr_b16 v[46:47], v5 offset:31744
  v_exp_f32 v15, v15
  v_fma_f32 v14, v14, v10, v10
  v_fma_f32 v15, v15, v10, v10
  v_rcp_f32 v14, v14
  v_mfma_f32_32x32x16_bf16 v[48:63], v[24:27], a[52:55], v[48:63]
  s_add_u32 m0, s42, 81920
  ds_read_b64_tr_b16 v[16:17], v1 offset:32768
  ds_read_b64_tr_b16 v[18:19], v1 offset:33792
  buffer_load_dwordx4 v3, s[8:11], s32 offen offset:0 lds
  v_rcp_f32 v15, v15
  v_mul_f32 v14, v14, v90
  v_mul_f32 v15, v15, v91
  v_mfma_f32_32x32x16_bf16 v[64:79], v[28:31], a[52:55], v[64:79]
  s_waitcnt lgkmcnt(6)
  ds_read_b64_tr_b16 v[20:21], v5 offset:32768
  ds_read_b64_tr_b16 v[22:23], v5 offset:33792
  v_cvt_pk_bf16_f32 v197, v14, v15
  v_mul_f32 v12, v92, v92
  v_mul_f32 v13, v93, v93
  v_fma_f32 v12, v12, v8, v6
  v_mfma_f32_32x32x16_bf16 v[48:63], v[32:35], a[56:59], v[48:63]
  ds_read_b64_tr_b16 v[24:25], v1 offset:34816
  ds_read_b64_tr_b16 v[26:27], v1 offset:35840
  v_fma_f32 v13, v13, v8, v6
  v_mul_f32 v12, v12, v92
  v_mul_f32 v13, v13, v93
  v_exp_f32 v12, v12
  v_mfma_f32_32x32x16_bf16 v[64:79], v[36:39], a[56:59], v[64:79]
  s_waitcnt lgkmcnt(6)
  ds_read_b64_tr_b16 v[28:29], v5 offset:34816
  ds_read_b64_tr_b16 v[30:31], v5 offset:35840
  v_subrev_u32 v3, 2654080, v3
  v_add_u32 v2, 0, v0
  v_xor_b32 v11, 64, v2
  v_exp_f32 v13, v13
  v_fma_f32 v12, v12, v10, v10
  v_fma_f32 v13, v13, v10, v10
  v_mfma_f32_32x32x16_bf16 v[48:63], v[40:43], a[60:63], v[48:63]
  v_rcp_f32 v12, v12
  v_rcp_f32 v13, v13
  v_mul_f32 v12, v12, v92
  v_mul_f32 v13, v13, v93
  v_mfma_f32_32x32x16_bf16 v[64:79], v[44:47], a[60:63], v[64:79]
  s_waitcnt vmcnt(18) lgkmcnt(0)
  s_barrier
  ds_read_b64_tr_b16 v[32:33], v2 offset:0
  ds_read_b64_tr_b16 v[34:35], v2 offset:1024
  ds_read_b64_tr_b16 v[36:37], v11 offset:0
  ds_read_b64_tr_b16 v[38:39], v11 offset:1024
  v_cvt_pk_bf16_f32 v198, v12, v13
  v_mul_f32 v14, v94, v94
  v_mul_f32 v15, v95, v95
  v_fma_f32 v14, v14, v8, v6
  v_mfma_f32_32x32x16_bf16 v[48:63], v[16:19], a[64:67], v[48:63]
  ds_read_b64_tr_b16 v[40:41], v2 offset:2048
  ds_read_b64_tr_b16 v[42:43], v2 offset:3072
  v_fma_f32 v15, v15, v8, v6
  v_mul_f32 v14, v14, v94
  v_mul_f32 v15, v15, v95
  v_exp_f32 v14, v14
  v_mfma_f32_32x32x16_bf16 v[64:79], v[20:23], a[64:67], v[64:79]
  s_waitcnt lgkmcnt(6)
  ds_read_b64_tr_b16 v[44:45], v11 offset:2048
  ds_read_b64_tr_b16 v[46:47], v11 offset:3072
  v_exp_f32 v15, v15
  v_fma_f32 v14, v14, v10, v10
  v_fma_f32 v15, v15, v10, v10
  v_mfma_f32_32x32x16_bf16 v[48:63], v[24:27], a[68:71], v[48:63]
  ds_read_b64_tr_b16 v[16:17], v2 offset:4096
  ds_read_b64_tr_b16 v[18:19], v2 offset:5120
  v_rcp_f32 v14, v14
  v_rcp_f32 v15, v15
  v_mul_f32 v14, v14, v94
  v_mul_f32 v15, v15, v95
  v_cvt_pk_bf16_f32 v199, v14, v15
  v_mfma_f32_32x32x16_bf16 v[64:79], v[28:31], a[68:71], v[64:79]
  s_waitcnt lgkmcnt(6)
  ds_read_b64_tr_b16 v[20:21], v11 offset:4096
  ds_read_b64_tr_b16 v[22:23], v11 offset:5120
  v_mfma_f32_32x32x16_bf16 v[48:63], v[32:35], a[72:75], v[48:63]
  ds_read_b64_tr_b16 v[24:25], v2 offset:6144
  ds_read_b64_tr_b16 v[26:27], v2 offset:7168
  v_mfma_f32_32x32x16_bf16 v[64:79], v[36:39], a[72:75], v[64:79]
  s_waitcnt lgkmcnt(6)
  ds_read_b64_tr_b16 v[28:29], v11 offset:6144
  ds_read_b64_tr_b16 v[30:31], v11 offset:7168
  v_mfma_f32_32x32x16_bf16 v[48:63], v[40:43], a[76:79], v[48:63]
  s_add_u32 m0, s42, 110592
  ds_read_b64_tr_b16 v[32:33], v2 offset:8192
  ds_read_b64_tr_b16 v[34:35], v2 offset:9216
  buffer_load_dwordx4 v3, s[8:11], s24 offen offset:0 lds
  v_mul_f32 v12, v96, v96
  v_mul_f32 v13, v97, v97
  v_mfma_f32_32x32x16_bf16 v[64:79], v[44:47], a[76:79], v[64:79]
  s_waitcnt lgkmcnt(6)
  ds_read_b64_tr_b16 v[36:37], v11 offset:8192
  ds_read_b64_tr_b16 v[38:39], v11 offset:9216
  v_fma_f32 v12, v12, v8, v6
  v_fma_f32 v13, v13, v8, v6
  v_mul_f32 v12, v12, v96
  v_mul_f32 v13, v13, v97
  v_exp_f32 v12, v12
  v_mfma_f32_32x32x16_bf16 v[48:63], v[16:19], a[80:83], v[48:63]
  ds_read_b64_tr_b16 v[40:41], v2 offset:10240
  ds_read_b64_tr_b16 v[42:43], v2 offset:11264
  v_exp_f32 v13, v13
  v_fma_f32 v12, v12, v10, v10
  v_mfma_f32_32x32x16_bf16 v[64:79], v[20:23], a[80:83], v[64:79]
  s_waitcnt lgkmcnt(6)
  ds_read_b64_tr_b16 v[44:45], v11 offset:10240
  ds_read_b64_tr_b16 v[46:47], v11 offset:11264
  buffer_load_dwordx4 v3, s[8:11], s25 offen offset:1024 lds
  v_fma_f32 v13, v13, v10, v10
  v_rcp_f32 v12, v12
  v_rcp_f32 v13, v13
  v_mfma_f32_32x32x16_bf16 v[48:63], v[24:27], a[84:87], v[48:63]
  ds_read_b64_tr_b16 v[16:17], v2 offset:12288
  ds_read_b64_tr_b16 v[18:19], v2 offset:13312
  v_mul_f32 v12, v12, v96
  v_mul_f32 v13, v13, v97
  v_cvt_pk_bf16_f32 v200, v12, v13
  v_mul_f32 v14, v98, v98
  v_mul_f32 v15, v99, v99
  v_mfma_f32_32x32x16_bf16 v[64:79], v[28:31], a[84:87], v[64:79]
  s_waitcnt lgkmcnt(6)
  ds_read_b64_tr_b16 v[20:21], v11 offset:12288
  ds_read_b64_tr_b16 v[22:23], v11 offset:13312
  v_fma_f32 v14, v14, v8, v6
  v_fma_f32 v15, v15, v8, v6
  v_mul_f32 v14, v14, v98
  v_mul_f32 v15, v15, v99
  v_mfma_f32_32x32x16_bf16 v[48:63], v[32:35], a[88:91], v[48:63]
  ds_read_b64_tr_b16 v[24:25], v2 offset:14336
  ds_read_b64_tr_b16 v[26:27], v2 offset:15360
  buffer_load_dwordx4 v3, s[8:11], s26 offen offset:2048 lds
  v_exp_f32 v14, v14
  v_exp_f32 v15, v15
  v_fma_f32 v14, v14, v10, v10
  v_mfma_f32_32x32x16_bf16 v[64:79], v[36:39], a[88:91], v[64:79]
  s_waitcnt lgkmcnt(6)
  ds_read_b64_tr_b16 v[28:29], v11 offset:14336
  ds_read_b64_tr_b16 v[30:31], v11 offset:15360
  v_fma_f32 v15, v15, v10, v10
  v_rcp_f32 v14, v14
  v_rcp_f32 v15, v15
  v_mfma_f32_32x32x16_bf16 v[48:63], v[40:43], a[92:95], v[48:63]
  ds_read_b64_tr_b16 v[32:33], v2 offset:16384
  ds_read_b64_tr_b16 v[34:35], v2 offset:17408
  v_mul_f32 v14, v14, v98
  v_mul_f32 v15, v15, v99
  v_cvt_pk_bf16_f32 v201, v14, v15
  v_mul_f32 v12, v100, v100
  v_mfma_f32_32x32x16_bf16 v[64:79], v[44:47], a[92:95], v[64:79]
  s_waitcnt lgkmcnt(6)
  ds_read_b64_tr_b16 v[36:37], v11 offset:16384
  ds_read_b64_tr_b16 v[38:39], v11 offset:17408
  buffer_load_dwordx4 v3, s[8:11], s27 offen offset:3072 lds
  v_mul_f32 v13, v101, v101
  v_fma_f32 v12, v12, v8, v6
  v_fma_f32 v13, v13, v8, v6
  v_mul_f32 v12, v12, v100
  v_mul_f32 v13, v13, v101
  v_mfma_f32_32x32x16_bf16 v[48:63], v[16:19], a[96:99], v[48:63]
  ds_read_b64_tr_b16 v[40:41], v2 offset:18432
  ds_read_b64_tr_b16 v[42:43], v2 offset:19456
  v_exp_f32 v12, v12
  v_exp_f32 v13, v13
  v_mfma_f32_32x32x16_bf16 v[64:79], v[20:23], a[96:99], v[64:79]
  s_waitcnt lgkmcnt(6)
  ds_read_b64_tr_b16 v[44:45], v11 offset:18432
  ds_read_b64_tr_b16 v[46:47], v11 offset:19456
  v_fma_f32 v12, v12, v10, v10
  v_fma_f32 v13, v13, v10, v10
  v_rcp_f32 v12, v12
  v_rcp_f32 v13, v13
  v_mfma_f32_32x32x16_bf16 v[48:63], v[24:27], a[100:103], v[48:63]
  s_add_u32 m0, s42, 114688
  ds_read_b64_tr_b16 v[16:17], v2 offset:20480
  ds_read_b64_tr_b16 v[18:19], v2 offset:21504
  buffer_load_dwordx4 v3, s[8:11], s28 offen offset:0 lds
  v_mul_f32 v12, v12, v100
  v_mul_f32 v13, v13, v101
  v_cvt_pk_bf16_f32 v202, v12, v13
  v_mfma_f32_32x32x16_bf16 v[64:79], v[28:31], a[100:103], v[64:79]
  s_waitcnt lgkmcnt(6)
  ds_read_b64_tr_b16 v[20:21], v11 offset:20480
  ds_read_b64_tr_b16 v[22:23], v11 offset:21504
  v_mul_f32 v14, v102, v102
  v_mul_f32 v15, v103, v103
  v_fma_f32 v14, v14, v8, v6
  v_fma_f32 v15, v15, v8, v6
  v_mul_f32 v14, v14, v102
  v_mfma_f32_32x32x16_bf16 v[48:63], v[32:35], a[104:107], v[48:63]
  ds_read_b64_tr_b16 v[24:25], v2 offset:22528
  ds_read_b64_tr_b16 v[26:27], v2 offset:23552
  v_mul_f32 v15, v15, v103
  v_exp_f32 v14, v14
  v_exp_f32 v15, v15
  v_mfma_f32_32x32x16_bf16 v[64:79], v[36:39], a[104:107], v[64:79]
  s_waitcnt lgkmcnt(6)
  ds_read_b64_tr_b16 v[28:29], v11 offset:22528
  ds_read_b64_tr_b16 v[30:31], v11 offset:23552
  buffer_load_dwordx4 v3, s[8:11], s29 offen offset:1024 lds
  v_fma_f32 v14, v14, v10, v10
  v_fma_f32 v15, v15, v10, v10
  v_rcp_f32 v14, v14
  v_mfma_f32_32x32x16_bf16 v[48:63], v[40:43], a[108:111], v[48:63]
  ds_read_b64_tr_b16 v[32:33], v2 offset:24576
  ds_read_b64_tr_b16 v[34:35], v2 offset:25600
  v_rcp_f32 v15, v15
  v_mul_f32 v14, v14, v102
  v_mul_f32 v15, v15, v103
  v_cvt_pk_bf16_f32 v203, v14, v15
  v_mfma_f32_32x32x16_bf16 v[64:79], v[44:47], a[108:111], v[64:79]
  s_waitcnt lgkmcnt(6)
  ds_read_b64_tr_b16 v[36:37], v11 offset:24576
  ds_read_b64_tr_b16 v[38:39], v11 offset:25600
  v_mul_f32 v12, v104, v104
  v_mul_f32 v13, v105, v105
  v_fma_f32 v12, v12, v8, v6
  v_fma_f32 v13, v13, v8, v6
  v_mfma_f32_32x32x16_bf16 v[48:63], v[16:19], a[112:115], v[48:63]
  ds_read_b64_tr_b16 v[40:41], v2 offset:26624
  ds_read_b64_tr_b16 v[42:43], v2 offset:27648
  buffer_load_dwordx4 v3, s[8:11], s30 offen offset:2048 lds
  v_mul_f32 v12, v12, v104
  v_mul_f32 v13, v13, v105
  v_exp_f32 v12, v12
  v_exp_f32 v13, v13
  v_mfma_f32_32x32x16_bf16 v[64:79], v[20:23], a[112:115], v[64:79]
  s_waitcnt lgkmcnt(6)
  ds_read_b64_tr_b16 v[44:45], v11 offset:26624
  ds_read_b64_tr_b16 v[46:47], v11 offset:27648
  v_fma_f32 v12, v12, v10, v10
  v_fma_f32 v13, v13, v10, v10
  v_rcp_f32 v12, v12
  v_mfma_f32_32x32x16_bf16 v[48:63], v[24:27], a[116:119], v[48:63]
  ds_read_b64_tr_b16 v[16:17], v2 offset:28672
  ds_read_b64_tr_b16 v[18:19], v2 offset:29696
  v_rcp_f32 v13, v13
  v_mul_f32 v12, v12, v104
  v_mul_f32 v13, v13, v105
  v_mfma_f32_32x32x16_bf16 v[64:79], v[28:31], a[116:119], v[64:79]
  s_waitcnt lgkmcnt(6)
  ds_read_b64_tr_b16 v[20:21], v11 offset:28672
  ds_read_b64_tr_b16 v[22:23], v11 offset:29696
  buffer_load_dwordx4 v3, s[8:11], s31 offen offset:3072 lds
  v_cvt_pk_bf16_f32 v204, v12, v13
  v_mul_f32 v14, v106, v106
  v_mul_f32 v15, v107, v107
  v_fma_f32 v14, v14, v8, v6
  v_fma_f32 v15, v15, v8, v6
  v_mfma_f32_32x32x16_bf16 v[48:63], v[32:35], a[120:123], v[48:63]
  ds_read_b64_tr_b16 v[24:25], v2 offset:30720
  ds_read_b64_tr_b16 v[26:27], v2 offset:31744
  v_mul_f32 v14, v14, v106
  v_mul_f32 v15, v15, v107
  v_exp_f32 v14, v14
  v_mfma_f32_32x32x16_bf16 v[64:79], v[36:39], a[120:123], v[64:79]
  s_waitcnt lgkmcnt(6)
  ds_read_b64_tr_b16 v[28:29], v11 offset:30720
  ds_read_b64_tr_b16 v[30:31], v11 offset:31744
  v_exp_f32 v15, v15
  v_fma_f32 v14, v14, v10, v10
  v_fma_f32 v15, v15, v10, v10
  v_rcp_f32 v14, v14
  v_mfma_f32_32x32x16_bf16 v[48:63], v[40:43], a[124:127], v[48:63]
  s_add_u32 m0, s42, 118784
  ds_read_b64_tr_b16 v[32:33], v2 offset:32768
  ds_read_b64_tr_b16 v[34:35], v2 offset:33792
  buffer_load_dwordx4 v3, s[8:11], s32 offen offset:0 lds
  v_rcp_f32 v15, v15
  v_mul_f32 v14, v14, v106
  v_mul_f32 v15, v15, v107
  v_mfma_f32_32x32x16_bf16 v[64:79], v[44:47], a[124:127], v[64:79]
  s_waitcnt lgkmcnt(6)
  ds_read_b64_tr_b16 v[36:37], v11 offset:32768
  ds_read_b64_tr_b16 v[38:39], v11 offset:33792
  v_cvt_pk_bf16_f32 v205, v14, v15
  v_mul_f32 v12, v108, v108
  v_mul_f32 v13, v109, v109
  v_fma_f32 v12, v12, v8, v6
  v_mfma_f32_32x32x16_bf16 v[48:63], v[16:19], a[128:131], v[48:63]
  ds_read_b64_tr_b16 v[40:41], v2 offset:34816
  ds_read_b64_tr_b16 v[42:43], v2 offset:35840
  v_fma_f32 v13, v13, v8, v6
  v_mul_f32 v12, v12, v108
  v_mul_f32 v13, v13, v109
  v_exp_f32 v12, v12
  v_mfma_f32_32x32x16_bf16 v[64:79], v[20:23], a[128:131], v[64:79]
  s_waitcnt lgkmcnt(6)
  ds_read_b64_tr_b16 v[44:45], v11 offset:34816
  ds_read_b64_tr_b16 v[46:47], v11 offset:35840
  v_add_u32 v3, 2654208, v3
  v_add_u32 v1, 36864, v0
  v_xor_b32 v5, 64, v1
  v_exp_f32 v13, v13
  v_fma_f32 v12, v12, v10, v10
  v_fma_f32 v13, v13, v10, v10
  v_mfma_f32_32x32x16_bf16 v[48:63], v[24:27], a[132:135], v[48:63]
  v_rcp_f32 v12, v12
  v_rcp_f32 v13, v13
  v_mul_f32 v12, v12, v108
  v_mul_f32 v13, v13, v109
  v_mfma_f32_32x32x16_bf16 v[64:79], v[28:31], a[132:135], v[64:79]
  s_waitcnt vmcnt(18) lgkmcnt(0)
  s_barrier
  ds_read_b64_tr_b16 v[16:17], v1 offset:0
  ds_read_b64_tr_b16 v[18:19], v1 offset:1024
  ds_read_b64_tr_b16 v[20:21], v5 offset:0
  ds_read_b64_tr_b16 v[22:23], v5 offset:1024
  v_cvt_pk_bf16_f32 v206, v12, v13
  v_mul_f32 v14, v110, v110
  v_mul_f32 v15, v111, v111
  v_fma_f32 v14, v14, v8, v6
  v_mfma_f32_32x32x16_bf16 v[48:63], v[32:35], a[136:139], v[48:63]
  ds_read_b64_tr_b16 v[24:25], v1 offset:2048
  ds_read_b64_tr_b16 v[26:27], v1 offset:3072
  v_fma_f32 v15, v15, v8, v6
  v_mul_f32 v14, v14, v110
  v_mul_f32 v15, v15, v111
  v_exp_f32 v14, v14
  v_mfma_f32_32x32x16_bf16 v[64:79], v[36:39], a[136:139], v[64:79]
  s_waitcnt lgkmcnt(6)
  ds_read_b64_tr_b16 v[28:29], v5 offset:2048
  ds_read_b64_tr_b16 v[30:31], v5 offset:3072
  v_exp_f32 v15, v15
  v_fma_f32 v14, v14, v10, v10
  v_fma_f32 v15, v15, v10, v10
  v_mfma_f32_32x32x16_bf16 v[48:63], v[40:43], a[140:143], v[48:63]
  ds_read_b64_tr_b16 v[32:33], v1 offset:4096
  ds_read_b64_tr_b16 v[34:35], v1 offset:5120
  v_rcp_f32 v14, v14
  v_rcp_f32 v15, v15
  v_mul_f32 v14, v14, v110
  v_mul_f32 v15, v15, v111
  v_cvt_pk_bf16_f32 v207, v14, v15
  v_mfma_f32_32x32x16_bf16 v[64:79], v[44:47], a[140:143], v[64:79]
  s_waitcnt lgkmcnt(6)
  ds_read_b64_tr_b16 v[36:37], v5 offset:4096
  ds_read_b64_tr_b16 v[38:39], v5 offset:5120
  v_mfma_f32_32x32x16_bf16 v[80:95], v[16:19], a[0:3], 0
  ds_read_b64_tr_b16 v[40:41], v1 offset:6144
  ds_read_b64_tr_b16 v[42:43], v1 offset:7168
  v_mfma_f32_32x32x16_bf16 v[96:111], v[20:23], a[0:3], 0
  s_waitcnt lgkmcnt(6)
  ds_read_b64_tr_b16 v[44:45], v5 offset:6144
  ds_read_b64_tr_b16 v[46:47], v5 offset:7168
  v_mfma_f32_32x32x16_bf16 v[80:95], v[24:27], a[4:7], v[80:95]
  s_add_u32 m0, s42, 0
  ds_read_b64_tr_b16 v[16:17], v1 offset:8192
  ds_read_b64_tr_b16 v[18:19], v1 offset:9216
  buffer_load_dwordx4 v3, s[8:11], s24 offen offset:0 lds
  v_mul_f32 v12, v48, v48
  v_mul_f32 v13, v49, v49
  v_mfma_f32_32x32x16_bf16 v[96:111], v[28:31], a[4:7], v[96:111]
  s_waitcnt lgkmcnt(6)
  ds_read_b64_tr_b16 v[20:21], v5 offset:8192
  ds_read_b64_tr_b16 v[22:23], v5 offset:9216
  v_fma_f32 v12, v12, v8, v6
  v_fma_f32 v13, v13, v8, v6
  v_mul_f32 v12, v12, v48
  v_mul_f32 v13, v13, v49
  v_exp_f32 v12, v12
  v_mfma_f32_32x32x16_bf16 v[80:95], v[32:35], a[8:11], v[80:95]
  ds_read_b64_tr_b16 v[24:25], v1 offset:10240
  ds_read_b64_tr_b16 v[26:27], v1 offset:11264
  v_exp_f32 v13, v13
  v_fma_f32 v12, v12, v10, v10
  v_mfma_f32_32x32x16_bf16 v[96:111], v[36:39], a[8:11], v[96:111]
  s_waitcnt lgkmcnt(6)
  ds_read_b64_tr_b16 v[28:29], v5 offset:10240
  ds_read_b64_tr_b16 v[30:31], v5 offset:11264
  buffer_load_dwordx4 v3, s[8:11], s25 offen offset:1024 lds
  v_fma_f32 v13, v13, v10, v10
  v_rcp_f32 v12, v12
  v_rcp_f32 v13, v13
  v_mfma_f32_32x32x16_bf16 v[80:95], v[40:43], a[12:15], v[80:95]
  ds_read_b64_tr_b16 v[32:33], v1 offset:12288
  ds_read_b64_tr_b16 v[34:35], v1 offset:13312
  v_mul_f32 v12, v12, v48
  v_mul_f32 v13, v13, v49
  v_cvt_pk_bf16_f32 v208, v12, v13
  v_mul_f32 v14, v50, v50
  v_mul_f32 v15, v51, v51
  v_mfma_f32_32x32x16_bf16 v[96:111], v[44:47], a[12:15], v[96:111]
  s_waitcnt lgkmcnt(6)
  ds_read_b64_tr_b16 v[36:37], v5 offset:12288
  ds_read_b64_tr_b16 v[38:39], v5 offset:13312
  v_fma_f32 v14, v14, v8, v6
  v_fma_f32 v15, v15, v8, v6
  v_mul_f32 v14, v14, v50
  v_mul_f32 v15, v15, v51
  v_mfma_f32_32x32x16_bf16 v[80:95], v[16:19], a[16:19], v[80:95]
  ds_read_b64_tr_b16 v[40:41], v1 offset:14336
  ds_read_b64_tr_b16 v[42:43], v1 offset:15360
  buffer_load_dwordx4 v3, s[8:11], s26 offen offset:2048 lds
  v_exp_f32 v14, v14
  v_exp_f32 v15, v15
  v_fma_f32 v14, v14, v10, v10
  v_mfma_f32_32x32x16_bf16 v[96:111], v[20:23], a[16:19], v[96:111]
  s_waitcnt lgkmcnt(6)
  ds_read_b64_tr_b16 v[44:45], v5 offset:14336
  ds_read_b64_tr_b16 v[46:47], v5 offset:15360
  v_fma_f32 v15, v15, v10, v10
  v_rcp_f32 v14, v14
  v_rcp_f32 v15, v15
  v_mfma_f32_32x32x16_bf16 v[80:95], v[24:27], a[20:23], v[80:95]
  ds_read_b64_tr_b16 v[16:17], v1 offset:16384
  ds_read_b64_tr_b16 v[18:19], v1 offset:17408
  v_mul_f32 v14, v14, v50
  v_mul_f32 v15, v15, v51
  v_cvt_pk_bf16_f32 v209, v14, v15
  v_mul_f32 v12, v52, v52
  v_mfma_f32_32x32x16_bf16 v[96:111], v[28:31], a[20:23], v[96:111]
  s_waitcnt lgkmcnt(6)
  ds_read_b64_tr_b16 v[20:21], v5 offset:16384
  ds_read_b64_tr_b16 v[22:23], v5 offset:17408
  buffer_load_dwordx4 v3, s[8:11], s27 offen offset:3072 lds
  v_mul_f32 v13, v53, v53
  v_fma_f32 v12, v12, v8, v6
  v_fma_f32 v13, v13, v8, v6
  v_mul_f32 v12, v12, v52
  v_mul_f32 v13, v13, v53
  v_mfma_f32_32x32x16_bf16 v[80:95], v[32:35], a[24:27], v[80:95]
  ds_read_b64_tr_b16 v[24:25], v1 offset:18432
  ds_read_b64_tr_b16 v[26:27], v1 offset:19456
  v_exp_f32 v12, v12
  v_exp_f32 v13, v13
  v_mfma_f32_32x32x16_bf16 v[96:111], v[36:39], a[24:27], v[96:111]
  s_waitcnt lgkmcnt(6)
  ds_read_b64_tr_b16 v[28:29], v5 offset:18432
  ds_read_b64_tr_b16 v[30:31], v5 offset:19456
  v_fma_f32 v12, v12, v10, v10
  v_fma_f32 v13, v13, v10, v10
  v_rcp_f32 v12, v12
  v_rcp_f32 v13, v13
  v_mfma_f32_32x32x16_bf16 v[80:95], v[40:43], a[28:31], v[80:95]
  s_add_u32 m0, s42, 4096
  ds_read_b64_tr_b16 v[32:33], v1 offset:20480
  ds_read_b64_tr_b16 v[34:35], v1 offset:21504
  buffer_load_dwordx4 v3, s[8:11], s28 offen offset:0 lds
  v_mul_f32 v12, v12, v52
  v_mul_f32 v13, v13, v53
  v_cvt_pk_bf16_f32 v210, v12, v13
  v_mfma_f32_32x32x16_bf16 v[96:111], v[44:47], a[28:31], v[96:111]
  s_waitcnt lgkmcnt(6)
  ds_read_b64_tr_b16 v[36:37], v5 offset:20480
  ds_read_b64_tr_b16 v[38:39], v5 offset:21504
  v_mul_f32 v14, v54, v54
  v_mul_f32 v15, v55, v55
  v_fma_f32 v14, v14, v8, v6
  v_fma_f32 v15, v15, v8, v6
  v_mul_f32 v14, v14, v54
  v_mfma_f32_32x32x16_bf16 v[80:95], v[16:19], a[32:35], v[80:95]
  ds_read_b64_tr_b16 v[40:41], v1 offset:22528
  ds_read_b64_tr_b16 v[42:43], v1 offset:23552
  v_mul_f32 v15, v15, v55
  v_exp_f32 v14, v14
  v_exp_f32 v15, v15
  v_mfma_f32_32x32x16_bf16 v[96:111], v[20:23], a[32:35], v[96:111]
  s_waitcnt lgkmcnt(6)
  ds_read_b64_tr_b16 v[44:45], v5 offset:22528
  ds_read_b64_tr_b16 v[46:47], v5 offset:23552
  buffer_load_dwordx4 v3, s[8:11], s29 offen offset:1024 lds
  v_fma_f32 v14, v14, v10, v10
  v_fma_f32 v15, v15, v10, v10
  v_rcp_f32 v14, v14
  v_mfma_f32_32x32x16_bf16 v[80:95], v[24:27], a[36:39], v[80:95]
  ds_read_b64_tr_b16 v[16:17], v1 offset:24576
  ds_read_b64_tr_b16 v[18:19], v1 offset:25600
  v_rcp_f32 v15, v15
  v_mul_f32 v14, v14, v54
  v_mul_f32 v15, v15, v55
  v_cvt_pk_bf16_f32 v211, v14, v15
  v_mfma_f32_32x32x16_bf16 v[96:111], v[28:31], a[36:39], v[96:111]
  s_waitcnt lgkmcnt(6)
  ds_read_b64_tr_b16 v[20:21], v5 offset:24576
  ds_read_b64_tr_b16 v[22:23], v5 offset:25600
  v_mul_f32 v12, v56, v56
  v_mul_f32 v13, v57, v57
  v_fma_f32 v12, v12, v8, v6
  v_fma_f32 v13, v13, v8, v6
  v_mfma_f32_32x32x16_bf16 v[80:95], v[32:35], a[40:43], v[80:95]
  ds_read_b64_tr_b16 v[24:25], v1 offset:26624
  ds_read_b64_tr_b16 v[26:27], v1 offset:27648
  buffer_load_dwordx4 v3, s[8:11], s30 offen offset:2048 lds
  v_mul_f32 v12, v12, v56
  v_mul_f32 v13, v13, v57
  v_exp_f32 v12, v12
  v_exp_f32 v13, v13
  v_mfma_f32_32x32x16_bf16 v[96:111], v[36:39], a[40:43], v[96:111]
  s_waitcnt lgkmcnt(6)
  ds_read_b64_tr_b16 v[28:29], v5 offset:26624
  ds_read_b64_tr_b16 v[30:31], v5 offset:27648
  v_fma_f32 v12, v12, v10, v10
  v_fma_f32 v13, v13, v10, v10
  v_rcp_f32 v12, v12
  v_mfma_f32_32x32x16_bf16 v[80:95], v[40:43], a[44:47], v[80:95]
  ds_read_b64_tr_b16 v[32:33], v1 offset:28672
  ds_read_b64_tr_b16 v[34:35], v1 offset:29696
  v_rcp_f32 v13, v13
  v_mul_f32 v12, v12, v56
  v_mul_f32 v13, v13, v57
  v_mfma_f32_32x32x16_bf16 v[96:111], v[44:47], a[44:47], v[96:111]
  s_waitcnt lgkmcnt(6)
  ds_read_b64_tr_b16 v[36:37], v5 offset:28672
  ds_read_b64_tr_b16 v[38:39], v5 offset:29696
  buffer_load_dwordx4 v3, s[8:11], s31 offen offset:3072 lds
  v_cvt_pk_bf16_f32 v212, v12, v13
  v_mul_f32 v14, v58, v58
  v_mul_f32 v15, v59, v59
  v_fma_f32 v14, v14, v8, v6
  v_fma_f32 v15, v15, v8, v6
  v_mfma_f32_32x32x16_bf16 v[80:95], v[16:19], a[48:51], v[80:95]
  ds_read_b64_tr_b16 v[40:41], v1 offset:30720
  ds_read_b64_tr_b16 v[42:43], v1 offset:31744
  v_mul_f32 v14, v14, v58
  v_mul_f32 v15, v15, v59
  v_exp_f32 v14, v14
  v_mfma_f32_32x32x16_bf16 v[96:111], v[20:23], a[48:51], v[96:111]
  s_waitcnt lgkmcnt(6)
  ds_read_b64_tr_b16 v[44:45], v5 offset:30720
  ds_read_b64_tr_b16 v[46:47], v5 offset:31744
  v_exp_f32 v15, v15
  v_fma_f32 v14, v14, v10, v10
  v_fma_f32 v15, v15, v10, v10
  v_rcp_f32 v14, v14
  v_mfma_f32_32x32x16_bf16 v[80:95], v[24:27], a[52:55], v[80:95]
  s_add_u32 m0, s42, 8192
  ds_read_b64_tr_b16 v[16:17], v1 offset:32768
  ds_read_b64_tr_b16 v[18:19], v1 offset:33792
  buffer_load_dwordx4 v3, s[8:11], s32 offen offset:0 lds
  v_rcp_f32 v15, v15
  v_mul_f32 v14, v14, v58
  v_mul_f32 v15, v15, v59
  v_mfma_f32_32x32x16_bf16 v[96:111], v[28:31], a[52:55], v[96:111]
  s_waitcnt lgkmcnt(6)
  ds_read_b64_tr_b16 v[20:21], v5 offset:32768
  ds_read_b64_tr_b16 v[22:23], v5 offset:33792
  v_cvt_pk_bf16_f32 v213, v14, v15
  v_mul_f32 v12, v60, v60
  v_mul_f32 v13, v61, v61
  v_fma_f32 v12, v12, v8, v6
  v_mfma_f32_32x32x16_bf16 v[80:95], v[32:35], a[56:59], v[80:95]
  ds_read_b64_tr_b16 v[24:25], v1 offset:34816
  ds_read_b64_tr_b16 v[26:27], v1 offset:35840
  v_fma_f32 v13, v13, v8, v6
  v_mul_f32 v12, v12, v60
  v_mul_f32 v13, v13, v61
  v_exp_f32 v12, v12
  v_mfma_f32_32x32x16_bf16 v[96:111], v[36:39], a[56:59], v[96:111]
  s_waitcnt lgkmcnt(6)
  ds_read_b64_tr_b16 v[28:29], v5 offset:34816
  ds_read_b64_tr_b16 v[30:31], v5 offset:35840
  v_subrev_u32 v3, 2654080, v3
  v_add_u32 v2, 73728, v0
  v_xor_b32 v11, 64, v2
  v_exp_f32 v13, v13
  v_fma_f32 v12, v12, v10, v10
  v_fma_f32 v13, v13, v10, v10
  v_mfma_f32_32x32x16_bf16 v[80:95], v[40:43], a[60:63], v[80:95]
  v_rcp_f32 v12, v12
  v_rcp_f32 v13, v13
  v_mul_f32 v12, v12, v60
  v_mul_f32 v13, v13, v61
  v_mfma_f32_32x32x16_bf16 v[96:111], v[44:47], a[60:63], v[96:111]
  s_waitcnt vmcnt(18) lgkmcnt(0)
  s_barrier
  ds_read_b64_tr_b16 v[32:33], v2 offset:0
  ds_read_b64_tr_b16 v[34:35], v2 offset:1024
  ds_read_b64_tr_b16 v[36:37], v11 offset:0
  ds_read_b64_tr_b16 v[38:39], v11 offset:1024
  v_cvt_pk_bf16_f32 v214, v12, v13
  v_mul_f32 v14, v62, v62
  v_mul_f32 v15, v63, v63
  v_fma_f32 v14, v14, v8, v6
  v_mfma_f32_32x32x16_bf16 v[80:95], v[16:19], a[64:67], v[80:95]
  ds_read_b64_tr_b16 v[40:41], v2 offset:2048
  ds_read_b64_tr_b16 v[42:43], v2 offset:3072
  v_fma_f32 v15, v15, v8, v6
  v_mul_f32 v14, v14, v62
  v_mul_f32 v15, v15, v63
  v_exp_f32 v14, v14
  v_mfma_f32_32x32x16_bf16 v[96:111], v[20:23], a[64:67], v[96:111]
  s_waitcnt lgkmcnt(6)
  ds_read_b64_tr_b16 v[44:45], v11 offset:2048
  ds_read_b64_tr_b16 v[46:47], v11 offset:3072
  v_exp_f32 v15, v15
  v_fma_f32 v14, v14, v10, v10
  v_fma_f32 v15, v15, v10, v10
  v_mfma_f32_32x32x16_bf16 v[80:95], v[24:27], a[68:71], v[80:95]
  ds_read_b64_tr_b16 v[16:17], v2 offset:4096
  ds_read_b64_tr_b16 v[18:19], v2 offset:5120
  v_rcp_f32 v14, v14
  v_rcp_f32 v15, v15
  v_mul_f32 v14, v14, v62
  v_mul_f32 v15, v15, v63
  v_cvt_pk_bf16_f32 v215, v14, v15
  v_mfma_f32_32x32x16_bf16 v[96:111], v[28:31], a[68:71], v[96:111]
  s_waitcnt lgkmcnt(6)
  ds_read_b64_tr_b16 v[20:21], v11 offset:4096
  ds_read_b64_tr_b16 v[22:23], v11 offset:5120
  v_mfma_f32_32x32x16_bf16 v[80:95], v[32:35], a[72:75], v[80:95]
  ds_read_b64_tr_b16 v[24:25], v2 offset:6144
  ds_read_b64_tr_b16 v[26:27], v2 offset:7168
  v_mfma_f32_32x32x16_bf16 v[96:111], v[36:39], a[72:75], v[96:111]
  s_waitcnt lgkmcnt(6)
  ds_read_b64_tr_b16 v[28:29], v11 offset:6144
  ds_read_b64_tr_b16 v[30:31], v11 offset:7168
  v_mfma_f32_32x32x16_bf16 v[80:95], v[40:43], a[76:79], v[80:95]
  s_add_u32 m0, s42, 36864
  ds_read_b64_tr_b16 v[32:33], v2 offset:8192
  ds_read_b64_tr_b16 v[34:35], v2 offset:9216
  buffer_load_dwordx4 v4, s[12:15], s33 offen offset:0 lds
  v_mul_f32 v12, v64, v64
  v_mul_f32 v13, v65, v65
  v_mfma_f32_32x32x16_bf16 v[96:111], v[44:47], a[76:79], v[96:111]
  s_waitcnt lgkmcnt(6)
  ds_read_b64_tr_b16 v[36:37], v11 offset:8192
  ds_read_b64_tr_b16 v[38:39], v11 offset:9216
  v_fma_f32 v12, v12, v8, v6
  v_fma_f32 v13, v13, v8, v6
  v_mul_f32 v12, v12, v64
  v_mul_f32 v13, v13, v65
  v_exp_f32 v12, v12
  v_mfma_f32_32x32x16_bf16 v[80:95], v[16:19], a[80:83], v[80:95]
  ds_read_b64_tr_b16 v[40:41], v2 offset:10240
  ds_read_b64_tr_b16 v[42:43], v2 offset:11264
  v_exp_f32 v13, v13
  v_fma_f32 v12, v12, v10, v10
  v_mfma_f32_32x32x16_bf16 v[96:111], v[20:23], a[80:83], v[96:111]
  s_waitcnt lgkmcnt(6)
  ds_read_b64_tr_b16 v[44:45], v11 offset:10240
  ds_read_b64_tr_b16 v[46:47], v11 offset:11264
  buffer_load_dwordx4 v4, s[12:15], s34 offen offset:1024 lds
  v_fma_f32 v13, v13, v10, v10
  v_rcp_f32 v12, v12
  v_rcp_f32 v13, v13
  v_mfma_f32_32x32x16_bf16 v[80:95], v[24:27], a[84:87], v[80:95]
  ds_read_b64_tr_b16 v[16:17], v2 offset:12288
  ds_read_b64_tr_b16 v[18:19], v2 offset:13312
  v_mul_f32 v12, v12, v64
  v_mul_f32 v13, v13, v65
  v_cvt_pk_bf16_f32 v216, v12, v13
  v_mul_f32 v14, v66, v66
  v_mul_f32 v15, v67, v67
  v_mfma_f32_32x32x16_bf16 v[96:111], v[28:31], a[84:87], v[96:111]
  s_waitcnt lgkmcnt(6)
  ds_read_b64_tr_b16 v[20:21], v11 offset:12288
  ds_read_b64_tr_b16 v[22:23], v11 offset:13312
  v_fma_f32 v14, v14, v8, v6
  v_fma_f32 v15, v15, v8, v6
  v_mul_f32 v14, v14, v66
  v_mul_f32 v15, v15, v67
  v_mfma_f32_32x32x16_bf16 v[80:95], v[32:35], a[88:91], v[80:95]
  ds_read_b64_tr_b16 v[24:25], v2 offset:14336
  ds_read_b64_tr_b16 v[26:27], v2 offset:15360
  buffer_load_dwordx4 v4, s[12:15], s35 offen offset:2048 lds
  v_exp_f32 v14, v14
  v_exp_f32 v15, v15
  v_fma_f32 v14, v14, v10, v10
  v_mfma_f32_32x32x16_bf16 v[96:111], v[36:39], a[88:91], v[96:111]
  s_waitcnt lgkmcnt(6)
  ds_read_b64_tr_b16 v[28:29], v11 offset:14336
  ds_read_b64_tr_b16 v[30:31], v11 offset:15360
  v_fma_f32 v15, v15, v10, v10
  v_rcp_f32 v14, v14
  v_rcp_f32 v15, v15
  v_mfma_f32_32x32x16_bf16 v[80:95], v[40:43], a[92:95], v[80:95]
  ds_read_b64_tr_b16 v[32:33], v2 offset:16384
  ds_read_b64_tr_b16 v[34:35], v2 offset:17408
  v_mul_f32 v14, v14, v66
  v_mul_f32 v15, v15, v67
  v_cvt_pk_bf16_f32 v217, v14, v15
  v_mul_f32 v12, v68, v68
  v_mfma_f32_32x32x16_bf16 v[96:111], v[44:47], a[92:95], v[96:111]
  s_waitcnt lgkmcnt(6)
  ds_read_b64_tr_b16 v[36:37], v11 offset:16384
  ds_read_b64_tr_b16 v[38:39], v11 offset:17408
  buffer_load_dwordx4 v4, s[12:15], s36 offen offset:3072 lds
  v_mul_f32 v13, v69, v69
  v_fma_f32 v12, v12, v8, v6
  v_fma_f32 v13, v13, v8, v6
  v_mul_f32 v12, v12, v68
  v_mul_f32 v13, v13, v69
  v_mfma_f32_32x32x16_bf16 v[80:95], v[16:19], a[96:99], v[80:95]
  ds_read_b64_tr_b16 v[40:41], v2 offset:18432
  ds_read_b64_tr_b16 v[42:43], v2 offset:19456
  v_exp_f32 v12, v12
  v_exp_f32 v13, v13
  v_mfma_f32_32x32x16_bf16 v[96:111], v[20:23], a[96:99], v[96:111]
  s_waitcnt lgkmcnt(6)
  ds_read_b64_tr_b16 v[44:45], v11 offset:18432
  ds_read_b64_tr_b16 v[46:47], v11 offset:19456
  v_fma_f32 v12, v12, v10, v10
  v_fma_f32 v13, v13, v10, v10
  v_rcp_f32 v12, v12
  v_rcp_f32 v13, v13
  v_mfma_f32_32x32x16_bf16 v[80:95], v[24:27], a[100:103], v[80:95]
  s_add_u32 m0, s42, 40960
  ds_read_b64_tr_b16 v[16:17], v2 offset:20480
  ds_read_b64_tr_b16 v[18:19], v2 offset:21504
  buffer_load_dwordx4 v4, s[12:15], s37 offen offset:0 lds
  v_mul_f32 v12, v12, v68
  v_mul_f32 v13, v13, v69
  v_cvt_pk_bf16_f32 v218, v12, v13
  v_mfma_f32_32x32x16_bf16 v[96:111], v[28:31], a[100:103], v[96:111]
  s_waitcnt lgkmcnt(6)
  ds_read_b64_tr_b16 v[20:21], v11 offset:20480
  ds_read_b64_tr_b16 v[22:23], v11 offset:21504
  v_mul_f32 v14, v70, v70
  v_mul_f32 v15, v71, v71
  v_fma_f32 v14, v14, v8, v6
  v_fma_f32 v15, v15, v8, v6
  v_mul_f32 v14, v14, v70
  v_mfma_f32_32x32x16_bf16 v[80:95], v[32:35], a[104:107], v[80:95]
  ds_read_b64_tr_b16 v[24:25], v2 offset:22528
  ds_read_b64_tr_b16 v[26:27], v2 offset:23552
  v_mul_f32 v15, v15, v71
  v_exp_f32 v14, v14
  v_exp_f32 v15, v15
  v_mfma_f32_32x32x16_bf16 v[96:111], v[36:39], a[104:107], v[96:111]
  s_waitcnt lgkmcnt(6)
  ds_read_b64_tr_b16 v[28:29], v11 offset:22528
  ds_read_b64_tr_b16 v[30:31], v11 offset:23552
  buffer_load_dwordx4 v4, s[12:15], s38 offen offset:1024 lds
  v_fma_f32 v14, v14, v10, v10
  v_fma_f32 v15, v15, v10, v10
  v_rcp_f32 v14, v14
  v_mfma_f32_32x32x16_bf16 v[80:95], v[40:43], a[108:111], v[80:95]
  ds_read_b64_tr_b16 v[32:33], v2 offset:24576
  ds_read_b64_tr_b16 v[34:35], v2 offset:25600
  v_rcp_f32 v15, v15
  v_mul_f32 v14, v14, v70
  v_mul_f32 v15, v15, v71
  v_cvt_pk_bf16_f32 v219, v14, v15
  v_mfma_f32_32x32x16_bf16 v[96:111], v[44:47], a[108:111], v[96:111]
  s_waitcnt lgkmcnt(6)
  ds_read_b64_tr_b16 v[36:37], v11 offset:24576
  ds_read_b64_tr_b16 v[38:39], v11 offset:25600
  v_mul_f32 v12, v72, v72
  v_mul_f32 v13, v73, v73
  v_fma_f32 v12, v12, v8, v6
  v_fma_f32 v13, v13, v8, v6
  v_mfma_f32_32x32x16_bf16 v[80:95], v[16:19], a[112:115], v[80:95]
  ds_read_b64_tr_b16 v[40:41], v2 offset:26624
  ds_read_b64_tr_b16 v[42:43], v2 offset:27648
  buffer_load_dwordx4 v4, s[12:15], s39 offen offset:2048 lds
  v_mul_f32 v12, v12, v72
  v_mul_f32 v13, v13, v73
  v_exp_f32 v12, v12
  v_exp_f32 v13, v13
  v_mfma_f32_32x32x16_bf16 v[96:111], v[20:23], a[112:115], v[96:111]
  s_waitcnt lgkmcnt(6)
  ds_read_b64_tr_b16 v[44:45], v11 offset:26624
  ds_read_b64_tr_b16 v[46:47], v11 offset:27648
  v_fma_f32 v12, v12, v10, v10
  v_fma_f32 v13, v13, v10, v10
  v_rcp_f32 v12, v12
  v_mfma_f32_32x32x16_bf16 v[80:95], v[24:27], a[116:119], v[80:95]
  ds_read_b64_tr_b16 v[16:17], v2 offset:28672
  ds_read_b64_tr_b16 v[18:19], v2 offset:29696
  v_rcp_f32 v13, v13
  v_mul_f32 v12, v12, v72
  v_mul_f32 v13, v13, v73
  v_mfma_f32_32x32x16_bf16 v[96:111], v[28:31], a[116:119], v[96:111]
  s_waitcnt lgkmcnt(6)
  ds_read_b64_tr_b16 v[20:21], v11 offset:28672
  ds_read_b64_tr_b16 v[22:23], v11 offset:29696
  buffer_load_dwordx4 v4, s[12:15], s40 offen offset:3072 lds
  v_cvt_pk_bf16_f32 v220, v12, v13
  v_mul_f32 v14, v74, v74
  v_mul_f32 v15, v75, v75
  v_fma_f32 v14, v14, v8, v6
  v_fma_f32 v15, v15, v8, v6
  v_mfma_f32_32x32x16_bf16 v[80:95], v[32:35], a[120:123], v[80:95]
  ds_read_b64_tr_b16 v[24:25], v2 offset:30720
  ds_read_b64_tr_b16 v[26:27], v2 offset:31744
  v_mul_f32 v14, v14, v74
  v_mul_f32 v15, v15, v75
  v_exp_f32 v14, v14
  v_mfma_f32_32x32x16_bf16 v[96:111], v[36:39], a[120:123], v[96:111]
  s_waitcnt lgkmcnt(6)
  ds_read_b64_tr_b16 v[28:29], v11 offset:30720
  ds_read_b64_tr_b16 v[30:31], v11 offset:31744
  v_exp_f32 v15, v15
  v_fma_f32 v14, v14, v10, v10
  v_fma_f32 v15, v15, v10, v10
  v_rcp_f32 v14, v14
  v_mfma_f32_32x32x16_bf16 v[80:95], v[40:43], a[124:127], v[80:95]
  s_add_u32 m0, s42, 45056
  ds_read_b64_tr_b16 v[32:33], v2 offset:32768
  ds_read_b64_tr_b16 v[34:35], v2 offset:33792
  buffer_load_dwordx4 v4, s[12:15], s41 offen offset:0 lds
  v_rcp_f32 v15, v15
  v_mul_f32 v14, v14, v74
  v_mul_f32 v15, v15, v75
  v_mfma_f32_32x32x16_bf16 v[96:111], v[44:47], a[124:127], v[96:111]
  s_waitcnt lgkmcnt(6)
  ds_read_b64_tr_b16 v[36:37], v11 offset:32768
  ds_read_b64_tr_b16 v[38:39], v11 offset:33792
  v_cvt_pk_bf16_f32 v221, v14, v15
  v_mul_f32 v12, v76, v76
  v_mul_f32 v13, v77, v77
  v_fma_f32 v12, v12, v8, v6
  v_mfma_f32_32x32x16_bf16 v[80:95], v[16:19], a[128:131], v[80:95]
  ds_read_b64_tr_b16 v[40:41], v2 offset:34816
  ds_read_b64_tr_b16 v[42:43], v2 offset:35840
  v_fma_f32 v13, v13, v8, v6
  v_mul_f32 v12, v12, v76
  v_mul_f32 v13, v13, v77
  v_exp_f32 v12, v12
  v_mfma_f32_32x32x16_bf16 v[96:111], v[20:23], a[128:131], v[96:111]
  s_waitcnt lgkmcnt(6)
  ds_read_b64_tr_b16 v[44:45], v11 offset:34816
  ds_read_b64_tr_b16 v[46:47], v11 offset:35840
  v_add_u32 v4, 331776, v4
  v_add_u32 v1, 110592, v0
  v_xor_b32 v5, 64, v1
  v_exp_f32 v13, v13
  v_fma_f32 v12, v12, v10, v10
  v_fma_f32 v13, v13, v10, v10
  v_mfma_f32_32x32x16_bf16 v[80:95], v[24:27], a[132:135], v[80:95]
  v_rcp_f32 v12, v12
  v_rcp_f32 v13, v13
  v_mul_f32 v12, v12, v76
  v_mul_f32 v13, v13, v77
  v_mfma_f32_32x32x16_bf16 v[96:111], v[28:31], a[132:135], v[96:111]
  s_waitcnt vmcnt(18) lgkmcnt(0)
  s_barrier
  ds_read_b64_tr_b16 v[16:17], v1 offset:0
  ds_read_b64_tr_b16 v[18:19], v1 offset:1024
  ds_read_b64_tr_b16 v[20:21], v5 offset:0
  ds_read_b64_tr_b16 v[22:23], v5 offset:1024
  v_cvt_pk_bf16_f32 v222, v12, v13
  v_mul_f32 v14, v78, v78
  v_mul_f32 v15, v79, v79
  v_fma_f32 v14, v14, v8, v6
  v_mfma_f32_32x32x16_bf16 v[80:95], v[32:35], a[136:139], v[80:95]
  ds_read_b64_tr_b16 v[24:25], v1 offset:2048
  ds_read_b64_tr_b16 v[26:27], v1 offset:3072
  v_fma_f32 v15, v15, v8, v6
  v_mul_f32 v14, v14, v78
  v_mul_f32 v15, v15, v79
  v_exp_f32 v14, v14
  v_mfma_f32_32x32x16_bf16 v[96:111], v[36:39], a[136:139], v[96:111]
  s_waitcnt lgkmcnt(6)
  ds_read_b64_tr_b16 v[28:29], v5 offset:2048
  ds_read_b64_tr_b16 v[30:31], v5 offset:3072
  v_exp_f32 v15, v15
  v_fma_f32 v14, v14, v10, v10
  v_fma_f32 v15, v15, v10, v10
  v_mfma_f32_32x32x16_bf16 v[80:95], v[40:43], a[140:143], v[80:95]
  ds_read_b64_tr_b16 v[32:33], v1 offset:4096
  ds_read_b64_tr_b16 v[34:35], v1 offset:5120
  v_rcp_f32 v14, v14
  v_rcp_f32 v15, v15
  v_mul_f32 v14, v14, v78
  v_mul_f32 v15, v15, v79
  v_cvt_pk_bf16_f32 v223, v14, v15
  v_mfma_f32_32x32x16_bf16 v[96:111], v[44:47], a[140:143], v[96:111]
  s_waitcnt lgkmcnt(6)
  ds_read_b64_tr_b16 v[36:37], v5 offset:4096
  ds_read_b64_tr_b16 v[38:39], v5 offset:5120
  v_mfma_f32_32x32x16_bf16 v[48:63], v[16:19], a[0:3], 0
  ds_read_b64_tr_b16 v[40:41], v1 offset:6144
  ds_read_b64_tr_b16 v[42:43], v1 offset:7168
  v_mfma_f32_32x32x16_bf16 v[64:79], v[20:23], a[0:3], 0
  s_waitcnt lgkmcnt(6)
  ds_read_b64_tr_b16 v[44:45], v5 offset:6144
  ds_read_b64_tr_b16 v[46:47], v5 offset:7168
  v_mfma_f32_32x32x16_bf16 v[48:63], v[24:27], a[4:7], v[48:63]
  s_add_u32 m0, s42, 73728
  ds_read_b64_tr_b16 v[16:17], v1 offset:8192
  ds_read_b64_tr_b16 v[18:19], v1 offset:9216
  buffer_load_dwordx4 v4, s[12:15], s33 offen offset:0 lds
  v_mul_f32 v12, v80, v80
  v_mul_f32 v13, v81, v81
  v_mfma_f32_32x32x16_bf16 v[64:79], v[28:31], a[4:7], v[64:79]
  s_waitcnt lgkmcnt(6)
  ds_read_b64_tr_b16 v[20:21], v5 offset:8192
  ds_read_b64_tr_b16 v[22:23], v5 offset:9216
  v_fma_f32 v12, v12, v8, v6
  v_fma_f32 v13, v13, v8, v6
  v_mul_f32 v12, v12, v80
  v_mul_f32 v13, v13, v81
  v_exp_f32 v12, v12
  v_mfma_f32_32x32x16_bf16 v[48:63], v[32:35], a[8:11], v[48:63]
  ds_read_b64_tr_b16 v[24:25], v1 offset:10240
  ds_read_b64_tr_b16 v[26:27], v1 offset:11264
  v_exp_f32 v13, v13
  v_fma_f32 v12, v12, v10, v10
  v_mfma_f32_32x32x16_bf16 v[64:79], v[36:39], a[8:11], v[64:79]
  s_waitcnt lgkmcnt(6)
  ds_read_b64_tr_b16 v[28:29], v5 offset:10240
  ds_read_b64_tr_b16 v[30:31], v5 offset:11264
  buffer_load_dwordx4 v4, s[12:15], s34 offen offset:1024 lds
  v_fma_f32 v13, v13, v10, v10
  v_rcp_f32 v12, v12
  v_rcp_f32 v13, v13
  v_mfma_f32_32x32x16_bf16 v[48:63], v[40:43], a[12:15], v[48:63]
  ds_read_b64_tr_b16 v[32:33], v1 offset:12288
  ds_read_b64_tr_b16 v[34:35], v1 offset:13312
  v_mul_f32 v12, v12, v80
  v_mul_f32 v13, v13, v81
  v_cvt_pk_bf16_f32 v224, v12, v13
  v_mul_f32 v14, v82, v82
  v_mul_f32 v15, v83, v83
  v_mfma_f32_32x32x16_bf16 v[64:79], v[44:47], a[12:15], v[64:79]
  s_waitcnt lgkmcnt(6)
  ds_read_b64_tr_b16 v[36:37], v5 offset:12288
  ds_read_b64_tr_b16 v[38:39], v5 offset:13312
  v_fma_f32 v14, v14, v8, v6
  v_fma_f32 v15, v15, v8, v6
  v_mul_f32 v14, v14, v82
  v_mul_f32 v15, v15, v83
  v_mfma_f32_32x32x16_bf16 v[48:63], v[16:19], a[16:19], v[48:63]
  ds_read_b64_tr_b16 v[40:41], v1 offset:14336
  ds_read_b64_tr_b16 v[42:43], v1 offset:15360
  buffer_load_dwordx4 v4, s[12:15], s35 offen offset:2048 lds
  v_exp_f32 v14, v14
  v_exp_f32 v15, v15
  v_fma_f32 v14, v14, v10, v10
  v_mfma_f32_32x32x16_bf16 v[64:79], v[20:23], a[16:19], v[64:79]
  s_waitcnt lgkmcnt(6)
  ds_read_b64_tr_b16 v[44:45], v5 offset:14336
  ds_read_b64_tr_b16 v[46:47], v5 offset:15360
  v_fma_f32 v15, v15, v10, v10
  v_rcp_f32 v14, v14
  v_rcp_f32 v15, v15
  v_mfma_f32_32x32x16_bf16 v[48:63], v[24:27], a[20:23], v[48:63]
  ds_read_b64_tr_b16 v[16:17], v1 offset:16384
  ds_read_b64_tr_b16 v[18:19], v1 offset:17408
  v_mul_f32 v14, v14, v82
  v_mul_f32 v15, v15, v83
  v_cvt_pk_bf16_f32 v225, v14, v15
  v_mul_f32 v12, v84, v84
  v_mfma_f32_32x32x16_bf16 v[64:79], v[28:31], a[20:23], v[64:79]
  s_waitcnt lgkmcnt(6)
  ds_read_b64_tr_b16 v[20:21], v5 offset:16384
  ds_read_b64_tr_b16 v[22:23], v5 offset:17408
  buffer_load_dwordx4 v4, s[12:15], s36 offen offset:3072 lds
  v_mul_f32 v13, v85, v85
  v_fma_f32 v12, v12, v8, v6
  v_fma_f32 v13, v13, v8, v6
  v_mul_f32 v12, v12, v84
  v_mul_f32 v13, v13, v85
  v_mfma_f32_32x32x16_bf16 v[48:63], v[32:35], a[24:27], v[48:63]
  ds_read_b64_tr_b16 v[24:25], v1 offset:18432
  ds_read_b64_tr_b16 v[26:27], v1 offset:19456
  v_exp_f32 v12, v12
  v_exp_f32 v13, v13
  v_mfma_f32_32x32x16_bf16 v[64:79], v[36:39], a[24:27], v[64:79]
  s_waitcnt lgkmcnt(6)
  ds_read_b64_tr_b16 v[28:29], v5 offset:18432
  ds_read_b64_tr_b16 v[30:31], v5 offset:19456
  v_fma_f32 v12, v12, v10, v10
  v_fma_f32 v13, v13, v10, v10
  v_rcp_f32 v12, v12
  v_rcp_f32 v13, v13
  v_mfma_f32_32x32x16_bf16 v[48:63], v[40:43], a[28:31], v[48:63]
  s_add_u32 m0, s42, 77824
  ds_read_b64_tr_b16 v[32:33], v1 offset:20480
  ds_read_b64_tr_b16 v[34:35], v1 offset:21504
  buffer_load_dwordx4 v4, s[12:15], s37 offen offset:0 lds
  v_mul_f32 v12, v12, v84
  v_mul_f32 v13, v13, v85
  v_cvt_pk_bf16_f32 v226, v12, v13
  v_mfma_f32_32x32x16_bf16 v[64:79], v[44:47], a[28:31], v[64:79]
  s_waitcnt lgkmcnt(6)
  ds_read_b64_tr_b16 v[36:37], v5 offset:20480
  ds_read_b64_tr_b16 v[38:39], v5 offset:21504
  v_mul_f32 v14, v86, v86
  v_mul_f32 v15, v87, v87
  v_fma_f32 v14, v14, v8, v6
  v_fma_f32 v15, v15, v8, v6
  v_mul_f32 v14, v14, v86
  v_mfma_f32_32x32x16_bf16 v[48:63], v[16:19], a[32:35], v[48:63]
  ds_read_b64_tr_b16 v[40:41], v1 offset:22528
  ds_read_b64_tr_b16 v[42:43], v1 offset:23552
  v_mul_f32 v15, v15, v87
  v_exp_f32 v14, v14
  v_exp_f32 v15, v15
  v_mfma_f32_32x32x16_bf16 v[64:79], v[20:23], a[32:35], v[64:79]
  s_waitcnt lgkmcnt(6)
  ds_read_b64_tr_b16 v[44:45], v5 offset:22528
  ds_read_b64_tr_b16 v[46:47], v5 offset:23552
  buffer_load_dwordx4 v4, s[12:15], s38 offen offset:1024 lds
  v_fma_f32 v14, v14, v10, v10
  v_fma_f32 v15, v15, v10, v10
  v_rcp_f32 v14, v14
  v_mfma_f32_32x32x16_bf16 v[48:63], v[24:27], a[36:39], v[48:63]
  ds_read_b64_tr_b16 v[16:17], v1 offset:24576
  ds_read_b64_tr_b16 v[18:19], v1 offset:25600
  v_rcp_f32 v15, v15
  v_mul_f32 v14, v14, v86
  v_mul_f32 v15, v15, v87
  v_cvt_pk_bf16_f32 v227, v14, v15
  v_mfma_f32_32x32x16_bf16 v[64:79], v[28:31], a[36:39], v[64:79]
  s_waitcnt lgkmcnt(6)
  ds_read_b64_tr_b16 v[20:21], v5 offset:24576
  ds_read_b64_tr_b16 v[22:23], v5 offset:25600
  v_mul_f32 v12, v88, v88
  v_mul_f32 v13, v89, v89
  v_fma_f32 v12, v12, v8, v6
  v_fma_f32 v13, v13, v8, v6
  v_mfma_f32_32x32x16_bf16 v[48:63], v[32:35], a[40:43], v[48:63]
  ds_read_b64_tr_b16 v[24:25], v1 offset:26624
  ds_read_b64_tr_b16 v[26:27], v1 offset:27648
  buffer_load_dwordx4 v4, s[12:15], s39 offen offset:2048 lds
  v_mul_f32 v12, v12, v88
  v_mul_f32 v13, v13, v89
  v_exp_f32 v12, v12
  v_exp_f32 v13, v13
  v_mfma_f32_32x32x16_bf16 v[64:79], v[36:39], a[40:43], v[64:79]
  s_waitcnt lgkmcnt(6)
  ds_read_b64_tr_b16 v[28:29], v5 offset:26624
  ds_read_b64_tr_b16 v[30:31], v5 offset:27648
  v_fma_f32 v12, v12, v10, v10
  v_fma_f32 v13, v13, v10, v10
  v_rcp_f32 v12, v12
  v_mfma_f32_32x32x16_bf16 v[48:63], v[40:43], a[44:47], v[48:63]
  ds_read_b64_tr_b16 v[32:33], v1 offset:28672
  ds_read_b64_tr_b16 v[34:35], v1 offset:29696
  v_rcp_f32 v13, v13
  v_mul_f32 v12, v12, v88
  v_mul_f32 v13, v13, v89
  v_mfma_f32_32x32x16_bf16 v[64:79], v[44:47], a[44:47], v[64:79]
  s_waitcnt lgkmcnt(6)
  ds_read_b64_tr_b16 v[36:37], v5 offset:28672
  ds_read_b64_tr_b16 v[38:39], v5 offset:29696
  buffer_load_dwordx4 v4, s[12:15], s40 offen offset:3072 lds
  v_cvt_pk_bf16_f32 v228, v12, v13
  v_mul_f32 v14, v90, v90
  v_mul_f32 v15, v91, v91
  v_fma_f32 v14, v14, v8, v6
  v_fma_f32 v15, v15, v8, v6
  v_mfma_f32_32x32x16_bf16 v[48:63], v[16:19], a[48:51], v[48:63]
  ds_read_b64_tr_b16 v[40:41], v1 offset:30720
  ds_read_b64_tr_b16 v[42:43], v1 offset:31744
  v_mul_f32 v14, v14, v90
  v_mul_f32 v15, v15, v91
  v_exp_f32 v14, v14
  v_mfma_f32_32x32x16_bf16 v[64:79], v[20:23], a[48:51], v[64:79]
  s_waitcnt lgkmcnt(6)
  ds_read_b64_tr_b16 v[44:45], v5 offset:30720
  ds_read_b64_tr_b16 v[46:47], v5 offset:31744
  v_exp_f32 v15, v15
  v_fma_f32 v14, v14, v10, v10
  v_fma_f32 v15, v15, v10, v10
  v_rcp_f32 v14, v14
  v_mfma_f32_32x32x16_bf16 v[48:63], v[24:27], a[52:55], v[48:63]
  s_add_u32 m0, s42, 81920
  ds_read_b64_tr_b16 v[16:17], v1 offset:32768
  ds_read_b64_tr_b16 v[18:19], v1 offset:33792
  buffer_load_dwordx4 v4, s[12:15], s41 offen offset:0 lds
  v_rcp_f32 v15, v15
  v_mul_f32 v14, v14, v90
  v_mul_f32 v15, v15, v91
  v_mfma_f32_32x32x16_bf16 v[64:79], v[28:31], a[52:55], v[64:79]
  s_waitcnt lgkmcnt(6)
  ds_read_b64_tr_b16 v[20:21], v5 offset:32768
  ds_read_b64_tr_b16 v[22:23], v5 offset:33792
  v_cvt_pk_bf16_f32 v229, v14, v15
  v_mul_f32 v12, v92, v92
  v_mul_f32 v13, v93, v93
  v_fma_f32 v12, v12, v8, v6
  v_mfma_f32_32x32x16_bf16 v[48:63], v[32:35], a[56:59], v[48:63]
  ds_read_b64_tr_b16 v[24:25], v1 offset:34816
  ds_read_b64_tr_b16 v[26:27], v1 offset:35840
  v_fma_f32 v13, v13, v8, v6
  v_mul_f32 v12, v12, v92
  v_mul_f32 v13, v13, v93
  v_exp_f32 v12, v12
  v_mfma_f32_32x32x16_bf16 v[64:79], v[36:39], a[56:59], v[64:79]
  s_waitcnt lgkmcnt(6)
  ds_read_b64_tr_b16 v[28:29], v5 offset:34816
  ds_read_b64_tr_b16 v[30:31], v5 offset:35840
  v_subrev_u32 v4, 331648, v4
  v_add_u32 v2, 0, v0
  v_xor_b32 v11, 64, v2
  v_exp_f32 v13, v13
  v_fma_f32 v12, v12, v10, v10
  v_fma_f32 v13, v13, v10, v10
  v_mfma_f32_32x32x16_bf16 v[48:63], v[40:43], a[60:63], v[48:63]
  v_rcp_f32 v12, v12
  v_rcp_f32 v13, v13
  v_mul_f32 v12, v12, v92
  v_mul_f32 v13, v13, v93
  v_mfma_f32_32x32x16_bf16 v[64:79], v[44:47], a[60:63], v[64:79]
  s_waitcnt vmcnt(18) lgkmcnt(0)
  s_barrier
  ds_read_b64_tr_b16 v[32:33], v2 offset:0
  ds_read_b64_tr_b16 v[34:35], v2 offset:1024
  ds_read_b64_tr_b16 v[36:37], v11 offset:0
  ds_read_b64_tr_b16 v[38:39], v11 offset:1024
  v_cvt_pk_bf16_f32 v230, v12, v13
  v_mul_f32 v14, v94, v94
  v_mul_f32 v15, v95, v95
  v_fma_f32 v14, v14, v8, v6
  v_mfma_f32_32x32x16_bf16 v[48:63], v[16:19], a[64:67], v[48:63]
  ds_read_b64_tr_b16 v[40:41], v2 offset:2048
  ds_read_b64_tr_b16 v[42:43], v2 offset:3072
  v_fma_f32 v15, v15, v8, v6
  v_mul_f32 v14, v14, v94
  v_mul_f32 v15, v15, v95
  v_exp_f32 v14, v14
  v_mfma_f32_32x32x16_bf16 v[64:79], v[20:23], a[64:67], v[64:79]
  s_waitcnt lgkmcnt(6)
  ds_read_b64_tr_b16 v[44:45], v11 offset:2048
  ds_read_b64_tr_b16 v[46:47], v11 offset:3072
  v_exp_f32 v15, v15
  v_fma_f32 v14, v14, v10, v10
  v_fma_f32 v15, v15, v10, v10
  v_mfma_f32_32x32x16_bf16 v[48:63], v[24:27], a[68:71], v[48:63]
  ds_read_b64_tr_b16 v[16:17], v2 offset:4096
  ds_read_b64_tr_b16 v[18:19], v2 offset:5120
  v_rcp_f32 v14, v14
  v_rcp_f32 v15, v15
  v_mul_f32 v14, v14, v94
  v_mul_f32 v15, v15, v95
  v_cvt_pk_bf16_f32 v231, v14, v15
  v_mfma_f32_32x32x16_bf16 v[64:79], v[28:31], a[68:71], v[64:79]
  s_waitcnt lgkmcnt(6)
  ds_read_b64_tr_b16 v[20:21], v11 offset:4096
  ds_read_b64_tr_b16 v[22:23], v11 offset:5120
  v_mfma_f32_32x32x16_bf16 v[48:63], v[32:35], a[72:75], v[48:63]
  ds_read_b64_tr_b16 v[24:25], v2 offset:6144
  ds_read_b64_tr_b16 v[26:27], v2 offset:7168
  v_mfma_f32_32x32x16_bf16 v[64:79], v[36:39], a[72:75], v[64:79]
  s_waitcnt lgkmcnt(6)
  ds_read_b64_tr_b16 v[28:29], v11 offset:6144
  ds_read_b64_tr_b16 v[30:31], v11 offset:7168
  v_mfma_f32_32x32x16_bf16 v[48:63], v[40:43], a[76:79], v[48:63]
  s_add_u32 m0, s42, 110592
  ds_read_b64_tr_b16 v[32:33], v2 offset:8192
  ds_read_b64_tr_b16 v[34:35], v2 offset:9216
  buffer_load_dwordx4 v4, s[12:15], s33 offen offset:0 lds
  v_mul_f32 v12, v96, v96
  v_mul_f32 v13, v97, v97
  v_mfma_f32_32x32x16_bf16 v[64:79], v[44:47], a[76:79], v[64:79]
  s_waitcnt lgkmcnt(6)
  ds_read_b64_tr_b16 v[36:37], v11 offset:8192
  ds_read_b64_tr_b16 v[38:39], v11 offset:9216
  v_fma_f32 v12, v12, v8, v6
  v_fma_f32 v13, v13, v8, v6
  v_mul_f32 v12, v12, v96
  v_mul_f32 v13, v13, v97
  v_exp_f32 v12, v12
  v_mfma_f32_32x32x16_bf16 v[48:63], v[16:19], a[80:83], v[48:63]
  ds_read_b64_tr_b16 v[40:41], v2 offset:10240
  ds_read_b64_tr_b16 v[42:43], v2 offset:11264
  v_exp_f32 v13, v13
  v_fma_f32 v12, v12, v10, v10
  v_mfma_f32_32x32x16_bf16 v[64:79], v[20:23], a[80:83], v[64:79]
  s_waitcnt lgkmcnt(6)
  ds_read_b64_tr_b16 v[44:45], v11 offset:10240
  ds_read_b64_tr_b16 v[46:47], v11 offset:11264
  buffer_load_dwordx4 v4, s[12:15], s34 offen offset:1024 lds
  v_fma_f32 v13, v13, v10, v10
  v_rcp_f32 v12, v12
  v_rcp_f32 v13, v13
  v_mfma_f32_32x32x16_bf16 v[48:63], v[24:27], a[84:87], v[48:63]
  ds_read_b64_tr_b16 v[16:17], v2 offset:12288
  ds_read_b64_tr_b16 v[18:19], v2 offset:13312
  v_mul_f32 v12, v12, v96
  v_mul_f32 v13, v13, v97
  v_cvt_pk_bf16_f32 v232, v12, v13
  v_mul_f32 v14, v98, v98
  v_mul_f32 v15, v99, v99
  v_mfma_f32_32x32x16_bf16 v[64:79], v[28:31], a[84:87], v[64:79]
  s_waitcnt lgkmcnt(6)
  ds_read_b64_tr_b16 v[20:21], v11 offset:12288
  ds_read_b64_tr_b16 v[22:23], v11 offset:13312
  v_fma_f32 v14, v14, v8, v6
  v_fma_f32 v15, v15, v8, v6
  v_mul_f32 v14, v14, v98
  v_mul_f32 v15, v15, v99
  v_mfma_f32_32x32x16_bf16 v[48:63], v[32:35], a[88:91], v[48:63]
  ds_read_b64_tr_b16 v[24:25], v2 offset:14336
  ds_read_b64_tr_b16 v[26:27], v2 offset:15360
  buffer_load_dwordx4 v4, s[12:15], s35 offen offset:2048 lds
  v_exp_f32 v14, v14
  v_exp_f32 v15, v15
  v_fma_f32 v14, v14, v10, v10
  v_mfma_f32_32x32x16_bf16 v[64:79], v[36:39], a[88:91], v[64:79]
  s_waitcnt lgkmcnt(6)
  ds_read_b64_tr_b16 v[28:29], v11 offset:14336
  ds_read_b64_tr_b16 v[30:31], v11 offset:15360
  v_fma_f32 v15, v15, v10, v10
  v_rcp_f32 v14, v14
  v_rcp_f32 v15, v15
  v_mfma_f32_32x32x16_bf16 v[48:63], v[40:43], a[92:95], v[48:63]
  ds_read_b64_tr_b16 v[32:33], v2 offset:16384
  ds_read_b64_tr_b16 v[34:35], v2 offset:17408
  v_mul_f32 v14, v14, v98
  v_mul_f32 v15, v15, v99
  v_cvt_pk_bf16_f32 v233, v14, v15
  v_mul_f32 v12, v100, v100
  v_mfma_f32_32x32x16_bf16 v[64:79], v[44:47], a[92:95], v[64:79]
  s_waitcnt lgkmcnt(6)
  ds_read_b64_tr_b16 v[36:37], v11 offset:16384
  ds_read_b64_tr_b16 v[38:39], v11 offset:17408
  buffer_load_dwordx4 v4, s[12:15], s36 offen offset:3072 lds
  v_mul_f32 v13, v101, v101
  v_fma_f32 v12, v12, v8, v6
  v_fma_f32 v13, v13, v8, v6
  v_mul_f32 v12, v12, v100
  v_mul_f32 v13, v13, v101
  v_mfma_f32_32x32x16_bf16 v[48:63], v[16:19], a[96:99], v[48:63]
  ds_read_b64_tr_b16 v[40:41], v2 offset:18432
  ds_read_b64_tr_b16 v[42:43], v2 offset:19456
  v_exp_f32 v12, v12
  v_exp_f32 v13, v13
  v_mfma_f32_32x32x16_bf16 v[64:79], v[20:23], a[96:99], v[64:79]
  s_waitcnt lgkmcnt(6)
  ds_read_b64_tr_b16 v[44:45], v11 offset:18432
  ds_read_b64_tr_b16 v[46:47], v11 offset:19456
  v_fma_f32 v12, v12, v10, v10
  v_fma_f32 v13, v13, v10, v10
  v_rcp_f32 v12, v12
  v_rcp_f32 v13, v13
  v_mfma_f32_32x32x16_bf16 v[48:63], v[24:27], a[100:103], v[48:63]
  s_add_u32 m0, s42, 114688
  ds_read_b64_tr_b16 v[16:17], v2 offset:20480
  ds_read_b64_tr_b16 v[18:19], v2 offset:21504
  buffer_load_dwordx4 v4, s[12:15], s37 offen offset:0 lds
  v_mul_f32 v12, v12, v100
  v_mul_f32 v13, v13, v101
  v_cvt_pk_bf16_f32 v234, v12, v13
  v_mfma_f32_32x32x16_bf16 v[64:79], v[28:31], a[100:103], v[64:79]
  s_waitcnt lgkmcnt(6)
  ds_read_b64_tr_b16 v[20:21], v11 offset:20480
  ds_read_b64_tr_b16 v[22:23], v11 offset:21504
  v_mul_f32 v14, v102, v102
  v_mul_f32 v15, v103, v103
  v_fma_f32 v14, v14, v8, v6
  v_fma_f32 v15, v15, v8, v6
  v_mul_f32 v14, v14, v102
  v_mfma_f32_32x32x16_bf16 v[48:63], v[32:35], a[104:107], v[48:63]
  ds_read_b64_tr_b16 v[24:25], v2 offset:22528
  ds_read_b64_tr_b16 v[26:27], v2 offset:23552
  v_mul_f32 v15, v15, v103
  v_exp_f32 v14, v14
  v_exp_f32 v15, v15
  v_mfma_f32_32x32x16_bf16 v[64:79], v[36:39], a[104:107], v[64:79]
  s_waitcnt lgkmcnt(6)
  ds_read_b64_tr_b16 v[28:29], v11 offset:22528
  ds_read_b64_tr_b16 v[30:31], v11 offset:23552
  buffer_load_dwordx4 v4, s[12:15], s38 offen offset:1024 lds
  v_fma_f32 v14, v14, v10, v10
  v_fma_f32 v15, v15, v10, v10
  v_rcp_f32 v14, v14
  v_mfma_f32_32x32x16_bf16 v[48:63], v[40:43], a[108:111], v[48:63]
  ds_read_b64_tr_b16 v[32:33], v2 offset:24576
  ds_read_b64_tr_b16 v[34:35], v2 offset:25600
  v_rcp_f32 v15, v15
  v_mul_f32 v14, v14, v102
  v_mul_f32 v15, v15, v103
  v_cvt_pk_bf16_f32 v235, v14, v15
  v_mfma_f32_32x32x16_bf16 v[64:79], v[44:47], a[108:111], v[64:79]
  s_waitcnt lgkmcnt(6)
  ds_read_b64_tr_b16 v[36:37], v11 offset:24576
  ds_read_b64_tr_b16 v[38:39], v11 offset:25600
  v_mul_f32 v12, v104, v104
  v_mul_f32 v13, v105, v105
  v_fma_f32 v12, v12, v8, v6
  v_fma_f32 v13, v13, v8, v6
  v_mfma_f32_32x32x16_bf16 v[48:63], v[16:19], a[112:115], v[48:63]
  ds_read_b64_tr_b16 v[40:41], v2 offset:26624
  ds_read_b64_tr_b16 v[42:43], v2 offset:27648
  buffer_load_dwordx4 v4, s[12:15], s39 offen offset:2048 lds
  v_mul_f32 v12, v12, v104
  v_mul_f32 v13, v13, v105
  v_exp_f32 v12, v12
  v_exp_f32 v13, v13
  v_mfma_f32_32x32x16_bf16 v[64:79], v[20:23], a[112:115], v[64:79]
  s_waitcnt lgkmcnt(6)
  ds_read_b64_tr_b16 v[44:45], v11 offset:26624
  ds_read_b64_tr_b16 v[46:47], v11 offset:27648
  v_fma_f32 v12, v12, v10, v10
  v_fma_f32 v13, v13, v10, v10
  v_rcp_f32 v12, v12
  v_mfma_f32_32x32x16_bf16 v[48:63], v[24:27], a[116:119], v[48:63]
  ds_read_b64_tr_b16 v[16:17], v2 offset:28672
  ds_read_b64_tr_b16 v[18:19], v2 offset:29696
  v_rcp_f32 v13, v13
  v_mul_f32 v12, v12, v104
  v_mul_f32 v13, v13, v105
  v_mfma_f32_32x32x16_bf16 v[64:79], v[28:31], a[116:119], v[64:79]
  s_waitcnt lgkmcnt(6)
  ds_read_b64_tr_b16 v[20:21], v11 offset:28672
  ds_read_b64_tr_b16 v[22:23], v11 offset:29696
  buffer_load_dwordx4 v4, s[12:15], s40 offen offset:3072 lds
  v_cvt_pk_bf16_f32 v236, v12, v13
  v_mul_f32 v14, v106, v106
  v_mul_f32 v15, v107, v107
  v_fma_f32 v14, v14, v8, v6
  v_fma_f32 v15, v15, v8, v6
  v_mfma_f32_32x32x16_bf16 v[48:63], v[32:35], a[120:123], v[48:63]
  ds_read_b64_tr_b16 v[24:25], v2 offset:30720
  ds_read_b64_tr_b16 v[26:27], v2 offset:31744
  v_mul_f32 v14, v14, v106
  v_mul_f32 v15, v15, v107
  v_exp_f32 v14, v14
  v_mfma_f32_32x32x16_bf16 v[64:79], v[36:39], a[120:123], v[64:79]
  s_waitcnt lgkmcnt(6)
  ds_read_b64_tr_b16 v[28:29], v11 offset:30720
  ds_read_b64_tr_b16 v[30:31], v11 offset:31744
  v_exp_f32 v15, v15
  v_fma_f32 v14, v14, v10, v10
  v_fma_f32 v15, v15, v10, v10
  v_rcp_f32 v14, v14
  v_mfma_f32_32x32x16_bf16 v[48:63], v[40:43], a[124:127], v[48:63]
  s_add_u32 m0, s42, 118784
  ds_read_b64_tr_b16 v[32:33], v2 offset:32768
  ds_read_b64_tr_b16 v[34:35], v2 offset:33792
  buffer_load_dwordx4 v4, s[12:15], s41 offen offset:0 lds
  v_rcp_f32 v15, v15
  v_mul_f32 v14, v14, v106
  v_mul_f32 v15, v15, v107
  v_mfma_f32_32x32x16_bf16 v[64:79], v[44:47], a[124:127], v[64:79]
  s_waitcnt lgkmcnt(6)
  ds_read_b64_tr_b16 v[36:37], v11 offset:32768
  ds_read_b64_tr_b16 v[38:39], v11 offset:33792
  v_cvt_pk_bf16_f32 v237, v14, v15
  v_mul_f32 v12, v108, v108
  v_mul_f32 v13, v109, v109
  v_fma_f32 v12, v12, v8, v6
  v_mfma_f32_32x32x16_bf16 v[48:63], v[16:19], a[128:131], v[48:63]
  ds_read_b64_tr_b16 v[40:41], v2 offset:34816
  ds_read_b64_tr_b16 v[42:43], v2 offset:35840
  v_fma_f32 v13, v13, v8, v6
  v_mul_f32 v12, v12, v108
  v_mul_f32 v13, v13, v109
  v_exp_f32 v12, v12
  v_mfma_f32_32x32x16_bf16 v[64:79], v[20:23], a[128:131], v[64:79]
  s_waitcnt lgkmcnt(6)
  ds_read_b64_tr_b16 v[44:45], v11 offset:34816
  ds_read_b64_tr_b16 v[46:47], v11 offset:35840
  v_add_u32 v4, 331776, v4
  v_add_u32 v1, 36864, v0
  v_xor_b32 v5, 64, v1
  v_exp_f32 v13, v13
  v_fma_f32 v12, v12, v10, v10
  v_fma_f32 v13, v13, v10, v10
  v_mfma_f32_32x32x16_bf16 v[48:63], v[24:27], a[132:135], v[48:63]
  v_rcp_f32 v12, v12
  v_rcp_f32 v13, v13
  v_mul_f32 v12, v12, v108
  v_mul_f32 v13, v13, v109
  v_mfma_f32_32x32x16_bf16 v[64:79], v[28:31], a[132:135], v[64:79]
  s_waitcnt vmcnt(18) lgkmcnt(0)
  s_barrier
  ds_read_b64_tr_b16 v[16:17], v1 offset:0
  ds_read_b64_tr_b16 v[18:19], v1 offset:1024
  ds_read_b64_tr_b16 v[20:21], v5 offset:0
  ds_read_b64_tr_b16 v[22:23], v5 offset:1024
  v_cvt_pk_bf16_f32 v238, v12, v13
  v_mul_f32 v14, v110, v110
  v_mul_f32 v15, v111, v111
  v_fma_f32 v14, v14, v8, v6
  v_mfma_f32_32x32x16_bf16 v[48:63], v[32:35], a[136:139], v[48:63]
  ds_read_b64_tr_b16 v[24:25], v1 offset:2048
  ds_read_b64_tr_b16 v[26:27], v1 offset:3072
  v_fma_f32 v15, v15, v8, v6
  v_mul_f32 v14, v14, v110
  v_mul_f32 v15, v15, v111
  v_exp_f32 v14, v14
  v_mfma_f32_32x32x16_bf16 v[64:79], v[36:39], a[136:139], v[64:79]
  s_waitcnt lgkmcnt(6)
  ds_read_b64_tr_b16 v[28:29], v5 offset:2048
  ds_read_b64_tr_b16 v[30:31], v5 offset:3072
  v_exp_f32 v15, v15
  v_fma_f32 v14, v14, v10, v10
  v_fma_f32 v15, v15, v10, v10
  v_mfma_f32_32x32x16_bf16 v[48:63], v[40:43], a[140:143], v[48:63]
  ds_read_b64_tr_b16 v[32:33], v1 offset:4096
  ds_read_b64_tr_b16 v[34:35], v1 offset:5120
  v_rcp_f32 v14, v14
  v_rcp_f32 v15, v15
  v_mul_f32 v14, v14, v110
  v_mul_f32 v15, v15, v111
  v_cvt_pk_bf16_f32 v239, v14, v15
  v_mfma_f32_32x32x16_bf16 v[64:79], v[44:47], a[140:143], v[64:79]
  s_waitcnt lgkmcnt(6)
  ds_read_b64_tr_b16 v[36:37], v5 offset:4096
  ds_read_b64_tr_b16 v[38:39], v5 offset:5120
  v_mfma_f32_32x32x16_bf16 v[80:95], v[16:19], v[112:115], 0
  ds_read_b64_tr_b16 v[40:41], v1 offset:6144
  ds_read_b64_tr_b16 v[42:43], v1 offset:7168
  v_mfma_f32_32x32x16_bf16 v[96:111], v[20:23], v[112:115], 0
  s_waitcnt lgkmcnt(6)
  ds_read_b64_tr_b16 v[44:45], v5 offset:6144
  ds_read_b64_tr_b16 v[46:47], v5 offset:7168
  v_mfma_f32_32x32x16_bf16 v[80:95], v[24:27], v[116:119], v[80:95]
  s_add_u32 m0, s42, 0
  ds_read_b64_tr_b16 v[16:17], v1 offset:8192
  ds_read_b64_tr_b16 v[18:19], v1 offset:9216
  buffer_load_dwordx4 v4, s[12:15], s33 offen offset:0 lds
  v_mul_f32 v12, v48, v48
  v_mul_f32 v13, v49, v49
  v_mfma_f32_32x32x16_bf16 v[96:111], v[28:31], v[116:119], v[96:111]
  s_waitcnt lgkmcnt(6)
  ds_read_b64_tr_b16 v[20:21], v5 offset:8192
  ds_read_b64_tr_b16 v[22:23], v5 offset:9216
  v_fma_f32 v12, v12, v8, v6
  v_fma_f32 v13, v13, v8, v6
  v_mul_f32 v12, v12, v48
  v_mul_f32 v13, v13, v49
  v_exp_f32 v12, v12
  v_mfma_f32_32x32x16_bf16 v[80:95], v[32:35], v[120:123], v[80:95]
  ds_read_b64_tr_b16 v[24:25], v1 offset:10240
  ds_read_b64_tr_b16 v[26:27], v1 offset:11264
  v_exp_f32 v13, v13
  v_fma_f32 v12, v12, v10, v10
  v_mfma_f32_32x32x16_bf16 v[96:111], v[36:39], v[120:123], v[96:111]
  s_waitcnt lgkmcnt(6)
  ds_read_b64_tr_b16 v[28:29], v5 offset:10240
  ds_read_b64_tr_b16 v[30:31], v5 offset:11264
  buffer_load_dwordx4 v4, s[12:15], s34 offen offset:1024 lds
  v_fma_f32 v13, v13, v10, v10
  v_rcp_f32 v12, v12
  v_rcp_f32 v13, v13
  v_mfma_f32_32x32x16_bf16 v[80:95], v[40:43], v[124:127], v[80:95]
  ds_read_b64_tr_b16 v[32:33], v1 offset:12288
  ds_read_b64_tr_b16 v[34:35], v1 offset:13312
  v_mul_f32 v12, v12, v48
  v_mul_f32 v13, v13, v49
  v_cvt_pk_bf16_f32 v240, v12, v13
  v_mul_f32 v14, v50, v50
  v_mul_f32 v15, v51, v51
  v_mfma_f32_32x32x16_bf16 v[96:111], v[44:47], v[124:127], v[96:111]
  s_waitcnt lgkmcnt(6)
  ds_read_b64_tr_b16 v[36:37], v5 offset:12288
  ds_read_b64_tr_b16 v[38:39], v5 offset:13312
  v_fma_f32 v14, v14, v8, v6
  v_fma_f32 v15, v15, v8, v6
  v_mul_f32 v14, v14, v50
  v_mul_f32 v15, v15, v51
  v_mfma_f32_32x32x16_bf16 v[80:95], v[16:19], v[128:131], v[80:95]
  ds_read_b64_tr_b16 v[40:41], v1 offset:14336
  ds_read_b64_tr_b16 v[42:43], v1 offset:15360
  buffer_load_dwordx4 v4, s[12:15], s35 offen offset:2048 lds
  v_exp_f32 v14, v14
  v_exp_f32 v15, v15
  v_fma_f32 v14, v14, v10, v10
  v_mfma_f32_32x32x16_bf16 v[96:111], v[20:23], v[128:131], v[96:111]
  s_waitcnt lgkmcnt(6)
  ds_read_b64_tr_b16 v[44:45], v5 offset:14336
  ds_read_b64_tr_b16 v[46:47], v5 offset:15360
  v_fma_f32 v15, v15, v10, v10
  v_rcp_f32 v14, v14
  v_rcp_f32 v15, v15
  v_mfma_f32_32x32x16_bf16 v[80:95], v[24:27], v[132:135], v[80:95]
  ds_read_b64_tr_b16 v[16:17], v1 offset:16384
  ds_read_b64_tr_b16 v[18:19], v1 offset:17408
  v_mul_f32 v14, v14, v50
  v_mul_f32 v15, v15, v51
  v_cvt_pk_bf16_f32 v241, v14, v15
  v_mul_f32 v12, v52, v52
  v_mfma_f32_32x32x16_bf16 v[96:111], v[28:31], v[132:135], v[96:111]
  s_waitcnt lgkmcnt(6)
  ds_read_b64_tr_b16 v[20:21], v5 offset:16384
  ds_read_b64_tr_b16 v[22:23], v5 offset:17408
  buffer_load_dwordx4 v4, s[12:15], s36 offen offset:3072 lds
  v_mul_f32 v13, v53, v53
  v_fma_f32 v12, v12, v8, v6
  v_fma_f32 v13, v13, v8, v6
  v_mul_f32 v12, v12, v52
  v_mul_f32 v13, v13, v53
  v_mfma_f32_32x32x16_bf16 v[80:95], v[32:35], v[136:139], v[80:95]
  ds_read_b64_tr_b16 v[24:25], v1 offset:18432
  ds_read_b64_tr_b16 v[26:27], v1 offset:19456
  v_exp_f32 v12, v12
  v_exp_f32 v13, v13
  v_mfma_f32_32x32x16_bf16 v[96:111], v[36:39], v[136:139], v[96:111]
  s_waitcnt lgkmcnt(6)
  ds_read_b64_tr_b16 v[28:29], v5 offset:18432
  ds_read_b64_tr_b16 v[30:31], v5 offset:19456
  v_fma_f32 v12, v12, v10, v10
  v_fma_f32 v13, v13, v10, v10
  v_rcp_f32 v12, v12
  v_rcp_f32 v13, v13
  v_mfma_f32_32x32x16_bf16 v[80:95], v[40:43], v[140:143], v[80:95]
  s_add_u32 m0, s42, 4096
  ds_read_b64_tr_b16 v[32:33], v1 offset:20480
  ds_read_b64_tr_b16 v[34:35], v1 offset:21504
  buffer_load_dwordx4 v4, s[12:15], s37 offen offset:0 lds
  v_mul_f32 v12, v12, v52
  v_mul_f32 v13, v13, v53
  v_cvt_pk_bf16_f32 v242, v12, v13
  v_mfma_f32_32x32x16_bf16 v[96:111], v[44:47], v[140:143], v[96:111]
  s_waitcnt lgkmcnt(6)
  ds_read_b64_tr_b16 v[36:37], v5 offset:20480
  ds_read_b64_tr_b16 v[38:39], v5 offset:21504
  v_mul_f32 v14, v54, v54
  v_mul_f32 v15, v55, v55
  v_fma_f32 v14, v14, v8, v6
  v_fma_f32 v15, v15, v8, v6
  v_mul_f32 v14, v14, v54
  v_mfma_f32_32x32x16_bf16 v[80:95], v[16:19], v[144:147], v[80:95]
  ds_read_b64_tr_b16 v[40:41], v1 offset:22528
  ds_read_b64_tr_b16 v[42:43], v1 offset:23552
  v_mul_f32 v15, v15, v55
  v_exp_f32 v14, v14
  v_exp_f32 v15, v15
  v_mfma_f32_32x32x16_bf16 v[96:111], v[20:23], v[144:147], v[96:111]
  s_waitcnt lgkmcnt(6)
  ds_read_b64_tr_b16 v[44:45], v5 offset:22528
  ds_read_b64_tr_b16 v[46:47], v5 offset:23552
  buffer_load_dwordx4 v4, s[12:15], s38 offen offset:1024 lds
  v_fma_f32 v14, v14, v10, v10
  v_fma_f32 v15, v15, v10, v10
  v_rcp_f32 v14, v14
  v_mfma_f32_32x32x16_bf16 v[80:95], v[24:27], v[148:151], v[80:95]
  ds_read_b64_tr_b16 v[16:17], v1 offset:24576
  ds_read_b64_tr_b16 v[18:19], v1 offset:25600
  v_rcp_f32 v15, v15
  v_mul_f32 v14, v14, v54
  v_mul_f32 v15, v15, v55
  v_cvt_pk_bf16_f32 v243, v14, v15
  v_mfma_f32_32x32x16_bf16 v[96:111], v[28:31], v[148:151], v[96:111]
  s_waitcnt lgkmcnt(6)
  ds_read_b64_tr_b16 v[20:21], v5 offset:24576
  ds_read_b64_tr_b16 v[22:23], v5 offset:25600
  v_mul_f32 v12, v56, v56
  v_mul_f32 v13, v57, v57
  v_fma_f32 v12, v12, v8, v6
  v_fma_f32 v13, v13, v8, v6
  v_mfma_f32_32x32x16_bf16 v[80:95], v[32:35], v[152:155], v[80:95]
  ds_read_b64_tr_b16 v[24:25], v1 offset:26624
  ds_read_b64_tr_b16 v[26:27], v1 offset:27648
  buffer_load_dwordx4 v4, s[12:15], s39 offen offset:2048 lds
  v_mul_f32 v12, v12, v56
  v_mul_f32 v13, v13, v57
  v_exp_f32 v12, v12
  v_exp_f32 v13, v13
  v_mfma_f32_32x32x16_bf16 v[96:111], v[36:39], v[152:155], v[96:111]
  s_waitcnt lgkmcnt(6)
  ds_read_b64_tr_b16 v[28:29], v5 offset:26624
  ds_read_b64_tr_b16 v[30:31], v5 offset:27648
  v_fma_f32 v12, v12, v10, v10
  v_fma_f32 v13, v13, v10, v10
  v_rcp_f32 v12, v12
  v_mfma_f32_32x32x16_bf16 v[80:95], v[40:43], v[156:159], v[80:95]
  ds_read_b64_tr_b16 v[32:33], v1 offset:28672
  ds_read_b64_tr_b16 v[34:35], v1 offset:29696
  v_rcp_f32 v13, v13
  v_mul_f32 v12, v12, v56
  v_mul_f32 v13, v13, v57
  v_mfma_f32_32x32x16_bf16 v[96:111], v[44:47], v[156:159], v[96:111]
  s_waitcnt lgkmcnt(6)
  ds_read_b64_tr_b16 v[36:37], v5 offset:28672
  ds_read_b64_tr_b16 v[38:39], v5 offset:29696
  buffer_load_dwordx4 v4, s[12:15], s40 offen offset:3072 lds
  v_cvt_pk_bf16_f32 v244, v12, v13
  v_mul_f32 v14, v58, v58
  v_mul_f32 v15, v59, v59
  v_fma_f32 v14, v14, v8, v6
  v_fma_f32 v15, v15, v8, v6
  v_mfma_f32_32x32x16_bf16 v[80:95], v[16:19], v[160:163], v[80:95]
  ds_read_b64_tr_b16 v[40:41], v1 offset:30720
  ds_read_b64_tr_b16 v[42:43], v1 offset:31744
  v_mul_f32 v14, v14, v58
  v_mul_f32 v15, v15, v59
  v_exp_f32 v14, v14
  v_mfma_f32_32x32x16_bf16 v[96:111], v[20:23], v[160:163], v[96:111]
  s_waitcnt lgkmcnt(6)
  ds_read_b64_tr_b16 v[44:45], v5 offset:30720
  ds_read_b64_tr_b16 v[46:47], v5 offset:31744
  v_exp_f32 v15, v15
  v_fma_f32 v14, v14, v10, v10
  v_fma_f32 v15, v15, v10, v10
  v_rcp_f32 v14, v14
  v_mfma_f32_32x32x16_bf16 v[80:95], v[24:27], v[164:167], v[80:95]
  s_add_u32 m0, s42, 8192
  ds_read_b64_tr_b16 v[16:17], v1 offset:32768
  ds_read_b64_tr_b16 v[18:19], v1 offset:33792
  buffer_load_dwordx4 v4, s[12:15], s41 offen offset:0 lds
  v_rcp_f32 v15, v15
  v_mul_f32 v14, v14, v58
  v_mul_f32 v15, v15, v59
  v_mfma_f32_32x32x16_bf16 v[96:111], v[28:31], v[164:167], v[96:111]
  s_waitcnt lgkmcnt(6)
  ds_read_b64_tr_b16 v[20:21], v5 offset:32768
  ds_read_b64_tr_b16 v[22:23], v5 offset:33792
  v_cvt_pk_bf16_f32 v245, v14, v15
  v_mul_f32 v12, v60, v60
  v_mul_f32 v13, v61, v61
  v_fma_f32 v12, v12, v8, v6
  v_mfma_f32_32x32x16_bf16 v[80:95], v[32:35], v[168:171], v[80:95]
  ds_read_b64_tr_b16 v[24:25], v1 offset:34816
  ds_read_b64_tr_b16 v[26:27], v1 offset:35840
  v_fma_f32 v13, v13, v8, v6
  v_mul_f32 v12, v12, v60
  v_mul_f32 v13, v13, v61
  v_exp_f32 v12, v12
  v_mfma_f32_32x32x16_bf16 v[96:111], v[36:39], v[168:171], v[96:111]
  s_waitcnt lgkmcnt(6)
  ds_read_b64_tr_b16 v[28:29], v5 offset:34816
  ds_read_b64_tr_b16 v[30:31], v5 offset:35840
  v_subrev_u32 v4, 331648, v4
  v_add_u32 v2, 73728, v0
  v_xor_b32 v11, 64, v2
  v_exp_f32 v13, v13
  v_fma_f32 v12, v12, v10, v10
  v_fma_f32 v13, v13, v10, v10
  v_mfma_f32_32x32x16_bf16 v[80:95], v[40:43], v[172:175], v[80:95]
  v_rcp_f32 v12, v12
  v_rcp_f32 v13, v13
  v_mul_f32 v12, v12, v60
  v_mul_f32 v13, v13, v61
  v_mfma_f32_32x32x16_bf16 v[96:111], v[44:47], v[172:175], v[96:111]
  s_waitcnt vmcnt(18) lgkmcnt(0)
  s_barrier
  ds_read_b64_tr_b16 v[32:33], v2 offset:0
  ds_read_b64_tr_b16 v[34:35], v2 offset:1024
  ds_read_b64_tr_b16 v[36:37], v11 offset:0
  ds_read_b64_tr_b16 v[38:39], v11 offset:1024
  v_cvt_pk_bf16_f32 v246, v12, v13
  v_mul_f32 v14, v62, v62
  v_mul_f32 v15, v63, v63
  v_fma_f32 v14, v14, v8, v6
  v_mfma_f32_32x32x16_bf16 v[80:95], v[16:19], v[176:179], v[80:95]
  ds_read_b64_tr_b16 v[40:41], v2 offset:2048
  ds_read_b64_tr_b16 v[42:43], v2 offset:3072
  v_fma_f32 v15, v15, v8, v6
  v_mul_f32 v14, v14, v62
  v_mul_f32 v15, v15, v63
  v_exp_f32 v14, v14
  v_mfma_f32_32x32x16_bf16 v[96:111], v[20:23], v[176:179], v[96:111]
  s_waitcnt lgkmcnt(6)
  ds_read_b64_tr_b16 v[44:45], v11 offset:2048
  ds_read_b64_tr_b16 v[46:47], v11 offset:3072
  v_exp_f32 v15, v15
  v_fma_f32 v14, v14, v10, v10
  v_fma_f32 v15, v15, v10, v10
  v_mfma_f32_32x32x16_bf16 v[80:95], v[24:27], v[180:183], v[80:95]
  ds_read_b64_tr_b16 v[16:17], v2 offset:4096
  ds_read_b64_tr_b16 v[18:19], v2 offset:5120
  v_rcp_f32 v14, v14
  v_rcp_f32 v15, v15
  v_mul_f32 v14, v14, v62
  v_mul_f32 v15, v15, v63
  v_cvt_pk_bf16_f32 v247, v14, v15
  v_mfma_f32_32x32x16_bf16 v[96:111], v[28:31], v[180:183], v[96:111]
  s_waitcnt lgkmcnt(6)
  ds_read_b64_tr_b16 v[20:21], v11 offset:4096
  ds_read_b64_tr_b16 v[22:23], v11 offset:5120
  v_mfma_f32_32x32x16_bf16 v[80:95], v[32:35], v[184:187], v[80:95]
  ds_read_b64_tr_b16 v[24:25], v2 offset:6144
  ds_read_b64_tr_b16 v[26:27], v2 offset:7168
  v_mul_f32 v12, v64, v64
  v_mul_f32 v13, v65, v65
  v_fma_f32 v12, v12, v8, v6
  v_mfma_f32_32x32x16_bf16 v[96:111], v[36:39], v[184:187], v[96:111]
  s_waitcnt lgkmcnt(6)
  ds_read_b64_tr_b16 v[28:29], v11 offset:6144
  ds_read_b64_tr_b16 v[30:31], v11 offset:7168
  v_fma_f32 v13, v13, v8, v6
  v_mul_f32 v12, v12, v64
  v_mul_f32 v13, v13, v65
  v_exp_f32 v12, v12
  v_mfma_f32_32x32x16_bf16 v[80:95], v[40:43], v[188:191], v[80:95]
  s_add_u32 m0, s42, 36864
  ds_read_b64_tr_b16 v[32:33], v2 offset:8192
  ds_read_b64_tr_b16 v[34:35], v2 offset:9216
  buffer_load_dwordx4 v4, s[12:15], s33 offen offset:0 lds
  v_exp_f32 v13, v13
  v_fma_f32 v12, v12, v10, v10
  v_fma_f32 v13, v13, v10, v10
  v_rcp_f32 v12, v12
  v_mfma_f32_32x32x16_bf16 v[96:111], v[44:47], v[188:191], v[96:111]
  s_waitcnt lgkmcnt(6)
  ds_read_b64_tr_b16 v[36:37], v11 offset:8192
  ds_read_b64_tr_b16 v[38:39], v11 offset:9216
  v_rcp_f32 v13, v13
  v_mul_f32 v12, v12, v64
  v_mul_f32 v13, v13, v65
  v_mfma_f32_32x32x16_bf16 v[80:95], v[16:19], v[192:195], v[80:95]
  ds_read_b64_tr_b16 v[40:41], v2 offset:10240
  ds_read_b64_tr_b16 v[42:43], v2 offset:11264
  v_cvt_pk_bf16_f32 v248, v12, v13
  v_mul_f32 v14, v66, v66
  v_mul_f32 v15, v67, v67
  v_fma_f32 v14, v14, v8, v6
  v_fma_f32 v15, v15, v8, v6
  v_mul_f32 v14, v14, v66
  v_mfma_f32_32x32x16_bf16 v[96:111], v[20:23], v[192:195], v[96:111]
  s_waitcnt lgkmcnt(6)
  ds_read_b64_tr_b16 v[44:45], v11 offset:10240
  ds_read_b64_tr_b16 v[46:47], v11 offset:11264
  buffer_load_dwordx4 v4, s[12:15], s34 offen offset:1024 lds
  v_mul_f32 v15, v15, v67
  v_exp_f32 v14, v14
  v_exp_f32 v15, v15
  v_mfma_f32_32x32x16_bf16 v[80:95], v[24:27], v[196:199], v[80:95]
  ds_read_b64_tr_b16 v[16:17], v2 offset:12288
  ds_read_b64_tr_b16 v[18:19], v2 offset:13312
  v_fma_f32 v14, v14, v10, v10
  v_fma_f32 v15, v15, v10, v10
  v_rcp_f32 v14, v14
  v_rcp_f32 v15, v15
  v_mfma_f32_32x32x16_bf16 v[96:111], v[28:31], v[196:199], v[96:111]
  s_waitcnt lgkmcnt(6)
  ds_read_b64_tr_b16 v[20:21], v11 offset:12288
  ds_read_b64_tr_b16 v[22:23], v11 offset:13312
  v_mul_f32 v14, v14, v66
  v_mul_f32 v15, v15, v67
  v_cvt_pk_bf16_f32 v249, v14, v15
  v_mul_f32 v12, v68, v68
  v_mfma_f32_32x32x16_bf16 v[80:95], v[32:35], v[200:203], v[80:95]
  ds_read_b64_tr_b16 v[24:25], v2 offset:14336
  ds_read_b64_tr_b16 v[26:27], v2 offset:15360
  buffer_load_dwordx4 v4, s[12:15], s35 offen offset:2048 lds
  v_mul_f32 v13, v69, v69
  v_fma_f32 v12, v12, v8, v6
  v_fma_f32 v13, v13, v8, v6
  v_mul_f32 v12, v12, v68
  v_mul_f32 v13, v13, v69
  v_exp_f32 v12, v12
  v_mfma_f32_32x32x16_bf16 v[96:111], v[36:39], v[200:203], v[96:111]
  s_waitcnt lgkmcnt(6)
  ds_read_b64_tr_b16 v[28:29], v11 offset:14336
  ds_read_b64_tr_b16 v[30:31], v11 offset:15360
  v_exp_f32 v13, v13
  v_fma_f32 v12, v12, v10, v10
  v_fma_f32 v13, v13, v10, v10
  v_mfma_f32_32x32x16_bf16 v[80:95], v[40:43], v[204:207], v[80:95]
  ds_read_b64_tr_b16 v[32:33], v2 offset:16384
  ds_read_b64_tr_b16 v[34:35], v2 offset:17408
  v_rcp_f32 v12, v12
  v_rcp_f32 v13, v13
  v_mul_f32 v12, v12, v68
  v_mfma_f32_32x32x16_bf16 v[96:111], v[44:47], v[204:207], v[96:111]
  s_waitcnt lgkmcnt(6)
  ds_read_b64_tr_b16 v[36:37], v11 offset:16384
  ds_read_b64_tr_b16 v[38:39], v11 offset:17408
  buffer_load_dwordx4 v4, s[12:15], s36 offen offset:3072 lds
  v_mul_f32 v13, v13, v69
  v_cvt_pk_bf16_f32 v250, v12, v13
  v_mul_f32 v14, v70, v70
  v_mul_f32 v15, v71, v71
  v_fma_f32 v14, v14, v8, v6
  v_mfma_f32_32x32x16_bf16 v[80:95], v[16:19], v[208:211], v[80:95]
  ds_read_b64_tr_b16 v[40:41], v2 offset:18432
  ds_read_b64_tr_b16 v[42:43], v2 offset:19456
  v_fma_f32 v15, v15, v8, v6
  v_mul_f32 v14, v14, v70
  v_mul_f32 v15, v15, v71
  v_exp_f32 v14, v14
  v_exp_f32 v15, v15
  v_mfma_f32_32x32x16_bf16 v[96:111], v[20:23], v[208:211], v[96:111]
  s_waitcnt lgkmcnt(6)
  ds_read_b64_tr_b16 v[44:45], v11 offset:18432
  ds_read_b64_tr_b16 v[46:47], v11 offset:19456
  v_fma_f32 v14, v14, v10, v10
  v_fma_f32 v15, v15, v10, v10
  v_rcp_f32 v14, v14
  v_mfma_f32_32x32x16_bf16 v[80:95], v[24:27], v[212:215], v[80:95]
  s_add_u32 m0, s42, 40960
  ds_read_b64_tr_b16 v[16:17], v2 offset:20480
  ds_read_b64_tr_b16 v[18:19], v2 offset:21504
  buffer_load_dwordx4 v4, s[12:15], s37 offen offset:0 lds
  v_rcp_f32 v15, v15
  v_mul_f32 v14, v14, v70
  v_mul_f32 v15, v15, v71
  v_cvt_pk_bf16_f32 v251, v14, v15
  v_mfma_f32_32x32x16_bf16 v[96:111], v[28:31], v[212:215], v[96:111]
  s_waitcnt lgkmcnt(6)
  ds_read_b64_tr_b16 v[20:21], v11 offset:20480
  ds_read_b64_tr_b16 v[22:23], v11 offset:21504
  v_mul_f32 v12, v72, v72
  v_mul_f32 v13, v73, v73
  v_fma_f32 v12, v12, v8, v6
  v_fma_f32 v13, v13, v8, v6
  v_mul_f32 v12, v12, v72
  v_mfma_f32_32x32x16_bf16 v[80:95], v[32:35], v[216:219], v[80:95]
  ds_read_b64_tr_b16 v[24:25], v2 offset:22528
  ds_read_b64_tr_b16 v[26:27], v2 offset:23552
  v_mul_f32 v13, v13, v73
  v_exp_f32 v12, v12
  v_exp_f32 v13, v13
  v_fma_f32 v12, v12, v10, v10
  v_mfma_f32_32x32x16_bf16 v[96:111], v[36:39], v[216:219], v[96:111]
  s_waitcnt lgkmcnt(6)
  ds_read_b64_tr_b16 v[28:29], v11 offset:22528
  ds_read_b64_tr_b16 v[30:31], v11 offset:23552
  buffer_load_dwordx4 v4, s[12:15], s38 offen offset:1024 lds
  v_fma_f32 v13, v13, v10, v10
  v_rcp_f32 v12, v12
  v_rcp_f32 v13, v13
  v_mfma_f32_32x32x16_bf16 v[80:95], v[40:43], v[220:223], v[80:95]
  ds_read_b64_tr_b16 v[32:33], v2 offset:24576
  ds_read_b64_tr_b16 v[34:35], v2 offset:25600
  v_mul_f32 v12, v12, v72
  v_mul_f32 v13, v13, v73
  v_cvt_pk_bf16_f32 v252, v12, v13
  v_mul_f32 v14, v74, v74
  v_mul_f32 v15, v75, v75
  v_mfma_f32_32x32x16_bf16 v[96:111], v[44:47], v[220:223], v[96:111]
  s_waitcnt lgkmcnt(6)
  ds_read_b64_tr_b16 v[36:37], v11 offset:24576
  ds_read_b64_tr_b16 v[38:39], v11 offset:25600
  v_fma_f32 v14, v14, v8, v6
  v_fma_f32 v15, v15, v8, v6
  v_mul_f32 v14, v14, v74
  v_mul_f32 v15, v15, v75
  v_exp_f32 v14, v14
  v_mfma_f32_32x32x16_bf16 v[80:95], v[16:19], v[224:227], v[80:95]
  ds_read_b64_tr_b16 v[40:41], v2 offset:26624
  ds_read_b64_tr_b16 v[42:43], v2 offset:27648
  buffer_load_dwordx4 v4, s[12:15], s39 offen offset:2048 lds
  v_exp_f32 v15, v15
  v_fma_f32 v14, v14, v10, v10
  v_fma_f32 v15, v15, v10, v10
  v_rcp_f32 v14, v14
  v_mfma_f32_32x32x16_bf16 v[96:111], v[20:23], v[224:227], v[96:111]
  s_waitcnt lgkmcnt(6)
  ds_read_b64_tr_b16 v[44:45], v11 offset:26624
  ds_read_b64_tr_b16 v[46:47], v11 offset:27648
  v_rcp_f32 v15, v15
  v_mul_f32 v14, v14, v74
  v_mul_f32 v15, v15, v75
  v_mfma_f32_32x32x16_bf16 v[80:95], v[24:27], v[228:231], v[80:95]
  ds_read_b64_tr_b16 v[16:17], v2 offset:28672
  ds_read_b64_tr_b16 v[18:19], v2 offset:29696
  v_cvt_pk_bf16_f32 v253, v14, v15
  v_mul_f32 v12, v76, v76
  v_mul_f32 v13, v77, v77
  v_fma_f32 v12, v12, v8, v6
  v_fma_f32 v13, v13, v8, v6
  v_mfma_f32_32x32x16_bf16 v[96:111], v[28:31], v[228:231], v[96:111]
  s_waitcnt lgkmcnt(6)
  ds_read_b64_tr_b16 v[20:21], v11 offset:28672
  ds_read_b64_tr_b16 v[22:23], v11 offset:29696
  buffer_load_dwordx4 v4, s[12:15], s40 offen offset:3072 lds
  v_mul_f32 v12, v12, v76
  v_mul_f32 v13, v13, v77
  v_exp_f32 v12, v12
  v_exp_f32 v13, v13
  v_mfma_f32_32x32x16_bf16 v[80:95], v[32:35], v[232:235], v[80:95]
  ds_read_b64_tr_b16 v[24:25], v2 offset:30720
  ds_read_b64_tr_b16 v[26:27], v2 offset:31744
  v_fma_f32 v12, v12, v10, v10
  v_fma_f32 v13, v13, v10, v10
  v_rcp_f32 v12, v12
  v_rcp_f32 v13, v13
  v_mfma_f32_32x32x16_bf16 v[96:111], v[36:39], v[232:235], v[96:111]
  s_waitcnt lgkmcnt(6)
  ds_read_b64_tr_b16 v[28:29], v11 offset:30720
  ds_read_b64_tr_b16 v[30:31], v11 offset:31744
  v_mul_f32 v12, v12, v76
  v_mul_f32 v13, v13, v77
  v_cvt_pk_bf16_f32 v254, v12, v13
  v_mul_f32 v14, v78, v78
  v_mfma_f32_32x32x16_bf16 v[80:95], v[40:43], v[236:239], v[80:95]
  s_add_u32 m0, s42, 45056
  ds_read_b64_tr_b16 v[32:33], v2 offset:32768
  ds_read_b64_tr_b16 v[34:35], v2 offset:33792
  buffer_load_dwordx4 v4, s[12:15], s41 offen offset:0 lds
  v_mul_f32 v15, v79, v79
  v_fma_f32 v14, v14, v8, v6
  v_fma_f32 v15, v15, v8, v6
  v_mul_f32 v14, v14, v78
  v_mul_f32 v15, v15, v79
  v_mfma_f32_32x32x16_bf16 v[96:111], v[44:47], v[236:239], v[96:111]
  s_waitcnt lgkmcnt(6)
  ds_read_b64_tr_b16 v[36:37], v11 offset:32768
  ds_read_b64_tr_b16 v[38:39], v11 offset:33792
  v_exp_f32 v14, v14
  v_exp_f32 v15, v15
  v_fma_f32 v14, v14, v10, v10
  v_mfma_f32_32x32x16_bf16 v[80:95], v[16:19], v[240:243], v[80:95]
  ds_read_b64_tr_b16 v[40:41], v2 offset:34816
  ds_read_b64_tr_b16 v[42:43], v2 offset:35840
  v_fma_f32 v15, v15, v10, v10
  v_rcp_f32 v14, v14
  v_rcp_f32 v15, v15
  v_mul_f32 v14, v14, v78
  v_mul_f32 v15, v15, v79
  v_cvt_pk_bf16_f32 v255, v14, v15
  v_mfma_f32_32x32x16_bf16 v[96:111], v[20:23], v[240:243], v[96:111]
  s_waitcnt lgkmcnt(6)
  ds_read_b64_tr_b16 v[44:45], v11 offset:34816
  ds_read_b64_tr_b16 v[46:47], v11 offset:35840
  v_add_u32 v4, 331776, v4
  v_add_u32 v1, 110592, v0
  v_xor_b32 v5, 64, v1
  v_mfma_f32_32x32x16_bf16 v[80:95], v[24:27], v[244:247], v[80:95]
  v_mfma_f32_32x32x16_bf16 v[96:111], v[28:31], v[244:247], v[96:111]
  s_waitcnt vmcnt(18) lgkmcnt(0)
  s_barrier
  ds_read_b64_tr_b16 v[16:17], v1 offset:0
  ds_read_b64_tr_b16 v[18:19], v1 offset:1024
  ds_read_b64_tr_b16 v[20:21], v5 offset:0
  ds_read_b64_tr_b16 v[22:23], v5 offset:1024
  v_mfma_f32_32x32x16_bf16 v[80:95], v[32:35], v[248:251], v[80:95]
  ds_read_b64_tr_b16 v[24:25], v1 offset:2048
  ds_read_b64_tr_b16 v[26:27], v1 offset:3072
  v_mfma_f32_32x32x16_bf16 v[96:111], v[36:39], v[248:251], v[96:111]
  s_waitcnt lgkmcnt(6)
  ds_read_b64_tr_b16 v[28:29], v5 offset:2048
  ds_read_b64_tr_b16 v[30:31], v5 offset:3072
  v_mfma_f32_32x32x16_bf16 v[80:95], v[40:43], v[252:255], v[80:95]
  ds_read_b64_tr_b16 v[32:33], v1 offset:4096
  ds_read_b64_tr_b16 v[34:35], v1 offset:5120
  v_mfma_f32_32x32x16_bf16 v[96:111], v[44:47], v[252:255], v[96:111]
  s_waitcnt lgkmcnt(6)
  ds_read_b64_tr_b16 v[36:37], v5 offset:4096
  ds_read_b64_tr_b16 v[38:39], v5 offset:5120
  s_mov_b32 s46, 4
.p2align 3
L_mlp_loop:
  v_mfma_f32_32x32x16_bf16 v[48:63], v[16:19], v[112:115], 0
  ds_read_b64_tr_b16 v[40:41], v1 offset:6144
  ds_read_b64_tr_b16 v[42:43], v1 offset:7168
  v_mfma_f32_32x32x16_bf16 v[64:79], v[20:23], v[112:115], 0
  s_waitcnt lgkmcnt(6)
  ds_read_b64_tr_b16 v[44:45], v5 offset:6144
  ds_read_b64_tr_b16 v[46:47], v5 offset:7168
  v_mfma_f32_32x32x16_bf16 v[48:63], v[24:27], v[116:119], v[48:63]
  s_add_u32 m0, s42, 73728
  ds_read_b64_tr_b16 v[16:17], v1 offset:8192
  ds_read_b64_tr_b16 v[18:19], v1 offset:9216
  buffer_load_dwordx4 v4, s[12:15], s33 offen offset:0 lds
  v_cvt_pk_bf16_f32 v80, v80, v81
  v_cvt_pk_bf16_f32 v81, v82, v83
  v_mfma_f32_32x32x16_bf16 v[64:79], v[28:31], v[116:119], v[64:79]
  s_waitcnt lgkmcnt(6)
  ds_read_b64_tr_b16 v[20:21], v5 offset:8192
  ds_read_b64_tr_b16 v[22:23], v5 offset:9216
  v_cvt_pk_bf16_f32 v82, v84, v85
  v_cvt_pk_bf16_f32 v83, v86, v87
  v_cvt_pk_bf16_f32 v84, v88, v89
  v_mfma_f32_32x32x16_bf16 v[48:63], v[32:35], v[120:123], v[48:63]
  ds_read_b64_tr_b16 v[24:25], v1 offset:10240
  ds_read_b64_tr_b16 v[26:27], v1 offset:11264
  v_cvt_pk_bf16_f32 v85, v90, v91
  v_cvt_pk_bf16_f32 v86, v92, v93
  v_mfma_f32_32x32x16_bf16 v[64:79], v[36:39], v[120:123], v[64:79]
  s_waitcnt lgkmcnt(6)
  ds_read_b64_tr_b16 v[28:29], v5 offset:10240
  ds_read_b64_tr_b16 v[30:31], v5 offset:11264
  buffer_load_dwordx4 v4, s[12:15], s34 offen offset:1024 lds
  v_cvt_pk_bf16_f32 v87, v94, v95
  v_mfma_f32_32x32x16_bf16 v[48:63], v[40:43], v[124:127], v[48:63]
  ds_read_b64_tr_b16 v[32:33], v1 offset:12288
  ds_read_b64_tr_b16 v[34:35], v1 offset:13312
  buffer_store_dwordx4 v[80:83], v7, s[16:19], s52 offen offset:0 sc1
  v_cvt_pk_bf16_f32 v96, v96, v97
  v_cvt_pk_bf16_f32 v97, v98, v99
  v_mfma_f32_32x32x16_bf16 v[64:79], v[44:47], v[124:127], v[64:79]
  s_waitcnt lgkmcnt(6)
  ds_read_b64_tr_b16 v[36:37], v5 offset:12288
  ds_read_b64_tr_b16 v[38:39], v5 offset:13312
  v_cvt_pk_bf16_f32 v98, v100, v101
  v_mfma_f32_32x32x16_bf16 v[48:63], v[16:19], v[128:131], v[48:63]
  ds_read_b64_tr_b16 v[40:41], v1 offset:14336
  ds_read_b64_tr_b16 v[42:43], v1 offset:15360
  buffer_load_dwordx4 v4, s[12:15], s35 offen offset:2048 lds
  v_cvt_pk_bf16_f32 v99, v102, v103
  v_cvt_pk_bf16_f32 v100, v104, v105
  v_mfma_f32_32x32x16_bf16 v[64:79], v[20:23], v[128:131], v[64:79]
  s_waitcnt lgkmcnt(6)
  ds_read_b64_tr_b16 v[44:45], v5 offset:14336
  ds_read_b64_tr_b16 v[46:47], v5 offset:15360
  buffer_store_dwordx4 v[84:87], v7, s[16:19], s52 offen offset:1024 sc1
  v_cvt_pk_bf16_f32 v101, v106, v107
  v_mfma_f32_32x32x16_bf16 v[48:63], v[24:27], v[132:135], v[48:63]
  ds_read_b64_tr_b16 v[16:17], v1 offset:16384
  ds_read_b64_tr_b16 v[18:19], v1 offset:17408
  v_cvt_pk_bf16_f32 v102, v108, v109
  v_cvt_pk_bf16_f32 v103, v110, v111
  v_mfma_f32_32x32x16_bf16 v[64:79], v[28:31], v[132:135], v[64:79]
  s_waitcnt lgkmcnt(6)
  ds_read_b64_tr_b16 v[20:21], v5 offset:16384
  ds_read_b64_tr_b16 v[22:23], v5 offset:17408
  buffer_load_dwordx4 v4, s[12:15], s36 offen offset:3072 lds
  v_mfma_f32_32x32x16_bf16 v[48:63], v[32:35], v[136:139], v[48:63]
  ds_read_b64_tr_b16 v[24:25], v1 offset:18432
  ds_read_b64_tr_b16 v[26:27], v1 offset:19456
  buffer_store_dwordx4 v[96:99], v7, s[16:19], s52 offen offset:2048 sc1
  v_mfma_f32_32x32x16_bf16 v[64:79], v[36:39], v[136:139], v[64:79]
  s_waitcnt lgkmcnt(6)
  ds_read_b64_tr_b16 v[28:29], v5 offset:18432
  ds_read_b64_tr_b16 v[30:31], v5 offset:19456
  v_mfma_f32_32x32x16_bf16 v[48:63], v[40:43], v[140:143], v[48:63]
  s_add_u32 m0, s42, 77824
  ds_read_b64_tr_b16 v[32:33], v1 offset:20480
  ds_read_b64_tr_b16 v[34:35], v1 offset:21504
  buffer_load_dwordx4 v4, s[12:15], s37 offen offset:0 lds
  v_mfma_f32_32x32x16_bf16 v[64:79], v[44:47], v[140:143], v[64:79]
  s_waitcnt lgkmcnt(6)
  ds_read_b64_tr_b16 v[36:37], v5 offset:20480
  ds_read_b64_tr_b16 v[38:39], v5 offset:21504
  buffer_store_dwordx4 v[100:103], v7, s[16:19], s52 offen offset:3072 sc1
  s_add_u32 s52, s52, 4096
  v_mfma_f32_32x32x16_bf16 v[48:63], v[16:19], v[144:147], v[48:63]
  ds_read_b64_tr_b16 v[40:41], v1 offset:22528
  ds_read_b64_tr_b16 v[42:43], v1 offset:23552
  v_mfma_f32_32x32x16_bf16 v[64:79], v[20:23], v[144:147], v[64:79]
  s_waitcnt lgkmcnt(6)
  ds_read_b64_tr_b16 v[44:45], v5 offset:22528
  ds_read_b64_tr_b16 v[46:47], v5 offset:23552
  buffer_load_dwordx4 v4, s[12:15], s38 offen offset:1024 lds
  v_mfma_f32_32x32x16_bf16 v[48:63], v[24:27], v[148:151], v[48:63]
  ds_read_b64_tr_b16 v[16:17], v1 offset:24576
  ds_read_b64_tr_b16 v[18:19], v1 offset:25600
  v_mfma_f32_32x32x16_bf16 v[64:79], v[28:31], v[148:151], v[64:79]
  s_waitcnt lgkmcnt(6)
  ds_read_b64_tr_b16 v[20:21], v5 offset:24576
  ds_read_b64_tr_b16 v[22:23], v5 offset:25600
  v_mfma_f32_32x32x16_bf16 v[48:63], v[32:35], v[152:155], v[48:63]
  ds_read_b64_tr_b16 v[24:25], v1 offset:26624
  ds_read_b64_tr_b16 v[26:27], v1 offset:27648
  buffer_load_dwordx4 v4, s[12:15], s39 offen offset:2048 lds
  v_mfma_f32_32x32x16_bf16 v[64:79], v[36:39], v[152:155], v[64:79]
  s_waitcnt lgkmcnt(6)
  ds_read_b64_tr_b16 v[28:29], v5 offset:26624
  ds_read_b64_tr_b16 v[30:31], v5 offset:27648
  v_mfma_f32_32x32x16_bf16 v[48:63], v[40:43], v[156:159], v[48:63]
  ds_read_b64_tr_b16 v[32:33], v1 offset:28672
  ds_read_b64_tr_b16 v[34:35], v1 offset:29696
  v_mfma_f32_32x32x16_bf16 v[64:79], v[44:47], v[156:159], v[64:79]
  s_waitcnt lgkmcnt(6)
  ds_read_b64_tr_b16 v[36:37], v5 offset:28672
  ds_read_b64_tr_b16 v[38:39], v5 offset:29696
  buffer_load_dwordx4 v4, s[12:15], s40 offen offset:3072 lds
  v_mfma_f32_32x32x16_bf16 v[48:63], v[16:19], v[160:163], v[48:63]
  ds_read_b64_tr_b16 v[40:41], v1 offset:30720
  ds_read_b64_tr_b16 v[42:43], v1 offset:31744
  v_mfma_f32_32x32x16_bf16 v[64:79], v[20:23], v[160:163], v[64:79]
  s_waitcnt lgkmcnt(6)
  ds_read_b64_tr_b16 v[44:45], v5 offset:30720
  ds_read_b64_tr_b16 v[46:47], v5 offset:31744
  v_mfma_f32_32x32x16_bf16 v[48:63], v[24:27], v[164:167], v[48:63]
  s_add_u32 m0, s42, 81920
  ds_read_b64_tr_b16 v[16:17], v1 offset:32768
  ds_read_b64_tr_b16 v[18:19], v1 offset:33792
  buffer_load_dwordx4 v4, s[12:15], s41 offen offset:0 lds
  v_mfma_f32_32x32x16_bf16 v[64:79], v[28:31], v[164:167], v[64:79]
  s_waitcnt lgkmcnt(6)
  ds_read_b64_tr_b16 v[20:21], v5 offset:32768
  ds_read_b64_tr_b16 v[22:23], v5 offset:33792
  v_mfma_f32_32x32x16_bf16 v[48:63], v[32:35], v[168:171], v[48:63]
  ds_read_b64_tr_b16 v[24:25], v1 offset:34816
  ds_read_b64_tr_b16 v[26:27], v1 offset:35840
  v_mfma_f32_32x32x16_bf16 v[64:79], v[36:39], v[168:171], v[64:79]
  s_waitcnt lgkmcnt(6)
  ds_read_b64_tr_b16 v[28:29], v5 offset:34816
  ds_read_b64_tr_b16 v[30:31], v5 offset:35840
  v_subrev_u32 v4, 331648, v4
  v_add_u32 v2, 0, v0
  v_xor_b32 v11, 64, v2
  v_mfma_f32_32x32x16_bf16 v[48:63], v[40:43], v[172:175], v[48:63]
  v_mfma_f32_32x32x16_bf16 v[64:79], v[44:47], v[172:175], v[64:79]
  s_waitcnt vmcnt(22) lgkmcnt(0)
  s_barrier
  ds_read_b64_tr_b16 v[32:33], v2 offset:0
  ds_read_b64_tr_b16 v[34:35], v2 offset:1024
  ds_read_b64_tr_b16 v[36:37], v11 offset:0
  ds_read_b64_tr_b16 v[38:39], v11 offset:1024
  v_mfma_f32_32x32x16_bf16 v[48:63], v[16:19], v[176:179], v[48:63]
  ds_read_b64_tr_b16 v[40:41], v2 offset:2048
  ds_read_b64_tr_b16 v[42:43], v2 offset:3072
  v_mfma_f32_32x32x16_bf16 v[64:79], v[20:23], v[176:179], v[64:79]
  s_waitcnt lgkmcnt(6)
  ds_read_b64_tr_b16 v[44:45], v11 offset:2048
  ds_read_b64_tr_b16 v[46:47], v11 offset:3072
  v_mfma_f32_32x32x16_bf16 v[48:63], v[24:27], v[180:183], v[48:63]
  ds_read_b64_tr_b16 v[16:17], v2 offset:4096
  ds_read_b64_tr_b16 v[18:19], v2 offset:5120
  v_mfma_f32_32x32x16_bf16 v[64:79], v[28:31], v[180:183], v[64:79]
  s_waitcnt lgkmcnt(6)
  ds_read_b64_tr_b16 v[20:21], v11 offset:4096
  ds_read_b64_tr_b16 v[22:23], v11 offset:5120
  v_mfma_f32_32x32x16_bf16 v[48:63], v[32:35], v[184:187], v[48:63]
  s_nop 0
  ds_read_b64_tr_b16 v[24:25], v2 offset:6144
  ds_read_b64_tr_b16 v[26:27], v2 offset:7168
  s_cmp_eq_u32 s46, 1
  s_cselect_b32 s14, 0, s14
  v_mfma_f32_32x32x16_bf16 v[64:79], v[36:39], v[184:187], v[64:79]
  s_waitcnt lgkmcnt(6)
  ds_read_b64_tr_b16 v[28:29], v11 offset:6144
  ds_read_b64_tr_b16 v[30:31], v11 offset:7168
  v_mfma_f32_32x32x16_bf16 v[48:63], v[40:43], v[188:191], v[48:63]
  s_add_u32 m0, s42, 110592
  ds_read_b64_tr_b16 v[32:33], v2 offset:8192
  ds_read_b64_tr_b16 v[34:35], v2 offset:9216
  buffer_load_dwordx4 v4, s[12:15], s33 offen offset:0 lds
  v_mfma_f32_32x32x16_bf16 v[64:79], v[44:47], v[188:191], v[64:79]
  s_waitcnt lgkmcnt(6)
  ds_read_b64_tr_b16 v[36:37], v11 offset:8192
  ds_read_b64_tr_b16 v[38:39], v11 offset:9216
  v_mfma_f32_32x32x16_bf16 v[48:63], v[16:19], v[192:195], v[48:63]
  ds_read_b64_tr_b16 v[40:41], v2 offset:10240
  ds_read_b64_tr_b16 v[42:43], v2 offset:11264
  v_mfma_f32_32x32x16_bf16 v[64:79], v[20:23], v[192:195], v[64:79]
  s_waitcnt lgkmcnt(6)
  ds_read_b64_tr_b16 v[44:45], v11 offset:10240
  ds_read_b64_tr_b16 v[46:47], v11 offset:11264
  buffer_load_dwordx4 v4, s[12:15], s34 offen offset:1024 lds
  v_mfma_f32_32x32x16_bf16 v[48:63], v[24:27], v[196:199], v[48:63]
  ds_read_b64_tr_b16 v[16:17], v2 offset:12288
  ds_read_b64_tr_b16 v[18:19], v2 offset:13312
  v_mfma_f32_32x32x16_bf16 v[64:79], v[28:31], v[196:199], v[64:79]
  s_waitcnt lgkmcnt(6)
  ds_read_b64_tr_b16 v[20:21], v11 offset:12288
  ds_read_b64_tr_b16 v[22:23], v11 offset:13312
  v_mfma_f32_32x32x16_bf16 v[48:63], v[32:35], v[200:203], v[48:63]
  ds_read_b64_tr_b16 v[24:25], v2 offset:14336
  ds_read_b64_tr_b16 v[26:27], v2 offset:15360
  buffer_load_dwordx4 v4, s[12:15], s35 offen offset:2048 lds
  v_mfma_f32_32x32x16_bf16 v[64:79], v[36:39], v[200:203], v[64:79]
  s_waitcnt lgkmcnt(6)
  ds_read_b64_tr_b16 v[28:29], v11 offset:14336
  ds_read_b64_tr_b16 v[30:31], v11 offset:15360
  v_mfma_f32_32x32x16_bf16 v[48:63], v[40:43], v[204:207], v[48:63]
  ds_read_b64_tr_b16 v[32:33], v2 offset:16384
  ds_read_b64_tr_b16 v[34:35], v2 offset:17408
  v_mfma_f32_32x32x16_bf16 v[64:79], v[44:47], v[204:207], v[64:79]
  s_waitcnt lgkmcnt(6)
  ds_read_b64_tr_b16 v[36:37], v11 offset:16384
  ds_read_b64_tr_b16 v[38:39], v11 offset:17408
  buffer_load_dwordx4 v4, s[12:15], s36 offen offset:3072 lds
  v_mfma_f32_32x32x16_bf16 v[48:63], v[16:19], v[208:211], v[48:63]
  ds_read_b64_tr_b16 v[40:41], v2 offset:18432
  ds_read_b64_tr_b16 v[42:43], v2 offset:19456
  v_mfma_f32_32x32x16_bf16 v[64:79], v[20:23], v[208:211], v[64:79]
  s_waitcnt lgkmcnt(6)
  ds_read_b64_tr_b16 v[44:45], v11 offset:18432
  ds_read_b64_tr_b16 v[46:47], v11 offset:19456
  v_mfma_f32_32x32x16_bf16 v[48:63], v[24:27], v[212:215], v[48:63]
  s_add_u32 m0, s42, 114688
  ds_read_b64_tr_b16 v[16:17], v2 offset:20480
  ds_read_b64_tr_b16 v[18:19], v2 offset:21504
  buffer_load_dwordx4 v4, s[12:15], s37 offen offset:0 lds
  v_mfma_f32_32x32x16_bf16 v[64:79], v[28:31], v[212:215], v[64:79]
  s_waitcnt lgkmcnt(6)
  ds_read_b64_tr_b16 v[20:21], v11 offset:20480
  ds_read_b64_tr_b16 v[22:23], v11 offset:21504
  v_mfma_f32_32x32x16_bf16 v[48:63], v[32:35], v[216:219], v[48:63]
  ds_read_b64_tr_b16 v[24:25], v2 offset:22528
  ds_read_b64_tr_b16 v[26:27], v2 offset:23552
  v_mfma_f32_32x32x16_bf16 v[64:79], v[36:39], v[216:219], v[64:79]
  s_waitcnt lgkmcnt(6)
  ds_read_b64_tr_b16 v[28:29], v11 offset:22528
  ds_read_b64_tr_b16 v[30:31], v11 offset:23552
  buffer_load_dwordx4 v4, s[12:15], s38 offen offset:1024 lds
  v_mfma_f32_32x32x16_bf16 v[48:63], v[40:43], v[220:223], v[48:63]
  ds_read_b64_tr_b16 v[32:33], v2 offset:24576
  ds_read_b64_tr_b16 v[34:35], v2 offset:25600
  v_mfma_f32_32x32x16_bf16 v[64:79], v[44:47], v[220:223], v[64:79]
  s_waitcnt lgkmcnt(6)
  ds_read_b64_tr_b16 v[36:37], v11 offset:24576
  ds_read_b64_tr_b16 v[38:39], v11 offset:25600
  v_mfma_f32_32x32x16_bf16 v[48:63], v[16:19], v[224:227], v[48:63]
  ds_read_b64_tr_b16 v[40:41], v2 offset:26624
  ds_read_b64_tr_b16 v[42:43], v2 offset:27648
  buffer_load_dwordx4 v4, s[12:15], s39 offen offset:2048 lds
  v_mfma_f32_32x32x16_bf16 v[64:79], v[20:23], v[224:227], v[64:79]
  s_waitcnt lgkmcnt(6)
  ds_read_b64_tr_b16 v[44:45], v11 offset:26624
  ds_read_b64_tr_b16 v[46:47], v11 offset:27648
  v_mfma_f32_32x32x16_bf16 v[48:63], v[24:27], v[228:231], v[48:63]
  ds_read_b64_tr_b16 v[16:17], v2 offset:28672
  ds_read_b64_tr_b16 v[18:19], v2 offset:29696
  v_mfma_f32_32x32x16_bf16 v[64:79], v[28:31], v[228:231], v[64:79]
  s_waitcnt lgkmcnt(6)
  ds_read_b64_tr_b16 v[20:21], v11 offset:28672
  ds_read_b64_tr_b16 v[22:23], v11 offset:29696
  buffer_load_dwordx4 v4, s[12:15], s40 offen offset:3072 lds
  v_mfma_f32_32x32x16_bf16 v[48:63], v[32:35], v[232:235], v[48:63]
  ds_read_b64_tr_b16 v[24:25], v2 offset:30720
  ds_read_b64_tr_b16 v[26:27], v2 offset:31744
  v_mfma_f32_32x32x16_bf16 v[64:79], v[36:39], v[232:235], v[64:79]
  s_waitcnt lgkmcnt(6)
  ds_read_b64_tr_b16 v[28:29], v11 offset:30720
  ds_read_b64_tr_b16 v[30:31], v11 offset:31744
  v_mfma_f32_32x32x16_bf16 v[48:63], v[40:43], v[236:239], v[48:63]
  s_add_u32 m0, s42, 118784
  ds_read_b64_tr_b16 v[32:33], v2 offset:32768
  ds_read_b64_tr_b16 v[34:35], v2 offset:33792
  buffer_load_dwordx4 v4, s[12:15], s41 offen offset:0 lds
  v_mfma_f32_32x32x16_bf16 v[64:79], v[44:47], v[236:239], v[64:79]
  s_waitcnt lgkmcnt(6)
  ds_read_b64_tr_b16 v[36:37], v11 offset:32768
  ds_read_b64_tr_b16 v[38:39], v11 offset:33792
  v_mfma_f32_32x32x16_bf16 v[48:63], v[16:19], v[240:243], v[48:63]
  ds_read_b64_tr_b16 v[40:41], v2 offset:34816
  ds_read_b64_tr_b16 v[42:43], v2 offset:35840
  v_mfma_f32_32x32x16_bf16 v[64:79], v[20:23], v[240:243], v[64:79]
  s_waitcnt lgkmcnt(6)
  ds_read_b64_tr_b16 v[44:45], v11 offset:34816
  ds_read_b64_tr_b16 v[46:47], v11 offset:35840
  v_add_u32 v4, 331776, v4
  v_add_u32 v1, 36864, v0
  v_xor_b32 v5, 64, v1
  v_mfma_f32_32x32x16_bf16 v[48:63], v[24:27], v[244:247], v[48:63]
  v_mfma_f32_32x32x16_bf16 v[64:79], v[28:31], v[244:247], v[64:79]
  s_waitcnt vmcnt(22) lgkmcnt(0)
  s_barrier
  ds_read_b64_tr_b16 v[16:17], v1 offset:0
  ds_read_b64_tr_b16 v[18:19], v1 offset:1024
  ds_read_b64_tr_b16 v[20:21], v5 offset:0
  ds_read_b64_tr_b16 v[22:23], v5 offset:1024
  v_mfma_f32_32x32x16_bf16 v[48:63], v[32:35], v[248:251], v[48:63]
  ds_read_b64_tr_b16 v[24:25], v1 offset:2048
  ds_read_b64_tr_b16 v[26:27], v1 offset:3072
  v_mfma_f32_32x32x16_bf16 v[64:79], v[36:39], v[248:251], v[64:79]
  s_waitcnt lgkmcnt(6)
  ds_read_b64_tr_b16 v[28:29], v5 offset:2048
  ds_read_b64_tr_b16 v[30:31], v5 offset:3072
  v_mfma_f32_32x32x16_bf16 v[48:63], v[40:43], v[252:255], v[48:63]
  ds_read_b64_tr_b16 v[32:33], v1 offset:4096
  ds_read_b64_tr_b16 v[34:35], v1 offset:5120
  v_mfma_f32_32x32x16_bf16 v[64:79], v[44:47], v[252:255], v[64:79]
  s_waitcnt lgkmcnt(6)
  ds_read_b64_tr_b16 v[36:37], v5 offset:4096
  ds_read_b64_tr_b16 v[38:39], v5 offset:5120
  v_mfma_f32_32x32x16_bf16 v[80:95], v[16:19], v[112:115], 0
  ds_read_b64_tr_b16 v[40:41], v1 offset:6144
  ds_read_b64_tr_b16 v[42:43], v1 offset:7168
  v_mfma_f32_32x32x16_bf16 v[96:111], v[20:23], v[112:115], 0
  s_waitcnt lgkmcnt(6)
  ds_read_b64_tr_b16 v[44:45], v5 offset:6144
  ds_read_b64_tr_b16 v[46:47], v5 offset:7168
  v_mfma_f32_32x32x16_bf16 v[80:95], v[24:27], v[116:119], v[80:95]
  s_add_u32 m0, s42, 0
  ds_read_b64_tr_b16 v[16:17], v1 offset:8192
  ds_read_b64_tr_b16 v[18:19], v1 offset:9216
  buffer_load_dwordx4 v4, s[12:15], s33 offen offset:0 lds
  v_cvt_pk_bf16_f32 v48, v48, v49
  v_cvt_pk_bf16_f32 v49, v50, v51
  v_mfma_f32_32x32x16_bf16 v[96:111], v[28:31], v[116:119], v[96:111]
  s_waitcnt lgkmcnt(6)
  ds_read_b64_tr_b16 v[20:21], v5 offset:8192
  ds_read_b64_tr_b16 v[22:23], v5 offset:9216
  v_cvt_pk_bf16_f32 v50, v52, v53
  v_cvt_pk_bf16_f32 v51, v54, v55
  v_cvt_pk_bf16_f32 v52, v56, v57
  v_mfma_f32_32x32x16_bf16 v[80:95], v[32:35], v[120:123], v[80:95]
  ds_read_b64_tr_b16 v[24:25], v1 offset:10240
  ds_read_b64_tr_b16 v[26:27], v1 offset:11264
  v_cvt_pk_bf16_f32 v53, v58, v59
  v_cvt_pk_bf16_f32 v54, v60, v61
  v_mfma_f32_32x32x16_bf16 v[96:111], v[36:39], v[120:123], v[96:111]
  s_waitcnt lgkmcnt(6)
  ds_read_b64_tr_b16 v[28:29], v5 offset:10240
  ds_read_b64_tr_b16 v[30:31], v5 offset:11264
  buffer_load_dwordx4 v4, s[12:15], s34 offen offset:1024 lds
  v_cvt_pk_bf16_f32 v55, v62, v63
  v_mfma_f32_32x32x16_bf16 v[80:95], v[40:43], v[124:127], v[80:95]
  ds_read_b64_tr_b16 v[32:33], v1 offset:12288
  ds_read_b64_tr_b16 v[34:35], v1 offset:13312
  buffer_store_dwordx4 v[48:51], v7, s[16:19], s52 offen offset:0 sc1
  v_cvt_pk_bf16_f32 v64, v64, v65
  v_cvt_pk_bf16_f32 v65, v66, v67
  v_mfma_f32_32x32x16_bf16 v[96:111], v[44:47], v[124:127], v[96:111]
  s_waitcnt lgkmcnt(6)
  ds_read_b64_tr_b16 v[36:37], v5 offset:12288
  ds_read_b64_tr_b16 v[38:39], v5 offset:13312
  v_cvt_pk_bf16_f32 v66, v68, v69
  v_mfma_f32_32x32x16_bf16 v[80:95], v[16:19], v[128:131], v[80:95]
  ds_read_b64_tr_b16 v[40:41], v1 offset:14336
  ds_read_b64_tr_b16 v[42:43], v1 offset:15360
  buffer_load_dwordx4 v4, s[12:15], s35 offen offset:2048 lds
  v_cvt_pk_bf16_f32 v67, v70, v71
  v_cvt_pk_bf16_f32 v68, v72, v73
  v_mfma_f32_32x32x16_bf16 v[96:111], v[20:23], v[128:131], v[96:111]
  s_waitcnt lgkmcnt(6)
  ds_read_b64_tr_b16 v[44:45], v5 offset:14336
  ds_read_b64_tr_b16 v[46:47], v5 offset:15360
  buffer_store_dwordx4 v[52:55], v7, s[16:19], s52 offen offset:1024 sc1
  v_cvt_pk_bf16_f32 v69, v74, v75
  v_mfma_f32_32x32x16_bf16 v[80:95], v[24:27], v[132:135], v[80:95]
  ds_read_b64_tr_b16 v[16:17], v1 offset:16384
  ds_read_b64_tr_b16 v[18:19], v1 offset:17408
  v_cvt_pk_bf16_f32 v70, v76, v77
  v_cvt_pk_bf16_f32 v71, v78, v79
  v_mfma_f32_32x32x16_bf16 v[96:111], v[28:31], v[132:135], v[96:111]
  s_waitcnt lgkmcnt(6)
  ds_read_b64_tr_b16 v[20:21], v5 offset:16384
  ds_read_b64_tr_b16 v[22:23], v5 offset:17408
  buffer_load_dwordx4 v4, s[12:15], s36 offen offset:3072 lds
  v_mfma_f32_32x32x16_bf16 v[80:95], v[32:35], v[136:139], v[80:95]
  ds_read_b64_tr_b16 v[24:25], v1 offset:18432
  ds_read_b64_tr_b16 v[26:27], v1 offset:19456
  buffer_store_dwordx4 v[64:67], v7, s[16:19], s52 offen offset:2048 sc1
  v_mfma_f32_32x32x16_bf16 v[96:111], v[36:39], v[136:139], v[96:111]
  s_waitcnt lgkmcnt(6)
  ds_read_b64_tr_b16 v[28:29], v5 offset:18432
  ds_read_b64_tr_b16 v[30:31], v5 offset:19456
  v_mfma_f32_32x32x16_bf16 v[80:95], v[40:43], v[140:143], v[80:95]
  s_add_u32 m0, s42, 4096
  ds_read_b64_tr_b16 v[32:33], v1 offset:20480
  ds_read_b64_tr_b16 v[34:35], v1 offset:21504
  buffer_load_dwordx4 v4, s[12:15], s37 offen offset:0 lds
  v_mfma_f32_32x32x16_bf16 v[96:111], v[44:47], v[140:143], v[96:111]
  s_waitcnt lgkmcnt(6)
  ds_read_b64_tr_b16 v[36:37], v5 offset:20480
  ds_read_b64_tr_b16 v[38:39], v5 offset:21504
  buffer_store_dwordx4 v[68:71], v7, s[16:19], s52 offen offset:3072 sc1
  s_add_u32 s52, s52, 4096
  v_mfma_f32_32x32x16_bf16 v[80:95], v[16:19], v[144:147], v[80:95]
  ds_read_b64_tr_b16 v[40:41], v1 offset:22528
  ds_read_b64_tr_b16 v[42:43], v1 offset:23552
  v_mfma_f32_32x32x16_bf16 v[96:111], v[20:23], v[144:147], v[96:111]
  s_waitcnt lgkmcnt(6)
  ds_read_b64_tr_b16 v[44:45], v5 offset:22528
  ds_read_b64_tr_b16 v[46:47], v5 offset:23552
  buffer_load_dwordx4 v4, s[12:15], s38 offen offset:1024 lds
  v_mfma_f32_32x32x16_bf16 v[80:95], v[24:27], v[148:151], v[80:95]
  ds_read_b64_tr_b16 v[16:17], v1 offset:24576
  ds_read_b64_tr_b16 v[18:19], v1 offset:25600
  v_mfma_f32_32x32x16_bf16 v[96:111], v[28:31], v[148:151], v[96:111]
  s_waitcnt lgkmcnt(6)
  ds_read_b64_tr_b16 v[20:21], v5 offset:24576
  ds_read_b64_tr_b16 v[22:23], v5 offset:25600
  v_mfma_f32_32x32x16_bf16 v[80:95], v[32:35], v[152:155], v[80:95]
  ds_read_b64_tr_b16 v[24:25], v1 offset:26624
  ds_read_b64_tr_b16 v[26:27], v1 offset:27648
  buffer_load_dwordx4 v4, s[12:15], s39 offen offset:2048 lds
  v_mfma_f32_32x32x16_bf16 v[96:111], v[36:39], v[152:155], v[96:111]
  s_waitcnt lgkmcnt(6)
  ds_read_b64_tr_b16 v[28:29], v5 offset:26624
  ds_read_b64_tr_b16 v[30:31], v5 offset:27648
  v_mfma_f32_32x32x16_bf16 v[80:95], v[40:43], v[156:159], v[80:95]
  ds_read_b64_tr_b16 v[32:33], v1 offset:28672
  ds_read_b64_tr_b16 v[34:35], v1 offset:29696
  v_mfma_f32_32x32x16_bf16 v[96:111], v[44:47], v[156:159], v[96:111]
  s_waitcnt lgkmcnt(6)
  ds_read_b64_tr_b16 v[36:37], v5 offset:28672
  ds_read_b64_tr_b16 v[38:39], v5 offset:29696
  buffer_load_dwordx4 v4, s[12:15], s40 offen offset:3072 lds
  v_mfma_f32_32x32x16_bf16 v[80:95], v[16:19], v[160:163], v[80:95]
  ds_read_b64_tr_b16 v[40:41], v1 offset:30720
  ds_read_b64_tr_b16 v[42:43], v1 offset:31744
  v_mfma_f32_32x32x16_bf16 v[96:111], v[20:23], v[160:163], v[96:111]
  s_waitcnt lgkmcnt(6)
  ds_read_b64_tr_b16 v[44:45], v5 offset:30720
  ds_read_b64_tr_b16 v[46:47], v5 offset:31744
  v_mfma_f32_32x32x16_bf16 v[80:95], v[24:27], v[164:167], v[80:95]
  s_add_u32 m0, s42, 8192
  ds_read_b64_tr_b16 v[16:17], v1 offset:32768
  ds_read_b64_tr_b16 v[18:19], v1 offset:33792
  buffer_load_dwordx4 v4, s[12:15], s41 offen offset:0 lds
  v_mfma_f32_32x32x16_bf16 v[96:111], v[28:31], v[164:167], v[96:111]
  s_waitcnt lgkmcnt(6)
  ds_read_b64_tr_b16 v[20:21], v5 offset:32768
  ds_read_b64_tr_b16 v[22:23], v5 offset:33792
  v_mfma_f32_32x32x16_bf16 v[80:95], v[32:35], v[168:171], v[80:95]
  ds_read_b64_tr_b16 v[24:25], v1 offset:34816
  ds_read_b64_tr_b16 v[26:27], v1 offset:35840
  v_mfma_f32_32x32x16_bf16 v[96:111], v[36:39], v[168:171], v[96:111]
  s_waitcnt lgkmcnt(6)
  ds_read_b64_tr_b16 v[28:29], v5 offset:34816
  ds_read_b64_tr_b16 v[30:31], v5 offset:35840
  v_subrev_u32 v4, 331648, v4
  v_add_u32 v2, 73728, v0
  v_xor_b32 v11, 64, v2
  v_mfma_f32_32x32x16_bf16 v[80:95], v[40:43], v[172:175], v[80:95]
  v_mfma_f32_32x32x16_bf16 v[96:111], v[44:47], v[172:175], v[96:111]
  s_waitcnt vmcnt(22) lgkmcnt(0)
  s_barrier
  ds_read_b64_tr_b16 v[32:33], v2 offset:0
  ds_read_b64_tr_b16 v[34:35], v2 offset:1024
  ds_read_b64_tr_b16 v[36:37], v11 offset:0
  ds_read_b64_tr_b16 v[38:39], v11 offset:1024
  v_mfma_f32_32x32x16_bf16 v[80:95], v[16:19], v[176:179], v[80:95]
  ds_read_b64_tr_b16 v[40:41], v2 offset:2048
  ds_read_b64_tr_b16 v[42:43], v2 offset:3072
  v_mfma_f32_32x32x16_bf16 v[96:111], v[20:23], v[176:179], v[96:111]
  s_waitcnt lgkmcnt(6)
  ds_read_b64_tr_b16 v[44:45], v11 offset:2048
  ds_read_b64_tr_b16 v[46:47], v11 offset:3072
  v_mfma_f32_32x32x16_bf16 v[80:95], v[24:27], v[180:183], v[80:95]
  ds_read_b64_tr_b16 v[16:17], v2 offset:4096
  ds_read_b64_tr_b16 v[18:19], v2 offset:5120
  v_mfma_f32_32x32x16_bf16 v[96:111], v[28:31], v[180:183], v[96:111]
  s_waitcnt lgkmcnt(6)
  ds_read_b64_tr_b16 v[20:21], v11 offset:4096
  ds_read_b64_tr_b16 v[22:23], v11 offset:5120
  v_mfma_f32_32x32x16_bf16 v[80:95], v[32:35], v[184:187], v[80:95]
  ds_read_b64_tr_b16 v[24:25], v2 offset:6144
  ds_read_b64_tr_b16 v[26:27], v2 offset:7168
  v_mfma_f32_32x32x16_bf16 v[96:111], v[36:39], v[184:187], v[96:111]
  s_waitcnt lgkmcnt(6)
  ds_read_b64_tr_b16 v[28:29], v11 offset:6144
  ds_read_b64_tr_b16 v[30:31], v11 offset:7168
  v_mfma_f32_32x32x16_bf16 v[80:95], v[40:43], v[188:191], v[80:95]
  s_add_u32 m0, s42, 36864
  ds_read_b64_tr_b16 v[32:33], v2 offset:8192
  ds_read_b64_tr_b16 v[34:35], v2 offset:9216
  buffer_load_dwordx4 v4, s[12:15], s33 offen offset:0 lds
  v_mfma_f32_32x32x16_bf16 v[96:111], v[44:47], v[188:191], v[96:111]
  s_waitcnt lgkmcnt(6)
  ds_read_b64_tr_b16 v[36:37], v11 offset:8192
  ds_read_b64_tr_b16 v[38:39], v11 offset:9216
  v_mfma_f32_32x32x16_bf16 v[80:95], v[16:19], v[192:195], v[80:95]
  ds_read_b64_tr_b16 v[40:41], v2 offset:10240
  ds_read_b64_tr_b16 v[42:43], v2 offset:11264
  v_mfma_f32_32x32x16_bf16 v[96:111], v[20:23], v[192:195], v[96:111]
  s_waitcnt lgkmcnt(6)
  ds_read_b64_tr_b16 v[44:45], v11 offset:10240
  ds_read_b64_tr_b16 v[46:47], v11 offset:11264
  buffer_load_dwordx4 v4, s[12:15], s34 offen offset:1024 lds
  v_mfma_f32_32x32x16_bf16 v[80:95], v[24:27], v[196:199], v[80:95]
  ds_read_b64_tr_b16 v[16:17], v2 offset:12288
  ds_read_b64_tr_b16 v[18:19], v2 offset:13312
  v_mfma_f32_32x32x16_bf16 v[96:111], v[28:31], v[196:199], v[96:111]
  s_waitcnt lgkmcnt(6)
  ds_read_b64_tr_b16 v[20:21], v11 offset:12288
  ds_read_b64_tr_b16 v[22:23], v11 offset:13312
  v_mfma_f32_32x32x16_bf16 v[80:95], v[32:35], v[200:203], v[80:95]
  ds_read_b64_tr_b16 v[24:25], v2 offset:14336
  ds_read_b64_tr_b16 v[26:27], v2 offset:15360
  buffer_load_dwordx4 v4, s[12:15], s35 offen offset:2048 lds
  v_mfma_f32_32x32x16_bf16 v[96:111], v[36:39], v[200:203], v[96:111]
  s_waitcnt lgkmcnt(6)
  ds_read_b64_tr_b16 v[28:29], v11 offset:14336
  ds_read_b64_tr_b16 v[30:31], v11 offset:15360
  v_mfma_f32_32x32x16_bf16 v[80:95], v[40:43], v[204:207], v[80:95]
  ds_read_b64_tr_b16 v[32:33], v2 offset:16384
  ds_read_b64_tr_b16 v[34:35], v2 offset:17408
  v_mfma_f32_32x32x16_bf16 v[96:111], v[44:47], v[204:207], v[96:111]
  s_waitcnt lgkmcnt(6)
  ds_read_b64_tr_b16 v[36:37], v11 offset:16384
  ds_read_b64_tr_b16 v[38:39], v11 offset:17408
  buffer_load_dwordx4 v4, s[12:15], s36 offen offset:3072 lds
  v_mfma_f32_32x32x16_bf16 v[80:95], v[16:19], v[208:211], v[80:95]
  ds_read_b64_tr_b16 v[40:41], v2 offset:18432
  ds_read_b64_tr_b16 v[42:43], v2 offset:19456
  v_mfma_f32_32x32x16_bf16 v[96:111], v[20:23], v[208:211], v[96:111]
  s_waitcnt lgkmcnt(6)
  ds_read_b64_tr_b16 v[44:45], v11 offset:18432
  ds_read_b64_tr_b16 v[46:47], v11 offset:19456
  v_mfma_f32_32x32x16_bf16 v[80:95], v[24:27], v[212:215], v[80:95]
  s_add_u32 m0, s42, 40960
  ds_read_b64_tr_b16 v[16:17], v2 offset:20480
  ds_read_b64_tr_b16 v[18:19], v2 offset:21504
  buffer_load_dwordx4 v4, s[12:15], s37 offen offset:0 lds
  v_mfma_f32_32x32x16_bf16 v[96:111], v[28:31], v[212:215], v[96:111]
  s_waitcnt lgkmcnt(6)
  ds_read_b64_tr_b16 v[20:21], v11 offset:20480
  ds_read_b64_tr_b16 v[22:23], v11 offset:21504
  v_mfma_f32_32x32x16_bf16 v[80:95], v[32:35], v[216:219], v[80:95]
  ds_read_b64_tr_b16 v[24:25], v2 offset:22528
  ds_read_b64_tr_b16 v[26:27], v2 offset:23552
  v_mfma_f32_32x32x16_bf16 v[96:111], v[36:39], v[216:219], v[96:111]
  s_waitcnt lgkmcnt(6)
  ds_read_b64_tr_b16 v[28:29], v11 offset:22528
  ds_read_b64_tr_b16 v[30:31], v11 offset:23552
  buffer_load_dwordx4 v4, s[12:15], s38 offen offset:1024 lds
  v_mfma_f32_32x32x16_bf16 v[80:95], v[40:43], v[220:223], v[80:95]
  ds_read_b64_tr_b16 v[32:33], v2 offset:24576
  ds_read_b64_tr_b16 v[34:35], v2 offset:25600
  v_mfma_f32_32x32x16_bf16 v[96:111], v[44:47], v[220:223], v[96:111]
  s_waitcnt lgkmcnt(6)
  ds_read_b64_tr_b16 v[36:37], v11 offset:24576
  ds_read_b64_tr_b16 v[38:39], v11 offset:25600
  v_mfma_f32_32x32x16_bf16 v[80:95], v[16:19], v[224:227], v[80:95]
  ds_read_b64_tr_b16 v[40:41], v2 offset:26624
  ds_read_b64_tr_b16 v[42:43], v2 offset:27648
  buffer_load_dwordx4 v4, s[12:15], s39 offen offset:2048 lds
  v_mfma_f32_32x32x16_bf16 v[96:111], v[20:23], v[224:227], v[96:111]
  s_waitcnt lgkmcnt(6)
  ds_read_b64_tr_b16 v[44:45], v11 offset:26624
  ds_read_b64_tr_b16 v[46:47], v11 offset:27648
  v_mfma_f32_32x32x16_bf16 v[80:95], v[24:27], v[228:231], v[80:95]
  ds_read_b64_tr_b16 v[16:17], v2 offset:28672
  ds_read_b64_tr_b16 v[18:19], v2 offset:29696
  v_mfma_f32_32x32x16_bf16 v[96:111], v[28:31], v[228:231], v[96:111]
  s_waitcnt lgkmcnt(6)
  ds_read_b64_tr_b16 v[20:21], v11 offset:28672
  ds_read_b64_tr_b16 v[22:23], v11 offset:29696
  buffer_load_dwordx4 v4, s[12:15], s40 offen offset:3072 lds
  v_mfma_f32_32x32x16_bf16 v[80:95], v[32:35], v[232:235], v[80:95]
  ds_read_b64_tr_b16 v[24:25], v2 offset:30720
  ds_read_b64_tr_b16 v[26:27], v2 offset:31744
  v_mfma_f32_32x32x16_bf16 v[96:111], v[36:39], v[232:235], v[96:111]
  s_waitcnt lgkmcnt(6)
  ds_read_b64_tr_b16 v[28:29], v11 offset:30720
  ds_read_b64_tr_b16 v[30:31], v11 offset:31744
  v_mfma_f32_32x32x16_bf16 v[80:95], v[40:43], v[236:239], v[80:95]
  s_add_u32 m0, s42, 45056
  ds_read_b64_tr_b16 v[32:33], v2 offset:32768
  ds_read_b64_tr_b16 v[34:35], v2 offset:33792
  buffer_load_dwordx4 v4, s[12:15], s41 offen offset:0 lds
  v_mfma_f32_32x32x16_bf16 v[96:111], v[44:47], v[236:239], v[96:111]
  s_waitcnt lgkmcnt(6)
  ds_read_b64_tr_b16 v[36:37], v11 offset:32768
  ds_read_b64_tr_b16 v[38:39], v11 offset:33792
  v_mfma_f32_32x32x16_bf16 v[80:95], v[16:19], v[240:243], v[80:95]
  ds_read_b64_tr_b16 v[40:41], v2 offset:34816
  ds_read_b64_tr_b16 v[42:43], v2 offset:35840
  v_mfma_f32_32x32x16_bf16 v[96:111], v[20:23], v[240:243], v[96:111]
  s_waitcnt lgkmcnt(6)
  ds_read_b64_tr_b16 v[44:45], v11 offset:34816
  ds_read_b64_tr_b16 v[46:47], v11 offset:35840
  v_add_u32 v4, 331776, v4
  v_add_u32 v1, 110592, v0
  v_xor_b32 v5, 64, v1
  v_mfma_f32_32x32x16_bf16 v[80:95], v[24:27], v[244:247], v[80:95]
  v_mfma_f32_32x32x16_bf16 v[96:111], v[28:31], v[244:247], v[96:111]
  s_waitcnt vmcnt(22) lgkmcnt(0)
  s_barrier
  ds_read_b64_tr_b16 v[16:17], v1 offset:0
  ds_read_b64_tr_b16 v[18:19], v1 offset:1024
  ds_read_b64_tr_b16 v[20:21], v5 offset:0
  ds_read_b64_tr_b16 v[22:23], v5 offset:1024
  v_mfma_f32_32x32x16_bf16 v[80:95], v[32:35], v[248:251], v[80:95]
  ds_read_b64_tr_b16 v[24:25], v1 offset:2048
  ds_read_b64_tr_b16 v[26:27], v1 offset:3072
  v_mfma_f32_32x32x16_bf16 v[96:111], v[36:39], v[248:251], v[96:111]
  s_waitcnt lgkmcnt(6)
  ds_read_b64_tr_b16 v[28:29], v5 offset:2048
  ds_read_b64_tr_b16 v[30:31], v5 offset:3072
  v_mfma_f32_32x32x16_bf16 v[80:95], v[40:43], v[252:255], v[80:95]
  ds_read_b64_tr_b16 v[32:33], v1 offset:4096
  ds_read_b64_tr_b16 v[34:35], v1 offset:5120
  v_mfma_f32_32x32x16_bf16 v[96:111], v[44:47], v[252:255], v[96:111]
  s_waitcnt lgkmcnt(6)
  ds_read_b64_tr_b16 v[36:37], v5 offset:4096
  ds_read_b64_tr_b16 v[38:39], v5 offset:5120
  s_sub_u32 s46, s46, 1
  s_cmp_lg_u32 s46, 0
  s_cbranch_scc1 L_mlp_loop
  s_waitcnt lgkmcnt(0)
  s_nop 1
  v_cvt_pk_bf16_f32 v80, v80, v81
  v_cvt_pk_bf16_f32 v81, v82, v83
  v_cvt_pk_bf16_f32 v82, v84, v85
  v_cvt_pk_bf16_f32 v83, v86, v87
  buffer_store_dwordx4 v[80:83], v7, s[16:19], s52 offen offset:0 sc1
  v_cvt_pk_bf16_f32 v84, v88, v89
  v_cvt_pk_bf16_f32 v85, v90, v91
  v_cvt_pk_bf16_f32 v86, v92, v93
  v_cvt_pk_bf16_f32 v87, v94, v95
  buffer_store_dwordx4 v[84:87], v7, s[16:19], s52 offen offset:1024 sc1
  v_cvt_pk_bf16_f32 v96, v96, v97
  v_cvt_pk_bf16_f32 v97, v98, v99
  v_cvt_pk_bf16_f32 v98, v100, v101
  v_cvt_pk_bf16_f32 v99, v102, v103
  buffer_store_dwordx4 v[96:99], v7, s[16:19], s52 offen offset:2048 sc1
  v_cvt_pk_bf16_f32 v100, v104, v105
  v_cvt_pk_bf16_f32 v101, v106, v107
  v_cvt_pk_bf16_f32 v102, v108, v109
  v_cvt_pk_bf16_f32 v103, v110, v111
  buffer_store_dwordx4 v[100:103], v7, s[16:19], s52 offen offset:3072 sc1
  s_add_u32 s52, s52, 4096
  s_lshl_b32 s53, s6, 3
  s_add_u32 s53, s53, s7
  s_lshl_b32 s53, s53, 7
  s_add_u32 s53, s53, 14401536
  s_mov_b32 s55, 0
L_final:
  s_load_dwordx2 s[56:57], s[0:1], 16
  s_load_dwordx2 s[64:65], s[0:1], 72
  v_mbcnt_lo_u32_b32 v237, -1, 0
  v_mbcnt_hi_u32_b32 v237, -1, v237
  s_lshr_b32 s52, s43, 1
  s_lshl_b32 s54, s6, 1
  s_add_u32 s54, s54, s55
  s_lshl_b32 s54, s54, 1
  s_and_b32 s44, s43, 1
  s_add_u32 s54, s54, s44
  s_mul_i32 s44, s44, 10240
  s_add_u32 s44, s44, 98304
  v_lshlrev_b32 v221, 4, v237
  v_add_u32 v235, s44, v221
  s_mul_i32 s68, s7, 9
  s_lshr_b32 s68, s68, 1
  s_movk_i32 s44, 6554
  s_movk_i32 s45, 1152
  v_add_u32 v240, 0, v237
  v_mul_u32_u24 v241, s44, v240
  v_lshrrev_b32 v241, 16, v241
  v_mul_u32_u24 v242, 10, v241
  v_sub_u32 v242, v240, v242
  v_lshlrev_b32 v242, 4, v242
  v_and_b32 v243, 1, v241
  v_bfe_u32 v244, v241, 1, 2
  v_lshl_or_b32 v243, v243, 2, v244
  v_lshrrev_b32 v240, 4, v241
  v_and_b32 v244, 8, v241
  v_add_u32 v244, v244, v243
  v_mad_u32_u24 v244, v240, 18, v244
  v_mad_u32_u24 v208, v244, s45, v242
  v_mul_u32_u24 v240, 144, v240
  v_bfe_u32 v244, v241, 3, 1
  v_mad_u32_u24 v240, v244, 36, v240
  v_and_b32 v244, 1, v241
  v_mul_u32_u24 v244, 72, v244
  v_add_u32 v240, v240, v244
  v_bfe_u32 v244, v241, 2, 1
  v_mad_u32_u24 v240, v244, 18, v240
  v_bfe_u32 v244, v241, 1, 1
  v_add3_u32 v240, v240, v244, 16
  v_mad_u32_u24 v213, v240, s45, v242
  v_add_u32 v240, 64, v237
  v_mul_u32_u24 v241, s44, v240
  v_lshrrev_b32 v241, 16, v241
  v_mul_u32_u24 v242, 10, v241
  v_sub_u32 v242, v240, v242
  v_lshlrev_b32 v242, 4, v242
  v_and_b32 v243, 1, v241
  v_bfe_u32 v244, v241, 1, 2
  v_lshl_or_b32 v243, v243, 2, v244
  v_lshrrev_b32 v240, 4, v241
  v_and_b32 v244, 8, v241
  v_add_u32 v244, v244, v243
  v_mad_u32_u24 v244, v240, 18, v244
  v_mad_u32_u24 v209, v244, s45, v242
  v_mul_u32_u24 v240, 144, v240
  v_bfe_u32 v244, v241, 3, 1
  v_mad_u32_u24 v240, v244, 36, v240
  v_and_b32 v244, 1, v241
  v_mul_u32_u24 v244, 72, v244
  v_add_u32 v240, v240, v244
  v_bfe_u32 v244, v241, 2, 1
  v_mad_u32_u24 v240, v244, 18, v240
  v_bfe_u32 v244, v241, 1, 1
  v_add3_u32 v240, v240, v244, 16
  v_mad_u32_u24 v214, v240, s45, v242
  v_subrev_u32 v209, 1024, v209
  v_subrev_u32 v214, 1024, v214
  v_add_u32 v240, 128, v237
  v_mul_u32_u24 v241, s44, v240
  v_lshrrev_b32 v241, 16, v241
  v_mul_u32_u24 v242, 10, v241
  v_sub_u32 v242, v240, v242
  v_lshlrev_b32 v242, 4, v242
  v_and_b32 v243, 1, v241
  v_bfe_u32 v244, v241, 1, 2
  v_lshl_or_b32 v243, v243, 2, v244
  v_lshrrev_b32 v240, 4, v241
  v_and_b32 v244, 8, v241
  v_add_u32 v244, v244, v243
  v_mad_u32_u24 v244, v240, 18, v244
  v_mad_u32_u24 v210, v244, s45, v242
  v_mul_u32_u24 v240, 144, v240
  v_bfe_u32 v244, v241, 3, 1
  v_mad_u32_u24 v240, v244, 36, v240
  v_and_b32 v244, 1, v241
  v_mul_u32_u24 v244, 72, v244
  v_add_u32 v240, v240, v244
  v_bfe_u32 v244, v241, 2, 1
  v_mad_u32_u24 v240, v244, 18, v240
  v_bfe_u32 v244, v241, 1, 1
  v_add3_u32 v240, v240, v244, 16
  v_mad_u32_u24 v215, v240, s45, v242
  v_subrev_u32 v210, 2048, v210
  v_subrev_u32 v215, 2048, v215
  v_add_u32 v240, 192, v237
  v_mul_u32_u24 v241, s44, v240
  v_lshrrev_b32 v241, 16, v241
  v_mul_u32_u24 v242, 10, v241
  v_sub_u32 v242, v240, v242
  v_lshlrev_b32 v242, 4, v242
  v_and_b32 v243, 1, v241
  v_bfe_u32 v244, v241, 1, 2
  v_lshl_or_b32 v243, v243, 2, v244
  v_lshrrev_b32 v240, 4, v241
  v_and_b32 v244, 8, v241
  v_add_u32 v244, v244, v243
  v_mad_u32_u24 v244, v240, 18, v244
  v_mad_u32_u24 v211, v244, s45, v242
  v_mul_u32_u24 v240, 144, v240
  v_bfe_u32 v244, v241, 3, 1
  v_mad_u32_u24 v240, v244, 36, v240
  v_and_b32 v244, 1, v241
  v_mul_u32_u24 v244, 72, v244
  v_add_u32 v240, v240, v244
  v_bfe_u32 v244, v241, 2, 1
  v_mad_u32_u24 v240, v244, 18, v240
  v_bfe_u32 v244, v241, 1, 1
  v_add3_u32 v240, v240, v244, 16
  v_mad_u32_u24 v216, v240, s45, v242
  v_subrev_u32 v211, 3072, v211
  v_subrev_u32 v216, 3072, v216
  v_add_u32 v240, 256, v237
  v_mul_u32_u24 v241, s44, v240
  v_lshrrev_b32 v241, 16, v241
  v_mul_u32_u24 v242, 10, v241
  v_sub_u32 v242, v240, v242
  v_lshlrev_b32 v242, 4, v242
  v_and_b32 v243, 1, v241
  v_bfe_u32 v244, v241, 1, 2
  v_lshl_or_b32 v243, v243, 2, v244
  v_lshrrev_b32 v240, 4, v241
  v_and_b32 v244, 8, v241
  v_add_u32 v244, v244, v243
  v_mad_u32_u24 v244, v240, 18, v244
  v_mad_u32_u24 v212, v244, s45, v242
  v_mul_u32_u24 v240, 144, v240
  v_bfe_u32 v244, v241, 3, 1
  v_mad_u32_u24 v240, v244, 36, v240
  v_and_b32 v244, 1, v241
  v_mul_u32_u24 v244, 72, v244
  v_add_u32 v240, v240, v244
  v_bfe_u32 v244, v241, 2, 1
  v_mad_u32_u24 v240, v244, 18, v240
  v_bfe_u32 v244, v241, 1, 1
  v_add3_u32 v240, v240, v244, 16
  v_mad_u32_u24 v217, v240, s45, v242
  s_mul_i32 s69, s43, 41472
  s_lshl_b32 s44, s68, 5
  s_add_u32 s69, s69, s44
  s_mul_i32 s70, s43, 5120
  s_add_u32 s72, s70, 81920
  s_cmp_lt_u32 s43, 2
  s_cselect_b32 s72, s72, 196608
  s_mul_i32 s73, s43, 331776
  s_add_u32 s73, s73, s44
  v_bfe_u32 v240, v237, 2, 2
  v_lshrrev_b32 v241, 5, v237
  v_lshl_add_u32 v240, v240, 1, v241
  v_mul_u32_u24 v242, 160, v240
  v_bfe_u32 v243, v237, 4, 1
  v_lshl_add_u32 v242, v243, 5, v242
  v_and_b32 v244, 3, v237
  v_lshl_add_u32 v218, v244, 3, v242
  v_add_u32 v219, 61440, v218
  s_mul_i32 s44, s52, 5120
  s_add_u32 s44, s44, 81920
  v_add_u32 v219, s44, v218
  s_mul_i32 s44, s52, 40960
  v_add_u32 v218, s44, v218
  s_mov_b32 s58, 663552
  s_mov_b32 s59, 131072
  s_mov_b32 s66, 2359296
  s_mov_b32 s67, 131072
  v_and_b32 v245, 31, v237
  v_lshrrev_b32 v246, 5, v237
  s_lshl_b32 s44, s54, 5
  v_add_u32 v241, s44, v245
  v_lshlrev_b32 v247, 2, v241
  s_movk_i32 s46, 1152
  v_mul_lo_u32 v220, v241, s46
  v_lshl_add_u32 v220, v246, 4, v220
  s_lshl_b32 s44, s68, 5
  v_add_u32 v220, s44, v220
  v_lshlrev_b32 v236, 2, v245
  v_lshl_add_u32 v236, v246, 9, v236
  s_lshr_b32 s44, s6, 2
  s_lshl_b32 s44, s44, 12
  s_add_u32 s44, s44, 16384
  v_lshlrev_b32 v238, 7, v245
  v_and_b32 v239, 896, v238
  v_add_u32 v238, s44, v238
  s_lshl_b32 s44, s6, 10
  v_add_u32 v239, s44, v239
  v_cmp_eq_u32 vcc, 0, v246
  s_nop 1
  v_cndmask_b32 v233, v239, v238, vcc
  s_mul_i32 s71, s54, 36864
  s_lshl_b32 s74, s68, 10
  s_add_u32 s74, s74, s71
  s_add_u32 s61, s74, 9437184
  s_cmp_eq_u32 s52, 0
  s_cselect_b32 s61, s61, 2146435072
  s_mul_i32 s44, s52, 9437184
  s_add_u32 s74, s74, s44
  s_add_u32 s71, s71, 11796480
  s_lshl_b32 s44, s52, 11
  s_add_u32 s60, s71, s44
  s_add_u32 s60, s60, 32768
  s_lshl_b32 s44, s52, 14
  s_add_u32 s71, s71, s44
  s_bitcmp1_b32 s7, 0
  s_mov_b32 s75, 2146435072
  s_cselect_b32 s75, 4096, s75
  v_bfe_u32 v240, v237, 2, 1
  v_cmp_eq_u32 vcc, v240, v246
  v_and_b32 v241, 1, v237
  v_lshlrev_b32 v241, 4, v241
  v_mov_b32 v242, 16256
  v_lshlrev_b32 v241, v241, v242
  v_cndmask_b32 v241, 0, v241, vcc
  v_bfe_u32 v240, v237, 1, 1
  v_bfe_u32 v242, v237, 3, 2
  v_lshl_add_u32 v240, v242, 1, v240
  v_cmp_eq_u32 vcc, 0, v240
  s_nop 1
  v_cndmask_b32 v224, 0, v241, vcc
  v_cmp_eq_u32 vcc, 1, v240
  s_nop 1
  v_cndmask_b32 v225, 0, v241, vcc
  v_cmp_eq_u32 vcc, 2, v240
  s_nop 1
  v_cndmask_b32 v226, 0, v241, vcc
  v_cmp_eq_u32 vcc, 3, v240
  s_nop 1
  v_cndmask_b32 v227, 0, v241, vcc
  v_cmp_eq_u32 vcc, 4, v240
  s_nop 1
  v_cndmask_b32 v228, 0, v241, vcc
  v_cmp_eq_u32 vcc, 5, v240
  s_nop 1
  v_cndmask_b32 v229, 0, v241, vcc
  v_cmp_eq_u32 vcc, 6, v240
  s_nop 1
  v_cndmask_b32 v230, 0, v241, vcc
  v_cmp_eq_u32 vcc, 7, v240
  s_nop 1
  v_cndmask_b32 v231, 0, v241, vcc
  s_waitcnt lgkmcnt(0)
  s_waitcnt vmcnt(0)
  s_barrier
  s_cmp_lg_u32 s43, 0
  s_cbranch_scc1 L_fin_sf
  v_mov_b32 v240, s3
  v_mov_b32 v241, 0
  s_mov_b64 exec, 1
  buffer_store_dword v240, v241, s[16:19], s53 offen sc1
  s_mov_b64 exec, -1
L_fin_sf:
  s_add_u32 m0, s70, 0
  s_nop 0
  buffer_load_dwordx4 v208, s[56:59], s69 offen offset:0 lds
  buffer_load_dwordx4 v209, s[56:59], s69 offen offset:1024 lds
  buffer_load_dwordx4 v210, s[56:59], s69 offen offset:2048 lds
  buffer_load_dwordx4 v211, s[56:59], s69 offen offset:3072 lds
  s_add_u32 m0, s70, 4096
  s_nop 0
  buffer_load_dwordx4 v212, s[56:59], s69 offen offset:0 lds
  s_add_u32 s69, s69, 165888
  s_add_u32 m0, s70, 20480
  s_nop 0
  buffer_load_dwordx4 v208, s[56:59], s69 offen offset:0 lds
  buffer_load_dwordx4 v209, s[56:59], s69 offen offset:1024 lds
  buffer_load_dwordx4 v210, s[56:59], s69 offen offset:2048 lds
  buffer_load_dwordx4 v211, s[56:59], s69 offen offset:3072 lds
  s_add_u32 m0, s70, 24576
  s_nop 0
  buffer_load_dwordx4 v212, s[56:59], s69 offen offset:0 lds
  s_add_u32 s69, s69, 165888
  s_add_u32 m0, s70, 40960
  s_nop 0
  buffer_load_dwordx4 v208, s[56:59], s69 offen offset:0 lds
  buffer_load_dwordx4 v209, s[56:59], s69 offen offset:1024 lds
  buffer_load_dwordx4 v210, s[56:59], s69 offen offset:2048 lds
  buffer_load_dwordx4 v211, s[56:59], s69 offen offset:3072 lds
  s_add_u32 m0, s70, 45056
  s_nop 0
  buffer_load_dwordx4 v212, s[56:59], s69 offen offset:0 lds
  s_add_u32 s69, s69, 165888
  s_add_u32 m0, s70, 61440
  s_nop 0
  buffer_load_dwordx4 v208, s[56:59], s69 offen offset:0 lds
  buffer_load_dwordx4 v209, s[56:59], s69 offen offset:1024 lds
  buffer_load_dwordx4 v210, s[56:59], s69 offen offset:2048 lds
  buffer_load_dwordx4 v211, s[56:59], s69 offen offset:3072 lds
  s_add_u32 m0, s70, 65536
  s_nop 0
  buffer_load_dwordx4 v212, s[56:59], s69 offen offset:0 lds
  s_add_u32 s69, s69, 165888
  s_add_u32 m0, s72, 0
  s_nop 0
  buffer_load_dwordx4 v213, s[56:59], s73 offen offset:0 lds
  buffer_load_dwordx4 v214, s[56:59], s73 offen offset:1024 lds
  buffer_load_dwordx4 v215, s[56:59], s73 offen offset:2048 lds
  buffer_load_dwordx4 v216, s[56:59], s73 offen offset:3072 lds
  s_add_u32 m0, s72, 4096
  s_nop 0
  buffer_load_dwordx4 v217, s[56:59], s73 offen offset:0 lds
  s_mov_b32 s44, 14401536
  s_waitcnt vmcnt(0)
  s_cmp_lg_u32 s43, 0
  s_cbranch_scc1 L_fin_w_d
  s_mov_b32 s45, 1048576
L_fin_w:
  buffer_load_dword v240, v233, s[16:19], s44 offen sc1
  s_sub_u32 s45, s45, 1
  s_waitcnt vmcnt(0)
  v_cmp_ne_u32 vcc, s3, v240
  s_cmp_eq_u32 s45, 0
  s_cbranch_scc1 L_fin_w_d
  s_cmp_lg_u64 vcc, 0
  s_cbranch_scc1 L_fin_w
L_fin_w_d:
  s_barrier
  buffer_load_dwordx4 a[0:3], v221, s[16:19], s71 offen offset:0 sc1
  buffer_load_dwordx4 a[4:7], v221, s[16:19], s71 offen offset:1024 sc1
  buffer_load_dwordx4 a[8:11], v221, s[16:19], s71 offen offset:2048 sc1
  buffer_load_dwordx4 a[12:15], v221, s[16:19], s71 offen offset:3072 sc1
  s_add_u32 s71, s71, 4096
  buffer_load_dwordx4 a[16:19], v221, s[16:19], s71 offen offset:0 sc1
  buffer_load_dwordx4 a[20:23], v221, s[16:19], s71 offen offset:1024 sc1
  buffer_load_dwordx4 a[24:27], v221, s[16:19], s71 offen offset:2048 sc1
  buffer_load_dwordx4 a[28:31], v221, s[16:19], s71 offen offset:3072 sc1
  s_add_u32 s71, s71, 4096
  buffer_load_dwordx4 a[32:35], v221, s[16:19], s71 offen offset:0 sc1
  buffer_load_dwordx4 a[36:39], v221, s[16:19], s71 offen offset:1024 sc1
  ds_read_b64_tr_b16 v[16:17], v218 offset:0
  ds_read_b64_tr_b16 v[18:19], v218 offset:1280
  ds_read_b64_tr_b16 v[20:21], v218 offset:64
  ds_read_b64_tr_b16 v[22:23], v218 offset:1344
  ds_read_b64_tr_b16 v[24:25], v218 offset:128
  ds_read_b64_tr_b16 v[26:27], v218 offset:1408
  ds_read_b64_tr_b16 v[28:29], v218 offset:2560
  ds_read_b64_tr_b16 v[30:31], v218 offset:3840
  ds_read_b64_tr_b16 v[32:33], v218 offset:2624
  ds_read_b64_tr_b16 v[34:35], v218 offset:3904
  ds_read_b64_tr_b16 v[36:37], v218 offset:2688
  ds_read_b64_tr_b16 v[38:39], v218 offset:3968
  s_waitcnt vmcnt(9) lgkmcnt(8)
  v_mfma_f32_32x32x16_bf16 v[48:63], v[16:19], a[0:3], 0
  ds_read_b64_tr_b16 v[40:41], v218 offset:5120
  ds_read_b64_tr_b16 v[42:43], v218 offset:6400
  buffer_load_dwordx4 a[40:43], v221, s[16:19], s71 offen offset:2048 sc1
  v_mfma_f32_32x32x16_bf16 v[64:79], v[20:23], a[0:3], 0
  s_waitcnt vmcnt(9) lgkmcnt(6)
  ds_read_b64_tr_b16 v[44:45], v218 offset:5184
  ds_read_b64_tr_b16 v[46:47], v218 offset:6464
  buffer_load_dwordx4 a[44:47], v221, s[16:19], s71 offen offset:3072 sc1
  s_add_u32 s71, s71, 4096
  v_mfma_f32_32x32x16_bf16 v[80:95], v[24:27], a[0:3], 0
  ds_read_b64_tr_b16 v[16:17], v218 offset:5248
  ds_read_b64_tr_b16 v[18:19], v218 offset:6528
  v_mfma_f32_32x32x16_bf16 v[48:63], v[28:31], a[4:7], v[48:63]
  s_waitcnt lgkmcnt(6)
  ds_read_b64_tr_b16 v[20:21], v218 offset:7680
  ds_read_b64_tr_b16 v[22:23], v218 offset:8960
  buffer_load_dwordx4 a[48:51], v221, s[16:19], s71 offen offset:0 sc1
  v_mfma_f32_32x32x16_bf16 v[64:79], v[32:35], a[4:7], v[64:79]
  ds_read_b64_tr_b16 v[24:25], v218 offset:7744
  ds_read_b64_tr_b16 v[26:27], v218 offset:9024
  buffer_load_dwordx4 a[52:55], v221, s[16:19], s71 offen offset:1024 sc1
  v_mfma_f32_32x32x16_bf16 v[80:95], v[36:39], a[4:7], v[80:95]
  s_waitcnt vmcnt(11) lgkmcnt(6)
  ds_read_b64_tr_b16 v[28:29], v218 offset:7808
  ds_read_b64_tr_b16 v[30:31], v218 offset:9088
  v_mfma_f32_32x32x16_bf16 v[48:63], v[40:43], a[8:11], v[48:63]
  ds_read_b64_tr_b16 v[32:33], v218 offset:10240
  ds_read_b64_tr_b16 v[34:35], v218 offset:11520
  buffer_load_dwordx4 a[56:59], v221, s[16:19], s71 offen offset:2048 sc1
  v_mfma_f32_32x32x16_bf16 v[64:79], v[44:47], a[8:11], v[64:79]
  s_waitcnt vmcnt(11) lgkmcnt(6)
  ds_read_b64_tr_b16 v[36:37], v218 offset:10304
  ds_read_b64_tr_b16 v[38:39], v218 offset:11584
  v_mfma_f32_32x32x16_bf16 v[80:95], v[16:19], a[8:11], v[80:95]
  ds_read_b64_tr_b16 v[40:41], v218 offset:10368
  ds_read_b64_tr_b16 v[42:43], v218 offset:11648
  buffer_load_dwordx4 a[60:63], v221, s[16:19], s71 offen offset:3072 sc1
  s_add_u32 s71, s71, 4096
  v_mfma_f32_32x32x16_bf16 v[48:63], v[20:23], a[12:15], v[48:63]
  s_waitcnt lgkmcnt(6)
  ds_read_b64_tr_b16 v[44:45], v218 offset:12800
  ds_read_b64_tr_b16 v[46:47], v218 offset:14080
  buffer_load_dword a64, v236, s[16:19], s60 offen offset:0 sc1
  buffer_load_dword a65, v236, s[16:19], s60 offen offset:128 sc1
  buffer_load_dword a66, v236, s[16:19], s60 offen offset:256 sc1
  buffer_load_dword a67, v236, s[16:19], s60 offen offset:384 sc1
  v_mfma_f32_32x32x16_bf16 v[64:79], v[24:27], a[12:15], v[64:79]
  ds_read_b64_tr_b16 v[16:17], v218 offset:12864
  ds_read_b64_tr_b16 v[18:19], v218 offset:14144
  v_mfma_f32_32x32x16_bf16 v[80:95], v[28:31], a[12:15], v[80:95]
  s_waitcnt vmcnt(15) lgkmcnt(6)
  ds_read_b64_tr_b16 v[20:21], v218 offset:12928
  ds_read_b64_tr_b16 v[22:23], v218 offset:14208
  buffer_load_dword a68, v236, s[16:19], s60 offen offset:1024 sc1
  buffer_load_dword a69, v236, s[16:19], s60 offen offset:1152 sc1
  buffer_load_dword a70, v236, s[16:19], s60 offen offset:1280 sc1
  buffer_load_dword a71, v236, s[16:19], s60 offen offset:1408 sc1
  v_mfma_f32_32x32x16_bf16 v[48:63], v[32:35], a[16:19], v[48:63]
  s_mov_b32 s46, 14163968
  ds_read_b64_tr_b16 v[24:25], v218 offset:15360
  ds_read_b64_tr_b16 v[26:27], v218 offset:16640
  buffer_load_dword v222, v247, s[16:19], s46 offen sc1
  v_mfma_f32_32x32x16_bf16 v[64:79], v[36:39], a[16:19], v[64:79]
  s_waitcnt vmcnt(19) lgkmcnt(6)
  ds_read_b64_tr_b16 v[28:29], v218 offset:15424
  ds_read_b64_tr_b16 v[30:31], v218 offset:16704
  v_mfma_f32_32x32x16_bf16 v[80:95], v[40:43], a[16:19], v[80:95]
  s_mov_b32 s46, 14172160
  ds_read_b64_tr_b16 v[32:33], v218 offset:15488
  ds_read_b64_tr_b16 v[34:35], v218 offset:16768
  buffer_load_dword v234, v247, s[16:19], s46 offen sc1
  v_mfma_f32_32x32x16_bf16 v[48:63], v[44:47], a[20:23], v[48:63]
  s_waitcnt lgkmcnt(6)
  ds_read_b64_tr_b16 v[36:37], v218 offset:17920
  ds_read_b64_tr_b16 v[38:39], v218 offset:19200
  v_mfma_f32_32x32x16_bf16 v[64:79], v[16:19], a[20:23], v[64:79]
  s_add_u32 s44, s74, 14680064
  ds_read_b64_tr_b16 v[40:41], v218 offset:17984
  ds_read_b64_tr_b16 v[42:43], v218 offset:19264
  s_add_u32 s45, s44, s75
  buffer_load_dwordx4 a[72:75], v221, s[16:19], s44 offen offset:0 sc1
  v_mfma_f32_32x32x16_bf16 v[80:95], v[20:23], a[20:23], v[80:95]
  s_waitcnt vmcnt(20) lgkmcnt(6)
  ds_read_b64_tr_b16 v[44:45], v218 offset:18048
  ds_read_b64_tr_b16 v[46:47], v218 offset:19328
  buffer_load_dwordx4 a[76:79], v221, s[16:19], s44 offen offset:1024 sc1
  v_mfma_f32_32x32x16_bf16 v[48:63], v[24:27], a[24:27], v[48:63]
  ds_read_b64_tr_b16 v[16:17], v218 offset:20480
  ds_read_b64_tr_b16 v[18:19], v218 offset:21760
  v_mfma_f32_32x32x16_bf16 v[64:79], v[28:31], a[24:27], v[64:79]
  s_waitcnt vmcnt(20) lgkmcnt(6)
  ds_read_b64_tr_b16 v[20:21], v218 offset:20544
  ds_read_b64_tr_b16 v[22:23], v218 offset:21824
  buffer_load_dwordx4 a[80:83], v221, s[16:19], s44 offen offset:2048 sc1
  v_mfma_f32_32x32x16_bf16 v[80:95], v[32:35], a[24:27], v[80:95]
  ds_read_b64_tr_b16 v[24:25], v218 offset:20608
  ds_read_b64_tr_b16 v[26:27], v218 offset:21888
  buffer_load_dwordx4 a[84:87], v221, s[16:19], s44 offen offset:3072 sc1
  v_mfma_f32_32x32x16_bf16 v[48:63], v[36:39], a[28:31], v[48:63]
  s_waitcnt lgkmcnt(6)
  ds_read_b64_tr_b16 v[28:29], v218 offset:23040
  ds_read_b64_tr_b16 v[30:31], v218 offset:24320
  v_mfma_f32_32x32x16_bf16 v[64:79], v[40:43], a[28:31], v[64:79]
  ds_read_b64_tr_b16 v[32:33], v218 offset:23104
  ds_read_b64_tr_b16 v[34:35], v218 offset:24384
  buffer_load_dwordx4 a[88:91], v221, s[16:19], s45 offen sc1
  v_mfma_f32_32x32x16_bf16 v[80:95], v[44:47], a[28:31], v[80:95]
  s_waitcnt vmcnt(22) lgkmcnt(6)
  ds_read_b64_tr_b16 v[36:37], v218 offset:23168
  ds_read_b64_tr_b16 v[38:39], v218 offset:24448
  v_mfma_f32_32x32x16_bf16 v[48:63], v[16:19], a[32:35], v[48:63]
  s_add_u32 s44, s74, 17039360
  ds_read_b64_tr_b16 v[40:41], v218 offset:25600
  ds_read_b64_tr_b16 v[42:43], v218 offset:26880
  s_add_u32 s45, s44, s75
  buffer_load_dwordx4 a[92:95], v221, s[16:19], s44 offen offset:0 sc1
  v_mfma_f32_32x32x16_bf16 v[64:79], v[20:23], a[32:35], v[64:79]
  s_waitcnt vmcnt(22) lgkmcnt(6)
  ds_read_b64_tr_b16 v[44:45], v218 offset:25664
  ds_read_b64_tr_b16 v[46:47], v218 offset:26944
  buffer_load_dwordx4 a[96:99], v221, s[16:19], s44 offen offset:1024 sc1
  v_mfma_f32_32x32x16_bf16 v[80:95], v[24:27], a[32:35], v[80:95]
  ds_read_b64_tr_b16 v[16:17], v218 offset:25728
  ds_read_b64_tr_b16 v[18:19], v218 offset:27008
  v_mfma_f32_32x32x16_bf16 v[48:63], v[28:31], a[36:39], v[48:63]
  s_waitcnt lgkmcnt(6)
  ds_read_b64_tr_b16 v[20:21], v218 offset:28160
  ds_read_b64_tr_b16 v[22:23], v218 offset:29440
  buffer_load_dwordx4 a[100:103], v221, s[16:19], s44 offen offset:2048 sc1
  v_mfma_f32_32x32x16_bf16 v[64:79], v[32:35], a[36:39], v[64:79]
  ds_read_b64_tr_b16 v[24:25], v218 offset:28224
  ds_read_b64_tr_b16 v[26:27], v218 offset:29504
  buffer_load_dwordx4 a[104:107], v221, s[16:19], s44 offen offset:3072 sc1
  v_mfma_f32_32x32x16_bf16 v[80:95], v[36:39], a[36:39], v[80:95]
  s_waitcnt vmcnt(24) lgkmcnt(6)
  ds_read_b64_tr_b16 v[28:29], v218 offset:28288
  ds_read_b64_tr_b16 v[30:31], v218 offset:29568
  v_mfma_f32_32x32x16_bf16 v[48:63], v[40:43], a[40:43], v[48:63]
  ds_read_b64_tr_b16 v[32:33], v218 offset:30720
  ds_read_b64_tr_b16 v[34:35], v218 offset:32000
  buffer_load_dwordx4 a[108:111], v221, s[16:19], s45 offen sc1
  v_mfma_f32_32x32x16_bf16 v[64:79], v[44:47], a[40:43], v[64:79]
  s_waitcnt vmcnt(24) lgkmcnt(6)
  ds_read_b64_tr_b16 v[36:37], v218 offset:30784
  ds_read_b64_tr_b16 v[38:39], v218 offset:32064
  v_mfma_f32_32x32x16_bf16 v[80:95], v[16:19], a[40:43], v[80:95]
  s_add_u32 s44, s74, 19398656
  ds_read_b64_tr_b16 v[40:41], v218 offset:30848
  ds_read_b64_tr_b16 v[42:43], v218 offset:32128
  s_add_u32 s45, s44, s75
  buffer_load_dwordx4 a[112:115], v221, s[16:19], s44 offen offset:0 sc1
  v_mfma_f32_32x32x16_bf16 v[48:63], v[20:23], a[44:47], v[48:63]
  s_waitcnt lgkmcnt(6)
  ds_read_b64_tr_b16 v[44:45], v218 offset:33280
  ds_read_b64_tr_b16 v[46:47], v218 offset:34560
  buffer_load_dwordx4 a[116:119], v221, s[16:19], s44 offen offset:1024 sc1
  v_mfma_f32_32x32x16_bf16 v[64:79], v[24:27], a[44:47], v[64:79]
  ds_read_b64_tr_b16 v[16:17], v218 offset:33344
  ds_read_b64_tr_b16 v[18:19], v218 offset:34624
  v_mfma_f32_32x32x16_bf16 v[80:95], v[28:31], a[44:47], v[80:95]
  s_waitcnt vmcnt(25) lgkmcnt(6)
  ds_read_b64_tr_b16 v[20:21], v218 offset:33408
  ds_read_b64_tr_b16 v[22:23], v218 offset:34688
  buffer_load_dwordx4 a[120:123], v221, s[16:19], s44 offen offset:2048 sc1
  v_mfma_f32_32x32x16_bf16 v[48:63], v[32:35], a[48:51], v[48:63]
  ds_read_b64_tr_b16 v[24:25], v218 offset:35840
  ds_read_b64_tr_b16 v[26:27], v218 offset:37120
  buffer_load_dwordx4 a[124:127], v221, s[16:19], s44 offen offset:3072 sc1
  v_mfma_f32_32x32x16_bf16 v[64:79], v[36:39], a[48:51], v[64:79]
  s_waitcnt vmcnt(26) lgkmcnt(6)
  ds_read_b64_tr_b16 v[28:29], v218 offset:35904
  ds_read_b64_tr_b16 v[30:31], v218 offset:37184
  v_mfma_f32_32x32x16_bf16 v[80:95], v[40:43], a[48:51], v[80:95]
  ds_read_b64_tr_b16 v[32:33], v218 offset:35968
  ds_read_b64_tr_b16 v[34:35], v218 offset:37248
  buffer_load_dwordx4 a[128:131], v221, s[16:19], s45 offen sc1
  v_mfma_f32_32x32x16_bf16 v[48:63], v[44:47], a[52:55], v[48:63]
  s_waitcnt lgkmcnt(6)
  ds_read_b64_tr_b16 v[36:37], v218 offset:38400
  ds_read_b64_tr_b16 v[38:39], v218 offset:39680
  v_mfma_f32_32x32x16_bf16 v[64:79], v[16:19], a[52:55], v[64:79]
  s_add_u32 s44, s74, 21757952
  ds_read_b64_tr_b16 v[40:41], v218 offset:38464
  ds_read_b64_tr_b16 v[42:43], v218 offset:39744
  s_add_u32 s45, s44, s75
  buffer_load_dwordx4 a[132:135], v221, s[16:19], s44 offen offset:0 sc1
  v_mfma_f32_32x32x16_bf16 v[80:95], v[20:23], a[52:55], v[80:95]
  s_waitcnt vmcnt(27) lgkmcnt(6)
  ds_read_b64_tr_b16 v[44:45], v218 offset:38528
  ds_read_b64_tr_b16 v[46:47], v218 offset:39808
  buffer_load_dwordx4 a[136:139], v221, s[16:19], s44 offen offset:1024 sc1
  v_mfma_f32_32x32x16_bf16 v[48:63], v[24:27], a[56:59], v[48:63]
  ds_read_b64_tr_b16 v[16:17], v219 offset:0
  ds_read_b64_tr_b16 v[18:19], v219 offset:1280
  v_mfma_f32_32x32x16_bf16 v[64:79], v[28:31], a[56:59], v[64:79]
  s_waitcnt vmcnt(27) lgkmcnt(6)
  ds_read_b64_tr_b16 v[20:21], v219 offset:64
  ds_read_b64_tr_b16 v[22:23], v219 offset:1344
  buffer_load_dwordx4 a[140:143], v221, s[16:19], s44 offen offset:2048 sc1
  v_mfma_f32_32x32x16_bf16 v[80:95], v[32:35], a[56:59], v[80:95]
  ds_read_b64_tr_b16 v[24:25], v219 offset:128
  ds_read_b64_tr_b16 v[26:27], v219 offset:1408
  buffer_load_dwordx4 a[144:147], v221, s[16:19], s44 offen offset:3072 sc1
  v_mfma_f32_32x32x16_bf16 v[48:63], v[36:39], a[60:63], v[48:63]
  s_waitcnt lgkmcnt(6)
  ds_read_b64_tr_b16 v[28:29], v219 offset:2560
  ds_read_b64_tr_b16 v[30:31], v219 offset:3840
  v_mfma_f32_32x32x16_bf16 v[64:79], v[40:43], a[60:63], v[64:79]
  ds_read_b64_tr_b16 v[32:33], v219 offset:2624
  ds_read_b64_tr_b16 v[34:35], v219 offset:3904
  buffer_load_dwordx4 a[148:151], v221, s[16:19], s45 offen sc1
  v_mfma_f32_32x32x16_bf16 v[80:95], v[44:47], a[60:63], v[80:95]
  s_waitcnt vmcnt(26) lgkmcnt(6)
  ds_read_b64_tr_b16 v[36:37], v219 offset:2688
  ds_read_b64_tr_b16 v[38:39], v219 offset:3968
  v_mfma_f32_32x32x16_bf16 v[48:63], v[16:19], a[64:67], v[48:63]
  s_mov_b32 s44, s61
  s_add_u32 s45, s44, s75
  buffer_load_dwordx4 a[152:155], v221, s[16:19], s44 offen offset:0 sc1
  v_mfma_f32_32x32x16_bf16 v[64:79], v[20:23], a[64:67], v[64:79]
  s_waitcnt vmcnt(23) lgkmcnt(4)
  buffer_load_dwordx4 a[156:159], v221, s[16:19], s44 offen offset:1024 sc1
  v_mfma_f32_32x32x16_bf16 v[80:95], v[24:27], a[64:67], v[80:95]
  v_mfma_f32_32x32x16_bf16 v[48:63], v[28:31], a[68:71], v[48:63]
  s_waitcnt lgkmcnt(0)
  buffer_load_dwordx4 a[160:163], v221, s[16:19], s44 offen offset:2048 sc1
  v_mfma_f32_32x32x16_bf16 v[64:79], v[32:35], a[68:71], v[64:79]
  buffer_load_dwordx4 a[164:167], v221, s[16:19], s44 offen offset:3072 sc1
  v_mfma_f32_32x32x16_bf16 v[80:95], v[36:39], a[68:71], v[80:95]
  s_waitcnt vmcnt(22)
  v_mfma_f32_32x32x16_bf16 v[128:143], v[224:227], a[72:75], 0
  buffer_load_dwordx4 a[168:171], v221, s[16:19], s45 offen sc1
  v_mfma_f32_32x32x16_bf16 v[128:143], v[228:231], a[76:79], v[128:143]
  s_waitcnt vmcnt(21)
  v_mfma_f32_32x32x16_bf16 v[144:159], v[224:227], a[80:83], 0
  v_mfma_f32_32x32x16_bf16 v[144:159], v[228:231], a[84:87], v[144:159]
  s_waitcnt vmcnt(19)
  v_mfma_f32_32x32x16_bf16 v[160:175], v[224:227], a[88:91], 0
  v_mfma_f32_32x32x16_bf16 v[128:143], v[224:227], a[92:95], v[128:143]
  s_waitcnt vmcnt(17)
  v_mfma_f32_32x32x16_bf16 v[128:143], v[228:231], a[96:99], v[128:143]
  v_mfma_f32_32x32x16_bf16 v[144:159], v[224:227], a[100:103], v[144:159]
  s_waitcnt vmcnt(15)
  v_mfma_f32_32x32x16_bf16 v[144:159], v[228:231], a[104:107], v[144:159]
  v_mfma_f32_32x32x16_bf16 v[160:175], v[224:227], a[108:111], v[160:175]
  s_waitcnt vmcnt(13)
  v_mfma_f32_32x32x16_bf16 v[128:143], v[224:227], a[112:115], v[128:143]
  v_mfma_f32_32x32x16_bf16 v[128:143], v[228:231], a[116:119], v[128:143]
  s_waitcnt vmcnt(11)
  v_mfma_f32_32x32x16_bf16 v[144:159], v[224:227], a[120:123], v[144:159]
  v_mfma_f32_32x32x16_bf16 v[144:159], v[228:231], a[124:127], v[144:159]
  s_waitcnt vmcnt(9)
  v_mfma_f32_32x32x16_bf16 v[160:175], v[224:227], a[128:131], v[160:175]
  v_mfma_f32_32x32x16_bf16 v[128:143], v[224:227], a[132:135], v[128:143]
  s_waitcnt vmcnt(7)
  v_mfma_f32_32x32x16_bf16 v[128:143], v[228:231], a[136:139], v[128:143]
  v_mfma_f32_32x32x16_bf16 v[144:159], v[224:227], a[140:143], v[144:159]
  s_waitcnt vmcnt(5)
  v_mfma_f32_32x32x16_bf16 v[144:159], v[228:231], a[144:147], v[144:159]
  v_mfma_f32_32x32x16_bf16 v[160:175], v[224:227], a[148:151], v[160:175]
  s_waitcnt vmcnt(3)
  v_mfma_f32_32x32x16_bf16 v[128:143], v[224:227], a[152:155], v[128:143]
  v_mfma_f32_32x32x16_bf16 v[128:143], v[228:231], a[156:159], v[128:143]
  s_waitcnt vmcnt(1)
  v_mfma_f32_32x32x16_bf16 v[144:159], v[224:227], a[160:163], v[144:159]
  v_mfma_f32_32x32x16_bf16 v[144:159], v[228:231], a[164:167], v[144:159]
  s_waitcnt vmcnt(0)
  v_mfma_f32_32x32x16_bf16 v[160:175], v[224:227], a[168:171], v[160:175]
  v_sub_f32 v240, 1.0, v222
  v_pk_mul_f32 v[48:49], v[48:49], v[222:223] op_sel_hi:[1,0]
  v_pk_mul_f32 v[50:51], v[50:51], v[222:223] op_sel_hi:[1,0]
  v_pk_mul_f32 v[52:53], v[52:53], v[222:223] op_sel_hi:[1,0]
  v_pk_mul_f32 v[54:55], v[54:55], v[222:223] op_sel_hi:[1,0]
  v_pk_mul_f32 v[56:57], v[56:57], v[222:223] op_sel_hi:[1,0]
  v_pk_mul_f32 v[58:59], v[58:59], v[222:223] op_sel_hi:[1,0]
  v_pk_mul_f32 v[60:61], v[60:61], v[222:223] op_sel_hi:[1,0]
  v_pk_mul_f32 v[62:63], v[62:63], v[222:223] op_sel_hi:[1,0]
  v_pk_mul_f32 v[64:65], v[64:65], v[222:223] op_sel_hi:[1,0]
  v_pk_mul_f32 v[66:67], v[66:67], v[222:223] op_sel_hi:[1,0]
  v_pk_mul_f32 v[68:69], v[68:69], v[222:223] op_sel_hi:[1,0]
  v_pk_mul_f32 v[70:71], v[70:71], v[222:223] op_sel_hi:[1,0]
  v_pk_mul_f32 v[72:73], v[72:73], v[222:223] op_sel_hi:[1,0]
  v_pk_mul_f32 v[74:75], v[74:75], v[222:223] op_sel_hi:[1,0]
  v_pk_mul_f32 v[76:77], v[76:77], v[222:223] op_sel_hi:[1,0]
  v_pk_mul_f32 v[78:79], v[78:79], v[222:223] op_sel_hi:[1,0]
  v_pk_mul_f32 v[80:81], v[80:81], v[222:223] op_sel_hi:[1,0]
  v_pk_mul_f32 v[82:83], v[82:83], v[222:223] op_sel_hi:[1,0]
  v_pk_mul_f32 v[84:85], v[84:85], v[222:223] op_sel_hi:[1,0]
  v_pk_mul_f32 v[86:87], v[86:87], v[222:223] op_sel_hi:[1,0]
  v_pk_fma_f32 v[48:49], v[128:129], v[240:241], v[48:49] op_sel_hi:[1,0,1]
  v_pk_fma_f32 v[50:51], v[130:131], v[240:241], v[50:51] op_sel_hi:[1,0,1]
  v_pk_fma_f32 v[52:53], v[132:133], v[240:241], v[52:53] op_sel_hi:[1,0,1]
  v_pk_fma_f32 v[54:55], v[134:135], v[240:241], v[54:55] op_sel_hi:[1,0,1]
  v_pk_fma_f32 v[56:57], v[136:137], v[240:241], v[56:57] op_sel_hi:[1,0,1]
  v_pk_fma_f32 v[58:59], v[138:139], v[240:241], v[58:59] op_sel_hi:[1,0,1]
  v_pk_fma_f32 v[60:61], v[140:141], v[240:241], v[60:61] op_sel_hi:[1,0,1]
  v_pk_fma_f32 v[62:63], v[142:143], v[240:241], v[62:63] op_sel_hi:[1,0,1]
  v_pk_fma_f32 v[64:65], v[144:145], v[240:241], v[64:65] op_sel_hi:[1,0,1]
  v_pk_fma_f32 v[66:67], v[146:147], v[240:241], v[66:67] op_sel_hi:[1,0,1]
  v_pk_fma_f32 v[68:69], v[148:149], v[240:241], v[68:69] op_sel_hi:[1,0,1]
  v_pk_fma_f32 v[70:71], v[150:151], v[240:241], v[70:71] op_sel_hi:[1,0,1]
  v_pk_fma_f32 v[72:73], v[152:153], v[240:241], v[72:73] op_sel_hi:[1,0,1]
  v_pk_fma_f32 v[74:75], v[154:155], v[240:241], v[74:75] op_sel_hi:[1,0,1]
  v_pk_fma_f32 v[76:77], v[156:157], v[240:241], v[76:77] op_sel_hi:[1,0,1]
  v_pk_fma_f32 v[78:79], v[158:159], v[240:241], v[78:79] op_sel_hi:[1,0,1]
  v_pk_fma_f32 v[80:81], v[160:161], v[240:241], v[80:81] op_sel_hi:[1,0,1]
  v_pk_fma_f32 v[82:83], v[162:163], v[240:241], v[82:83] op_sel_hi:[1,0,1]
  v_pk_fma_f32 v[84:85], v[164:165], v[240:241], v[84:85] op_sel_hi:[1,0,1]
  v_pk_fma_f32 v[86:87], v[166:167], v[240:241], v[86:87] op_sel_hi:[1,0,1]
  s_cmp_eq_u32 s52, 0
  s_cbranch_scc1 L_fin_k0
  ds_write_b128 v235, v[48:51] offset:0
  ds_write_b128 v235, v[52:55] offset:1024
  ds_write_b128 v235, v[56:59] offset:2048
  ds_write_b128 v235, v[60:63] offset:3072
  ds_write_b128 v235, v[64:67] offset:4096
  ds_write_b128 v235, v[68:71] offset:5120
  ds_write_b128 v235, v[72:75] offset:6144
  ds_write_b128 v235, v[76:79] offset:7168
  ds_write_b128 v235, v[80:83] offset:8192
  ds_write_b128 v235, v[84:87] offset:9216
  s_waitcnt lgkmcnt(0)
  s_barrier
  s_endpgm
L_fin_k0:
  v_mul_f32 v242, v240, v234
  v_pk_add_f32 v[48:49], v[48:49], v[242:243] op_sel_hi:[1,0]
  v_pk_add_f32 v[50:51], v[50:51], v[242:243] op_sel_hi:[1,0]
  v_pk_add_f32 v[52:53], v[52:53], v[242:243] op_sel_hi:[1,0]
  v_pk_add_f32 v[54:55], v[54:55], v[242:243] op_sel_hi:[1,0]
  v_pk_add_f32 v[56:57], v[56:57], v[242:243] op_sel_hi:[1,0]
  v_pk_add_f32 v[58:59], v[58:59], v[242:243] op_sel_hi:[1,0]
  v_pk_add_f32 v[60:61], v[60:61], v[242:243] op_sel_hi:[1,0]
  v_pk_add_f32 v[62:63], v[62:63], v[242:243] op_sel_hi:[1,0]
  v_pk_add_f32 v[64:65], v[64:65], v[242:243] op_sel_hi:[1,0]
  v_pk_add_f32 v[66:67], v[66:67], v[242:243] op_sel_hi:[1,0]
  v_pk_add_f32 v[68:69], v[68:69], v[242:243] op_sel_hi:[1,0]
  v_pk_add_f32 v[70:71], v[70:71], v[242:243] op_sel_hi:[1,0]
  v_pk_add_f32 v[72:73], v[72:73], v[242:243] op_sel_hi:[1,0]
  v_pk_add_f32 v[74:75], v[74:75], v[242:243] op_sel_hi:[1,0]
  v_pk_add_f32 v[76:77], v[76:77], v[242:243] op_sel_hi:[1,0]
  v_pk_add_f32 v[78:79], v[78:79], v[242:243] op_sel_hi:[1,0]
  v_pk_add_f32 v[80:81], v[80:81], v[242:243] op_sel_hi:[1,0]
  v_pk_add_f32 v[82:83], v[82:83], v[242:243] op_sel_hi:[1,0]
  v_pk_add_f32 v[84:85], v[84:85], v[242:243] op_sel_hi:[1,0]
  v_pk_add_f32 v[86:87], v[86:87], v[242:243] op_sel_hi:[1,0]
  s_bitcmp1_b32 s7, 0
  s_cselect_b32 s44, 0, 2146435072
  s_barrier
  ds_read_b128 v[128:131], v235 offset:0
  ds_read_b128 v[132:135], v235 offset:1024
  ds_read_b128 v[136:139], v235 offset:2048
  ds_read_b128 v[140:143], v235 offset:3072
  ds_read_b128 v[144:147], v235 offset:4096
  ds_read_b128 v[148:151], v235 offset:5120
  ds_read_b128 v[152:155], v235 offset:6144
  ds_read_b128 v[156:159], v235 offset:7168
  ds_read_b128 v[160:163], v235 offset:8192
  ds_read_b128 v[164:167], v235 offset:9216
  s_waitcnt lgkmcnt(9)
  v_pk_add_f32 v[48:49], v[48:49], v[128:129]
  v_cvt_pk_bf16_f32 v16, v48, v49
  v_pk_add_f32 v[50:51], v[50:51], v[130:131]
  v_cvt_pk_bf16_f32 v17, v50, v51
  s_waitcnt lgkmcnt(8)
  v_pk_add_f32 v[52:53], v[52:53], v[132:133]
  v_cvt_pk_bf16_f32 v18, v52, v53
  v_pk_add_f32 v[54:55], v[54:55], v[134:135]
  v_cvt_pk_bf16_f32 v19, v54, v55
  v_permlane32_swap_b32 v16, v18
  s_nop 0
  v_permlane32_swap_b32 v17, v19
  buffer_store_dwordx4 v[16:19], v220, s[64:67], 0 offen offset:0
  s_waitcnt lgkmcnt(7)
  v_pk_add_f32 v[56:57], v[56:57], v[136:137]
  v_cvt_pk_bf16_f32 v20, v56, v57
  v_pk_add_f32 v[58:59], v[58:59], v[138:139]
  v_cvt_pk_bf16_f32 v21, v58, v59
  s_waitcnt lgkmcnt(6)
  v_pk_add_f32 v[60:61], v[60:61], v[140:141]
  v_cvt_pk_bf16_f32 v22, v60, v61
  v_pk_add_f32 v[62:63], v[62:63], v[142:143]
  v_cvt_pk_bf16_f32 v23, v62, v63
  v_permlane32_swap_b32 v20, v22
  s_nop 0
  v_permlane32_swap_b32 v21, v23
  buffer_store_dwordx4 v[20:23], v220, s[64:67], 0 offen offset:32
  s_waitcnt lgkmcnt(5)
  v_pk_add_f32 v[64:65], v[64:65], v[144:145]
  v_cvt_pk_bf16_f32 v24, v64, v65
  v_pk_add_f32 v[66:67], v[66:67], v[146:147]
  v_cvt_pk_bf16_f32 v25, v66, v67
  s_waitcnt lgkmcnt(4)
  v_pk_add_f32 v[68:69], v[68:69], v[148:149]
  v_cvt_pk_bf16_f32 v26, v68, v69
  v_pk_add_f32 v[70:71], v[70:71], v[150:151]
  v_cvt_pk_bf16_f32 v27, v70, v71
  v_permlane32_swap_b32 v24, v26
  s_nop 0
  v_permlane32_swap_b32 v25, v27
  buffer_store_dwordx4 v[24:27], v220, s[64:67], 0 offen offset:64
  s_waitcnt lgkmcnt(3)
  v_pk_add_f32 v[72:73], v[72:73], v[152:153]
  v_cvt_pk_bf16_f32 v28, v72, v73
  v_pk_add_f32 v[74:75], v[74:75], v[154:155]
  v_cvt_pk_bf16_f32 v29, v74, v75
  s_waitcnt lgkmcnt(2)
  v_pk_add_f32 v[76:77], v[76:77], v[156:157]
  v_cvt_pk_bf16_f32 v30, v76, v77
  v_pk_add_f32 v[78:79], v[78:79], v[158:159]
  v_cvt_pk_bf16_f32 v31, v78, v79
  v_permlane32_swap_b32 v28, v30
  s_nop 0
  v_permlane32_swap_b32 v29, v31
  buffer_store_dwordx4 v[28:31], v220, s[64:67], 0 offen offset:96
  s_waitcnt lgkmcnt(1)
  v_pk_add_f32 v[80:81], v[80:81], v[160:161]
  v_cvt_pk_bf16_f32 v32, v80, v81
  v_pk_add_f32 v[82:83], v[82:83], v[162:163]
  v_cvt_pk_bf16_f32 v33, v82, v83
  s_waitcnt lgkmcnt(0)
  v_pk_add_f32 v[84:85], v[84:85], v[164:165]
  v_cvt_pk_bf16_f32 v34, v84, v85
  v_pk_add_f32 v[86:87], v[86:87], v[166:167]
  v_cvt_pk_bf16_f32 v35, v86, v87
  v_permlane32_swap_b32 v32, v34
  s_nop 0
  v_permlane32_swap_b32 v33, v35
  buffer_store_dwordx4 v[32:35], v220, s[64:67], s44 offen offset:128
  s_endpgm
L_teamA:
  s_load_dwordx4 s[48:51], s[0:1], 48
  s_load_dwordx2 s[52:53], s[0:1], 16
  v_lshrrev_b32 v5, 6, v0
  v_and_b32 v4, 63, v0
  v_readfirstlane_b32 s20, v5
  s_lshl_b32 s21, s4, 4
  s_add_u32 s21, s21, s5
  s_mul_i32 s21, s21, 144
  v_add_u32 v5, s21, v0
  v_and_b32 v6, 3, v5
  v_bfe_u32 v7, v5, 2, 3
  v_lshrrev_b32 v8, 5, v5
  s_movk_i32 s21, 9216
  v_mul_u32_u24 v9, 1152, v7
  v_mad_u32_u24 v9, v8, s21, v9
  v_lshl_add_u32 v9, v6, 7, v9
  v_mov_b32 v5, 2146435072
  v_cmp_gt_u32 vcc, 144, v0
  s_nop 1
  v_cndmask_b32 v122, v5, v9, vcc
  s_load_dwordx4 s[36:39], s[0:1], 0
  s_load_dwordx4 s[40:43], s[0:1], 80
  s_load_dwordx2 s[16:17], s[0:1], 40
  s_and_b32 s21, s5, 7
  s_lshr_b32 s22, s5, 3
  s_and_b32 s64, s4, 1
  s_lshl_b32 s64, s64, 3
  s_add_u32 s64, s64, s21
  s_and_b32 s65, s4, 6
  s_add_u32 s65, s65, s22
  s_add_u32 s66, s21, s22
  s_and_b32 s66, s66, 1
  s_mul_i32 s66, s66, 4
  s_mul_i32 s21, s20, 448
  v_add_u32 v5, s21, v4
  s_movk_i32 s21, 2341
  s_movk_i32 s22, 3456
  v_mul_u32_u24 v6, s21, v5
  v_lshrrev_b32 v6, 16, v6
  v_mul_u32_u24 v7, 28, v6
  v_sub_u32 v7, v5, v7
  v_add_u32 v8, 5, v7
  v_lshrrev_b32 v8, 5, v8
  v_lshlrev_b32 v7, 4, v7
  v_lshl_add_u32 v7, v8, 30, v7
  v_mad_u32_u24 v64, v6, s22, v7
  v_add_u32 v5, 64, v5
  v_mul_u32_u24 v6, s21, v5
  v_lshrrev_b32 v6, 16, v6
  v_mul_u32_u24 v7, 28, v6
  v_sub_u32 v7, v5, v7
  v_add_u32 v8, 5, v7
  v_lshrrev_b32 v8, 5, v8
  v_lshlrev_b32 v7, 4, v7
  v_lshl_add_u32 v7, v8, 30, v7
  v_mad_u32_u24 v65, v6, s22, v7
  v_subrev_u32 v65, 1024, v65
  v_add_u32 v5, 64, v5
  v_mul_u32_u24 v6, s21, v5
  v_lshrrev_b32 v6, 16, v6
  v_mul_u32_u24 v7, 28, v6
  v_sub_u32 v7, v5, v7
  v_add_u32 v8, 5, v7
  v_lshrrev_b32 v8, 5, v8
  v_lshlrev_b32 v7, 4, v7
  v_lshl_add_u32 v7, v8, 30, v7
  v_mad_u32_u24 v66, v6, s22, v7
  v_subrev_u32 v66, 2048, v66
  v_add_u32 v5, 64, v5
  v_mul_u32_u24 v6, s21, v5
  v_lshrrev_b32 v6, 16, v6
  v_mul_u32_u24 v7, 28, v6
  v_sub_u32 v7, v5, v7
  v_add_u32 v8, 5, v7
  v_lshrrev_b32 v8, 5, v8
  v_lshlrev_b32 v7, 4, v7
  v_lshl_add_u32 v7, v8, 30, v7
  v_mad_u32_u24 v67, v6, s22, v7
  v_subrev_u32 v67, 3072, v67
  v_add_u32 v5, 64, v5
  v_mul_u32_u24 v6, s21, v5
  v_lshrrev_b32 v6, 16, v6
  v_mul_u32_u24 v7, 28, v6
  v_sub_u32 v7, v5, v7
  v_add_u32 v8, 5, v7
  v_lshrrev_b32 v8, 5, v8
  v_lshlrev_b32 v7, 4, v7
  v_lshl_add_u32 v7, v8, 30, v7
  v_mad_u32_u24 v68, v6, s22, v7
  v_add_u32 v5, 64, v5
  v_mul_u32_u24 v6, s21, v5
  v_lshrrev_b32 v6, 16, v6
  v_mul_u32_u24 v7, 28, v6
  v_sub_u32 v7, v5, v7
  v_add_u32 v8, 5, v7
  v_lshrrev_b32 v8, 5, v8
  v_lshlrev_b32 v7, 4, v7
  v_lshl_add_u32 v7, v8, 30, v7
  v_mad_u32_u24 v69, v6, s22, v7
  v_subrev_u32 v69, 1024, v69
  v_add_u32 v5, 64, v5
  v_mul_u32_u24 v6, s21, v5
  v_lshrrev_b32 v6, 16, v6
  v_mul_u32_u24 v7, 28, v6
  v_sub_u32 v7, v5, v7
  v_add_u32 v8, 5, v7
  v_lshrrev_b32 v8, 5, v8
  v_lshlrev_b32 v7, 4, v7
  v_lshl_add_u32 v7, v8, 30, v7
  v_mad_u32_u24 v70, v6, s22, v7
  v_subrev_u32 v70, 2048, v70
  v_lshrrev_b32 v5, 5, v4
  v_bfe_u32 v6, v4, 3, 2
  v_lshl_add_u32 v5, v5, 3, v6
  v_and_b32 v6, 7, v4
  v_lshrrev_b32 v7, 4, v4
  v_xor_b32 v6, v6, v7
  v_lshlrev_b32 v6, 4, v6
  s_movk_i32 s21, 1152
  v_mad_u32_u24 v71, v5, s21, v6
  v_xor_b32 v6, 64, v71
  v_add_u32 v72, 3584, v6
  v_add_u32 v73, 16384, v71
  v_add_u32 v74, 19968, v6
  s_lshl_b32 s21, s64, 2
  s_add_u32 s21, s21, s20
  s_mul_i32 s67, s21, 36864
  s_mul_i32 s73, s21, 2560
  s_add_u32 s73, s73, 37748736
  s_mul_i32 s68, s65, 432
  s_lshl_b32 s71, s20, 12
  s_mul_i32 s72, s20, 7168
  s_add_u32 s72, s72, 49152
  v_and_b32 v5, 31, v4
  v_lshrrev_b32 v6, 5, v4
  v_bfe_u32 v7, v4, 1, 3
  v_xor_b32 v7, v7, v6
  v_lshlrev_b32 v7, 4, v7
  v_lshl_add_u32 v7, v5, 7, v7
  v_add_u32 v75, s71, v7
  v_xor_b32 v76, 32, v75
  v_xor_b32 v77, 64, v75
  v_xor_b32 v78, 96, v75
  v_bfe_u32 v7, v4, 2, 2
  v_lshl_add_u32 v7, v6, 3, v7
  v_mul_u32_u24 v7, 448, v7
  v_bfe_u32 v8, v4, 4, 1
  v_lshl_add_u32 v7, v8, 5, v7
  v_and_b32 v8, 3, v4
  v_lshl_add_u32 v7, v8, 3, v7
  v_add_u32 v79, 49152, v7
  v_add_u32 v80, 106496, v7
  s_lshl_b32 s74, s4, 4
  s_add_u32 s74, s74, s5
  s_cmp_eq_u32 s20, 3
  s_cselect_b32 s74, s74, 255
  s_mul_i32 s21, s74, 9216
  s_movk_i32 s22, 1152
  v_lshrrev_b32 v5, 3, v4
  v_and_b32 v6, 7, v4
  v_lshlrev_b32 v6, 4, v6
  v_mad_u32_u24 v5, v5, s22, v6
  v_add_u32 v246, s21, v5
  s_mov_b32 s18, 663552
  s_mov_b32 s19, 131072
  s_mov_b32 s58, 2359296
  s_mov_b32 s59, 131072
  s_mov_b32 s62, 1990656
  s_mov_b32 s63, 131072
  s_waitcnt lgkmcnt(0)
  s_mov_b32 s56, s36
  s_mov_b32 s57, s37
  s_mov_b32 s60, s38
  s_mov_b32 s61, s39
  s_mul_i32 s70, s66, 221184
  s_add_u32 m0, s72, 0
  s_add_u32 s70, s70, s68
  buffer_load_dwordx4 v64, s[60:63], s70 offen offset:0 lds
  buffer_load_dwordx4 v65, s[60:63], s70 offen offset:1024 lds
  buffer_load_dwordx4 v66, s[60:63], s70 offen offset:2048 lds
  buffer_load_dwordx4 v67, s[60:63], s70 offen offset:3072 lds
  s_add_u32 m0, s72, 4096
  s_lshl_b32 s69, s66, 7
  buffer_load_dwordx4 v68, s[60:63], s70 offen offset:0 lds
  buffer_load_dwordx4 v69, s[60:63], s70 offen offset:1024 lds
  buffer_load_dwordx4 v70, s[60:63], s70 offen offset:2048 lds
  s_add_u32 m0, s71, 0
  s_add_u32 s69, s69, s67
  buffer_load_dwordx4 v71, s[56:59], s69 offen offset:0 lds
  buffer_load_dwordx4 v72, s[56:59], s69 offen offset:1024 lds
  buffer_load_dwordx4 v73, s[56:59], s69 offen offset:2048 lds
  buffer_load_dwordx4 v74, s[56:59], s69 offen offset:3072 lds
  s_add_u32 s66, s66, 1
  s_cmp_eq_u32 s66, 9
  s_cselect_b32 s66, 0, s66
  s_mul_i32 s70, s66, 221184
  s_add_u32 m0, s72, 28672
  s_add_u32 s70, s70, s68
  buffer_load_dwordx4 v64, s[60:63], s70 offen offset:0 lds
  buffer_load_dwordx4 v65, s[60:63], s70 offen offset:1024 lds
  buffer_load_dwordx4 v66, s[60:63], s70 offen offset:2048 lds
  buffer_load_dwordx4 v67, s[60:63], s70 offen offset:3072 lds
  s_add_u32 m0, s72, 32768
  s_lshl_b32 s69, s66, 7
  buffer_load_dwordx4 v68, s[60:63], s70 offen offset:0 lds
  buffer_load_dwordx4 v69, s[60:63], s70 offen offset:1024 lds
  buffer_load_dwordx4 v70, s[60:63], s70 offen offset:2048 lds
  s_add_u32 m0, s71, 16384
  s_add_u32 s69, s69, s67
  buffer_load_dwordx4 v71, s[56:59], s69 offen offset:0 lds
  buffer_load_dwordx4 v72, s[56:59], s69 offen offset:1024 lds
  buffer_load_dwordx4 v73, s[56:59], s69 offen offset:2048 lds
  buffer_load_dwordx4 v74, s[56:59], s69 offen offset:3072 lds
  s_add_u32 s66, s66, 1
  s_cmp_eq_u32 s66, 9
  s_cselect_b32 s66, 0, s66
  s_cmp_ge_u32 s74, 72
  s_cbranch_scc1 L_a1_nl
  buffer_load_dwordx4 a[0:3], v246, s[16:19], 0 offen offset:0
  buffer_load_dwordx4 a[4:7], v246, s[16:19], 0 offen offset:128
  buffer_load_dwordx4 a[8:11], v246, s[16:19], 0 offen offset:256
  buffer_load_dwordx4 a[12:15], v246, s[16:19], 0 offen offset:384
  buffer_load_dwordx4 a[16:19], v246, s[16:19], 0 offen offset:512
  buffer_load_dwordx4 a[20:23], v246, s[16:19], 0 offen offset:640
  buffer_load_dwordx4 a[24:27], v246, s[16:19], 0 offen offset:768
  buffer_load_dwordx4 a[28:31], v246, s[16:19], 0 offen offset:896
  buffer_load_dwordx4 a[32:35], v246, s[16:19], 0 offen offset:1024
L_a1_nl:
  s_mov_b32 s12, s40
  s_mov_b32 s13, s41
  s_mov_b32 s14, 256
  s_mov_b32 s15, 131072
  s_mov_b32 s8, s42
  s_mov_b32 s9, s43
  s_mov_b32 s10, 48234496
  s_mov_b32 s11, 131072
  v_mov_b32 v121, 0
  s_waitcnt vmcnt(11)
  s_barrier
  ds_read_b128 v[48:51], v75 offset:0
  ds_read_b64_tr_b16 v[16:17], v79 offset:0
  ds_read_b64_tr_b16 v[18:19], v79 offset:1792
  ds_read_b64_tr_b16 v[20:21], v79 offset:64
  ds_read_b64_tr_b16 v[22:23], v79 offset:1856
  ds_read_b64_tr_b16 v[24:25], v79 offset:128
  ds_read_b64_tr_b16 v[26:27], v79 offset:1920
  ds_read_b64_tr_b16 v[28:29], v79 offset:192
  ds_read_b64_tr_b16 v[30:31], v79 offset:1984
  ds_read_b64_tr_b16 v[32:33], v79 offset:256
  ds_read_b64_tr_b16 v[34:35], v79 offset:2048
  ds_read_b64_tr_b16 v[36:37], v79 offset:320
  ds_read_b64_tr_b16 v[38:39], v79 offset:2112
  s_waitcnt lgkmcnt(8)
  v_mfma_f32_32x32x16_bf16 v[128:143], v[48:51], v[16:19], 0
  s_mul_i32 s70, s66, 221184
  ds_read_b64_tr_b16 v[40:41], v79 offset:384
  ds_read_b64_tr_b16 v[42:43], v79 offset:2176
  s_add_u32 m0, s72, 57344
  s_add_u32 s70, s70, s68
  buffer_load_dwordx4 v64, s[60:63], s70 offen offset:0 lds
  buffer_load_dwordx4 v65, s[60:63], s70 offen offset:1024 lds
  v_mfma_f32_32x32x16_bf16 v[144:159], v[48:51], v[20:23], 0
  s_waitcnt lgkmcnt(6)
  ds_read_b128 v[52:55], v76 offset:0
  ds_read_b64_tr_b16 v[44:45], v79 offset:7168
  ds_read_b64_tr_b16 v[46:47], v79 offset:8960
  v_and_b32 v5, 31, v4
  v_lshrrev_b32 v6, 5, v4
  v_mfma_f32_32x32x16_bf16 v[160:175], v[48:51], v[24:27], 0
  s_mul_i32 s23, s20, 16640
  ds_read_b64_tr_b16 v[16:17], v79 offset:7232
  ds_read_b64_tr_b16 v[18:19], v79 offset:9024
  buffer_load_dwordx4 v66, s[60:63], s70 offen offset:2048 lds
  v_mul_u32_u24 v6, 320, v6
  v_add_u32 v6, s23, v6
  v_mfma_f32_32x32x16_bf16 v[176:191], v[48:51], v[28:31], 0
  s_waitcnt lgkmcnt(7)
  ds_read_b64_tr_b16 v[20:21], v79 offset:7296
  ds_read_b64_tr_b16 v[22:23], v79 offset:9088
  s_movk_i32 s21, 3641
  s_movk_i32 s22, 1280
  s_mul_i32 s25, s65, 12
  v_mfma_f32_32x32x16_bf16 v[192:207], v[48:51], v[32:35], 0
  ds_read_b64_tr_b16 v[24:25], v79 offset:7360
  ds_read_b64_tr_b16 v[26:27], v79 offset:9152
  buffer_load_dwordx4 v67, s[60:63], s70 offen offset:3072 lds
  v_mov_b32 v11, 1051597459
  v_add_u32 v7, 0, v5
  v_mfma_f32_32x32x16_bf16 v[208:223], v[48:51], v[36:39], 0
  s_waitcnt lgkmcnt(6)
  ds_read_b64_tr_b16 v[28:29], v79 offset:7424
  ds_read_b64_tr_b16 v[30:31], v79 offset:9216
  v_mul_u32_u24 v8, s21, v7
  v_lshrrev_b32 v8, 16, v8
  v_mul_u32_u24 v9, 18, v8
  v_mfma_f32_32x32x16_bf16 v[224:239], v[48:51], v[40:43], 0
  s_add_u32 m0, s72, 61440
  ds_read_b64_tr_b16 v[32:33], v79 offset:7488
  ds_read_b64_tr_b16 v[34:35], v79 offset:9280
  s_lshl_b32 s69, s66, 7
  buffer_load_dwordx4 v68, s[60:63], s70 offen offset:0 lds
  v_sub_u32 v7, v7, v9
  v_mfma_f32_32x32x16_bf16 v[128:143], v[52:55], v[44:47], v[128:143]
  s_waitcnt lgkmcnt(6)
  ds_read_b64_tr_b16 v[36:37], v79 offset:7552
  ds_read_b64_tr_b16 v[38:39], v79 offset:9344
  v_lshl_add_u32 v7, v7, 4, v6
  v_mad_u32_u24 v81, v8, s22, v7
  v_add_u32 v8, s25, v8
  v_mfma_f32_32x32x16_bf16 v[144:159], v[52:55], v[16:19], v[144:159]
  ds_read_b128 v[56:59], v77 offset:0
  ds_read_b64_tr_b16 v[40:41], v79 offset:14336
  ds_read_b64_tr_b16 v[42:43], v79 offset:16128
  buffer_load_dwordx4 v69, s[60:63], s70 offen offset:1024 lds
  v_cmp_gt_u32 vcc, 32, v8
  v_mfma_f32_32x32x16_bf16 v[160:175], v[52:55], v[20:23], v[160:175]
  s_waitcnt lgkmcnt(7)
  ds_read_b64_tr_b16 v[44:45], v79 offset:14400
  ds_read_b64_tr_b16 v[46:47], v79 offset:16192
  v_cndmask_b32 v88, 1.0, v11, vcc
  v_add_u32 v7, 32, v5
  v_mul_u32_u24 v8, s21, v7
  v_mfma_f32_32x32x16_bf16 v[176:191], v[52:55], v[24:27], v[176:191]
  ds_read_b64_tr_b16 v[16:17], v79 offset:14464
  ds_read_b64_tr_b16 v[18:19], v79 offset:16256
  v_lshrrev_b32 v8, 16, v8
  v_mul_u32_u24 v9, 18, v8
  v_sub_u32 v7, v7, v9
  v_mfma_f32_32x32x16_bf16 v[192:207], v[52:55], v[28:31], v[192:207]
  s_waitcnt lgkmcnt(7)
  ds_read_b64_tr_b16 v[20:21], v79 offset:14528
  ds_read_b64_tr_b16 v[22:23], v79 offset:16320
  buffer_load_dwordx4 v70, s[60:63], s70 offen offset:2048 lds
  v_lshl_add_u32 v7, v7, 4, v6
  v_mad_u32_u24 v82, v8, s22, v7
  v_mfma_f32_32x32x16_bf16 v[208:223], v[52:55], v[32:35], v[208:223]
  s_add_u32 m0, s71, 32768
  ds_read_b64_tr_b16 v[24:25], v79 offset:14592
  ds_read_b64_tr_b16 v[26:27], v79 offset:16384
  v_add_u32 v8, s25, v8
  v_cmp_gt_u32 vcc, 32, v8
  s_nop 1
  v_cndmask_b32 v90, 1.0, v11, vcc
  v_mfma_f32_32x32x16_bf16 v[224:239], v[52:55], v[36:39], v[224:239]
  s_waitcnt lgkmcnt(6)
  ds_read_b64_tr_b16 v[28:29], v79 offset:14656
  ds_read_b64_tr_b16 v[30:31], v79 offset:16448
  s_add_u32 s69, s69, s67
  buffer_load_dwordx4 v71, s[56:59], s69 offen offset:0 lds
  v_add_u32 v7, 64, v5
  v_mfma_f32_32x32x16_bf16 v[128:143], v[56:59], v[40:43], v[128:143]
  ds_read_b64_tr_b16 v[32:33], v79 offset:14720
  ds_read_b64_tr_b16 v[34:35], v79 offset:16512
  v_mul_u32_u24 v8, s21, v7
  v_lshrrev_b32 v8, 16, v8
  v_mul_u32_u24 v9, 18, v8
  v_mfma_f32_32x32x16_bf16 v[144:159], v[56:59], v[44:47], v[144:159]
  s_waitcnt lgkmcnt(6)
  ds_read_b128 v[60:63], v78 offset:0
  ds_read_b64_tr_b16 v[36:37], v79 offset:21504
  ds_read_b64_tr_b16 v[38:39], v79 offset:23296
  buffer_load_dwordx4 v72, s[56:59], s69 offen offset:1024 lds
  v_sub_u32 v7, v7, v9
  v_mfma_f32_32x32x16_bf16 v[160:175], v[56:59], v[16:19], v[160:175]
  ds_read_b64_tr_b16 v[40:41], v79 offset:21568
  ds_read_b64_tr_b16 v[42:43], v79 offset:23360
  v_lshl_add_u32 v7, v7, 4, v6
  v_mad_u32_u24 v83, v8, s22, v7
  v_add_u32 v8, s25, v8
  v_mfma_f32_32x32x16_bf16 v[176:191], v[56:59], v[20:23], v[176:191]
  s_waitcnt lgkmcnt(7)
  ds_read_b64_tr_b16 v[44:45], v79 offset:21632
  ds_read_b64_tr_b16 v[46:47], v79 offset:23424
  buffer_load_dwordx4 v73, s[56:59], s69 offen offset:2048 lds
  v_cmp_gt_u32 vcc, 32, v8
  s_nop 1
  v_cndmask_b32 v92, 1.0, v11, vcc
  v_mfma_f32_32x32x16_bf16 v[192:207], v[56:59], v[24:27], v[192:207]
  ds_read_b64_tr_b16 v[16:17], v79 offset:21696
  ds_read_b64_tr_b16 v[18:19], v79 offset:23488
  v_add_u32 v7, 96, v5
  v_mul_u32_u24 v8, s21, v7
  v_lshrrev_b32 v8, 16, v8
  v_mfma_f32_32x32x16_bf16 v[208:223], v[56:59], v[28:31], v[208:223]
  s_waitcnt lgkmcnt(6)
  ds_read_b64_tr_b16 v[20:21], v79 offset:21760
  ds_read_b64_tr_b16 v[22:23], v79 offset:23552
  buffer_load_dwordx4 v74, s[56:59], s69 offen offset:3072 lds
  s_add_u32 s66, s66, 1
  s_cmp_eq_u32 s66, 9
  s_cselect_b32 s66, 0, s66
  v_mfma_f32_32x32x16_bf16 v[224:239], v[56:59], v[32:35], v[224:239]
  ds_read_b64_tr_b16 v[24:25], v79 offset:21824
  ds_read_b64_tr_b16 v[26:27], v79 offset:23616
  v_mul_u32_u24 v9, 18, v8
  v_sub_u32 v7, v7, v9
  v_lshl_add_u32 v7, v7, 4, v6
  v_mfma_f32_32x32x16_bf16 v[128:143], v[60:63], v[36:39], v[128:143]
  s_waitcnt lgkmcnt(6)
  ds_read_b64_tr_b16 v[28:29], v79 offset:21888
  ds_read_b64_tr_b16 v[30:31], v79 offset:23680
  v_mad_u32_u24 v84, v8, s22, v7
  v_add_u32 v8, s25, v8
  v_cmp_gt_u32 vcc, 32, v8
  v_mfma_f32_32x32x16_bf16 v[144:159], v[60:63], v[40:43], v[144:159]
  s_nop 0
  v_cndmask_b32 v94, 1.0, v11, vcc
  v_add_u32 v7, 128, v5
  v_mul_u32_u24 v8, s21, v7
  v_lshrrev_b32 v8, 16, v8
  v_mul_u32_u24 v9, 18, v8
  v_sub_u32 v7, v7, v9
  v_mfma_f32_32x32x16_bf16 v[160:175], v[60:63], v[44:47], v[160:175]
  s_waitcnt lgkmcnt(4)
  v_lshl_add_u32 v7, v7, 4, v6
  v_mad_u32_u24 v85, v8, s22, v7
  v_add_u32 v8, s25, v8
  v_cmp_gt_u32 vcc, 32, v8
  s_nop 1
  v_cndmask_b32 v96, 1.0, v11, vcc
  v_add_u32 v7, 160, v5
  v_mfma_f32_32x32x16_bf16 v[176:191], v[60:63], v[16:19], v[176:191]
  s_waitcnt vmcnt(11) lgkmcnt(0)
  s_barrier
  ds_read_b128 v[48:51], v75 offset:16384
  ds_read_b64_tr_b16 v[32:33], v79 offset:28672
  ds_read_b64_tr_b16 v[34:35], v79 offset:30464
  ds_read_b64_tr_b16 v[36:37], v79 offset:28736
  ds_read_b64_tr_b16 v[38:39], v79 offset:30528
  v_mfma_f32_32x32x16_bf16 v[192:207], v[60:63], v[20:23], v[192:207]
  s_mul_i32 s70, s66, 221184
  ds_read_b64_tr_b16 v[40:41], v79 offset:28800
  ds_read_b64_tr_b16 v[42:43], v79 offset:30592
  ds_read_b64_tr_b16 v[44:45], v79 offset:28864
  ds_read_b64_tr_b16 v[46:47], v79 offset:30656
  v_mul_u32_u24 v8, s21, v7
  v_mfma_f32_32x32x16_bf16 v[208:223], v[60:63], v[24:27], v[208:223]
  s_add_u32 m0, s72, 0
  ds_read_b64_tr_b16 v[16:17], v79 offset:28928
  ds_read_b64_tr_b16 v[18:19], v79 offset:30720
  s_add_u32 s70, s70, s68
  buffer_load_dwordx4 v64, s[60:63], s70 offen offset:0 lds
  v_lshrrev_b32 v8, 16, v8
  v_mfma_f32_32x32x16_bf16 v[224:239], v[60:63], v[28:31], v[224:239]
  s_waitcnt lgkmcnt(6)
  ds_read_b64_tr_b16 v[20:21], v79 offset:28992
  ds_read_b64_tr_b16 v[22:23], v79 offset:30784
  v_mul_u32_u24 v9, 18, v8
  v_sub_u32 v7, v7, v9
  v_lshl_add_u32 v7, v7, 4, v6
  v_mfma_f32_32x32x16_bf16 v[128:143], v[48:51], v[32:35], v[128:143]
  ds_read_b64_tr_b16 v[24:25], v79 offset:29056
  ds_read_b64_tr_b16 v[26:27], v79 offset:30848
  buffer_load_dwordx4 v65, s[60:63], s70 offen offset:1024 lds
  v_mad_u32_u24 v86, v8, s22, v7
  v_add_u32 v8, s25, v8
  v_mfma_f32_32x32x16_bf16 v[144:159], v[48:51], v[36:39], v[144:159]
  s_waitcnt lgkmcnt(6)
  ds_read_b128 v[52:55], v76 offset:16384
  ds_read_b64_tr_b16 v[28:29], v79 offset:35840
  ds_read_b64_tr_b16 v[30:31], v79 offset:37632
  v_cmp_gt_u32 vcc, 32, v8
  s_nop 1
  v_cndmask_b32 v98, 1.0, v11, vcc
  v_mfma_f32_32x32x16_bf16 v[160:175], v[48:51], v[40:43], v[160:175]
  ds_read_b64_tr_b16 v[32:33], v79 offset:35904
  ds_read_b64_tr_b16 v[34:35], v79 offset:37696
  buffer_load_dwordx4 v66, s[60:63], s70 offen offset:2048 lds
  v_add_u32 v7, 192, v5
  v_mul_u32_u24 v8, s21, v7
  v_mfma_f32_32x32x16_bf16 v[176:191], v[48:51], v[44:47], v[176:191]
  s_waitcnt lgkmcnt(7)
  ds_read_b64_tr_b16 v[36:37], v79 offset:35968
  ds_read_b64_tr_b16 v[38:39], v79 offset:37760
  v_lshrrev_b32 v8, 16, v8
  v_mul_u32_u24 v9, 18, v8
  v_sub_u32 v7, v7, v9
  v_mfma_f32_32x32x16_bf16 v[192:207], v[48:51], v[16:19], v[192:207]
  ds_read_b64_tr_b16 v[40:41], v79 offset:36032
  ds_read_b64_tr_b16 v[42:43], v79 offset:37824
  buffer_load_dwordx4 v67, s[60:63], s70 offen offset:3072 lds
  v_lshl_add_u32 v7, v7, 4, v6
  v_mad_u32_u24 v87, v8, s22, v7
  v_mfma_f32_32x32x16_bf16 v[208:223], v[48:51], v[20:23], v[208:223]
  s_waitcnt lgkmcnt(6)
  ds_read_b64_tr_b16 v[44:45], v79 offset:36096
  ds_read_b64_tr_b16 v[46:47], v79 offset:37888
  v_add_u32 v8, s25, v8
  v_cmp_gt_u32 vcc, 32, v8
  s_nop 1
  v_cndmask_b32 v100, 1.0, v11, vcc
  v_mfma_f32_32x32x16_bf16 v[224:239], v[48:51], v[24:27], v[224:239]
  s_add_u32 m0, s72, 4096
  ds_read_b64_tr_b16 v[16:17], v79 offset:36160
  ds_read_b64_tr_b16 v[18:19], v79 offset:37952
  s_lshl_b32 s69, s66, 7
  buffer_load_dwordx4 v68, s[60:63], s70 offen offset:0 lds
  s_movk_i32 s21, 3277
  v_mfma_f32_32x32x16_bf16 v[128:143], v[52:55], v[28:31], v[128:143]
  s_waitcnt lgkmcnt(6)
  ds_read_b64_tr_b16 v[20:21], v79 offset:36224
  ds_read_b64_tr_b16 v[22:23], v79 offset:38016
  s_mov_b32 s22, 163840
  v_add_u32 v7, 0, v4
  v_mul_u32_u24 v8, s21, v7
  v_mfma_f32_32x32x16_bf16 v[144:159], v[52:55], v[32:35], v[144:159]
  ds_read_b128 v[56:59], v77 offset:16384
  ds_read_b64_tr_b16 v[24:25], v79 offset:43008
  ds_read_b64_tr_b16 v[26:27], v79 offset:44800
  buffer_load_dwordx4 v69, s[60:63], s70 offen offset:1024 lds
  v_lshrrev_b32 v8, 18, v8
  v_mfma_f32_32x32x16_bf16 v[160:175], v[52:55], v[36:39], v[160:175]
  s_waitcnt lgkmcnt(7)
  ds_read_b64_tr_b16 v[28:29], v79 offset:43072
  ds_read_b64_tr_b16 v[30:31], v79 offset:44864
  v_mul_u32_u24 v9, 80, v8
  v_sub_u32 v7, v7, v9
  v_add_u32 v8, s25, v8
  v_mfma_f32_32x32x16_bf16 v[176:191], v[52:55], v[40:43], v[176:191]
  ds_read_b64_tr_b16 v[32:33], v79 offset:43136
  ds_read_b64_tr_b16 v[34:35], v79 offset:44928
  v_lshrrev_b32 v9, 6, v8
  v_mad_u32_u24 v7, v9, 40, v7
  v_mad_u32_u24 v7, v9, 40, v7
  v_mfma_f32_32x32x16_bf16 v[192:207], v[52:55], v[44:47], v[192:207]
  s_waitcnt lgkmcnt(7)
  ds_read_b64_tr_b16 v[36:37], v79 offset:43200
  ds_read_b64_tr_b16 v[38:39], v79 offset:44992
  buffer_load_dwordx4 v70, s[60:63], s70 offen offset:2048 lds
  v_lshlrev_b32 v9, 5, v9
  v_sub_u32 v8, v8, v9
  v_mfma_f32_32x32x16_bf16 v[208:223], v[52:55], v[16:19], v[208:223]
  s_add_u32 m0, s71, 0
  ds_read_b64_tr_b16 v[40:41], v79 offset:43264
  ds_read_b64_tr_b16 v[42:43], v79 offset:45056
  v_lshlrev_b32 v7, 4, v7
  v_mad_u32_u24 v102, v8, s22, v7
  v_add_u32 v7, 64, v4
  v_mfma_f32_32x32x16_bf16 v[224:239], v[52:55], v[20:23], v[224:239]
  s_waitcnt lgkmcnt(6)
  ds_read_b64_tr_b16 v[44:45], v79 offset:43328
  ds_read_b64_tr_b16 v[46:47], v79 offset:45120
  s_add_u32 s69, s69, s67
  buffer_load_dwordx4 v71, s[56:59], s69 offen offset:0 lds
  v_mul_u32_u24 v8, s21, v7
  v_mfma_f32_32x32x16_bf16 v[128:143], v[56:59], v[24:27], v[128:143]
  ds_read_b64_tr_b16 v[16:17], v79 offset:43392
  ds_read_b64_tr_b16 v[18:19], v79 offset:45184
  v_lshrrev_b32 v8, 18, v8
  v_mul_u32_u24 v9, 80, v8
  v_sub_u32 v7, v7, v9
  v_mfma_f32_32x32x16_bf16 v[144:159], v[56:59], v[28:31], v[144:159]
  s_waitcnt lgkmcnt(6)
  ds_read_b128 v[60:63], v78 offset:16384
  ds_read_b64_tr_b16 v[20:21], v79 offset:50176
  ds_read_b64_tr_b16 v[22:23], v79 offset:51968
  buffer_load_dwordx4 v72, s[56:59], s69 offen offset:1024 lds
  v_add_u32 v8, s25, v8
  v_mfma_f32_32x32x16_bf16 v[160:175], v[56:59], v[32:35], v[160:175]
  ds_read_b64_tr_b16 v[24:25], v79 offset:50240
  ds_read_b64_tr_b16 v[26:27], v79 offset:52032
  v_lshrrev_b32 v9, 6, v8
  v_mad_u32_u24 v7, v9, 40, v7
  v_mad_u32_u24 v7, v9, 40, v7
  v_mfma_f32_32x32x16_bf16 v[176:191], v[56:59], v[36:39], v[176:191]
  s_waitcnt lgkmcnt(7)
  ds_read_b64_tr_b16 v[28:29], v79 offset:50304
  ds_read_b64_tr_b16 v[30:31], v79 offset:52096
  buffer_load_dwordx4 v73, s[56:59], s69 offen offset:2048 lds
  v_lshlrev_b32 v9, 5, v9
  v_sub_u32 v8, v8, v9
  v_mfma_f32_32x32x16_bf16 v[192:207], v[56:59], v[40:43], v[192:207]
  ds_read_b64_tr_b16 v[32:33], v79 offset:50368
  ds_read_b64_tr_b16 v[34:35], v79 offset:52160
  v_lshlrev_b32 v7, 4, v7
  v_mad_u32_u24 v103, v8, s22, v7
  v_add_u32 v7, 128, v4
  v_mfma_f32_32x32x16_bf16 v[208:223], v[56:59], v[44:47], v[208:223]
  s_waitcnt lgkmcnt(6)
  ds_read_b64_tr_b16 v[36:37], v79 offset:50432
  ds_read_b64_tr_b16 v[38:39], v79 offset:52224
  buffer_load_dwordx4 v74, s[56:59], s69 offen offset:3072 lds
  s_add_u32 s66, s66, 1
  s_cmp_eq_u32 s66, 9
  s_cselect_b32 s66, 0, s66
  v_mfma_f32_32x32x16_bf16 v[224:239], v[56:59], v[16:19], v[224:239]
  ds_read_b64_tr_b16 v[40:41], v79 offset:50496
  ds_read_b64_tr_b16 v[42:43], v79 offset:52288
  v_mul_u32_u24 v8, s21, v7
  v_lshrrev_b32 v8, 18, v8
  v_mul_u32_u24 v9, 80, v8
  v_mfma_f32_32x32x16_bf16 v[128:143], v[60:63], v[20:23], v[128:143]
  s_waitcnt lgkmcnt(6)
  ds_read_b64_tr_b16 v[44:45], v79 offset:50560
  ds_read_b64_tr_b16 v[46:47], v79 offset:52352
  v_sub_u32 v7, v7, v9
  v_add_u32 v8, s25, v8
  v_lshrrev_b32 v9, 6, v8
  v_mfma_f32_32x32x16_bf16 v[144:159], v[60:63], v[24:27], v[144:159]
  v_mad_u32_u24 v7, v9, 40, v7
  v_mad_u32_u24 v7, v9, 40, v7
  v_lshlrev_b32 v9, 5, v9
  v_sub_u32 v8, v8, v9
  v_lshlrev_b32 v7, 4, v7
  v_mad_u32_u24 v104, v8, s22, v7
  v_mfma_f32_32x32x16_bf16 v[160:175], v[60:63], v[28:31], v[160:175]
  s_waitcnt lgkmcnt(4)
  v_add_u32 v7, 192, v4
  v_mul_u32_u24 v8, s21, v7
  v_lshrrev_b32 v8, 18, v8
  v_mul_u32_u24 v9, 80, v8
  v_sub_u32 v7, v7, v9
  v_add_u32 v8, s25, v8
  v_mfma_f32_32x32x16_bf16 v[176:191], v[60:63], v[32:35], v[176:191]
  s_waitcnt vmcnt(11) lgkmcnt(0)
  s_barrier
  ds_read_b128 v[48:51], v75 offset:32768
  ds_read_b64_tr_b16 v[16:17], v80 offset:0
  ds_read_b64_tr_b16 v[18:19], v80 offset:1792
  ds_read_b64_tr_b16 v[20:21], v80 offset:64
  ds_read_b64_tr_b16 v[22:23], v80 offset:1856
  v_mfma_f32_32x32x16_bf16 v[192:207], v[60:63], v[36:39], v[192:207]
  s_mul_i32 s70, s66, 221184
  ds_read_b64_tr_b16 v[24:25], v80 offset:128
  ds_read_b64_tr_b16 v[26:27], v80 offset:1920
  ds_read_b64_tr_b16 v[28:29], v80 offset:192
  ds_read_b64_tr_b16 v[30:31], v80 offset:1984
  v_lshrrev_b32 v9, 6, v8
  v_mfma_f32_32x32x16_bf16 v[208:223], v[60:63], v[40:43], v[208:223]
  s_add_u32 m0, s72, 28672
  ds_read_b64_tr_b16 v[32:33], v80 offset:256
  ds_read_b64_tr_b16 v[34:35], v80 offset:2048
  s_add_u32 s70, s70, s68
  buffer_load_dwordx4 v64, s[60:63], s70 offen offset:0 lds
  v_mad_u32_u24 v7, v9, 40, v7
  v_mfma_f32_32x32x16_bf16 v[224:239], v[60:63], v[44:47], v[224:239]
  s_waitcnt lgkmcnt(6)
  ds_read_b64_tr_b16 v[36:37], v80 offset:320
  ds_read_b64_tr_b16 v[38:39], v80 offset:2112
  v_mad_u32_u24 v7, v9, 40, v7
  v_lshlrev_b32 v9, 5, v9
  v_sub_u32 v8, v8, v9
  v_mfma_f32_32x32x16_bf16 v[128:143], v[48:51], v[16:19], v[128:143]
  ds_read_b64_tr_b16 v[40:41], v80 offset:384
  ds_read_b64_tr_b16 v[42:43], v80 offset:2176
  buffer_load_dwordx4 v65, s[60:63], s70 offen offset:1024 lds
  v_lshlrev_b32 v7, 4, v7
  v_mad_u32_u24 v105, v8, s22, v7
  v_mfma_f32_32x32x16_bf16 v[144:159], v[48:51], v[20:23], v[144:159]
  s_waitcnt lgkmcnt(6)
  ds_read_b128 v[52:55], v76 offset:32768
  ds_read_b64_tr_b16 v[44:45], v80 offset:7168
  ds_read_b64_tr_b16 v[46:47], v80 offset:8960
  v_add_u32 v7, 256, v4
  v_mul_u32_u24 v8, s21, v7
  v_mfma_f32_32x32x16_bf16 v[160:175], v[48:51], v[24:27], v[160:175]
  ds_read_b64_tr_b16 v[16:17], v80 offset:7232
  ds_read_b64_tr_b16 v[18:19], v80 offset:9024
  buffer_load_dwordx4 v66, s[60:63], s70 offen offset:2048 lds
  v_lshrrev_b32 v8, 18, v8
  v_mul_u32_u24 v9, 80, v8
  v_mfma_f32_32x32x16_bf16 v[176:191], v[48:51], v[28:31], v[176:191]
  s_waitcnt lgkmcnt(7)
  ds_read_b64_tr_b16 v[20:21], v80 offset:7296
  ds_read_b64_tr_b16 v[22:23], v80 offset:9088
  v_sub_u32 v7, v7, v9
  v_add_u32 v8, s25, v8
  v_lshrrev_b32 v9, 6, v8
  v_mfma_f32_32x32x16_bf16 v[192:207], v[48:51], v[32:35], v[192:207]
  ds_read_b64_tr_b16 v[24:25], v80 offset:7360
  ds_read_b64_tr_b16 v[26:27], v80 offset:9152
  buffer_load_dwordx4 v67, s[60:63], s70 offen offset:3072 lds
  v_mad_u32_u24 v7, v9, 40, v7
  v_mad_u32_u24 v7, v9, 40, v7
  v_mfma_f32_32x32x16_bf16 v[208:223], v[48:51], v[36:39], v[208:223]
  s_waitcnt lgkmcnt(6)
  ds_read_b64_tr_b16 v[28:29], v80 offset:7424
  ds_read_b64_tr_b16 v[30:31], v80 offset:9216
  v_lshlrev_b32 v9, 5, v9
  v_sub_u32 v8, v8, v9
  v_lshlrev_b32 v7, 4, v7
  v_mfma_f32_32x32x16_bf16 v[224:239], v[48:51], v[40:43], v[224:239]
  s_add_u32 m0, s72, 32768
  ds_read_b64_tr_b16 v[32:33], v80 offset:7488
  ds_read_b64_tr_b16 v[34:35], v80 offset:9280
  s_lshl_b32 s69, s66, 7
  buffer_load_dwordx4 v68, s[60:63], s70 offen offset:0 lds
  v_mad_u32_u24 v106, v8, s22, v7
  v_mfma_f32_32x32x16_bf16 v[128:143], v[52:55], v[44:47], v[128:143]
  s_waitcnt lgkmcnt(6)
  ds_read_b64_tr_b16 v[36:37], v80 offset:7552
  ds_read_b64_tr_b16 v[38:39], v80 offset:9344
  v_add_u32 v7, 320, v4
  v_mul_u32_u24 v8, s21, v7
  v_lshrrev_b32 v8, 18, v8
  v_mfma_f32_32x32x16_bf16 v[144:159], v[52:55], v[16:19], v[144:159]
  ds_read_b128 v[56:59], v77 offset:32768
  ds_read_b64_tr_b16 v[40:41], v80 offset:14336
  ds_read_b64_tr_b16 v[42:43], v80 offset:16128
  buffer_load_dwordx4 v69, s[60:63], s70 offen offset:1024 lds
  v_mul_u32_u24 v9, 80, v8
  v_mfma_f32_32x32x16_bf16 v[160:175], v[52:55], v[20:23], v[160:175]
  s_waitcnt lgkmcnt(7)
  ds_read_b64_tr_b16 v[44:45], v80 offset:14400
  ds_read_b64_tr_b16 v[46:47], v80 offset:16192
  v_sub_u32 v7, v7, v9
  v_add_u32 v8, s25, v8
  v_lshrrev_b32 v9, 6, v8
  v_mfma_f32_32x32x16_bf16 v[176:191], v[52:55], v[24:27], v[176:191]
  ds_read_b64_tr_b16 v[16:17], v80 offset:14464
  ds_read_b64_tr_b16 v[18:19], v80 offset:16256
  v_mad_u32_u24 v7, v9, 40, v7
  v_mad_u32_u24 v7, v9, 40, v7
  v_lshlrev_b32 v9, 5, v9
  v_mfma_f32_32x32x16_bf16 v[192:207], v[52:55], v[28:31], v[192:207]
  s_waitcnt lgkmcnt(7)
  ds_read_b64_tr_b16 v[20:21], v80 offset:14528
  ds_read_b64_tr_b16 v[22:23], v80 offset:16320
  buffer_load_dwordx4 v70, s[60:63], s70 offen offset:2048 lds
  v_sub_u32 v8, v8, v9
  v_lshlrev_b32 v7, 4, v7
  v_mfma_f32_32x32x16_bf16 v[208:223], v[52:55], v[32:35], v[208:223]
  s_add_u32 m0, s71, 16384
  ds_read_b64_tr_b16 v[24:25], v80 offset:14592
  ds_read_b64_tr_b16 v[26:27], v80 offset:16384
  v_mad_u32_u24 v107, v8, s22, v7
  v_add_u32 v7, 384, v4
  v_mul_u32_u24 v8, s21, v7
  v_mfma_f32_32x32x16_bf16 v[224:239], v[52:55], v[36:39], v[224:239]
  s_waitcnt lgkmcnt(6)
  ds_read_b64_tr_b16 v[28:29], v80 offset:14656
  ds_read_b64_tr_b16 v[30:31], v80 offset:16448
  s_add_u32 s69, s69, s67
  buffer_load_dwordx4 v71, s[56:59], s69 offen offset:0 lds
  v_lshrrev_b32 v8, 18, v8
  v_mfma_f32_32x32x16_bf16 v[128:143], v[56:59], v[40:43], v[128:143]
  ds_read_b64_tr_b16 v[32:33], v80 offset:14720
  ds_read_b64_tr_b16 v[34:35], v80 offset:16512
  v_mul_u32_u24 v9, 80, v8
  v_sub_u32 v7, v7, v9
  v_add_u32 v8, s25, v8
  v_mfma_f32_32x32x16_bf16 v[144:159], v[56:59], v[44:47], v[144:159]
  s_waitcnt lgkmcnt(6)
  ds_read_b128 v[60:63], v78 offset:32768
  ds_read_b64_tr_b16 v[36:37], v80 offset:21504
  ds_read_b64_tr_b16 v[38:39], v80 offset:23296
  buffer_load_dwordx4 v72, s[56:59], s69 offen offset:1024 lds
  v_lshrrev_b32 v9, 6, v8
  v_mfma_f32_32x32x16_bf16 v[160:175], v[56:59], v[16:19], v[160:175]
  ds_read_b64_tr_b16 v[40:41], v80 offset:21568
  ds_read_b64_tr_b16 v[42:43], v80 offset:23360
  v_mad_u32_u24 v7, v9, 40, v7
  v_mad_u32_u24 v7, v9, 40, v7
  v_lshlrev_b32 v9, 5, v9
  v_mfma_f32_32x32x16_bf16 v[176:191], v[56:59], v[20:23], v[176:191]
  s_waitcnt lgkmcnt(7)
  ds_read_b64_tr_b16 v[44:45], v80 offset:21632
  ds_read_b64_tr_b16 v[46:47], v80 offset:23424
  buffer_load_dwordx4 v73, s[56:59], s69 offen offset:2048 lds
  v_sub_u32 v8, v8, v9
  v_lshlrev_b32 v7, 4, v7
  v_mfma_f32_32x32x16_bf16 v[192:207], v[56:59], v[24:27], v[192:207]
  ds_read_b64_tr_b16 v[16:17], v80 offset:21696
  ds_read_b64_tr_b16 v[18:19], v80 offset:23488
  v_mad_u32_u24 v108, v8, s22, v7
  v_add_u32 v7, 448, v4
  v_mul_u32_u24 v8, s21, v7
  v_mfma_f32_32x32x16_bf16 v[208:223], v[56:59], v[28:31], v[208:223]
  s_waitcnt lgkmcnt(6)
  ds_read_b64_tr_b16 v[20:21], v80 offset:21760
  ds_read_b64_tr_b16 v[22:23], v80 offset:23552
  buffer_load_dwordx4 v74, s[56:59], s69 offen offset:3072 lds
  s_add_u32 s66, s66, 1
  s_cmp_eq_u32 s66, 9
  s_cselect_b32 s66, 0, s66
  v_mfma_f32_32x32x16_bf16 v[224:239], v[56:59], v[32:35], v[224:239]
  ds_read_b64_tr_b16 v[24:25], v80 offset:21824
  ds_read_b64_tr_b16 v[26:27], v80 offset:23616
  v_lshrrev_b32 v8, 18, v8
  v_mul_u32_u24 v9, 80, v8
  v_sub_u32 v7, v7, v9
  v_mfma_f32_32x32x16_bf16 v[128:143], v[60:63], v[36:39], v[128:143]
  s_waitcnt lgkmcnt(6)
  ds_read_b64_tr_b16 v[28:29], v80 offset:21888
  ds_read_b64_tr_b16 v[30:31], v80 offset:23680
  v_add_u32 v8, s25, v8
  v_lshrrev_b32 v9, 6, v8
  v_mad_u32_u24 v7, v9, 40, v7
  v_mfma_f32_32x32x16_bf16 v[144:159], v[60:63], v[40:43], v[144:159]
  buffer_load_dword v120, v121, s[12:15], 0 offen sc1
  v_mad_u32_u24 v7, v9, 40, v7
  v_lshlrev_b32 v9, 5, v9
  v_sub_u32 v8, v8, v9
  v_lshlrev_b32 v7, 4, v7
  v_mad_u32_u24 v109, v8, s22, v7
  v_mfma_f32_32x32x16_bf16 v[160:175], v[60:63], v[44:47], v[160:175]
  s_waitcnt lgkmcnt(4)
  v_add_u32 v7, 512, v4
  v_mul_u32_u24 v8, s21, v7
  v_lshrrev_b32 v8, 18, v8
  v_mul_u32_u24 v9, 80, v8
  v_sub_u32 v7, v7, v9
  v_add_u32 v8, s25, v8
  v_mfma_f32_32x32x16_bf16 v[176:191], v[60:63], v[16:19], v[176:191]
  s_waitcnt vmcnt(12) lgkmcnt(0)
  s_barrier
  ds_read_b128 v[48:51], v75 offset:0
  ds_read_b64_tr_b16 v[32:33], v79 offset:0
  ds_read_b64_tr_b16 v[34:35], v79 offset:1792
  ds_read_b64_tr_b16 v[36:37], v79 offset:64
  ds_read_b64_tr_b16 v[38:39], v79 offset:1856
  v_mfma_f32_32x32x16_bf16 v[192:207], v[60:63], v[20:23], v[192:207]
  s_mul_i32 s70, s66, 221184
  ds_read_b64_tr_b16 v[40:41], v79 offset:128
  ds_read_b64_tr_b16 v[42:43], v79 offset:1920
  ds_read_b64_tr_b16 v[44:45], v79 offset:192
  ds_read_b64_tr_b16 v[46:47], v79 offset:1984
  v_lshrrev_b32 v9, 6, v8
  v_mfma_f32_32x32x16_bf16 v[208:223], v[60:63], v[24:27], v[208:223]
  s_add_u32 m0, s72, 57344
  ds_read_b64_tr_b16 v[16:17], v79 offset:256
  ds_read_b64_tr_b16 v[18:19], v79 offset:2048
  s_add_u32 s70, s70, s68
  buffer_load_dwordx4 v64, s[60:63], s70 offen offset:0 lds
  v_mad_u32_u24 v7, v9, 40, v7
  v_mfma_f32_32x32x16_bf16 v[224:239], v[60:63], v[28:31], v[224:239]
  s_waitcnt lgkmcnt(6)
  ds_read_b64_tr_b16 v[20:21], v79 offset:320
  ds_read_b64_tr_b16 v[22:23], v79 offset:2112
  v_mad_u32_u24 v7, v9, 40, v7
  v_lshlrev_b32 v9, 5, v9
  v_sub_u32 v8, v8, v9
  v_mfma_f32_32x32x16_bf16 v[128:143], v[48:51], v[32:35], v[128:143]
  ds_read_b64_tr_b16 v[24:25], v79 offset:384
  ds_read_b64_tr_b16 v[26:27], v79 offset:2176
  buffer_load_dwordx4 v65, s[60:63], s70 offen offset:1024 lds
  v_lshlrev_b32 v7, 4, v7
  v_mad_u32_u24 v110, v8, s22, v7
  v_mfma_f32_32x32x16_bf16 v[144:159], v[48:51], v[36:39], v[144:159]
  s_waitcnt lgkmcnt(6)
  ds_read_b128 v[52:55], v76 offset:0
  ds_read_b64_tr_b16 v[28:29], v79 offset:7168
  ds_read_b64_tr_b16 v[30:31], v79 offset:8960
  v_add_u32 v7, 576, v4
  v_mul_u32_u24 v8, s21, v7
  v_mfma_f32_32x32x16_bf16 v[160:175], v[48:51], v[40:43], v[160:175]
  ds_read_b64_tr_b16 v[32:33], v79 offset:7232
  ds_read_b64_tr_b16 v[34:35], v79 offset:9024
  buffer_load_dwordx4 v66, s[60:63], s70 offen offset:2048 lds
  v_lshrrev_b32 v8, 18, v8
  v_mul_u32_u24 v9, 80, v8
  v_mfma_f32_32x32x16_bf16 v[176:191], v[48:51], v[44:47], v[176:191]
  s_waitcnt lgkmcnt(7)
  ds_read_b64_tr_b16 v[36:37], v79 offset:7296
  ds_read_b64_tr_b16 v[38:39], v79 offset:9088
  v_sub_u32 v7, v7, v9
  v_add_u32 v8, s25, v8
  v_lshrrev_b32 v9, 6, v8
  v_mfma_f32_32x32x16_bf16 v[192:207], v[48:51], v[16:19], v[192:207]
  ds_read_b64_tr_b16 v[40:41], v79 offset:7360
  ds_read_b64_tr_b16 v[42:43], v79 offset:9152
  buffer_load_dwordx4 v67, s[60:63], s70 offen offset:3072 lds
  v_mad_u32_u24 v7, v9, 40, v7
  v_mad_u32_u24 v7, v9, 40, v7
  v_mfma_f32_32x32x16_bf16 v[208:223], v[48:51], v[20:23], v[208:223]
  s_waitcnt lgkmcnt(6)
  ds_read_b64_tr_b16 v[44:45], v79 offset:7424
  ds_read_b64_tr_b16 v[46:47], v79 offset:9216
  v_lshlrev_b32 v9, 5, v9
  v_sub_u32 v8, v8, v9
  v_lshlrev_b32 v7, 4, v7
  v_mfma_f32_32x32x16_bf16 v[224:239], v[48:51], v[24:27], v[224:239]
  s_add_u32 m0, s72, 61440
  ds_read_b64_tr_b16 v[16:17], v79 offset:7488
  ds_read_b64_tr_b16 v[18:19], v79 offset:9280
  s_lshl_b32 s69, s66, 7
  buffer_load_dwordx4 v68, s[60:63], s70 offen offset:0 lds
  v_mad_u32_u24 v111, v8, s22, v7
  v_mfma_f32_32x32x16_bf16 v[128:143], v[52:55], v[28:31], v[128:143]
  s_waitcnt lgkmcnt(6)
  ds_read_b64_tr_b16 v[20:21], v79 offset:7552
  ds_read_b64_tr_b16 v[22:23], v79 offset:9344
  v_add_u32 v7, 640, v4
  v_mul_u32_u24 v8, s21, v7
  v_lshrrev_b32 v8, 18, v8
  v_mfma_f32_32x32x16_bf16 v[144:159], v[52:55], v[32:35], v[144:159]
  ds_read_b128 v[56:59], v77 offset:0
  ds_read_b64_tr_b16 v[24:25], v79 offset:14336
  ds_read_b64_tr_b16 v[26:27], v79 offset:16128
  buffer_load_dwordx4 v69, s[60:63], s70 offen offset:1024 lds
  v_mul_u32_u24 v9, 80, v8
  v_mfma_f32_32x32x16_bf16 v[160:175], v[52:55], v[36:39], v[160:175]
  s_waitcnt lgkmcnt(7)
  ds_read_b64_tr_b16 v[28:29], v79 offset:14400
  ds_read_b64_tr_b16 v[30:31], v79 offset:16192
  v_sub_u32 v7, v7, v9
  v_add_u32 v8, s25, v8
  v_lshrrev_b32 v9, 6, v8
  v_mfma_f32_32x32x16_bf16 v[176:191], v[52:55], v[40:43], v[176:191]
  ds_read_b64_tr_b16 v[32:33], v79 offset:14464
  ds_read_b64_tr_b16 v[34:35], v79 offset:16256
  v_mad_u32_u24 v7, v9, 40, v7
  v_mad_u32_u24 v7, v9, 40, v7
  v_lshlrev_b32 v9, 5, v9
  v_mfma_f32_32x32x16_bf16 v[192:207], v[52:55], v[44:47], v[192:207]
  s_waitcnt lgkmcnt(7)
  ds_read_b64_tr_b16 v[36:37], v79 offset:14528
  ds_read_b64_tr_b16 v[38:39], v79 offset:16320
  buffer_load_dwordx4 v70, s[60:63], s70 offen offset:2048 lds
  v_sub_u32 v8, v8, v9
  v_lshlrev_b32 v7, 4, v7
  v_mfma_f32_32x32x16_bf16 v[208:223], v[52:55], v[16:19], v[208:223]
  s_add_u32 m0, s71, 32768
  ds_read_b64_tr_b16 v[40:41], v79 offset:14592
  ds_read_b64_tr_b16 v[42:43], v79 offset:16384
  v_mad_u32_u24 v112, v8, s22, v7
  v_add_u32 v7, 704, v4
  v_mul_u32_u24 v8, s21, v7
  v_mfma_f32_32x32x16_bf16 v[224:239], v[52:55], v[20:23], v[224:239]
  s_waitcnt lgkmcnt(6)
  ds_read_b64_tr_b16 v[44:45], v79 offset:14656
  ds_read_b64_tr_b16 v[46:47], v79 offset:16448
  s_add_u32 s69, s69, s67
  buffer_load_dwordx4 v71, s[56:59], s69 offen offset:0 lds
  v_lshrrev_b32 v8, 18, v8
  v_mfma_f32_32x32x16_bf16 v[128:143], v[56:59], v[24:27], v[128:143]
  ds_read_b64_tr_b16 v[16:17], v79 offset:14720
  ds_read_b64_tr_b16 v[18:19], v79 offset:16512
  v_mul_u32_u24 v9, 80, v8
  v_sub_u32 v7, v7, v9
  v_add_u32 v8, s25, v8
  v_mfma_f32_32x32x16_bf16 v[144:159], v[56:59], v[28:31], v[144:159]
  s_waitcnt lgkmcnt(6)
  ds_read_b128 v[60:63], v78 offset:0
  ds_read_b64_tr_b16 v[20:21], v79 offset:21504
  ds_read_b64_tr_b16 v[22:23], v79 offset:23296
  buffer_load_dwordx4 v72, s[56:59], s69 offen offset:1024 lds
  v_lshrrev_b32 v9, 6, v8
  v_mfma_f32_32x32x16_bf16 v[160:175], v[56:59], v[32:35], v[160:175]
  ds_read_b64_tr_b16 v[24:25], v79 offset:21568
  ds_read_b64_tr_b16 v[26:27], v79 offset:23360
  v_mad_u32_u24 v7, v9, 40, v7
  v_mad_u32_u24 v7, v9, 40, v7
  v_lshlrev_b32 v9, 5, v9
  v_mfma_f32_32x32x16_bf16 v[176:191], v[56:59], v[36:39], v[176:191]
  s_waitcnt lgkmcnt(7)
  ds_read_b64_tr_b16 v[28:29], v79 offset:21632
  ds_read_b64_tr_b16 v[30:31], v79 offset:23424
  buffer_load_dwordx4 v73, s[56:59], s69 offen offset:2048 lds
  v_sub_u32 v8, v8, v9
  v_lshlrev_b32 v7, 4, v7
  v_mfma_f32_32x32x16_bf16 v[192:207], v[56:59], v[40:43], v[192:207]
  ds_read_b64_tr_b16 v[32:33], v79 offset:21696
  ds_read_b64_tr_b16 v[34:35], v79 offset:23488
  v_mad_u32_u24 v113, v8, s22, v7
  v_add_u32 v7, 768, v4
  v_mul_u32_u24 v8, s21, v7
  v_mfma_f32_32x32x16_bf16 v[208:223], v[56:59], v[44:47], v[208:223]
  s_waitcnt lgkmcnt(6)
  ds_read_b64_tr_b16 v[36:37], v79 offset:21760
  ds_read_b64_tr_b16 v[38:39], v79 offset:23552
  buffer_load_dwordx4 v74, s[56:59], s69 offen offset:3072 lds
  s_add_u32 s66, s66, 1
  s_cmp_eq_u32 s66, 9
  s_cselect_b32 s66, 0, s66
  v_mfma_f32_32x32x16_bf16 v[224:239], v[56:59], v[16:19], v[224:239]
  ds_read_b64_tr_b16 v[40:41], v79 offset:21824
  ds_read_b64_tr_b16 v[42:43], v79 offset:23616
  v_lshrrev_b32 v8, 18, v8
  v_mul_u32_u24 v9, 80, v8
  v_sub_u32 v7, v7, v9
  v_mfma_f32_32x32x16_bf16 v[128:143], v[60:63], v[20:23], v[128:143]
  s_waitcnt lgkmcnt(6)
  ds_read_b64_tr_b16 v[44:45], v79 offset:21888
  ds_read_b64_tr_b16 v[46:47], v79 offset:23680
  v_add_u32 v8, s25, v8
  v_lshrrev_b32 v9, 6, v8
  v_mad_u32_u24 v7, v9, 40, v7
  v_mfma_f32_32x32x16_bf16 v[144:159], v[60:63], v[24:27], v[144:159]
  v_mad_u32_u24 v7, v9, 40, v7
  v_lshlrev_b32 v9, 5, v9
  v_sub_u32 v8, v8, v9
  v_lshlrev_b32 v7, 4, v7
  v_mad_u32_u24 v114, v8, s22, v7
  v_add_u32 v7, 832, v4
  v_mfma_f32_32x32x16_bf16 v[160:175], v[60:63], v[28:31], v[160:175]
  s_waitcnt lgkmcnt(4)
  v_mul_u32_u24 v8, s21, v7
  v_lshrrev_b32 v8, 18, v8
  v_mul_u32_u24 v9, 80, v8
  v_sub_u32 v7, v7, v9
  v_add_u32 v8, s25, v8
  v_lshrrev_b32 v9, 6, v8
  v_mfma_f32_32x32x16_bf16 v[176:191], v[60:63], v[32:35], v[176:191]
  s_waitcnt vmcnt(12) lgkmcnt(0)
  s_barrier
  ds_read_b128 v[48:51], v75 offset:16384
  ds_read_b64_tr_b16 v[16:17], v79 offset:28672
  ds_read_b64_tr_b16 v[18:19], v79 offset:30464
  ds_read_b64_tr_b16 v[20:21], v79 offset:28736
  ds_read_b64_tr_b16 v[22:23], v79 offset:30528
  v_mfma_f32_32x32x16_bf16 v[192:207], v[60:63], v[36:39], v[192:207]
  s_mul_i32 s70, s66, 221184
  ds_read_b64_tr_b16 v[24:25], v79 offset:28800
  ds_read_b64_tr_b16 v[26:27], v79 offset:30592
  ds_read_b64_tr_b16 v[28:29], v79 offset:28864
  ds_read_b64_tr_b16 v[30:31], v79 offset:30656
  v_mad_u32_u24 v7, v9, 40, v7
  v_mfma_f32_32x32x16_bf16 v[208:223], v[60:63], v[40:43], v[208:223]
  s_add_u32 m0, s72, 0
  ds_read_b64_tr_b16 v[32:33], v79 offset:28928
  ds_read_b64_tr_b16 v[34:35], v79 offset:30720
  s_add_u32 s70, s70, s68
  buffer_load_dwordx4 v64, s[60:63], s70 offen offset:0 lds
  v_mad_u32_u24 v7, v9, 40, v7
  v_mfma_f32_32x32x16_bf16 v[224:239], v[60:63], v[44:47], v[224:239]
  s_waitcnt lgkmcnt(6)
  ds_read_b64_tr_b16 v[36:37], v79 offset:28992
  ds_read_b64_tr_b16 v[38:39], v79 offset:30784
  v_lshlrev_b32 v9, 5, v9
  v_sub_u32 v8, v8, v9
  v_lshlrev_b32 v7, 4, v7
  v_mfma_f32_32x32x16_bf16 v[128:143], v[48:51], v[16:19], v[128:143]
  ds_read_b64_tr_b16 v[40:41], v79 offset:29056
  ds_read_b64_tr_b16 v[42:43], v79 offset:30848
  buffer_load_dwordx4 v65, s[60:63], s70 offen offset:1024 lds
  v_mad_u32_u24 v115, v8, s22, v7
  v_add_u32 v7, 896, v4
  v_mfma_f32_32x32x16_bf16 v[144:159], v[48:51], v[20:23], v[144:159]
  s_waitcnt lgkmcnt(6)
  ds_read_b128 v[52:55], v76 offset:16384
  ds_read_b64_tr_b16 v[44:45], v79 offset:35840
  ds_read_b64_tr_b16 v[46:47], v79 offset:37632
  v_mul_u32_u24 v8, s21, v7
  v_lshrrev_b32 v8, 18, v8
  v_mfma_f32_32x32x16_bf16 v[160:175], v[48:51], v[24:27], v[160:175]
  ds_read_b64_tr_b16 v[16:17], v79 offset:35904
  ds_read_b64_tr_b16 v[18:19], v79 offset:37696
  buffer_load_dwordx4 v66, s[60:63], s70 offen offset:2048 lds
  v_mul_u32_u24 v9, 80, v8
  v_sub_u32 v7, v7, v9
  v_mfma_f32_32x32x16_bf16 v[176:191], v[48:51], v[28:31], v[176:191]
  s_waitcnt lgkmcnt(7)
  ds_read_b64_tr_b16 v[20:21], v79 offset:35968
  ds_read_b64_tr_b16 v[22:23], v79 offset:37760
  v_add_u32 v8, s25, v8
  v_lshrrev_b32 v9, 6, v8
  v_mad_u32_u24 v7, v9, 40, v7
  v_mfma_f32_32x32x16_bf16 v[192:207], v[48:51], v[32:35], v[192:207]
  ds_read_b64_tr_b16 v[24:25], v79 offset:36032
  ds_read_b64_tr_b16 v[26:27], v79 offset:37824
  buffer_load_dwordx4 v67, s[60:63], s70 offen offset:3072 lds
  v_mad_u32_u24 v7, v9, 40, v7
  v_lshlrev_b32 v9, 5, v9
  v_mfma_f32_32x32x16_bf16 v[208:223], v[48:51], v[36:39], v[208:223]
  s_waitcnt lgkmcnt(6)
  ds_read_b64_tr_b16 v[28:29], v79 offset:36096
  ds_read_b64_tr_b16 v[30:31], v79 offset:37888
  v_sub_u32 v8, v8, v9
  v_lshlrev_b32 v7, 4, v7
  v_mad_u32_u24 v116, v8, s22, v7
  v_mfma_f32_32x32x16_bf16 v[224:239], v[48:51], v[40:43], v[224:239]
  s_add_u32 m0, s72, 4096
  ds_read_b64_tr_b16 v[32:33], v79 offset:36160
  ds_read_b64_tr_b16 v[34:35], v79 offset:37952
  s_lshl_b32 s69, s66, 7
  buffer_load_dwordx4 v68, s[60:63], s70 offen offset:0 lds
  v_lshlrev_b32 v117, 4, v4
  v_mfma_f32_32x32x16_bf16 v[128:143], v[52:55], v[44:47], v[128:143]
  s_waitcnt lgkmcnt(6)
  ds_read_b64_tr_b16 v[36:37], v79 offset:36224
  ds_read_b64_tr_b16 v[38:39], v79 offset:38016
  v_add_u32 v117, s23, v117
  s_movk_i32 s22, 1280
  v_mov_b32 v11, 1065369472
  v_mfma_f32_32x32x16_bf16 v[144:159], v[52:55], v[16:19], v[144:159]
  ds_read_b128 v[56:59], v77 offset:16384
  ds_read_b64_tr_b16 v[40:41], v79 offset:43008
  ds_read_b64_tr_b16 v[42:43], v79 offset:44800
  buffer_load_dwordx4 v69, s[60:63], s70 offen offset:1024 lds
  v_lshrrev_b32 v7, 3, v4
  v_mfma_f32_32x32x16_bf16 v[160:175], v[52:55], v[20:23], v[160:175]
  s_waitcnt lgkmcnt(7)
  ds_read_b64_tr_b16 v[44:45], v79 offset:43072
  ds_read_b64_tr_b16 v[46:47], v79 offset:44864
  s_waitcnt vmcnt(17)
  s_mov_b32 s75, 1048576
L_a1_non:
  v_readfirstlane_b32 s3, v120
  s_sub_u32 s75, s75, 1
  s_cmp_lg_u32 s3, 0
  s_cbranch_scc1 L_a1_non_d
  s_cmp_eq_u32 s75, 0
  s_cbranch_scc1 L_a1_non_d
  buffer_load_dword v120, v121, s[12:15], 0 offen sc1
  s_waitcnt vmcnt(0)
  s_branch L_a1_non
L_a1_non_d:
  s_cmp_ge_u32 s74, 72
  s_cbranch_scc1 L_a1_nw
  v_mov_b32 v248, 0
  v_mov_b32 v249, 0
  v_mov_b32 v252, 1065369472
  v_accvgpr_read_b32 v250, a0
  v_dot2c_f32_bf16 v248, v250, v252
  v_accvgpr_read_b32 v251, a1
  v_dot2c_f32_bf16 v249, v251, v252
  v_accvgpr_read_b32 v250, a2
  v_dot2c_f32_bf16 v248, v250, v252
  v_accvgpr_read_b32 v251, a3
  v_dot2c_f32_bf16 v249, v251, v252
  v_accvgpr_read_b32 v250, a4
  v_dot2c_f32_bf16 v248, v250, v252
  v_accvgpr_read_b32 v251, a5
  v_dot2c_f32_bf16 v249, v251, v252
  v_accvgpr_read_b32 v250, a6
  v_dot2c_f32_bf16 v248, v250, v252
  v_accvgpr_read_b32 v251, a7
  v_dot2c_f32_bf16 v249, v251, v252
  v_accvgpr_read_b32 v250, a8
  v_dot2c_f32_bf16 v248, v250, v252
  v_accvgpr_read_b32 v251, a9
  v_dot2c_f32_bf16 v249, v251, v252
  v_accvgpr_read_b32 v250, a10
  v_dot2c_f32_bf16 v248, v250, v252
  v_accvgpr_read_b32 v251, a11
  v_dot2c_f32_bf16 v249, v251, v252
  v_accvgpr_read_b32 v250, a12
  v_dot2c_f32_bf16 v248, v250, v252
  v_accvgpr_read_b32 v251, a13
  v_dot2c_f32_bf16 v249, v251, v252
  v_accvgpr_read_b32 v250, a14
  v_dot2c_f32_bf16 v248, v250, v252
  v_accvgpr_read_b32 v251, a15
  v_dot2c_f32_bf16 v249, v251, v252
  v_accvgpr_read_b32 v250, a16
  v_dot2c_f32_bf16 v248, v250, v252
  v_accvgpr_read_b32 v251, a17
  v_dot2c_f32_bf16 v249, v251, v252
  v_accvgpr_read_b32 v250, a18
  v_dot2c_f32_bf16 v248, v250, v252
  v_accvgpr_read_b32 v251, a19
  v_dot2c_f32_bf16 v249, v251, v252
  v_accvgpr_read_b32 v250, a20
  v_dot2c_f32_bf16 v248, v250, v252
  v_accvgpr_read_b32 v251, a21
  v_dot2c_f32_bf16 v249, v251, v252
  v_accvgpr_read_b32 v250, a22
  v_dot2c_f32_bf16 v248, v250, v252
  v_accvgpr_read_b32 v251, a23
  v_dot2c_f32_bf16 v249, v251, v252
  v_accvgpr_read_b32 v250, a24
  v_dot2c_f32_bf16 v248, v250, v252
  v_accvgpr_read_b32 v251, a25
  v_dot2c_f32_bf16 v249, v251, v252
  v_accvgpr_read_b32 v250, a26
  v_dot2c_f32_bf16 v248, v250, v252
  v_accvgpr_read_b32 v251, a27
  v_dot2c_f32_bf16 v249, v251, v252
  v_accvgpr_read_b32 v250, a28
  v_dot2c_f32_bf16 v248, v250, v252
  v_accvgpr_read_b32 v251, a29
  v_dot2c_f32_bf16 v249, v251, v252
  v_accvgpr_read_b32 v250, a30
  v_dot2c_f32_bf16 v248, v250, v252
  v_accvgpr_read_b32 v251, a31
  v_dot2c_f32_bf16 v249, v251, v252
  v_accvgpr_read_b32 v250, a32
  v_dot2c_f32_bf16 v248, v250, v252
  v_accvgpr_read_b32 v251, a33
  v_dot2c_f32_bf16 v249, v251, v252
  v_accvgpr_read_b32 v250, a34
  v_dot2c_f32_bf16 v248, v250, v252
  v_accvgpr_read_b32 v251, a35
  v_dot2c_f32_bf16 v249, v251, v252
  s_nop 2
  v_add_f32 v248, v248, v249
  s_nop 1
  v_add_f32_dpp v248, v248, v248 quad_perm:[1,0,3,2] row_mask:0xf bank_mask:0xf
  s_nop 1
  v_add_f32_dpp v248, v248, v248 quad_perm:[2,3,0,1] row_mask:0xf bank_mask:0xf
  s_nop 1
  v_add_f32_dpp v248, v248, v248 row_half_mirror row_mask:0xf bank_mask:0xf
  v_mul_f32 v248, 987991609, v248
  v_and_b32 v249, 4294901760, v248
  v_sub_f32 v250, v248, v249
  v_lshrrev_b32 v249, 16, v249
  v_and_b32 v250, 4294901760, v250
  v_or_b32 v250, v250, v249
  v_mov_b32 v251, s3
  v_bfe_u32 v248, v4, 3, 2
  v_lshrrev_b32 v249, 5, v4
  v_lshl_add_u32 v248, v248, 1, v249
  v_lshlrev_b32 v248, 3, v248
  s_lshl_b32 s75, s74, 6
  s_add_u32 s75, s75, 14180352
  buffer_store_dwordx2 v[250:251], v248, s[8:11], s75 offen sc1
L_a1_nw:
  v_mfma_f32_32x32x16_bf16 v[176:191], v[52:55], v[24:27], v[176:191]
  ds_read_b64_tr_b16 v[16:17], v79 offset:43136
  ds_read_b64_tr_b16 v[18:19], v79 offset:44928
  v_bfe_u32 v8, v4, 1, 2
  v_mul_u32_u24 v8, 320, v8
  v_and_b32 v9, 1, v4
  v_mfma_f32_32x32x16_bf16 v[192:207], v[52:55], v[28:31], v[192:207]
  s_waitcnt lgkmcnt(7)
  ds_read_b64_tr_b16 v[20:21], v79 offset:43200
  ds_read_b64_tr_b16 v[22:23], v79 offset:44992
  buffer_load_dwordx4 v70, s[60:63], s70 offen offset:2048 lds
  v_lshl_add_u32 v8, v9, 4, v8
  v_mad_u32_u24 v8, v7, s22, v8
  v_mfma_f32_32x32x16_bf16 v[208:223], v[52:55], v[32:35], v[208:223]
  s_add_u32 m0, s71, 0
  ds_read_b64_tr_b16 v[24:25], v79 offset:43264
  ds_read_b64_tr_b16 v[26:27], v79 offset:45056
  v_add_u32 v8, s23, v8
  v_add_u32 v118, 288, v8
  v_add_u32 v7, s25, v7
  v_mfma_f32_32x32x16_bf16 v[224:239], v[52:55], v[36:39], v[224:239]
  s_waitcnt lgkmcnt(6)
  ds_read_b64_tr_b16 v[28:29], v79 offset:43328
  ds_read_b64_tr_b16 v[30:31], v79 offset:45120
  s_add_u32 s69, s69, s67
  buffer_load_dwordx4 v71, s[56:59], s69 offen offset:0 lds
  v_lshrrev_b32 v7, 6, v7
  v_mfma_f32_32x32x16_bf16 v[128:143], v[56:59], v[40:43], v[128:143]
  ds_read_b64_tr_b16 v[32:33], v79 offset:43392
  ds_read_b64_tr_b16 v[34:35], v79 offset:45184
  v_and_b32 v7, v7, v9
  v_cmp_eq_u32 vcc, 0, v7
  s_nop 1
  v_cndmask_b32 v124, 0, v11, vcc
  v_mfma_f32_32x32x16_bf16 v[144:159], v[56:59], v[44:47], v[144:159]
  s_waitcnt lgkmcnt(6)
  ds_read_b128 v[60:63], v78 offset:16384
  ds_read_b64_tr_b16 v[36:37], v79 offset:50176
  ds_read_b64_tr_b16 v[38:39], v79 offset:51968
  buffer_load_dwordx4 v72, s[56:59], s69 offen offset:1024 lds
  v_cndmask_b32 v125, 0, v11, vcc
  v_mfma_f32_32x32x16_bf16 v[160:175], v[56:59], v[16:19], v[160:175]
  ds_read_b64_tr_b16 v[40:41], v79 offset:50240
  ds_read_b64_tr_b16 v[42:43], v79 offset:52032
  v_cndmask_b32 v126, 0, v11, vcc
  v_cndmask_b32 v127, 0, v11, vcc
  v_lshrrev_b32 v7, 3, v4
  v_mfma_f32_32x32x16_bf16 v[176:191], v[56:59], v[20:23], v[176:191]
  s_waitcnt lgkmcnt(7)
  ds_read_b64_tr_b16 v[44:45], v79 offset:50304
  ds_read_b64_tr_b16 v[46:47], v79 offset:52096
  buffer_load_dwordx4 v73, s[56:59], s69 offen offset:2048 lds
  v_add_u32 v7, 8, v7
  v_min_u32 v7, 12, v7
  v_mfma_f32_32x32x16_bf16 v[192:207], v[56:59], v[24:27], v[192:207]
  ds_read_b64_tr_b16 v[16:17], v79 offset:50368
  ds_read_b64_tr_b16 v[18:19], v79 offset:52160
  v_bfe_u32 v8, v4, 1, 2
  v_mul_u32_u24 v8, 320, v8
  v_and_b32 v9, 1, v4
  v_mfma_f32_32x32x16_bf16 v[208:223], v[56:59], v[28:31], v[208:223]
  s_waitcnt lgkmcnt(6)
  ds_read_b64_tr_b16 v[20:21], v79 offset:50432
  ds_read_b64_tr_b16 v[22:23], v79 offset:52224
  buffer_load_dwordx4 v74, s[56:59], s69 offen offset:3072 lds
  s_add_u32 s66, s66, 1
  s_cmp_eq_u32 s66, 9
  s_cselect_b32 s66, 0, s66
  v_mfma_f32_32x32x16_bf16 v[224:239], v[56:59], v[32:35], v[224:239]
  ds_read_b64_tr_b16 v[24:25], v79 offset:50496
  ds_read_b64_tr_b16 v[26:27], v79 offset:52288
  v_lshl_add_u32 v8, v9, 4, v8
  v_mad_u32_u24 v8, v7, s22, v8
  v_add_u32 v8, s23, v8
  v_mfma_f32_32x32x16_bf16 v[128:143], v[60:63], v[36:39], v[128:143]
  s_waitcnt lgkmcnt(6)
  ds_read_b64_tr_b16 v[28:29], v79 offset:50560
  ds_read_b64_tr_b16 v[30:31], v79 offset:52352
  v_add_u32 v119, 288, v8
  v_add_u32 v7, s25, v7
  v_lshrrev_b32 v7, 6, v7
  v_mfma_f32_32x32x16_bf16 v[144:159], v[60:63], v[40:43], v[144:159]
  v_and_b32 v7, v7, v9
  v_cmp_eq_u32 vcc, 0, v7
  s_nop 1
  v_cndmask_b32 v240, 0, v11, vcc
  v_cndmask_b32 v241, 0, v11, vcc
  v_cndmask_b32 v242, 0, v11, vcc
  v_cndmask_b32 v243, 0, v11, vcc
  v_mfma_f32_32x32x16_bf16 v[160:175], v[60:63], v[44:47], v[160:175]
  s_waitcnt lgkmcnt(4)
  v_mfma_f32_32x32x16_bf16 v[176:191], v[60:63], v[16:19], v[176:191]
  s_waitcnt vmcnt(11) lgkmcnt(0)
  s_barrier
  ds_read_b128 v[48:51], v75 offset:32768
  ds_read_b64_tr_b16 v[32:33], v80 offset:0
  ds_read_b64_tr_b16 v[34:35], v80 offset:1792
  ds_read_b64_tr_b16 v[36:37], v80 offset:64
  ds_read_b64_tr_b16 v[38:39], v80 offset:1856
  v_mfma_f32_32x32x16_bf16 v[192:207], v[60:63], v[20:23], v[192:207]
  s_mul_i32 s70, s66, 221184
  ds_read_b64_tr_b16 v[40:41], v80 offset:128
  ds_read_b64_tr_b16 v[42:43], v80 offset:1920
  ds_read_b64_tr_b16 v[44:45], v80 offset:192
  ds_read_b64_tr_b16 v[46:47], v80 offset:1984
  v_mfma_f32_32x32x16_bf16 v[208:223], v[60:63], v[24:27], v[208:223]
  s_add_u32 m0, s72, 28672
  ds_read_b64_tr_b16 v[16:17], v80 offset:256
  ds_read_b64_tr_b16 v[18:19], v80 offset:2048
  s_add_u32 s70, s70, s68
  buffer_load_dwordx4 v64, s[60:63], s70 offen offset:0 lds
  v_mfma_f32_32x32x16_bf16 v[224:239], v[60:63], v[28:31], v[224:239]
  s_waitcnt lgkmcnt(6)
  ds_read_b64_tr_b16 v[20:21], v80 offset:320
  ds_read_b64_tr_b16 v[22:23], v80 offset:2112
  v_mfma_f32_32x32x16_bf16 v[128:143], v[48:51], v[32:35], v[128:143]
  ds_read_b64_tr_b16 v[24:25], v80 offset:384
  ds_read_b64_tr_b16 v[26:27], v80 offset:2176
  buffer_load_dwordx4 v65, s[60:63], s70 offen offset:1024 lds
  v_mfma_f32_32x32x16_bf16 v[144:159], v[48:51], v[36:39], v[144:159]
  s_waitcnt lgkmcnt(6)
  ds_read_b128 v[52:55], v76 offset:32768
  ds_read_b64_tr_b16 v[28:29], v80 offset:7168
  ds_read_b64_tr_b16 v[30:31], v80 offset:8960
  v_mfma_f32_32x32x16_bf16 v[160:175], v[48:51], v[40:43], v[160:175]
  ds_read_b64_tr_b16 v[32:33], v80 offset:7232
  ds_read_b64_tr_b16 v[34:35], v80 offset:9024
  buffer_load_dwordx4 v66, s[60:63], s70 offen offset:2048 lds
  v_mfma_f32_32x32x16_bf16 v[176:191], v[48:51], v[44:47], v[176:191]
  s_waitcnt lgkmcnt(7)
  ds_read_b64_tr_b16 v[36:37], v80 offset:7296
  ds_read_b64_tr_b16 v[38:39], v80 offset:9088
  v_mfma_f32_32x32x16_bf16 v[192:207], v[48:51], v[16:19], v[192:207]
  ds_read_b64_tr_b16 v[40:41], v80 offset:7360
  ds_read_b64_tr_b16 v[42:43], v80 offset:9152
  buffer_load_dwordx4 v67, s[60:63], s70 offen offset:3072 lds
  v_mfma_f32_32x32x16_bf16 v[208:223], v[48:51], v[20:23], v[208:223]
  s_waitcnt lgkmcnt(6)
  ds_read_b64_tr_b16 v[44:45], v80 offset:7424
  ds_read_b64_tr_b16 v[46:47], v80 offset:9216
  v_mfma_f32_32x32x16_bf16 v[224:239], v[48:51], v[24:27], v[224:239]
  s_add_u32 m0, s72, 32768
  ds_read_b64_tr_b16 v[16:17], v80 offset:7488
  ds_read_b64_tr_b16 v[18:19], v80 offset:9280
  s_lshl_b32 s69, s66, 7
  buffer_load_dwordx4 v68, s[60:63], s70 offen offset:0 lds
  v_mfma_f32_32x32x16_bf16 v[128:143], v[52:55], v[28:31], v[128:143]
  s_waitcnt lgkmcnt(6)
  ds_read_b64_tr_b16 v[20:21], v80 offset:7552
  ds_read_b64_tr_b16 v[22:23], v80 offset:9344
  v_mfma_f32_32x32x16_bf16 v[144:159], v[52:55], v[32:35], v[144:159]
  ds_read_b128 v[56:59], v77 offset:32768
  ds_read_b64_tr_b16 v[24:25], v80 offset:14336
  ds_read_b64_tr_b16 v[26:27], v80 offset:16128
  buffer_load_dwordx4 v69, s[60:63], s70 offen offset:1024 lds
  v_mfma_f32_32x32x16_bf16 v[160:175], v[52:55], v[36:39], v[160:175]
  s_waitcnt lgkmcnt(7)
  ds_read_b64_tr_b16 v[28:29], v80 offset:14400
  ds_read_b64_tr_b16 v[30:31], v80 offset:16192
  v_mfma_f32_32x32x16_bf16 v[176:191], v[52:55], v[40:43], v[176:191]
  ds_read_b64_tr_b16 v[32:33], v80 offset:14464
  ds_read_b64_tr_b16 v[34:35], v80 offset:16256
  v_mfma_f32_32x32x16_bf16 v[192:207], v[52:55], v[44:47], v[192:207]
  s_waitcnt lgkmcnt(7)
  ds_read_b64_tr_b16 v[36:37], v80 offset:14528
  ds_read_b64_tr_b16 v[38:39], v80 offset:16320
  buffer_load_dwordx4 v70, s[60:63], s70 offen offset:2048 lds
  v_mfma_f32_32x32x16_bf16 v[208:223], v[52:55], v[16:19], v[208:223]
  s_add_u32 m0, s71, 16384
  ds_read_b64_tr_b16 v[40:41], v80 offset:14592
  ds_read_b64_tr_b16 v[42:43], v80 offset:16384
  v_mfma_f32_32x32x16_bf16 v[224:239], v[52:55], v[20:23], v[224:239]
  s_waitcnt lgkmcnt(6)
  ds_read_b64_tr_b16 v[44:45], v80 offset:14656
  ds_read_b64_tr_b16 v[46:47], v80 offset:16448
  s_add_u32 s69, s69, s67
  buffer_load_dwordx4 v71, s[56:59], s69 offen offset:0 lds
  v_mfma_f32_32x32x16_bf16 v[128:143], v[56:59], v[24:27], v[128:143]
  ds_read_b64_tr_b16 v[16:17], v80 offset:14720
  ds_read_b64_tr_b16 v[18:19], v80 offset:16512
  v_mfma_f32_32x32x16_bf16 v[144:159], v[56:59], v[28:31], v[144:159]
  s_waitcnt lgkmcnt(6)
  ds_read_b128 v[60:63], v78 offset:32768
  ds_read_b64_tr_b16 v[20:21], v80 offset:21504
  ds_read_b64_tr_b16 v[22:23], v80 offset:23296
  buffer_load_dwordx4 v72, s[56:59], s69 offen offset:1024 lds
  v_mfma_f32_32x32x16_bf16 v[160:175], v[56:59], v[32:35], v[160:175]
  ds_read_b64_tr_b16 v[24:25], v80 offset:21568
  ds_read_b64_tr_b16 v[26:27], v80 offset:23360
  v_mfma_f32_32x32x16_bf16 v[176:191], v[56:59], v[36:39], v[176:191]
  s_waitcnt lgkmcnt(7)
  ds_read_b64_tr_b16 v[28:29], v80 offset:21632
  ds_read_b64_tr_b16 v[30:31], v80 offset:23424
  buffer_load_dwordx4 v73, s[56:59], s69 offen offset:2048 lds
  v_mfma_f32_32x32x16_bf16 v[192:207], v[56:59], v[40:43], v[192:207]
  ds_read_b64_tr_b16 v[32:33], v80 offset:21696
  ds_read_b64_tr_b16 v[34:35], v80 offset:23488
  v_mfma_f32_32x32x16_bf16 v[208:223], v[56:59], v[44:47], v[208:223]
  s_waitcnt lgkmcnt(6)
  ds_read_b64_tr_b16 v[36:37], v80 offset:21760
  ds_read_b64_tr_b16 v[38:39], v80 offset:23552
  buffer_load_dwordx4 v74, s[56:59], s69 offen offset:3072 lds
  s_add_u32 s66, s66, 1
  s_cmp_eq_u32 s66, 9
  s_cselect_b32 s66, 0, s66
  v_mfma_f32_32x32x16_bf16 v[224:239], v[56:59], v[16:19], v[224:239]
  ds_read_b64_tr_b16 v[40:41], v80 offset:21824
  ds_read_b64_tr_b16 v[42:43], v80 offset:23616
  v_mfma_f32_32x32x16_bf16 v[128:143], v[60:63], v[20:23], v[128:143]
  s_waitcnt lgkmcnt(6)
  ds_read_b64_tr_b16 v[44:45], v80 offset:21888
  ds_read_b64_tr_b16 v[46:47], v80 offset:23680
  v_mfma_f32_32x32x16_bf16 v[144:159], v[60:63], v[24:27], v[144:159]
  v_mfma_f32_32x32x16_bf16 v[160:175], v[60:63], v[28:31], v[160:175]
  s_waitcnt lgkmcnt(4)
  v_mfma_f32_32x32x16_bf16 v[176:191], v[60:63], v[32:35], v[176:191]
  s_waitcnt vmcnt(11) lgkmcnt(0)
  s_barrier
  ds_read_b128 v[48:51], v75 offset:0
  ds_read_b64_tr_b16 v[16:17], v79 offset:0
  ds_read_b64_tr_b16 v[18:19], v79 offset:1792
  ds_read_b64_tr_b16 v[20:21], v79 offset:64
  ds_read_b64_tr_b16 v[22:23], v79 offset:1856
  v_mfma_f32_32x32x16_bf16 v[192:207], v[60:63], v[36:39], v[192:207]
  s_mul_i32 s70, s66, 221184
  ds_read_b64_tr_b16 v[24:25], v79 offset:128
  ds_read_b64_tr_b16 v[26:27], v79 offset:1920
  ds_read_b64_tr_b16 v[28:29], v79 offset:192
  ds_read_b64_tr_b16 v[30:31], v79 offset:1984
  v_mfma_f32_32x32x16_bf16 v[208:223], v[60:63], v[40:43], v[208:223]
  s_add_u32 m0, s72, 57344
  ds_read_b64_tr_b16 v[32:33], v79 offset:256
  ds_read_b64_tr_b16 v[34:35], v79 offset:2048
  s_add_u32 s70, s70, s68
  buffer_load_dwordx4 v64, s[60:63], s70 offen offset:0 lds
  v_mfma_f32_32x32x16_bf16 v[224:239], v[60:63], v[44:47], v[224:239]
  s_waitcnt lgkmcnt(6)
  ds_read_b64_tr_b16 v[36:37], v79 offset:320
  ds_read_b64_tr_b16 v[38:39], v79 offset:2112
  v_mfma_f32_32x32x16_bf16 v[128:143], v[48:51], v[16:19], v[128:143]
  ds_read_b64_tr_b16 v[40:41], v79 offset:384
  ds_read_b64_tr_b16 v[42:43], v79 offset:2176
  buffer_load_dwordx4 v65, s[60:63], s70 offen offset:1024 lds
  v_mfma_f32_32x32x16_bf16 v[144:159], v[48:51], v[20:23], v[144:159]
  s_waitcnt lgkmcnt(6)
  ds_read_b128 v[52:55], v76 offset:0
  ds_read_b64_tr_b16 v[44:45], v79 offset:7168
  ds_read_b64_tr_b16 v[46:47], v79 offset:8960
  v_mfma_f32_32x32x16_bf16 v[160:175], v[48:51], v[24:27], v[160:175]
  ds_read_b64_tr_b16 v[16:17], v79 offset:7232
  ds_read_b64_tr_b16 v[18:19], v79 offset:9024
  buffer_load_dwordx4 v66, s[60:63], s70 offen offset:2048 lds
  v_mfma_f32_32x32x16_bf16 v[176:191], v[48:51], v[28:31], v[176:191]
  s_waitcnt lgkmcnt(7)
  ds_read_b64_tr_b16 v[20:21], v79 offset:7296
  ds_read_b64_tr_b16 v[22:23], v79 offset:9088
  v_mfma_f32_32x32x16_bf16 v[192:207], v[48:51], v[32:35], v[192:207]
  ds_read_b64_tr_b16 v[24:25], v79 offset:7360
  ds_read_b64_tr_b16 v[26:27], v79 offset:9152
  buffer_load_dwordx4 v67, s[60:63], s70 offen offset:3072 lds
  v_mfma_f32_32x32x16_bf16 v[208:223], v[48:51], v[36:39], v[208:223]
  s_waitcnt lgkmcnt(6)
  ds_read_b64_tr_b16 v[28:29], v79 offset:7424
  ds_read_b64_tr_b16 v[30:31], v79 offset:9216
  v_mfma_f32_32x32x16_bf16 v[224:239], v[48:51], v[40:43], v[224:239]
  s_add_u32 m0, s72, 61440
  ds_read_b64_tr_b16 v[32:33], v79 offset:7488
  ds_read_b64_tr_b16 v[34:35], v79 offset:9280
  s_lshl_b32 s69, s66, 7
  buffer_load_dwordx4 v68, s[60:63], s70 offen offset:0 lds
  v_mfma_f32_32x32x16_bf16 v[128:143], v[52:55], v[44:47], v[128:143]
  s_waitcnt lgkmcnt(6)
  ds_read_b64_tr_b16 v[36:37], v79 offset:7552
  ds_read_b64_tr_b16 v[38:39], v79 offset:9344
  v_mfma_f32_32x32x16_bf16 v[144:159], v[52:55], v[16:19], v[144:159]
  ds_read_b128 v[56:59], v77 offset:0
  ds_read_b64_tr_b16 v[40:41], v79 offset:14336
  ds_read_b64_tr_b16 v[42:43], v79 offset:16128
  buffer_load_dwordx4 v69, s[60:63], s70 offen offset:1024 lds
  v_mfma_f32_32x32x16_bf16 v[160:175], v[52:55], v[20:23], v[160:175]
  s_waitcnt lgkmcnt(7)
  ds_read_b64_tr_b16 v[44:45], v79 offset:14400
  ds_read_b64_tr_b16 v[46:47], v79 offset:16192
  v_mfma_f32_32x32x16_bf16 v[176:191], v[52:55], v[24:27], v[176:191]
  ds_read_b64_tr_b16 v[16:17], v79 offset:14464
  ds_read_b64_tr_b16 v[18:19], v79 offset:16256
  v_mfma_f32_32x32x16_bf16 v[192:207], v[52:55], v[28:31], v[192:207]
  s_waitcnt lgkmcnt(7)
  ds_read_b64_tr_b16 v[20:21], v79 offset:14528
  ds_read_b64_tr_b16 v[22:23], v79 offset:16320
  buffer_load_dwordx4 v70, s[60:63], s70 offen offset:2048 lds
  v_mfma_f32_32x32x16_bf16 v[208:223], v[52:55], v[32:35], v[208:223]
  s_add_u32 m0, s71, 32768
  ds_read_b64_tr_b16 v[24:25], v79 offset:14592
  ds_read_b64_tr_b16 v[26:27], v79 offset:16384
  v_mfma_f32_32x32x16_bf16 v[224:239], v[52:55], v[36:39], v[224:239]
  s_waitcnt lgkmcnt(6)
  ds_read_b64_tr_b16 v[28:29], v79 offset:14656
  ds_read_b64_tr_b16 v[30:31], v79 offset:16448
  s_add_u32 s69, s69, s67
  buffer_load_dwordx4 v71, s[56:59], s69 offen offset:0 lds
  v_mfma_f32_32x32x16_bf16 v[128:143], v[56:59], v[40:43], v[128:143]
  ds_read_b64_tr_b16 v[32:33], v79 offset:14720
  ds_read_b64_tr_b16 v[34:35], v79 offset:16512
  v_mfma_f32_32x32x16_bf16 v[144:159], v[56:59], v[44:47], v[144:159]
  s_waitcnt lgkmcnt(6)
  ds_read_b128 v[60:63], v78 offset:0
  ds_read_b64_tr_b16 v[36:37], v79 offset:21504
  ds_read_b64_tr_b16 v[38:39], v79 offset:23296
  buffer_load_dwordx4 v72, s[56:59], s69 offen offset:1024 lds
  v_mfma_f32_32x32x16_bf16 v[160:175], v[56:59], v[16:19], v[160:175]
  ds_read_b64_tr_b16 v[40:41], v79 offset:21568
  ds_read_b64_tr_b16 v[42:43], v79 offset:23360
  v_mfma_f32_32x32x16_bf16 v[176:191], v[56:59], v[20:23], v[176:191]
  s_waitcnt lgkmcnt(7)
  ds_read_b64_tr_b16 v[44:45], v79 offset:21632
  ds_read_b64_tr_b16 v[46:47], v79 offset:23424
  buffer_load_dwordx4 v73, s[56:59], s69 offen offset:2048 lds
  v_mfma_f32_32x32x16_bf16 v[192:207], v[56:59], v[24:27], v[192:207]
  ds_read_b64_tr_b16 v[16:17], v79 offset:21696
  ds_read_b64_tr_b16 v[18:19], v79 offset:23488
  v_mfma_f32_32x32x16_bf16 v[208:223], v[56:59], v[28:31], v[208:223]
  s_waitcnt lgkmcnt(6)
  ds_read_b64_tr_b16 v[20:21], v79 offset:21760
  ds_read_b64_tr_b16 v[22:23], v79 offset:23552
  buffer_load_dwordx4 v74, s[56:59], s69 offen offset:3072 lds
  s_add_u32 s66, s66, 1
  s_cmp_eq_u32 s66, 9
  s_cselect_b32 s66, 0, s66
  v_mfma_f32_32x32x16_bf16 v[224:239], v[56:59], v[32:35], v[224:239]
  ds_read_b64_tr_b16 v[24:25], v79 offset:21824
  ds_read_b64_tr_b16 v[26:27], v79 offset:23616
  v_mfma_f32_32x32x16_bf16 v[128:143], v[60:63], v[36:39], v[128:143]
  s_waitcnt lgkmcnt(6)
  ds_read_b64_tr_b16 v[28:29], v79 offset:21888
  ds_read_b64_tr_b16 v[30:31], v79 offset:23680
  v_mfma_f32_32x32x16_bf16 v[144:159], v[60:63], v[40:43], v[144:159]
  v_mfma_f32_32x32x16_bf16 v[160:175], v[60:63], v[44:47], v[160:175]
  s_waitcnt lgkmcnt(4)
  v_mfma_f32_32x32x16_bf16 v[176:191], v[60:63], v[16:19], v[176:191]
  s_waitcnt vmcnt(11) lgkmcnt(0)
  s_barrier
  ds_read_b128 v[48:51], v75 offset:16384
  ds_read_b64_tr_b16 v[32:33], v79 offset:28672
  ds_read_b64_tr_b16 v[34:35], v79 offset:30464
  ds_read_b64_tr_b16 v[36:37], v79 offset:28736
  ds_read_b64_tr_b16 v[38:39], v79 offset:30528
  v_mfma_f32_32x32x16_bf16 v[192:207], v[60:63], v[20:23], v[192:207]
  ds_read_b64_tr_b16 v[40:41], v79 offset:28800
  ds_read_b64_tr_b16 v[42:43], v79 offset:30592
  ds_read_b64_tr_b16 v[44:45], v79 offset:28864
  ds_read_b64_tr_b16 v[46:47], v79 offset:30656
  v_mfma_f32_32x32x16_bf16 v[208:223], v[60:63], v[24:27], v[208:223]
  ds_read_b64_tr_b16 v[16:17], v79 offset:28928
  ds_read_b64_tr_b16 v[18:19], v79 offset:30720
  v_mfma_f32_32x32x16_bf16 v[224:239], v[60:63], v[28:31], v[224:239]
  s_waitcnt lgkmcnt(6)
  ds_read_b64_tr_b16 v[20:21], v79 offset:28992
  ds_read_b64_tr_b16 v[22:23], v79 offset:30784
  v_mfma_f32_32x32x16_bf16 v[128:143], v[48:51], v[32:35], v[128:143]
  s_mov_b32 s44, s48
  ds_read_b64_tr_b16 v[24:25], v79 offset:29056
  ds_read_b64_tr_b16 v[26:27], v79 offset:30848
  s_mov_b32 s45, s49
  s_mov_b32 s46, 5308416
  s_mov_b32 s47, 131072
  buffer_load_dword v244, v122, s[44:47], 0 offen
  v_mfma_f32_32x32x16_bf16 v[144:159], v[48:51], v[36:39], v[144:159]
  s_waitcnt lgkmcnt(6)
  ds_read_b128 v[52:55], v76 offset:16384
  ds_read_b64_tr_b16 v[28:29], v79 offset:35840
  ds_read_b64_tr_b16 v[30:31], v79 offset:37632
  v_mfma_f32_32x32x16_bf16 v[160:175], v[48:51], v[40:43], v[160:175]
  ds_read_b64_tr_b16 v[32:33], v79 offset:35904
  ds_read_b64_tr_b16 v[34:35], v79 offset:37696
  v_mfma_f32_32x32x16_bf16 v[176:191], v[48:51], v[44:47], v[176:191]
  s_waitcnt lgkmcnt(7)
  ds_read_b64_tr_b16 v[36:37], v79 offset:35968
  ds_read_b64_tr_b16 v[38:39], v79 offset:37760
  v_mfma_f32_32x32x16_bf16 v[192:207], v[48:51], v[16:19], v[192:207]
  ds_read_b64_tr_b16 v[40:41], v79 offset:36032
  ds_read_b64_tr_b16 v[42:43], v79 offset:37824
  v_mfma_f32_32x32x16_bf16 v[208:223], v[48:51], v[20:23], v[208:223]
  s_waitcnt lgkmcnt(6)
  ds_read_b64_tr_b16 v[44:45], v79 offset:36096
  ds_read_b64_tr_b16 v[46:47], v79 offset:37888
  v_mfma_f32_32x32x16_bf16 v[224:239], v[48:51], v[24:27], v[224:239]
  ds_read_b64_tr_b16 v[16:17], v79 offset:36160
  ds_read_b64_tr_b16 v[18:19], v79 offset:37952
  v_mfma_f32_32x32x16_bf16 v[128:143], v[52:55], v[28:31], v[128:143]
  s_waitcnt lgkmcnt(6)
  ds_read_b64_tr_b16 v[20:21], v79 offset:36224
  ds_read_b64_tr_b16 v[22:23], v79 offset:38016
  v_mfma_f32_32x32x16_bf16 v[144:159], v[52:55], v[32:35], v[144:159]
  ds_read_b128 v[56:59], v77 offset:16384
  ds_read_b64_tr_b16 v[24:25], v79 offset:43008
  ds_read_b64_tr_b16 v[26:27], v79 offset:44800
  v_mfma_f32_32x32x16_bf16 v[160:175], v[52:55], v[36:39], v[160:175]
  s_waitcnt lgkmcnt(7)
  ds_read_b64_tr_b16 v[28:29], v79 offset:43072
  ds_read_b64_tr_b16 v[30:31], v79 offset:44864
  v_mfma_f32_32x32x16_bf16 v[176:191], v[52:55], v[40:43], v[176:191]
  ds_read_b64_tr_b16 v[32:33], v79 offset:43136
  ds_read_b64_tr_b16 v[34:35], v79 offset:44928
  v_mfma_f32_32x32x16_bf16 v[192:207], v[52:55], v[44:47], v[192:207]
  s_waitcnt lgkmcnt(7)
  ds_read_b64_tr_b16 v[36:37], v79 offset:43200
  ds_read_b64_tr_b16 v[38:39], v79 offset:44992
  v_mfma_f32_32x32x16_bf16 v[208:223], v[52:55], v[16:19], v[208:223]
  ds_read_b64_tr_b16 v[40:41], v79 offset:43264
  ds_read_b64_tr_b16 v[42:43], v79 offset:45056
  v_mfma_f32_32x32x16_bf16 v[224:239], v[52:55], v[20:23], v[224:239]
  s_waitcnt lgkmcnt(6)
  ds_read_b64_tr_b16 v[44:45], v79 offset:43328
  ds_read_b64_tr_b16 v[46:47], v79 offset:45120
  v_mfma_f32_32x32x16_bf16 v[128:143], v[56:59], v[24:27], v[128:143]
  ds_read_b64_tr_b16 v[16:17], v79 offset:43392
  ds_read_b64_tr_b16 v[18:19], v79 offset:45184
  v_mfma_f32_32x32x16_bf16 v[144:159], v[56:59], v[28:31], v[144:159]
  s_waitcnt lgkmcnt(6)
  ds_read_b128 v[60:63], v78 offset:16384
  ds_read_b64_tr_b16 v[20:21], v79 offset:50176
  ds_read_b64_tr_b16 v[22:23], v79 offset:51968
  v_mfma_f32_32x32x16_bf16 v[160:175], v[56:59], v[32:35], v[160:175]
  ds_read_b64_tr_b16 v[24:25], v79 offset:50240
  ds_read_b64_tr_b16 v[26:27], v79 offset:52032
  v_mfma_f32_32x32x16_bf16 v[176:191], v[56:59], v[36:39], v[176:191]
  s_waitcnt lgkmcnt(7)
  ds_read_b64_tr_b16 v[28:29], v79 offset:50304
  ds_read_b64_tr_b16 v[30:31], v79 offset:52096
  v_mfma_f32_32x32x16_bf16 v[192:207], v[56:59], v[40:43], v[192:207]
  ds_read_b64_tr_b16 v[32:33], v79 offset:50368
  ds_read_b64_tr_b16 v[34:35], v79 offset:52160
  v_mfma_f32_32x32x16_bf16 v[208:223], v[56:59], v[44:47], v[208:223]
  s_waitcnt lgkmcnt(6)
  ds_read_b64_tr_b16 v[36:37], v79 offset:50432
  ds_read_b64_tr_b16 v[38:39], v79 offset:52224
  v_mfma_f32_32x32x16_bf16 v[224:239], v[56:59], v[16:19], v[224:239]
  ds_read_b64_tr_b16 v[40:41], v79 offset:50496
  ds_read_b64_tr_b16 v[42:43], v79 offset:52288
  v_mfma_f32_32x32x16_bf16 v[128:143], v[60:63], v[20:23], v[128:143]
  s_waitcnt lgkmcnt(6)
  ds_read_b64_tr_b16 v[44:45], v79 offset:50560
  ds_read_b64_tr_b16 v[46:47], v79 offset:52352
  v_mfma_f32_32x32x16_bf16 v[144:159], v[60:63], v[24:27], v[144:159]
  v_mfma_f32_32x32x16_bf16 v[160:175], v[60:63], v[28:31], v[160:175]
  s_waitcnt lgkmcnt(4)
  v_mfma_f32_32x32x16_bf16 v[176:191], v[60:63], v[32:35], v[176:191]
  s_waitcnt vmcnt(1) lgkmcnt(0)
  s_barrier
  ds_read_b128 v[48:51], v75 offset:32768
  ds_read_b64_tr_b16 v[16:17], v80 offset:0
  ds_read_b64_tr_b16 v[18:19], v80 offset:1792
  ds_read_b64_tr_b16 v[20:21], v80 offset:64
  ds_read_b64_tr_b16 v[22:23], v80 offset:1856
  v_mfma_f32_32x32x16_bf16 v[192:207], v[60:63], v[36:39], v[192:207]
  ds_read_b64_tr_b16 v[24:25], v80 offset:128
  ds_read_b64_tr_b16 v[26:27], v80 offset:1920
  ds_read_b64_tr_b16 v[28:29], v80 offset:192
  ds_read_b64_tr_b16 v[30:31], v80 offset:1984
  v_mfma_f32_32x32x16_bf16 v[208:223], v[60:63], v[40:43], v[208:223]
  ds_read_b64_tr_b16 v[32:33], v80 offset:256
  ds_read_b64_tr_b16 v[34:35], v80 offset:2048
  v_mfma_f32_32x32x16_bf16 v[224:239], v[60:63], v[44:47], v[224:239]
  s_waitcnt lgkmcnt(6)
  ds_read_b64_tr_b16 v[36:37], v80 offset:320
  ds_read_b64_tr_b16 v[38:39], v80 offset:2112
  v_mfma_f32_32x32x16_bf16 v[128:143], v[48:51], v[16:19], v[128:143]
  ds_read_b64_tr_b16 v[40:41], v80 offset:384
  ds_read_b64_tr_b16 v[42:43], v80 offset:2176
  v_mfma_f32_32x32x16_bf16 v[144:159], v[48:51], v[20:23], v[144:159]
  s_waitcnt lgkmcnt(6)
  ds_read_b128 v[52:55], v76 offset:32768
  ds_read_b64_tr_b16 v[44:45], v80 offset:7168
  ds_read_b64_tr_b16 v[46:47], v80 offset:8960
  v_mfma_f32_32x32x16_bf16 v[160:175], v[48:51], v[24:27], v[160:175]
  ds_read_b64_tr_b16 v[16:17], v80 offset:7232
  ds_read_b64_tr_b16 v[18:19], v80 offset:9024
  v_mfma_f32_32x32x16_bf16 v[176:191], v[48:51], v[28:31], v[176:191]
  s_waitcnt lgkmcnt(7)
  ds_read_b64_tr_b16 v[20:21], v80 offset:7296
  ds_read_b64_tr_b16 v[22:23], v80 offset:9088
  v_mfma_f32_32x32x16_bf16 v[192:207], v[48:51], v[32:35], v[192:207]
  ds_read_b64_tr_b16 v[24:25], v80 offset:7360
  ds_read_b64_tr_b16 v[26:27], v80 offset:9152
  v_mfma_f32_32x32x16_bf16 v[208:223], v[48:51], v[36:39], v[208:223]
  s_waitcnt lgkmcnt(6)
  ds_read_b64_tr_b16 v[28:29], v80 offset:7424
  ds_read_b64_tr_b16 v[30:31], v80 offset:9216
  v_mfma_f32_32x32x16_bf16 v[224:239], v[48:51], v[40:43], v[224:239]
  ds_read_b64_tr_b16 v[32:33], v80 offset:7488
  ds_read_b64_tr_b16 v[34:35], v80 offset:9280
  v_mfma_f32_32x32x16_bf16 v[128:143], v[52:55], v[44:47], v[128:143]
  s_waitcnt lgkmcnt(6)
  ds_read_b64_tr_b16 v[36:37], v80 offset:7552
  ds_read_b64_tr_b16 v[38:39], v80 offset:9344
  v_mfma_f32_32x32x16_bf16 v[144:159], v[52:55], v[16:19], v[144:159]
  ds_read_b128 v[56:59], v77 offset:32768
  ds_read_b64_tr_b16 v[40:41], v80 offset:14336
  ds_read_b64_tr_b16 v[42:43], v80 offset:16128
  v_mfma_f32_32x32x16_bf16 v[160:175], v[52:55], v[20:23], v[160:175]
  s_waitcnt lgkmcnt(7)
  ds_read_b64_tr_b16 v[44:45], v80 offset:14400
  ds_read_b64_tr_b16 v[46:47], v80 offset:16192
  v_mfma_f32_32x32x16_bf16 v[176:191], v[52:55], v[24:27], v[176:191]
  ds_read_b64_tr_b16 v[16:17], v80 offset:14464
  ds_read_b64_tr_b16 v[18:19], v80 offset:16256
  v_mfma_f32_32x32x16_bf16 v[192:207], v[52:55], v[28:31], v[192:207]
  s_waitcnt lgkmcnt(7)
  ds_read_b64_tr_b16 v[20:21], v80 offset:14528
  ds_read_b64_tr_b16 v[22:23], v80 offset:16320
  v_mfma_f32_32x32x16_bf16 v[208:223], v[52:55], v[32:35], v[208:223]
  ds_read_b64_tr_b16 v[24:25], v80 offset:14592
  ds_read_b64_tr_b16 v[26:27], v80 offset:16384
  v_mfma_f32_32x32x16_bf16 v[224:239], v[52:55], v[36:39], v[224:239]
  s_waitcnt lgkmcnt(6)
  ds_read_b64_tr_b16 v[28:29], v80 offset:14656
  ds_read_b64_tr_b16 v[30:31], v80 offset:16448
  v_mfma_f32_32x32x16_bf16 v[128:143], v[56:59], v[40:43], v[128:143]
  ds_read_b64_tr_b16 v[32:33], v80 offset:14720
  ds_read_b64_tr_b16 v[34:35], v80 offset:16512
  v_mfma_f32_32x32x16_bf16 v[144:159], v[56:59], v[44:47], v[144:159]
  s_waitcnt lgkmcnt(6)
  ds_read_b128 v[60:63], v78 offset:32768
  ds_read_b64_tr_b16 v[36:37], v80 offset:21504
  ds_read_b64_tr_b16 v[38:39], v80 offset:23296
  v_mfma_f32_32x32x16_bf16 v[160:175], v[56:59], v[16:19], v[160:175]
  ds_read_b64_tr_b16 v[40:41], v80 offset:21568
  ds_read_b64_tr_b16 v[42:43], v80 offset:23360
  v_mfma_f32_32x32x16_bf16 v[176:191], v[56:59], v[20:23], v[176:191]
  s_waitcnt lgkmcnt(7)
  ds_read_b64_tr_b16 v[44:45], v80 offset:21632
  ds_read_b64_tr_b16 v[46:47], v80 offset:23424
  v_mfma_f32_32x32x16_bf16 v[192:207], v[56:59], v[24:27], v[192:207]
  ds_read_b64_tr_b16 v[16:17], v80 offset:21696
  ds_read_b64_tr_b16 v[18:19], v80 offset:23488
  v_mfma_f32_32x32x16_bf16 v[208:223], v[56:59], v[28:31], v[208:223]
  s_waitcnt lgkmcnt(6)
  ds_read_b64_tr_b16 v[20:21], v80 offset:21760
  ds_read_b64_tr_b16 v[22:23], v80 offset:23552
  v_mfma_f32_32x32x16_bf16 v[224:239], v[56:59], v[32:35], v[224:239]
  ds_read_b64_tr_b16 v[24:25], v80 offset:21824
  ds_read_b64_tr_b16 v[26:27], v80 offset:23616
  v_mfma_f32_32x32x16_bf16 v[128:143], v[60:63], v[36:39], v[128:143]
  s_waitcnt lgkmcnt(6)
  ds_read_b64_tr_b16 v[28:29], v80 offset:21888
  ds_read_b64_tr_b16 v[30:31], v80 offset:23680
  v_mfma_f32_32x32x16_bf16 v[144:159], v[60:63], v[40:43], v[144:159]
  v_mfma_f32_32x32x16_bf16 v[160:175], v[60:63], v[44:47], v[160:175]
  s_waitcnt lgkmcnt(4)
  v_mfma_f32_32x32x16_bf16 v[176:191], v[60:63], v[16:19], v[176:191]
  v_mfma_f32_32x32x16_bf16 v[192:207], v[60:63], v[20:23], v[192:207]
  s_waitcnt lgkmcnt(0)
  v_mfma_f32_32x32x16_bf16 v[208:223], v[60:63], v[24:27], v[208:223]
  v_mfma_f32_32x32x16_bf16 v[224:239], v[60:63], v[28:31], v[224:239]
  s_barrier
  ds_write_b128 v118, v[124:127]
  ds_write_b128 v119, v[240:243]
  v_pk_mul_f32 v[128:129], v[128:129], v[88:89] op_sel_hi:[1,0]
  v_pk_mul_f32 v[130:131], v[130:131], v[88:89] op_sel_hi:[1,0]
  v_pk_mul_f32 v[132:133], v[132:133], v[88:89] op_sel_hi:[1,0]
  v_pk_mul_f32 v[134:135], v[134:135], v[88:89] op_sel_hi:[1,0]
  v_pk_mul_f32 v[136:137], v[136:137], v[88:89] op_sel_hi:[1,0]
  v_pk_mul_f32 v[138:139], v[138:139], v[88:89] op_sel_hi:[1,0]
  v_pk_mul_f32 v[140:141], v[140:141], v[88:89] op_sel_hi:[1,0]
  v_pk_mul_f32 v[142:143], v[142:143], v[88:89] op_sel_hi:[1,0]
  v_cvt_pk_bf16_f32 v128, v128, v129
  v_cvt_pk_bf16_f32 v129, v130, v131
  v_cvt_pk_bf16_f32 v130, v132, v133
  v_cvt_pk_bf16_f32 v131, v134, v135
  v_cvt_pk_bf16_f32 v132, v136, v137
  v_cvt_pk_bf16_f32 v133, v138, v139
  v_cvt_pk_bf16_f32 v134, v140, v141
  v_cvt_pk_bf16_f32 v135, v142, v143
  ds_write_b128 v81, v[128:131]
  ds_write_b128 v81, v[132:135] offset:640
  v_pk_mul_f32 v[144:145], v[144:145], v[90:91] op_sel_hi:[1,0]
  v_pk_mul_f32 v[146:147], v[146:147], v[90:91] op_sel_hi:[1,0]
  v_pk_mul_f32 v[148:149], v[148:149], v[90:91] op_sel_hi:[1,0]
  v_pk_mul_f32 v[150:151], v[150:151], v[90:91] op_sel_hi:[1,0]
  v_pk_mul_f32 v[152:153], v[152:153], v[90:91] op_sel_hi:[1,0]
  v_pk_mul_f32 v[154:155], v[154:155], v[90:91] op_sel_hi:[1,0]
  v_pk_mul_f32 v[156:157], v[156:157], v[90:91] op_sel_hi:[1,0]
  v_pk_mul_f32 v[158:159], v[158:159], v[90:91] op_sel_hi:[1,0]
  v_cvt_pk_bf16_f32 v144, v144, v145
  v_cvt_pk_bf16_f32 v145, v146, v147
  v_cvt_pk_bf16_f32 v146, v148, v149
  v_cvt_pk_bf16_f32 v147, v150, v151
  v_cvt_pk_bf16_f32 v148, v152, v153
  v_cvt_pk_bf16_f32 v149, v154, v155
  v_cvt_pk_bf16_f32 v150, v156, v157
  v_cvt_pk_bf16_f32 v151, v158, v159
  ds_write_b128 v82, v[144:147]
  ds_write_b128 v82, v[148:151] offset:640
  v_pk_mul_f32 v[160:161], v[160:161], v[92:93] op_sel_hi:[1,0]
  v_pk_mul_f32 v[162:163], v[162:163], v[92:93] op_sel_hi:[1,0]
  v_pk_mul_f32 v[164:165], v[164:165], v[92:93] op_sel_hi:[1,0]
  v_pk_mul_f32 v[166:167], v[166:167], v[92:93] op_sel_hi:[1,0]
  v_pk_mul_f32 v[168:169], v[168:169], v[92:93] op_sel_hi:[1,0]
  v_pk_mul_f32 v[170:171], v[170:171], v[92:93] op_sel_hi:[1,0]
  v_pk_mul_f32 v[172:173], v[172:173], v[92:93] op_sel_hi:[1,0]
  v_pk_mul_f32 v[174:175], v[174:175], v[92:93] op_sel_hi:[1,0]
  v_cvt_pk_bf16_f32 v160, v160, v161
  v_cvt_pk_bf16_f32 v161, v162, v163
  v_cvt_pk_bf16_f32 v162, v164, v165
  v_cvt_pk_bf16_f32 v163, v166, v167
  v_cvt_pk_bf16_f32 v164, v168, v169
  v_cvt_pk_bf16_f32 v165, v170, v171
  v_cvt_pk_bf16_f32 v166, v172, v173
  v_cvt_pk_bf16_f32 v167, v174, v175
  ds_write_b128 v83, v[160:163]
  ds_write_b128 v83, v[164:167] offset:640
  v_pk_mul_f32 v[176:177], v[176:177], v[94:95] op_sel_hi:[1,0]
  v_pk_mul_f32 v[178:179], v[178:179], v[94:95] op_sel_hi:[1,0]
  v_pk_mul_f32 v[180:181], v[180:181], v[94:95] op_sel_hi:[1,0]
  v_pk_mul_f32 v[182:183], v[182:183], v[94:95] op_sel_hi:[1,0]
  v_pk_mul_f32 v[184:185], v[184:185], v[94:95] op_sel_hi:[1,0]
  v_pk_mul_f32 v[186:187], v[186:187], v[94:95] op_sel_hi:[1,0]
  v_pk_mul_f32 v[188:189], v[188:189], v[94:95] op_sel_hi:[1,0]
  v_pk_mul_f32 v[190:191], v[190:191], v[94:95] op_sel_hi:[1,0]
  v_cvt_pk_bf16_f32 v176, v176, v177
  v_cvt_pk_bf16_f32 v177, v178, v179
  v_cvt_pk_bf16_f32 v178, v180, v181
  v_cvt_pk_bf16_f32 v179, v182, v183
  v_cvt_pk_bf16_f32 v180, v184, v185
  v_cvt_pk_bf16_f32 v181, v186, v187
  v_cvt_pk_bf16_f32 v182, v188, v189
  v_cvt_pk_bf16_f32 v183, v190, v191
  ds_write_b128 v84, v[176:179]
  ds_write_b128 v84, v[180:183] offset:640
  v_pk_mul_f32 v[192:193], v[192:193], v[96:97] op_sel_hi:[1,0]
  v_pk_mul_f32 v[194:195], v[194:195], v[96:97] op_sel_hi:[1,0]
  v_pk_mul_f32 v[196:197], v[196:197], v[96:97] op_sel_hi:[1,0]
  v_pk_mul_f32 v[198:199], v[198:199], v[96:97] op_sel_hi:[1,0]
  v_pk_mul_f32 v[200:201], v[200:201], v[96:97] op_sel_hi:[1,0]
  v_pk_mul_f32 v[202:203], v[202:203], v[96:97] op_sel_hi:[1,0]
  v_pk_mul_f32 v[204:205], v[204:205], v[96:97] op_sel_hi:[1,0]
  v_pk_mul_f32 v[206:207], v[206:207], v[96:97] op_sel_hi:[1,0]
  v_cvt_pk_bf16_f32 v192, v192, v193
  v_cvt_pk_bf16_f32 v193, v194, v195
  v_cvt_pk_bf16_f32 v194, v196, v197
  v_cvt_pk_bf16_f32 v195, v198, v199
  v_cvt_pk_bf16_f32 v196, v200, v201
  v_cvt_pk_bf16_f32 v197, v202, v203
  v_cvt_pk_bf16_f32 v198, v204, v205
  v_cvt_pk_bf16_f32 v199, v206, v207
  ds_write_b128 v85, v[192:195]
  ds_write_b128 v85, v[196:199] offset:640
  v_pk_mul_f32 v[208:209], v[208:209], v[98:99] op_sel_hi:[1,0]
  v_pk_mul_f32 v[210:211], v[210:211], v[98:99] op_sel_hi:[1,0]
  v_pk_mul_f32 v[212:213], v[212:213], v[98:99] op_sel_hi:[1,0]
  v_pk_mul_f32 v[214:215], v[214:215], v[98:99] op_sel_hi:[1,0]
  v_pk_mul_f32 v[216:217], v[216:217], v[98:99] op_sel_hi:[1,0]
  v_pk_mul_f32 v[218:219], v[218:219], v[98:99] op_sel_hi:[1,0]
  v_pk_mul_f32 v[220:221], v[220:221], v[98:99] op_sel_hi:[1,0]
  v_pk_mul_f32 v[222:223], v[222:223], v[98:99] op_sel_hi:[1,0]
  v_cvt_pk_bf16_f32 v208, v208, v209
  v_cvt_pk_bf16_f32 v209, v210, v211
  v_cvt_pk_bf16_f32 v210, v212, v213
  v_cvt_pk_bf16_f32 v211, v214, v215
  v_cvt_pk_bf16_f32 v212, v216, v217
  v_cvt_pk_bf16_f32 v213, v218, v219
  v_cvt_pk_bf16_f32 v214, v220, v221
  v_cvt_pk_bf16_f32 v215, v222, v223
  ds_write_b128 v86, v[208:211]
  ds_write_b128 v86, v[212:215] offset:640
  v_pk_mul_f32 v[224:225], v[224:225], v[100:101] op_sel_hi:[1,0]
  v_pk_mul_f32 v[226:227], v[226:227], v[100:101] op_sel_hi:[1,0]
  v_pk_mul_f32 v[228:229], v[228:229], v[100:101] op_sel_hi:[1,0]
  v_pk_mul_f32 v[230:231], v[230:231], v[100:101] op_sel_hi:[1,0]
  v_pk_mul_f32 v[232:233], v[232:233], v[100:101] op_sel_hi:[1,0]
  v_pk_mul_f32 v[234:235], v[234:235], v[100:101] op_sel_hi:[1,0]
  v_pk_mul_f32 v[236:237], v[236:237], v[100:101] op_sel_hi:[1,0]
  v_pk_mul_f32 v[238:239], v[238:239], v[100:101] op_sel_hi:[1,0]
  v_cvt_pk_bf16_f32 v224, v224, v225
  v_cvt_pk_bf16_f32 v225, v226, v227
  v_cvt_pk_bf16_f32 v226, v228, v229
  v_cvt_pk_bf16_f32 v227, v230, v231
  v_cvt_pk_bf16_f32 v228, v232, v233
  v_cvt_pk_bf16_f32 v229, v234, v235
  v_cvt_pk_bf16_f32 v230, v236, v237
  v_cvt_pk_bf16_f32 v231, v238, v239
  ds_write_b128 v87, v[224:227]
  ds_write_b128 v87, v[228:231] offset:640
  s_waitcnt lgkmcnt(0)
  ds_read_b128 v[128:131], v117 offset:0
  ds_read_b128 v[132:135], v117 offset:1024
  ds_read_b128 v[136:139], v117 offset:2048
  ds_read_b128 v[140:143], v117 offset:3072
  ds_read_b128 v[144:147], v117 offset:4096
  ds_read_b128 v[148:151], v117 offset:5120
  ds_read_b128 v[152:155], v117 offset:6144
  ds_read_b128 v[156:159], v117 offset:7168
  ds_read_b128 v[160:163], v117 offset:8192
  ds_read_b128 v[164:167], v117 offset:9216
  ds_read_b128 v[168:171], v117 offset:10240
  ds_read_b128 v[172:175], v117 offset:11264
  ds_read_b128 v[176:179], v117 offset:12288
  ds_read_b128 v[180:183], v117 offset:13312
  ds_read_b128 v[184:187], v117 offset:14336
  s_waitcnt lgkmcnt(14)
  buffer_store_dwordx4 v[128:131], v102, s[8:11], s73 offen sc1
  s_waitcnt lgkmcnt(13)
  buffer_store_dwordx4 v[132:135], v103, s[8:11], s73 offen sc1
  s_waitcnt lgkmcnt(12)
  buffer_store_dwordx4 v[136:139], v104, s[8:11], s73 offen sc1
  s_waitcnt lgkmcnt(11)
  buffer_store_dwordx4 v[140:143], v105, s[8:11], s73 offen sc1
  s_waitcnt lgkmcnt(10)
  buffer_store_dwordx4 v[144:147], v106, s[8:11], s73 offen sc1
  s_waitcnt lgkmcnt(9)
  buffer_store_dwordx4 v[148:151], v107, s[8:11], s73 offen sc1
  s_waitcnt lgkmcnt(8)
  buffer_store_dwordx4 v[152:155], v108, s[8:11], s73 offen sc1
  s_waitcnt lgkmcnt(7)
  buffer_store_dwordx4 v[156:159], v109, s[8:11], s73 offen sc1
  s_waitcnt lgkmcnt(6)
  buffer_store_dwordx4 v[160:163], v110, s[8:11], s73 offen sc1
  s_waitcnt lgkmcnt(5)
  buffer_store_dwordx4 v[164:167], v111, s[8:11], s73 offen sc1
  s_waitcnt lgkmcnt(4)
  buffer_store_dwordx4 v[168:171], v112, s[8:11], s73 offen sc1
  s_waitcnt lgkmcnt(3)
  buffer_store_dwordx4 v[172:175], v113, s[8:11], s73 offen sc1
  s_waitcnt lgkmcnt(2)
  buffer_store_dwordx4 v[176:179], v114, s[8:11], s73 offen sc1
  s_waitcnt lgkmcnt(1)
  buffer_store_dwordx4 v[180:183], v115, s[8:11], s73 offen sc1
  s_waitcnt lgkmcnt(0)
  buffer_store_dwordx4 v[184:187], v116, s[8:11], s73 offen sc1
  s_lshl_b32 s73, s65, 4
  s_add_u32 s73, s73, s64
  s_lshl_b32 s73, s73, 7
  s_add_u32 s73, s73, 14352384
  s_lshl_b32 s4, s4, 2
  s_and_b32 s21, s5, 3
  s_add_u32 s4, s4, s21
  s_lshr_b32 s5, s5, 2
  v_lshlrev_b32 v197, 4, v4
  s_lshl_b32 s21, s5, 4
  s_lshl_b32 s22, s20, 2
  s_add_u32 s21, s21, s22
  s_mul_i32 s33, s21, 2560
  s_mul_i32 s22, s4, 163840
  s_add_u32 s33, s33, s22
  s_add_u32 s33, s33, 37748736
  s_mul_i32 s34, s20, 5120
  s_add_u32 s34, s34, 143360
  s_add_u32 s22, s22, 42991616
  s_add_u32 s12, s8, s22
  s_addc_u32 s13, s9, 0
  s_mov_b32 s14, 163840
  s_lshl_b32 s32, s20, 10
  v_lshrrev_b32 v11, 4, v4
  v_add_u32 v11, 1, v11
  v_cmp_gt_u32 vcc, 32, v4
  s_nop 1
  v_cndmask_b32 v11, 0, v11, vcc
  v_lshlrev_b32 v11, 5, v11
  v_add_u32 v11, s4, v11
  v_mul_u32_u24 v11, 171, v11
  v_lshrrev_b32 v11, 11, v11
  v_and_b32 v12, 15, v4
  v_and_b32 v13, 3, v4
  s_lshl_b32 s22, s5, 2
  v_add_u32 v13, s22, v13
  v_cndmask_b32 v12, v13, v12, vcc
  v_lshl_add_u32 v11, v11, 4, v12
  v_lshlrev_b32 v11, 7, v11
  v_bfe_u32 v5, v4, 2, 2
  v_lshlrev_b32 v5, 4, v5
  v_bfe_u32 v6, v4, 4, 1
  s_movk_i32 s22, 640
  v_mad_u32_u24 v5, v6, s22, v5
  v_lshrrev_b32 v8, 5, v4
  v_and_b32 v6, 1, v4
  v_bfe_u32 v10, v4, 1, 1
  s_movk_i32 s22, 320
  v_mad_u32_u24 v9, v10, s22, v5
  v_lshl_add_u32 v9, v6, 3, v9
  v_mad_u32_u24 v7, v6, s22, v5
  v_lshl_add_u32 v7, v10, 3, v7
  v_lshl_add_u32 v1, v8, 6, v7
  v_add_u32 v3, 256, v7
  v_add_u32 v9, s34, v9
  v_lshl_add_u32 v10, v8, 6, v9
  v_and_b32 v6, 31, v4
  v_min_u32 v7, 19, v6
  v_cmp_eq_u32 vcc, 22, v6
  s_nop 1
  v_cndmask_b32 v7, v7, 18, vcc
  v_mul_u32_u24 v8, 320, v8
  v_lshl_add_u32 v2, v7, 4, v8
  v_add_u32 v2, 1280, v2
  v_cmp_gt_u32 s[28:29], 32, v4
  s_add_u32 s16, s8, 11796480
  s_addc_u32 s17, s9, 0
  s_mov_b32 s18, 2359296
  s_mov_b32 s19, 131072
  s_mul_i32 s21, s21, 36864
  s_lshl_b32 s22, s4, 10
  s_add_u32 s30, s21, s22
  s_lshl_b32 s22, s4, 7
  s_add_u32 s31, s21, s22
  s_add_u32 s31, s31, 32768
  v_lshlrev_b32 v206, 2, v4
  s_mov_b32 s24, 0
  s_mov_b32 s25, 1
  s_waitcnt vmcnt(0)
  s_barrier
  s_cmp_lg_u32 s20, 0
  s_cbranch_scc1 L_a1_sf
  v_mov_b32 v12, s3
  v_mov_b32 v13, 0
  s_mov_b64 exec, 1
  buffer_store_dword v12, v13, s[8:11], s73 offen sc1
  s_mov_b64 exec, -1
L_a1_sf:
  v_mov_b32 v128, 0
  v_mov_b32 v129, 0
  v_mov_b32 v130, 0
  v_mov_b32 v131, 0
  v_mov_b32 v132, 0
  v_mov_b32 v133, 0
  v_mov_b32 v134, 0
  v_mov_b32 v135, 0
  v_mov_b32 v136, 0
  v_mov_b32 v137, 0
  v_mov_b32 v138, 0
  v_mov_b32 v139, 0
  v_mov_b32 v140, 0
  v_mov_b32 v141, 0
  v_mov_b32 v142, 0
  v_mov_b32 v143, 0
  v_mov_b32 v144, 0
  v_mov_b32 v145, 0
  v_mov_b32 v146, 0
  v_mov_b32 v147, 0
  v_mov_b32 v148, 0
  v_mov_b32 v149, 0
  v_mov_b32 v150, 0
  v_mov_b32 v151, 0
  v_mov_b32 v152, 0
  v_mov_b32 v153, 0
  v_mov_b32 v154, 0
  v_mov_b32 v155, 0
  v_mov_b32 v156, 0
  v_mov_b32 v157, 0
  v_mov_b32 v158, 0
  v_mov_b32 v159, 0
  v_mov_b32 v88, 0
  v_mov_b32 v72, 0
  v_mov_b32 v89, 0
  v_mov_b32 v73, 0
  v_mov_b32 v90, 0
  v_mov_b32 v74, 0
  v_mov_b32 v91, 0
  v_mov_b32 v75, 0
  v_mov_b32 v92, 0
  v_mov_b32 v76, 0
  v_mov_b32 v93, 0
  v_mov_b32 v77, 0
  v_mov_b32 v94, 0
  v_mov_b32 v78, 0
  v_mov_b32 v95, 0
  v_mov_b32 v79, 0
  s_lshl_b32 s21, s4, 2
  s_add_u32 s21, s21, s5
  s_lshl_b32 s21, s21, 2
  s_add_u32 s21, s21, s20
  s_mov_b32 s36, s48
  s_mov_b32 s37, s49
  s_mov_b32 s38, 5308416
  s_mov_b32 s39, 131072
  s_mov_b32 s40, s50
  s_mov_b32 s41, s51
  s_mov_b32 s42, 5308416
  s_mov_b32 s43, 131072
  s_mov_b32 s44, s52
  s_mov_b32 s45, s53
  s_mov_b32 s46, 663552
  s_mov_b32 s47, 131072
  v_mul_u32_u24 v245, 57, v4
  v_lshrrev_b32 v245, 9, v245
  v_mul_u32_u24 v244, 9, v245
  v_sub_u32 v244, v4, v244
  s_mul_i32 s22, s21, 9
  v_add_u32 v244, s22, v244
  v_and_b32 v240, 7, v244
  v_lshrrev_b32 v241, 3, v244
  s_movk_i32 s22, 9216
  v_mul_u32_u24 v242, 1152, v240
  v_mad_u32_u24 v242, v241, s22, v242
  v_lshl_add_u32 v242, v245, 7, v242
  s_mul_i32 s22, s21, 21
  v_add_u32 v243, s22, v4
  v_lshlrev_b32 v243, 7, v243
  v_mov_b32 v244, 2146435072
  v_cmp_gt_u32 vcc, 27, v4
  s_nop 1
  v_cndmask_b32 v198, v244, v242, vcc
  v_cmp_gt_u32 vcc, 21, v4
  s_nop 1
  v_cndmask_b32 v199, v244, v243, vcc
  s_mov_b32 s56, 512
  s_mov_b32 s57, 0
  s_mov_b32 s58, 896
  s_getpc_b64 s[60:61]
L_at_cs:
  s_add_u32 s60, s60, L_cs-L_at_cs
  s_addc_u32 s61, s61, (L_cs-L_at_cs)>>32
  s_mov_b32 s62, L_exit-L_cs
  s_mov_b32 s63, 131072
  s_and_b32 s21, s21, 63
  s_lshl_b32 s54, s21, 13
  s_sub_u32 s54, s54, 2621440
  v_lshlrev_b32 v201, 7, v4
  v_add_u32 v201, s54, v201
  v_add_u32 v205, 2621440, v201
  s_mov_b32 s21, 14352384
  s_cmp_lg_u32 s20, 0
  s_cbranch_scc1 L_at_wq_d
  s_mov_b32 s22, 1048576
L_at_wq:
  buffer_load_dword v12, v11, s[8:11], s21 offen sc1
  s_sub_u32 s22, s22, 1
  s_waitcnt vmcnt(0)
  v_cmp_ne_u32 vcc, s3, v12
  s_cmp_eq_u32 s22, 0
  s_cbranch_scc1 L_at_wq_d
  s_cmp_lg_u64 vcc, 0
  s_cbranch_scc1 L_at_wq
L_at_wq_d:
  s_barrier
  s_mov_b32 m0, s32
  s_nop 0
  buffer_load_dwordx4 v197, s[12:15], s32 offen sc1 lds
  s_add_u32 s32, s32, 4096
  s_add_u32 m0, s34, 0
  s_nop 0
  buffer_load_dwordx4 v197, s[8:11], s33 offen sc1 lds
  buffer_load_dword v206, s[8:11], s33 offen offset:1024 sc1 lds
  s_add_u32 s33, s33, 2560
  s_add_u32 m0, s34, 1280
  s_nop 0
  buffer_load_dwordx4 v197, s[8:11], s33 offen sc1 lds
  buffer_load_dword v206, s[8:11], s33 offen offset:1024 sc1 lds
  s_add_u32 s33, s33, 2560
  s_add_u32 m0, s34, 2560
  s_nop 0
  buffer_load_dwordx4 v197, s[8:11], s33 offen sc1 lds
  buffer_load_dword v206, s[8:11], s33 offen offset:1024 sc1 lds
  s_add_u32 s33, s33, 2560
  s_add_u32 m0, s34, 3840
  s_nop 0
  buffer_load_dwordx4 v197, s[8:11], s33 offen sc1 lds
  buffer_load_dword v206, s[8:11], s33 offen offset:1024 sc1 lds
  s_add_u32 s33, s33, 2560
  s_mov_b32 m0, s32
  s_nop 0
  buffer_load_dwordx4 v197, s[12:15], s32 offen sc1 lds
  s_add_u32 s32, s32, 4096
  s_mov_b32 m0, s32
  s_nop 0
  buffer_load_dwordx4 v197, s[12:15], s32 offen sc1 lds
  s_add_u32 s32, s32, 4096
  s_mov_b32 m0, s32
  s_nop 0
  buffer_load_dwordx4 v197, s[12:15], s32 offen sc1 lds
  s_add_u32 s32, s32, 4096
  s_mov_b32 m0, s32
  s_nop 0
  buffer_load_dwordx4 v197, s[12:15], s32 offen sc1 lds
  s_add_u32 s32, s32, 4096
  s_mov_b32 m0, s32
  s_nop 0
  buffer_load_dwordx4 v197, s[12:15], s32 offen sc1 lds
  s_add_u32 s32, s32, 4096
  s_waitcnt vmcnt(5)
  s_barrier
  ds_read_b64_tr_b16 v[16:17], v10 offset:0
  ds_read_b64_tr_b16 v[18:19], v10 offset:128
  ds_read_b64_tr_b16 v[20:21], v9 offset:256
  ds_read_b64_tr_b16 v[24:25], v10 offset:1280
  ds_read_b64_tr_b16 v[26:27], v10 offset:1408
  ds_read_b64_tr_b16 v[28:29], v9 offset:1536
  ds_read_b64_tr_b16 v[32:33], v10 offset:2560
  ds_read_b64_tr_b16 v[34:35], v10 offset:2688
  ds_read_b64_tr_b16 v[36:37], v9 offset:2816
  ds_read_b64_tr_b16 v[40:41], v10 offset:3840
  ds_read_b64_tr_b16 v[42:43], v10 offset:3968
  ds_read_b64_tr_b16 v[44:45], v9 offset:4096
  s_waitcnt lgkmcnt(9)
  v_cndmask_b32 v20, 0, v20, s[28:29]
  s_waitcnt lgkmcnt(6)
  v_cndmask_b32 v28, 0, v28, s[28:29]
  s_waitcnt lgkmcnt(3)
  v_cndmask_b32 v36, 0, v36, s[28:29]
  s_waitcnt lgkmcnt(0)
  v_cndmask_b32 v44, 0, v44, s[28:29]
L_at_max:
  v_mov_b32 v21, 0
  v_mov_b32 v192, 4286578688
  v_mov_b32 v29, 0
  v_mov_b32 v193, 4286578688
  v_mov_b32 v37, 0
  v_mov_b32 v194, 4286578688
  v_mov_b32 v45, 0
  v_mov_b32 v195, 4286578688
  v_mov_b32 v5, v1
  v_mov_b32 v6, v3
L_at_maxloop:
  ds_read_b64_tr_b16 v[48:49], v5 offset:0
  ds_read_b64_tr_b16 v[50:51], v5 offset:128
  ds_read_b64_tr_b16 v[52:53], v6 offset:0
  v_add_u32 v5, 2560, v5
  v_add_u32 v6, 2560, v6
  s_waitcnt lgkmcnt(1)
  v_mfma_f32_32x32x16_bf16 v[96:111], v[48:51], v[16:19], 0
  s_waitcnt lgkmcnt(0)
  v_mfma_f32_32x32x8_bf16 v[96:111], v[52:53], v[20:21], v[96:111]
  v_mfma_f32_32x32x16_bf16 v[112:127], v[48:51], v[24:27], 0
  v_mfma_f32_32x32x8_bf16 v[112:127], v[52:53], v[28:29], v[112:127]
  v_mfma_f32_32x32x16_bf16 v[160:175], v[48:51], v[32:35], 0
  v_mfma_f32_32x32x8_bf16 v[160:175], v[52:53], v[36:37], v[160:175]
  v_mfma_f32_32x32x16_bf16 v[176:191], v[48:51], v[40:43], 0
  v_mfma_f32_32x32x8_bf16 v[176:191], v[52:53], v[44:45], v[176:191]
  s_nop 5
  v_max3_f32 v192, v192, v96, v97
  v_max3_f32 v192, v192, v98, v99
  v_max3_f32 v192, v192, v100, v101
  v_max3_f32 v192, v192, v102, v103
  v_max3_f32 v192, v192, v104, v105
  v_max3_f32 v192, v192, v106, v107
  v_max3_f32 v192, v192, v108, v109
  v_max3_f32 v192, v192, v110, v111
  v_max3_f32 v193, v193, v112, v113
  v_max3_f32 v193, v193, v114, v115
  v_max3_f32 v193, v193, v116, v117
  v_max3_f32 v193, v193, v118, v119
  v_max3_f32 v193, v193, v120, v121
  v_max3_f32 v193, v193, v122, v123
  v_max3_f32 v193, v193, v124, v125
  v_max3_f32 v193, v193, v126, v127
  v_max3_f32 v194, v194, v160, v161
  v_max3_f32 v194, v194, v162, v163
  v_max3_f32 v194, v194, v164, v165
  v_max3_f32 v194, v194, v166, v167
  v_max3_f32 v194, v194, v168, v169
  v_max3_f32 v194, v194, v170, v171
  v_max3_f32 v194, v194, v172, v173
  v_max3_f32 v194, v194, v174, v175
  v_max3_f32 v195, v195, v176, v177
  v_max3_f32 v195, v195, v178, v179
  v_max3_f32 v195, v195, v180, v181
  v_max3_f32 v195, v195, v182, v183
  v_max3_f32 v195, v195, v184, v185
  v_max3_f32 v195, v195, v186, v187
  v_max3_f32 v195, v195, v188, v189
  v_max3_f32 v195, v195, v190, v191
  s_sub_u32 s25, s25, 1
  s_cmp_lg_u32 s25, 0
  s_cbranch_scc1 L_at_maxloop
  ds_read_b64_tr_b16 v[48:49], v1 offset:0
  ds_read_b64_tr_b16 v[50:51], v1 offset:128
  ds_read_b64_tr_b16 v[52:53], v3 offset:0
  ds_read_b128 v[64:67], v2 offset:0
  ds_read_b128 v[68:71], v2 offset:640
  v_mov_b32 v8, v192
  v_mov_b32 v9, v193
  v_mov_b32 v10, v194
  v_mov_b32 v11, v195
  v_permlane32_swap_b32 v8, v192
  v_permlane32_swap_b32 v9, v193
  v_permlane32_swap_b32 v10, v194
  v_permlane32_swap_b32 v11, v195
  v_max_f32 v5, v8, v192
  v_xor_b32 v5, 2147483648, v5
  v_and_b32 v6, 4294901760, v5
  v_sub_f32 v5, v5, v6
  v_and_b32 v7, 4294901760, v5
  v_sub_f32 v5, v5, v7
  v_lshrrev_b32 v6, 16, v6
  v_or_b32 v6, v6, v7
  v_lshrrev_b32 v5, 16, v5
  v_cndmask_b32 v21, v5, v6, s[28:29]
  v_max_f32 v5, v9, v193
  v_xor_b32 v5, 2147483648, v5
  v_and_b32 v6, 4294901760, v5
  v_sub_f32 v5, v5, v6
  v_and_b32 v7, 4294901760, v5
  v_sub_f32 v5, v5, v7
  v_lshrrev_b32 v6, 16, v6
  v_or_b32 v6, v6, v7
  v_lshrrev_b32 v5, 16, v5
  v_cndmask_b32 v29, v5, v6, s[28:29]
  v_max_f32 v5, v10, v194
  v_xor_b32 v5, 2147483648, v5
  v_and_b32 v6, 4294901760, v5
  v_sub_f32 v5, v5, v6
  v_and_b32 v7, 4294901760, v5
  v_sub_f32 v5, v5, v7
  v_lshrrev_b32 v6, 16, v6
  v_or_b32 v6, v6, v7
  v_lshrrev_b32 v5, 16, v5
  v_cndmask_b32 v37, v5, v6, s[28:29]
  v_max_f32 v5, v11, v195
  v_xor_b32 v5, 2147483648, v5
  v_and_b32 v6, 4294901760, v5
  v_sub_f32 v5, v5, v6
  v_and_b32 v7, 4294901760, v5
  v_sub_f32 v5, v5, v7
  v_lshrrev_b32 v6, 16, v6
  v_or_b32 v6, v6, v7
  v_lshrrev_b32 v5, 16, v5
  v_cndmask_b32 v45, v5, v6, s[28:29]
  v_mov_b32 v120, 0
  v_mov_b32 v121, 0
  v_mov_b32 v122, 0
  v_mov_b32 v123, 0
  v_mov_b32 v124, 0
  v_mov_b32 v125, 0
  v_mov_b32 v126, 0
  v_mov_b32 v127, 0
  s_waitcnt lgkmcnt(3)
  v_mfma_f32_32x32x16_bf16 v[96:111], v[48:51], v[16:19], 0
  s_waitcnt lgkmcnt(2)
  v_mfma_f32_32x32x8_bf16 v[96:111], v[52:53], v[20:21], v[96:111]
  v_mov_b32 v160, 0
  v_mov_b32 v161, 0
  v_mov_b32 v162, 0
  v_mov_b32 v163, 0
  v_mov_b32 v164, 0
  v_mov_b32 v165, 0
  v_mov_b32 v166, 0
  v_mov_b32 v167, 0
  v_mov_b32 v168, 0
  v_mov_b32 v169, 0
  v_mov_b32 v170, 0
  v_mov_b32 v171, 0
  v_mov_b32 v172, 0
  v_mov_b32 v173, 0
  v_mov_b32 v174, 0
  v_mov_b32 v175, 0
  v_mov_b32 v176, 0
  v_mov_b32 v177, 0
  v_mov_b32 v178, 0
  v_mov_b32 v179, 0
  v_mov_b32 v180, 0
  v_mov_b32 v181, 0
  v_mov_b32 v182, 0
  v_mov_b32 v183, 0
  v_mov_b32 v184, 0
  v_mov_b32 v185, 0
  v_mov_b32 v186, 0
  v_mov_b32 v187, 0
  v_mov_b32 v188, 0
  v_mov_b32 v189, 0
  v_mov_b32 v190, 0
  v_mov_b32 v191, 0
  s_cmp_lg_u32 s24, 0
  s_cbranch_scc1 L_at_nobar0
  s_waitcnt vmcnt(0)
  s_barrier
L_at_nobar0:
  s_mov_b32 s23, 8
  s_waitcnt lgkmcnt(0)
  s_nop 10
.p2align 3
L_at_loop:
  v_mfma_f32_32x32x16_bf16 v[176:191], v[72:75], v[88:91], v[176:191]
  buffer_load_dword v204, v198, s[36:39], s56 offen
  v_exp_f32 v96, v96
  v_cvt_pk_bf16_f32 v95, v126, v127
  v_exp_f32 v97, v97
  v_exp_f32 v98, v98
  v_cvt_pk_bf16_f32 v80, v96, v97
  v_exp_f32 v99, v99
  v_mfma_f32_32x32x16_bf16 v[112:127], v[48:51], v[24:27], 0
  buffer_load_dword v204, v199, s[40:43], s57 offen
  v_exp_f32 v100, v100
  v_cvt_pk_bf16_f32 v81, v98, v99
  v_exp_f32 v101, v101
  v_exp_f32 v102, v102
  v_cvt_pk_bf16_f32 v82, v100, v101
  v_exp_f32 v103, v103
  v_mfma_f32_32x32x8_bf16 v[112:127], v[52:53], v[28:29], v[112:127]
  v_exp_f32 v104, v104
  v_cvt_pk_bf16_f32 v83, v102, v103
  v_exp_f32 v105, v105
  v_exp_f32 v106, v106
  v_cvt_pk_bf16_f32 v84, v104, v105
  v_exp_f32 v107, v107
  v_mfma_f32_32x32x16_bf16 v[176:191], v[76:79], v[92:95], v[176:191]
  s_mov_b32 s56, s58
  v_exp_f32 v108, v108
  v_cvt_pk_bf16_f32 v85, v106, v107
  v_exp_f32 v109, v109
  v_exp_f32 v110, v110
  v_cvt_pk_bf16_f32 v86, v108, v109
  v_exp_f32 v111, v111
  v_mfma_f32_32x32x16_bf16 v[128:143], v[64:67], v[80:83], v[128:143]
  ds_read_b64_tr_b16 v[56:57], v1 offset:2560
  ds_read_b64_tr_b16 v[58:59], v1 offset:2688
  v_exp_f32 v112, v112
  v_cvt_pk_bf16_f32 v87, v110, v111
  v_exp_f32 v113, v113
  v_exp_f32 v114, v114
  v_cvt_pk_bf16_f32 v88, v112, v113
  v_exp_f32 v115, v115
  v_mfma_f32_32x32x16_bf16 v[96:111], v[48:51], v[32:35], 0
  ds_read_b64_tr_b16 v[60:61], v3 offset:2560
  ds_read_b128 v[72:75], v2 offset:2560
  v_exp_f32 v116, v116
  v_cvt_pk_bf16_f32 v89, v114, v115
  v_exp_f32 v117, v117
  v_exp_f32 v118, v118
  v_cvt_pk_bf16_f32 v90, v116, v117
  v_exp_f32 v119, v119
  v_mfma_f32_32x32x8_bf16 v[96:111], v[52:53], v[36:37], v[96:111]
  v_exp_f32 v120, v120
  v_cvt_pk_bf16_f32 v91, v118, v119
  v_exp_f32 v121, v121
  v_exp_f32 v122, v122
  v_cvt_pk_bf16_f32 v92, v120, v121
  v_exp_f32 v123, v123
  v_mfma_f32_32x32x16_bf16 v[128:143], v[68:71], v[84:87], v[128:143]
  ds_read_b128 v[76:79], v2 offset:3200
  v_exp_f32 v124, v124
  v_cvt_pk_bf16_f32 v93, v122, v123
  v_exp_f32 v125, v125
  v_exp_f32 v126, v126
  v_cvt_pk_bf16_f32 v94, v124, v125
  v_exp_f32 v127, v127
  v_mfma_f32_32x32x16_bf16 v[144:159], v[64:67], v[88:91], v[144:159]
  s_mov_b32 m0, s32
  v_exp_f32 v96, v96
  v_cvt_pk_bf16_f32 v95, v126, v127
  v_exp_f32 v97, v97
  v_exp_f32 v98, v98
  v_cvt_pk_bf16_f32 v80, v96, v97
  v_exp_f32 v99, v99
  v_mfma_f32_32x32x16_bf16 v[112:127], v[48:51], v[40:43], 0
  buffer_load_dwordx4 v197, s[12:15], s32 offen sc1 lds
  v_exp_f32 v100, v100
  v_cvt_pk_bf16_f32 v81, v98, v99
  v_exp_f32 v101, v101
  v_exp_f32 v102, v102
  v_cvt_pk_bf16_f32 v82, v100, v101
  v_exp_f32 v103, v103
  v_mfma_f32_32x32x8_bf16 v[112:127], v[52:53], v[44:45], v[112:127]
  v_exp_f32 v104, v104
  v_cvt_pk_bf16_f32 v83, v102, v103
  v_exp_f32 v105, v105
  v_exp_f32 v106, v106
  v_cvt_pk_bf16_f32 v84, v104, v105
  v_exp_f32 v107, v107
  v_mfma_f32_32x32x16_bf16 v[144:159], v[68:71], v[92:95], v[144:159]
  s_add_u32 s32, s32, 4096
  v_exp_f32 v108, v108
  v_cvt_pk_bf16_f32 v85, v106, v107
  v_exp_f32 v109, v109
  v_exp_f32 v110, v110
  v_cvt_pk_bf16_f32 v86, v108, v109
  v_exp_f32 v111, v111
  v_mfma_f32_32x32x16_bf16 v[160:175], v[64:67], v[80:83], v[160:175]
  s_waitcnt lgkmcnt(0)
  v_exp_f32 v112, v112
  v_cvt_pk_bf16_f32 v87, v110, v111
  v_exp_f32 v113, v113
  v_exp_f32 v114, v114
  v_cvt_pk_bf16_f32 v88, v112, v113
  v_exp_f32 v115, v115
  v_mfma_f32_32x32x16_bf16 v[96:111], v[56:59], v[16:19], 0
  v_exp_f32 v116, v116
  v_cvt_pk_bf16_f32 v89, v114, v115
  v_exp_f32 v117, v117
  v_exp_f32 v118, v118
  v_cvt_pk_bf16_f32 v90, v116, v117
  v_exp_f32 v119, v119
  v_mfma_f32_32x32x8_bf16 v[96:111], v[60:61], v[20:21], v[96:111]
  v_exp_f32 v120, v120
  v_cvt_pk_bf16_f32 v91, v118, v119
  v_exp_f32 v121, v121
  v_exp_f32 v122, v122
  v_cvt_pk_bf16_f32 v92, v120, v121
  v_exp_f32 v123, v123
  v_mfma_f32_32x32x16_bf16 v[160:175], v[68:71], v[84:87], v[160:175]
  v_exp_f32 v124, v124
  v_cvt_pk_bf16_f32 v93, v122, v123
  v_exp_f32 v125, v125
  v_exp_f32 v126, v126
  v_cvt_pk_bf16_f32 v94, v124, v125
  v_exp_f32 v127, v127
  v_mfma_f32_32x32x16_bf16 v[176:191], v[64:67], v[88:91], v[176:191]
  s_add_u32 s57, s57, 1376256
  v_exp_f32 v96, v96
  v_cvt_pk_bf16_f32 v95, v126, v127
  v_exp_f32 v97, v97
  v_exp_f32 v98, v98
  v_cvt_pk_bf16_f32 v80, v96, v97
  v_exp_f32 v99, v99
  v_mfma_f32_32x32x16_bf16 v[112:127], v[56:59], v[24:27], 0
  s_mov_b32 s58, 536870912
  v_exp_f32 v100, v100
  v_cvt_pk_bf16_f32 v81, v98, v99
  v_exp_f32 v101, v101
  v_exp_f32 v102, v102
  v_cvt_pk_bf16_f32 v82, v100, v101
  v_exp_f32 v103, v103
  v_mfma_f32_32x32x8_bf16 v[112:127], v[60:61], v[28:29], v[112:127]
  v_exp_f32 v104, v104
  v_cvt_pk_bf16_f32 v83, v102, v103
  v_exp_f32 v105, v105
  v_exp_f32 v106, v106
  v_cvt_pk_bf16_f32 v84, v104, v105
  v_exp_f32 v107, v107
  v_mfma_f32_32x32x16_bf16 v[176:191], v[68:71], v[92:95], v[176:191]
  v_exp_f32 v108, v108
  v_cvt_pk_bf16_f32 v85, v106, v107
  v_exp_f32 v109, v109
  v_exp_f32 v110, v110
  v_cvt_pk_bf16_f32 v86, v108, v109
  v_exp_f32 v111, v111
  v_mfma_f32_32x32x16_bf16 v[128:143], v[72:75], v[80:83], v[128:143]
  ds_read_b64_tr_b16 v[48:49], v1 offset:5120
  ds_read_b64_tr_b16 v[50:51], v1 offset:5248
  v_exp_f32 v112, v112
  v_cvt_pk_bf16_f32 v87, v110, v111
  v_exp_f32 v113, v113
  v_exp_f32 v114, v114
  v_cvt_pk_bf16_f32 v88, v112, v113
  v_exp_f32 v115, v115
  v_mfma_f32_32x32x16_bf16 v[96:111], v[56:59], v[32:35], 0
  ds_read_b64_tr_b16 v[52:53], v3 offset:5120
  ds_read_b128 v[64:67], v2 offset:5120
  v_exp_f32 v116, v116
  v_cvt_pk_bf16_f32 v89, v114, v115
  v_exp_f32 v117, v117
  v_exp_f32 v118, v118
  v_cvt_pk_bf16_f32 v90, v116, v117
  v_exp_f32 v119, v119
  v_mfma_f32_32x32x8_bf16 v[96:111], v[60:61], v[36:37], v[96:111]
  v_exp_f32 v120, v120
  v_cvt_pk_bf16_f32 v91, v118, v119
  v_exp_f32 v121, v121
  v_exp_f32 v122, v122
  v_cvt_pk_bf16_f32 v92, v120, v121
  v_exp_f32 v123, v123
  v_mfma_f32_32x32x16_bf16 v[128:143], v[76:79], v[84:87], v[128:143]
  ds_read_b128 v[68:71], v2 offset:5760
  v_exp_f32 v124, v124
  v_cvt_pk_bf16_f32 v93, v122, v123
  v_exp_f32 v125, v125
  v_exp_f32 v126, v126
  v_cvt_pk_bf16_f32 v94, v124, v125
  v_exp_f32 v127, v127
  v_mfma_f32_32x32x16_bf16 v[144:159], v[72:75], v[88:91], v[144:159]
  s_mov_b32 m0, s32
  v_exp_f32 v96, v96
  v_cvt_pk_bf16_f32 v95, v126, v127
  v_exp_f32 v97, v97
  v_exp_f32 v98, v98
  v_cvt_pk_bf16_f32 v80, v96, v97
  v_exp_f32 v99, v99
  v_mfma_f32_32x32x16_bf16 v[112:127], v[56:59], v[40:43], 0
  buffer_load_dwordx4 v197, s[12:15], s32 offen sc1 lds
  v_exp_f32 v100, v100
  v_cvt_pk_bf16_f32 v81, v98, v99
  v_exp_f32 v101, v101
  v_exp_f32 v102, v102
  v_cvt_pk_bf16_f32 v82, v100, v101
  v_exp_f32 v103, v103
  v_mfma_f32_32x32x8_bf16 v[112:127], v[60:61], v[44:45], v[112:127]
  v_exp_f32 v104, v104
  v_cvt_pk_bf16_f32 v83, v102, v103
  v_exp_f32 v105, v105
  v_exp_f32 v106, v106
  v_cvt_pk_bf16_f32 v84, v104, v105
  v_exp_f32 v107, v107
  v_mfma_f32_32x32x16_bf16 v[144:159], v[76:79], v[92:95], v[144:159]
  s_add_u32 s32, s32, 4096
  v_exp_f32 v108, v108
  v_cvt_pk_bf16_f32 v85, v106, v107
  v_exp_f32 v109, v109
  v_exp_f32 v110, v110
  v_cvt_pk_bf16_f32 v86, v108, v109
  v_exp_f32 v111, v111
  v_mfma_f32_32x32x16_bf16 v[160:175], v[72:75], v[80:83], v[160:175]
  s_waitcnt lgkmcnt(0)
  v_exp_f32 v112, v112
  v_cvt_pk_bf16_f32 v87, v110, v111
  v_exp_f32 v113, v113
  v_exp_f32 v114, v114
  v_cvt_pk_bf16_f32 v88, v112, v113
  v_exp_f32 v115, v115
  v_mfma_f32_32x32x16_bf16 v[96:111], v[48:51], v[16:19], 0
  v_exp_f32 v116, v116
  v_cvt_pk_bf16_f32 v89, v114, v115
  v_exp_f32 v117, v117
  v_exp_f32 v118, v118
  v_cvt_pk_bf16_f32 v90, v116, v117
  v_exp_f32 v119, v119
  v_mfma_f32_32x32x8_bf16 v[96:111], v[52:53], v[20:21], v[96:111]
  v_exp_f32 v120, v120
  v_cvt_pk_bf16_f32 v91, v118, v119
  v_exp_f32 v121, v121
  v_exp_f32 v122, v122
  v_cvt_pk_bf16_f32 v92, v120, v121
  v_exp_f32 v123, v123
  v_mfma_f32_32x32x16_bf16 v[160:175], v[76:79], v[84:87], v[160:175]
  v_exp_f32 v124, v124
  v_cvt_pk_bf16_f32 v93, v122, v123
  v_exp_f32 v125, v125
  v_exp_f32 v126, v126
  v_cvt_pk_bf16_f32 v94, v124, v125
  v_exp_f32 v127, v127
  v_mfma_f32_32x32x16_bf16 v[176:191], v[72:75], v[88:91], v[176:191]
  v_exp_f32 v96, v96
  v_cvt_pk_bf16_f32 v95, v126, v127
  v_exp_f32 v97, v97
  v_exp_f32 v98, v98
  v_cvt_pk_bf16_f32 v80, v96, v97
  v_exp_f32 v99, v99
  v_mfma_f32_32x32x16_bf16 v[112:127], v[48:51], v[24:27], 0
  v_exp_f32 v100, v100
  v_cvt_pk_bf16_f32 v81, v98, v99
  v_exp_f32 v101, v101
  v_exp_f32 v102, v102
  v_cvt_pk_bf16_f32 v82, v100, v101
  v_exp_f32 v103, v103
  v_mfma_f32_32x32x8_bf16 v[112:127], v[52:53], v[28:29], v[112:127]
  v_exp_f32 v104, v104
  v_cvt_pk_bf16_f32 v83, v102, v103
  v_exp_f32 v105, v105
  v_exp_f32 v106, v106
  v_cvt_pk_bf16_f32 v84, v104, v105
  v_exp_f32 v107, v107
  v_mfma_f32_32x32x16_bf16 v[176:191], v[76:79], v[92:95], v[176:191]
  v_exp_f32 v108, v108
  v_cvt_pk_bf16_f32 v85, v106, v107
  v_exp_f32 v109, v109
  v_exp_f32 v110, v110
  v_cvt_pk_bf16_f32 v86, v108, v109
  v_exp_f32 v111, v111
  v_mfma_f32_32x32x16_bf16 v[128:143], v[64:67], v[80:83], v[128:143]
  ds_read_b64_tr_b16 v[56:57], v1 offset:7680
  ds_read_b64_tr_b16 v[58:59], v1 offset:7808
  v_exp_f32 v112, v112
  v_cvt_pk_bf16_f32 v87, v110, v111
  v_exp_f32 v113, v113
  v_exp_f32 v114, v114
  v_cvt_pk_bf16_f32 v88, v112, v113
  v_exp_f32 v115, v115
  v_mfma_f32_32x32x16_bf16 v[96:111], v[48:51], v[32:35], 0
  ds_read_b64_tr_b16 v[60:61], v3 offset:7680
  ds_read_b128 v[72:75], v2 offset:7680
  v_exp_f32 v116, v116
  v_cvt_pk_bf16_f32 v89, v114, v115
  v_exp_f32 v117, v117
  v_exp_f32 v118, v118
  v_cvt_pk_bf16_f32 v90, v116, v117
  v_exp_f32 v119, v119
  v_mfma_f32_32x32x8_bf16 v[96:111], v[52:53], v[36:37], v[96:111]
  v_exp_f32 v120, v120
  v_cvt_pk_bf16_f32 v91, v118, v119
  v_exp_f32 v121, v121
  v_exp_f32 v122, v122
  v_cvt_pk_bf16_f32 v92, v120, v121
  v_exp_f32 v123, v123
  v_mfma_f32_32x32x16_bf16 v[128:143], v[68:71], v[84:87], v[128:143]
  ds_read_b128 v[76:79], v2 offset:8320
  v_exp_f32 v124, v124
  v_cvt_pk_bf16_f32 v93, v122, v123
  v_exp_f32 v125, v125
  v_exp_f32 v126, v126
  v_cvt_pk_bf16_f32 v94, v124, v125
  v_exp_f32 v127, v127
  v_mfma_f32_32x32x16_bf16 v[144:159], v[64:67], v[88:91], v[144:159]
  s_mov_b32 m0, s32
  v_exp_f32 v96, v96
  v_cvt_pk_bf16_f32 v95, v126, v127
  v_exp_f32 v97, v97
  v_exp_f32 v98, v98
  v_cvt_pk_bf16_f32 v80, v96, v97
  v_exp_f32 v99, v99
  v_mfma_f32_32x32x16_bf16 v[112:127], v[48:51], v[40:43], 0
  buffer_load_dwordx4 v197, s[12:15], s32 offen sc1 lds
  v_exp_f32 v100, v100
  v_cvt_pk_bf16_f32 v81, v98, v99
  v_exp_f32 v101, v101
  v_exp_f32 v102, v102
  v_cvt_pk_bf16_f32 v82, v100, v101
  v_exp_f32 v103, v103
  v_mfma_f32_32x32x8_bf16 v[112:127], v[52:53], v[44:45], v[112:127]
  v_exp_f32 v104, v104
  v_cvt_pk_bf16_f32 v83, v102, v103
  v_exp_f32 v105, v105
  v_exp_f32 v106, v106
  v_cvt_pk_bf16_f32 v84, v104, v105
  v_exp_f32 v107, v107
  v_mfma_f32_32x32x16_bf16 v[144:159], v[68:71], v[92:95], v[144:159]
  s_add_u32 s32, s32, 4096
  v_exp_f32 v108, v108
  v_cvt_pk_bf16_f32 v85, v106, v107
  v_exp_f32 v109, v109
  v_exp_f32 v110, v110
  v_cvt_pk_bf16_f32 v86, v108, v109
  v_exp_f32 v111, v111
  v_mfma_f32_32x32x16_bf16 v[160:175], v[64:67], v[80:83], v[160:175]
  s_waitcnt lgkmcnt(0)
  v_exp_f32 v112, v112
  v_cvt_pk_bf16_f32 v87, v110, v111
  v_exp_f32 v113, v113
  v_exp_f32 v114, v114
  v_cvt_pk_bf16_f32 v88, v112, v113
  v_exp_f32 v115, v115
  v_mfma_f32_32x32x16_bf16 v[96:111], v[56:59], v[16:19], 0
  v_exp_f32 v116, v116
  v_cvt_pk_bf16_f32 v89, v114, v115
  v_exp_f32 v117, v117
  v_exp_f32 v118, v118
  v_cvt_pk_bf16_f32 v90, v116, v117
  v_exp_f32 v119, v119
  v_mfma_f32_32x32x8_bf16 v[96:111], v[60:61], v[20:21], v[96:111]
  v_exp_f32 v120, v120
  v_cvt_pk_bf16_f32 v91, v118, v119
  v_exp_f32 v121, v121
  v_exp_f32 v122, v122
  v_cvt_pk_bf16_f32 v92, v120, v121
  v_exp_f32 v123, v123
  v_mfma_f32_32x32x16_bf16 v[160:175], v[68:71], v[84:87], v[160:175]
  v_exp_f32 v124, v124
  v_cvt_pk_bf16_f32 v93, v122, v123
  v_exp_f32 v125, v125
  v_exp_f32 v126, v126
  v_cvt_pk_bf16_f32 v94, v124, v125
  v_exp_f32 v127, v127
  v_mfma_f32_32x32x16_bf16 v[176:191], v[64:67], v[88:91], v[176:191]
  v_exp_f32 v96, v96
  v_cvt_pk_bf16_f32 v95, v126, v127
  v_exp_f32 v97, v97
  v_exp_f32 v98, v98
  v_cvt_pk_bf16_f32 v80, v96, v97
  v_exp_f32 v99, v99
  v_mfma_f32_32x32x16_bf16 v[112:127], v[56:59], v[24:27], 0
  buffer_load_dword v202, v205, s[60:63], 0 offen
  v_exp_f32 v100, v100
  v_cvt_pk_bf16_f32 v81, v98, v99
  v_exp_f32 v101, v101
  v_exp_f32 v102, v102
  v_cvt_pk_bf16_f32 v82, v100, v101
  v_exp_f32 v103, v103
  v_mfma_f32_32x32x8_bf16 v[112:127], v[60:61], v[28:29], v[112:127]
  v_exp_f32 v104, v104
  v_cvt_pk_bf16_f32 v83, v102, v103
  v_exp_f32 v105, v105
  v_exp_f32 v106, v106
  v_cvt_pk_bf16_f32 v84, v104, v105
  v_exp_f32 v107, v107
  v_mfma_f32_32x32x16_bf16 v[176:191], v[68:71], v[92:95], v[176:191]
  v_exp_f32 v108, v108
  v_cvt_pk_bf16_f32 v85, v106, v107
  v_exp_f32 v109, v109
  v_exp_f32 v110, v110
  v_cvt_pk_bf16_f32 v86, v108, v109
  v_exp_f32 v111, v111
  v_mfma_f32_32x32x16_bf16 v[128:143], v[72:75], v[80:83], v[128:143]
  ds_read_b64_tr_b16 v[48:49], v1 offset:10240
  ds_read_b64_tr_b16 v[50:51], v1 offset:10368
  v_exp_f32 v112, v112
  v_cvt_pk_bf16_f32 v87, v110, v111
  v_exp_f32 v113, v113
  v_exp_f32 v114, v114
  v_cvt_pk_bf16_f32 v88, v112, v113
  v_exp_f32 v115, v115
  v_mfma_f32_32x32x16_bf16 v[96:111], v[56:59], v[32:35], 0
  ds_read_b64_tr_b16 v[52:53], v3 offset:10240
  ds_read_b128 v[64:67], v2 offset:10240
  v_exp_f32 v116, v116
  v_cvt_pk_bf16_f32 v89, v114, v115
  v_exp_f32 v117, v117
  v_exp_f32 v118, v118
  v_cvt_pk_bf16_f32 v90, v116, v117
  v_exp_f32 v119, v119
  v_mfma_f32_32x32x8_bf16 v[96:111], v[60:61], v[36:37], v[96:111]
  v_exp_f32 v120, v120
  v_cvt_pk_bf16_f32 v91, v118, v119
  v_exp_f32 v121, v121
  v_exp_f32 v122, v122
  v_cvt_pk_bf16_f32 v92, v120, v121
  v_exp_f32 v123, v123
  v_mfma_f32_32x32x16_bf16 v[128:143], v[76:79], v[84:87], v[128:143]
  ds_read_b128 v[68:71], v2 offset:10880
  v_exp_f32 v124, v124
  v_cvt_pk_bf16_f32 v93, v122, v123
  v_exp_f32 v125, v125
  v_exp_f32 v126, v126
  v_cvt_pk_bf16_f32 v94, v124, v125
  v_exp_f32 v127, v127
  v_mfma_f32_32x32x16_bf16 v[144:159], v[72:75], v[88:91], v[144:159]
  s_mov_b32 m0, s32
  v_exp_f32 v96, v96
  v_cvt_pk_bf16_f32 v95, v126, v127
  v_exp_f32 v97, v97
  v_exp_f32 v98, v98
  v_cvt_pk_bf16_f32 v80, v96, v97
  v_exp_f32 v99, v99
  v_mfma_f32_32x32x16_bf16 v[112:127], v[56:59], v[40:43], 0
  buffer_load_dwordx4 v197, s[12:15], s32 offen sc1 lds
  v_exp_f32 v100, v100
  v_cvt_pk_bf16_f32 v81, v98, v99
  v_exp_f32 v101, v101
  v_exp_f32 v102, v102
  v_cvt_pk_bf16_f32 v82, v100, v101
  v_exp_f32 v103, v103
  v_mfma_f32_32x32x8_bf16 v[112:127], v[60:61], v[44:45], v[112:127]
  v_exp_f32 v104, v104
  v_cvt_pk_bf16_f32 v83, v102, v103
  v_exp_f32 v105, v105
  v_exp_f32 v106, v106
  v_cvt_pk_bf16_f32 v84, v104, v105
  v_exp_f32 v107, v107
  v_mfma_f32_32x32x16_bf16 v[144:159], v[76:79], v[92:95], v[144:159]
  s_add_u32 s32, s32, 4096
  v_exp_f32 v108, v108
  v_cvt_pk_bf16_f32 v85, v106, v107
  v_exp_f32 v109, v109
  v_exp_f32 v110, v110
  v_cvt_pk_bf16_f32 v86, v108, v109
  v_exp_f32 v111, v111
  v_mfma_f32_32x32x16_bf16 v[160:175], v[72:75], v[80:83], v[160:175]
  s_waitcnt lgkmcnt(0)
  v_exp_f32 v112, v112
  v_cvt_pk_bf16_f32 v87, v110, v111
  v_exp_f32 v113, v113
  v_exp_f32 v114, v114
  v_cvt_pk_bf16_f32 v88, v112, v113
  v_exp_f32 v115, v115
  v_mfma_f32_32x32x16_bf16 v[96:111], v[48:51], v[16:19], 0
  v_exp_f32 v116, v116
  v_cvt_pk_bf16_f32 v89, v114, v115
  v_exp_f32 v117, v117
  v_exp_f32 v118, v118
  v_cvt_pk_bf16_f32 v90, v116, v117
  v_exp_f32 v119, v119
  v_mfma_f32_32x32x8_bf16 v[96:111], v[52:53], v[20:21], v[96:111]
  v_exp_f32 v120, v120
  v_cvt_pk_bf16_f32 v91, v118, v119
  v_exp_f32 v121, v121
  v_exp_f32 v122, v122
  v_cvt_pk_bf16_f32 v92, v120, v121
  v_exp_f32 v123, v123
  v_mfma_f32_32x32x16_bf16 v[160:175], v[76:79], v[84:87], v[160:175]
  v_exp_f32 v124, v124
  v_cvt_pk_bf16_f32 v93, v122, v123
  v_exp_f32 v125, v125
  v_exp_f32 v126, v126
  v_cvt_pk_bf16_f32 v94, v124, v125
  v_exp_f32 v127, v127
  v_mfma_f32_32x32x16_bf16 v[176:191], v[72:75], v[88:91], v[176:191]
  v_exp_f32 v96, v96
  v_cvt_pk_bf16_f32 v95, v126, v127
  v_exp_f32 v97, v97
  v_exp_f32 v98, v98
  v_cvt_pk_bf16_f32 v80, v96, v97
  v_exp_f32 v99, v99
  v_mfma_f32_32x32x16_bf16 v[112:127], v[48:51], v[24:27], 0
  v_exp_f32 v100, v100
  v_cvt_pk_bf16_f32 v81, v98, v99
  v_exp_f32 v101, v101
  v_exp_f32 v102, v102
  v_cvt_pk_bf16_f32 v82, v100, v101
  v_exp_f32 v103, v103
  v_mfma_f32_32x32x8_bf16 v[112:127], v[52:53], v[28:29], v[112:127]
  v_exp_f32 v104, v104
  v_cvt_pk_bf16_f32 v83, v102, v103
  v_exp_f32 v105, v105
  v_exp_f32 v106, v106
  v_cvt_pk_bf16_f32 v84, v104, v105
  v_exp_f32 v107, v107
  v_mfma_f32_32x32x16_bf16 v[176:191], v[76:79], v[92:95], v[176:191]
  v_exp_f32 v108, v108
  v_cvt_pk_bf16_f32 v85, v106, v107
  v_exp_f32 v109, v109
  v_exp_f32 v110, v110
  v_cvt_pk_bf16_f32 v86, v108, v109
  v_exp_f32 v111, v111
  v_mfma_f32_32x32x16_bf16 v[128:143], v[64:67], v[80:83], v[128:143]
  ds_read_b64_tr_b16 v[56:57], v1 offset:12800
  ds_read_b64_tr_b16 v[58:59], v1 offset:12928
  v_exp_f32 v112, v112
  v_cvt_pk_bf16_f32 v87, v110, v111
  v_exp_f32 v113, v113
  v_exp_f32 v114, v114
  v_cvt_pk_bf16_f32 v88, v112, v113
  v_exp_f32 v115, v115
  v_mfma_f32_32x32x16_bf16 v[96:111], v[48:51], v[32:35], 0
  ds_read_b64_tr_b16 v[60:61], v3 offset:12800
  ds_read_b128 v[72:75], v2 offset:12800
  v_exp_f32 v116, v116
  v_cvt_pk_bf16_f32 v89, v114, v115
  v_exp_f32 v117, v117
  v_exp_f32 v118, v118
  v_cvt_pk_bf16_f32 v90, v116, v117
  v_exp_f32 v119, v119
  v_mfma_f32_32x32x8_bf16 v[96:111], v[52:53], v[36:37], v[96:111]
  v_exp_f32 v120, v120
  v_cvt_pk_bf16_f32 v91, v118, v119
  v_exp_f32 v121, v121
  v_exp_f32 v122, v122
  v_cvt_pk_bf16_f32 v92, v120, v121
  v_exp_f32 v123, v123
  v_mfma_f32_32x32x16_bf16 v[128:143], v[68:71], v[84:87], v[128:143]
  ds_read_b128 v[76:79], v2 offset:13440
  v_exp_f32 v124, v124
  v_cvt_pk_bf16_f32 v93, v122, v123
  v_exp_f32 v125, v125
  v_exp_f32 v126, v126
  v_cvt_pk_bf16_f32 v94, v124, v125
  v_exp_f32 v127, v127
  v_mfma_f32_32x32x16_bf16 v[144:159], v[64:67], v[88:91], v[144:159]
  s_mov_b32 m0, s32
  v_exp_f32 v96, v96
  v_cvt_pk_bf16_f32 v95, v126, v127
  v_exp_f32 v97, v97
  v_exp_f32 v98, v98
  v_cvt_pk_bf16_f32 v80, v96, v97
  v_exp_f32 v99, v99
  v_mfma_f32_32x32x16_bf16 v[112:127], v[48:51], v[40:43], 0
  buffer_load_dwordx4 v197, s[12:15], s32 offen sc1 lds
  v_exp_f32 v100, v100
  v_cvt_pk_bf16_f32 v81, v98, v99
  v_exp_f32 v101, v101
  v_exp_f32 v102, v102
  v_cvt_pk_bf16_f32 v82, v100, v101
  v_exp_f32 v103, v103
  v_mfma_f32_32x32x8_bf16 v[112:127], v[52:53], v[44:45], v[112:127]
  v_exp_f32 v104, v104
  v_cvt_pk_bf16_f32 v83, v102, v103
  v_exp_f32 v105, v105
  v_exp_f32 v106, v106
  v_cvt_pk_bf16_f32 v84, v104, v105
  v_exp_f32 v107, v107
  v_mfma_f32_32x32x16_bf16 v[144:159], v[68:71], v[92:95], v[144:159]
  s_add_u32 s32, s32, 4096
  v_exp_f32 v108, v108
  v_cvt_pk_bf16_f32 v85, v106, v107
  v_exp_f32 v109, v109
  v_exp_f32 v110, v110
  v_cvt_pk_bf16_f32 v86, v108, v109
  v_exp_f32 v111, v111
  v_mfma_f32_32x32x16_bf16 v[160:175], v[64:67], v[80:83], v[160:175]
  s_waitcnt lgkmcnt(0)
  v_exp_f32 v112, v112
  v_cvt_pk_bf16_f32 v87, v110, v111
  v_exp_f32 v113, v113
  v_exp_f32 v114, v114
  v_cvt_pk_bf16_f32 v88, v112, v113
  v_exp_f32 v115, v115
  v_mfma_f32_32x32x16_bf16 v[96:111], v[56:59], v[16:19], 0
  v_exp_f32 v116, v116
  v_cvt_pk_bf16_f32 v89, v114, v115
  v_exp_f32 v117, v117
  v_exp_f32 v118, v118
  v_cvt_pk_bf16_f32 v90, v116, v117
  v_exp_f32 v119, v119
  v_mfma_f32_32x32x8_bf16 v[96:111], v[60:61], v[20:21], v[96:111]
  v_exp_f32 v120, v120
  v_cvt_pk_bf16_f32 v91, v118, v119
  v_exp_f32 v121, v121
  v_exp_f32 v122, v122
  v_cvt_pk_bf16_f32 v92, v120, v121
  v_exp_f32 v123, v123
  v_mfma_f32_32x32x16_bf16 v[160:175], v[68:71], v[84:87], v[160:175]
  v_exp_f32 v124, v124
  v_cvt_pk_bf16_f32 v93, v122, v123
  v_exp_f32 v125, v125
  v_exp_f32 v126, v126
  v_cvt_pk_bf16_f32 v94, v124, v125
  v_exp_f32 v127, v127
  v_mfma_f32_32x32x16_bf16 v[176:191], v[64:67], v[88:91], v[176:191]
  v_exp_f32 v96, v96
  v_cvt_pk_bf16_f32 v95, v126, v127
  v_exp_f32 v97, v97
  v_exp_f32 v98, v98
  v_cvt_pk_bf16_f32 v80, v96, v97
  v_exp_f32 v99, v99
  v_mfma_f32_32x32x16_bf16 v[112:127], v[56:59], v[24:27], 0
  v_exp_f32 v100, v100
  v_cvt_pk_bf16_f32 v81, v98, v99
  v_exp_f32 v101, v101
  v_exp_f32 v102, v102
  v_cvt_pk_bf16_f32 v82, v100, v101
  v_exp_f32 v103, v103
  v_mfma_f32_32x32x8_bf16 v[112:127], v[60:61], v[28:29], v[112:127]
  v_exp_f32 v104, v104
  v_cvt_pk_bf16_f32 v83, v102, v103
  v_exp_f32 v105, v105
  v_exp_f32 v106, v106
  v_cvt_pk_bf16_f32 v84, v104, v105
  v_exp_f32 v107, v107
  v_mfma_f32_32x32x16_bf16 v[176:191], v[68:71], v[92:95], v[176:191]
  v_exp_f32 v108, v108
  v_cvt_pk_bf16_f32 v85, v106, v107
  v_exp_f32 v109, v109
  v_exp_f32 v110, v110
  v_cvt_pk_bf16_f32 v86, v108, v109
  v_exp_f32 v111, v111
  v_mfma_f32_32x32x16_bf16 v[128:143], v[72:75], v[80:83], v[128:143]
  ds_read_b64_tr_b16 v[48:49], v1 offset:15360
  ds_read_b64_tr_b16 v[50:51], v1 offset:15488
  v_exp_f32 v112, v112
  v_cvt_pk_bf16_f32 v87, v110, v111
  v_exp_f32 v113, v113
  v_exp_f32 v114, v114
  v_cvt_pk_bf16_f32 v88, v112, v113
  v_exp_f32 v115, v115
  v_mfma_f32_32x32x16_bf16 v[96:111], v[56:59], v[32:35], 0
  ds_read_b64_tr_b16 v[52:53], v3 offset:15360
  ds_read_b128 v[64:67], v2 offset:15360
  v_exp_f32 v116, v116
  v_cvt_pk_bf16_f32 v89, v114, v115
  v_exp_f32 v117, v117
  v_exp_f32 v118, v118
  v_cvt_pk_bf16_f32 v90, v116, v117
  v_exp_f32 v119, v119
  v_mfma_f32_32x32x8_bf16 v[96:111], v[60:61], v[36:37], v[96:111]
  v_exp_f32 v120, v120
  v_cvt_pk_bf16_f32 v91, v118, v119
  v_exp_f32 v121, v121
  v_exp_f32 v122, v122
  v_cvt_pk_bf16_f32 v92, v120, v121
  v_exp_f32 v123, v123
  v_mfma_f32_32x32x16_bf16 v[128:143], v[76:79], v[84:87], v[128:143]
  ds_read_b128 v[68:71], v2 offset:16000
  v_exp_f32 v124, v124
  v_cvt_pk_bf16_f32 v93, v122, v123
  v_exp_f32 v125, v125
  v_exp_f32 v126, v126
  v_cvt_pk_bf16_f32 v94, v124, v125
  v_exp_f32 v127, v127
  v_mfma_f32_32x32x16_bf16 v[144:159], v[72:75], v[88:91], v[144:159]
  s_min_u32 s32, s32, 163840
  v_exp_f32 v96, v96
  v_cvt_pk_bf16_f32 v95, v126, v127
  v_exp_f32 v97, v97
  v_exp_f32 v98, v98
  v_cvt_pk_bf16_f32 v80, v96, v97
  v_exp_f32 v99, v99
  v_mfma_f32_32x32x16_bf16 v[112:127], v[56:59], v[40:43], 0
  buffer_load_dword v202, v201, s[44:47], 0 offen
  v_exp_f32 v100, v100
  v_cvt_pk_bf16_f32 v81, v98, v99
  v_exp_f32 v101, v101
  v_exp_f32 v102, v102
  v_cvt_pk_bf16_f32 v82, v100, v101
  v_exp_f32 v103, v103
  v_mfma_f32_32x32x8_bf16 v[112:127], v[60:61], v[44:45], v[112:127]
  v_exp_f32 v104, v104
  v_cvt_pk_bf16_f32 v83, v102, v103
  v_exp_f32 v105, v105
  v_exp_f32 v106, v106
  v_cvt_pk_bf16_f32 v84, v104, v105
  v_exp_f32 v107, v107
  v_mfma_f32_32x32x16_bf16 v[144:159], v[76:79], v[92:95], v[144:159]
  v_add_u32 v201, 524288, v201
  v_exp_f32 v108, v108
  v_cvt_pk_bf16_f32 v85, v106, v107
  v_exp_f32 v109, v109
  v_exp_f32 v110, v110
  v_cvt_pk_bf16_f32 v86, v108, v109
  v_exp_f32 v111, v111
  v_mfma_f32_32x32x16_bf16 v[160:175], v[72:75], v[80:83], v[160:175]
  s_waitcnt lgkmcnt(0)
  v_exp_f32 v112, v112
  v_cvt_pk_bf16_f32 v87, v110, v111
  v_exp_f32 v113, v113
  v_exp_f32 v114, v114
  v_cvt_pk_bf16_f32 v88, v112, v113
  v_exp_f32 v115, v115
  v_mfma_f32_32x32x16_bf16 v[96:111], v[48:51], v[16:19], 0
  v_exp_f32 v116, v116
  v_cvt_pk_bf16_f32 v89, v114, v115
  v_exp_f32 v117, v117
  v_exp_f32 v118, v118
  v_cvt_pk_bf16_f32 v90, v116, v117
  v_exp_f32 v119, v119
  v_mfma_f32_32x32x8_bf16 v[96:111], v[52:53], v[20:21], v[96:111]
  v_exp_f32 v120, v120
  v_cvt_pk_bf16_f32 v91, v118, v119
  v_exp_f32 v121, v121
  v_exp_f32 v122, v122
  v_cvt_pk_bf16_f32 v92, v120, v121
  v_exp_f32 v123, v123
  v_mfma_f32_32x32x16_bf16 v[160:175], v[76:79], v[84:87], v[160:175]
  v_exp_f32 v124, v124
  v_cvt_pk_bf16_f32 v93, v122, v123
  v_exp_f32 v125, v125
  v_exp_f32 v126, v126
  v_cvt_pk_bf16_f32 v94, v124, v125
  v_exp_f32 v127, v127
  v_mfma_f32_32x32x16_bf16 v[176:191], v[72:75], v[88:91], v[176:191]
  v_exp_f32 v96, v96
  v_cvt_pk_bf16_f32 v95, v126, v127
  v_exp_f32 v97, v97
  v_exp_f32 v98, v98
  v_cvt_pk_bf16_f32 v80, v96, v97
  v_exp_f32 v99, v99
  v_mfma_f32_32x32x16_bf16 v[112:127], v[48:51], v[24:27], 0
  v_exp_f32 v100, v100
  v_cvt_pk_bf16_f32 v81, v98, v99
  v_exp_f32 v101, v101
  v_exp_f32 v102, v102
  v_cvt_pk_bf16_f32 v82, v100, v101
  v_exp_f32 v103, v103
  v_mfma_f32_32x32x8_bf16 v[112:127], v[52:53], v[28:29], v[112:127]
  v_exp_f32 v104, v104
  v_cvt_pk_bf16_f32 v83, v102, v103
  v_exp_f32 v105, v105
  v_exp_f32 v106, v106
  v_cvt_pk_bf16_f32 v84, v104, v105
  v_exp_f32 v107, v107
  v_mfma_f32_32x32x16_bf16 v[176:191], v[76:79], v[92:95], v[176:191]
  v_exp_f32 v108, v108
  v_cvt_pk_bf16_f32 v85, v106, v107
  v_exp_f32 v109, v109
  v_exp_f32 v110, v110
  v_cvt_pk_bf16_f32 v86, v108, v109
  v_exp_f32 v111, v111
  v_mfma_f32_32x32x16_bf16 v[128:143], v[64:67], v[80:83], v[128:143]
  ds_read_b64_tr_b16 v[56:57], v1 offset:17920
  ds_read_b64_tr_b16 v[58:59], v1 offset:18048
  v_exp_f32 v112, v112
  v_cvt_pk_bf16_f32 v87, v110, v111
  v_exp_f32 v113, v113
  v_exp_f32 v114, v114
  v_cvt_pk_bf16_f32 v88, v112, v113
  v_exp_f32 v115, v115
  v_mfma_f32_32x32x16_bf16 v[96:111], v[48:51], v[32:35], 0
  ds_read_b64_tr_b16 v[60:61], v3 offset:17920
  ds_read_b128 v[72:75], v2 offset:17920
  v_exp_f32 v116, v116
  v_cvt_pk_bf16_f32 v89, v114, v115
  v_exp_f32 v117, v117
  v_exp_f32 v118, v118
  v_cvt_pk_bf16_f32 v90, v116, v117
  v_exp_f32 v119, v119
  v_mfma_f32_32x32x8_bf16 v[96:111], v[52:53], v[36:37], v[96:111]
  v_exp_f32 v120, v120
  v_cvt_pk_bf16_f32 v91, v118, v119
  v_exp_f32 v121, v121
  v_exp_f32 v122, v122
  v_cvt_pk_bf16_f32 v92, v120, v121
  v_exp_f32 v123, v123
  v_mfma_f32_32x32x16_bf16 v[128:143], v[68:71], v[84:87], v[128:143]
  ds_read_b128 v[76:79], v2 offset:18560
  v_exp_f32 v124, v124
  v_cvt_pk_bf16_f32 v93, v122, v123
  v_exp_f32 v125, v125
  v_exp_f32 v126, v126
  v_cvt_pk_bf16_f32 v94, v124, v125
  v_exp_f32 v127, v127
  v_mfma_f32_32x32x16_bf16 v[144:159], v[64:67], v[88:91], v[144:159]
  v_exp_f32 v96, v96
  v_cvt_pk_bf16_f32 v95, v126, v127
  v_exp_f32 v97, v97
  v_exp_f32 v98, v98
  v_cvt_pk_bf16_f32 v80, v96, v97
  v_exp_f32 v99, v99
  v_mfma_f32_32x32x16_bf16 v[112:127], v[48:51], v[40:43], 0
  v_exp_f32 v100, v100
  v_cvt_pk_bf16_f32 v81, v98, v99
  v_exp_f32 v101, v101
  v_exp_f32 v102, v102
  v_cvt_pk_bf16_f32 v82, v100, v101
  v_exp_f32 v103, v103
  v_mfma_f32_32x32x8_bf16 v[112:127], v[52:53], v[44:45], v[112:127]
  v_exp_f32 v104, v104
  v_cvt_pk_bf16_f32 v83, v102, v103
  v_exp_f32 v105, v105
  v_exp_f32 v106, v106
  v_cvt_pk_bf16_f32 v84, v104, v105
  v_exp_f32 v107, v107
  v_mfma_f32_32x32x16_bf16 v[144:159], v[68:71], v[92:95], v[144:159]
  v_exp_f32 v108, v108
  v_cvt_pk_bf16_f32 v85, v106, v107
  v_exp_f32 v109, v109
  v_exp_f32 v110, v110
  v_cvt_pk_bf16_f32 v86, v108, v109
  v_exp_f32 v111, v111
  v_mfma_f32_32x32x16_bf16 v[160:175], v[64:67], v[80:83], v[160:175]
  s_waitcnt lgkmcnt(0)
  v_exp_f32 v112, v112
  v_cvt_pk_bf16_f32 v87, v110, v111
  v_exp_f32 v113, v113
  v_exp_f32 v114, v114
  v_cvt_pk_bf16_f32 v88, v112, v113
  v_exp_f32 v115, v115
  v_mfma_f32_32x32x16_bf16 v[96:111], v[56:59], v[16:19], 0
  v_exp_f32 v116, v116
  v_cvt_pk_bf16_f32 v89, v114, v115
  v_exp_f32 v117, v117
  v_exp_f32 v118, v118
  v_cvt_pk_bf16_f32 v90, v116, v117
  v_exp_f32 v119, v119
  v_mfma_f32_32x32x8_bf16 v[96:111], v[60:61], v[20:21], v[96:111]
  v_exp_f32 v120, v120
  v_cvt_pk_bf16_f32 v91, v118, v119
  v_exp_f32 v121, v121
  v_exp_f32 v122, v122
  v_cvt_pk_bf16_f32 v92, v120, v121
  v_exp_f32 v123, v123
  v_mfma_f32_32x32x16_bf16 v[160:175], v[68:71], v[84:87], v[160:175]
  v_exp_f32 v124, v124
  v_cvt_pk_bf16_f32 v93, v122, v123
  v_exp_f32 v125, v125
  v_exp_f32 v126, v126
  v_cvt_pk_bf16_f32 v94, v124, v125
  v_exp_f32 v127, v127
  v_mfma_f32_32x32x16_bf16 v[176:191], v[64:67], v[88:91], v[176:191]
  v_exp_f32 v96, v96
  v_cvt_pk_bf16_f32 v95, v126, v127
  v_exp_f32 v97, v97
  v_exp_f32 v98, v98
  v_cvt_pk_bf16_f32 v80, v96, v97
  v_exp_f32 v99, v99
  v_mfma_f32_32x32x16_bf16 v[112:127], v[56:59], v[24:27], 0
  v_exp_f32 v100, v100
  v_cvt_pk_bf16_f32 v81, v98, v99
  v_exp_f32 v101, v101
  v_exp_f32 v102, v102
  v_cvt_pk_bf16_f32 v82, v100, v101
  v_exp_f32 v103, v103
  v_mfma_f32_32x32x8_bf16 v[112:127], v[60:61], v[28:29], v[112:127]
  v_exp_f32 v104, v104
  v_cvt_pk_bf16_f32 v83, v102, v103
  v_exp_f32 v105, v105
  v_exp_f32 v106, v106
  v_cvt_pk_bf16_f32 v84, v104, v105
  v_exp_f32 v107, v107
  v_mfma_f32_32x32x16_bf16 v[176:191], v[68:71], v[92:95], v[176:191]
  v_exp_f32 v108, v108
  v_cvt_pk_bf16_f32 v85, v106, v107
  v_exp_f32 v109, v109
  v_exp_f32 v110, v110
  v_cvt_pk_bf16_f32 v86, v108, v109
  v_exp_f32 v111, v111
  v_mfma_f32_32x32x16_bf16 v[128:143], v[72:75], v[80:83], v[128:143]
  ds_read_b64_tr_b16 v[48:49], v1 offset:20480
  ds_read_b64_tr_b16 v[50:51], v1 offset:20608
  v_exp_f32 v112, v112
  v_cvt_pk_bf16_f32 v87, v110, v111
  v_exp_f32 v113, v113
  v_exp_f32 v114, v114
  v_cvt_pk_bf16_f32 v88, v112, v113
  v_exp_f32 v115, v115
  v_mfma_f32_32x32x16_bf16 v[96:111], v[56:59], v[32:35], 0
  ds_read_b64_tr_b16 v[52:53], v3 offset:20480
  ds_read_b128 v[64:67], v2 offset:20480
  v_exp_f32 v116, v116
  v_cvt_pk_bf16_f32 v89, v114, v115
  v_exp_f32 v117, v117
  v_exp_f32 v118, v118
  v_cvt_pk_bf16_f32 v90, v116, v117
  v_exp_f32 v119, v119
  v_mfma_f32_32x32x8_bf16 v[96:111], v[60:61], v[36:37], v[96:111]
  v_exp_f32 v120, v120
  v_cvt_pk_bf16_f32 v91, v118, v119
  v_exp_f32 v121, v121
  v_exp_f32 v122, v122
  v_cvt_pk_bf16_f32 v92, v120, v121
  v_exp_f32 v123, v123
  v_mfma_f32_32x32x16_bf16 v[128:143], v[76:79], v[84:87], v[128:143]
  ds_read_b128 v[68:71], v2 offset:21120
  v_exp_f32 v124, v124
  v_cvt_pk_bf16_f32 v93, v122, v123
  v_exp_f32 v125, v125
  v_exp_f32 v126, v126
  v_cvt_pk_bf16_f32 v94, v124, v125
  v_exp_f32 v127, v127
  v_mfma_f32_32x32x16_bf16 v[144:159], v[72:75], v[88:91], v[144:159]
  s_sub_u32 s23, s23, 1
  v_exp_f32 v96, v96
  v_cvt_pk_bf16_f32 v95, v126, v127
  v_exp_f32 v97, v97
  v_exp_f32 v98, v98
  v_cvt_pk_bf16_f32 v80, v96, v97
  v_exp_f32 v99, v99
  v_mfma_f32_32x32x16_bf16 v[112:127], v[56:59], v[40:43], 0
  v_exp_f32 v100, v100
  v_cvt_pk_bf16_f32 v81, v98, v99
  v_exp_f32 v101, v101
  v_exp_f32 v102, v102
  v_cvt_pk_bf16_f32 v82, v100, v101
  v_exp_f32 v103, v103
  v_mfma_f32_32x32x8_bf16 v[112:127], v[60:61], v[44:45], v[112:127]
  v_exp_f32 v104, v104
  v_cvt_pk_bf16_f32 v83, v102, v103
  v_exp_f32 v105, v105
  v_exp_f32 v106, v106
  v_cvt_pk_bf16_f32 v84, v104, v105
  v_exp_f32 v107, v107
  v_mfma_f32_32x32x16_bf16 v[144:159], v[76:79], v[92:95], v[144:159]
  v_exp_f32 v108, v108
  v_cvt_pk_bf16_f32 v85, v106, v107
  v_exp_f32 v109, v109
  v_exp_f32 v110, v110
  v_cvt_pk_bf16_f32 v86, v108, v109
  v_exp_f32 v111, v111
  v_mfma_f32_32x32x16_bf16 v[160:175], v[72:75], v[80:83], v[160:175]
  s_waitcnt lgkmcnt(0)
  v_exp_f32 v112, v112
  v_cvt_pk_bf16_f32 v87, v110, v111
  v_exp_f32 v113, v113
  v_add_u32 v1, 20480, v1
  v_exp_f32 v114, v114
  v_cvt_pk_bf16_f32 v88, v112, v113
  v_exp_f32 v115, v115
  v_mfma_f32_32x32x16_bf16 v[96:111], v[48:51], v[16:19], 0
  v_exp_f32 v116, v116
  v_cvt_pk_bf16_f32 v89, v114, v115
  v_exp_f32 v117, v117
  v_add_u32 v3, 20480, v3
  v_exp_f32 v118, v118
  v_cvt_pk_bf16_f32 v90, v116, v117
  v_exp_f32 v119, v119
  v_mfma_f32_32x32x8_bf16 v[96:111], v[52:53], v[20:21], v[96:111]
  v_exp_f32 v120, v120
  v_cvt_pk_bf16_f32 v91, v118, v119
  v_exp_f32 v121, v121
  v_add_u32 v2, 20480, v2
  v_exp_f32 v122, v122
  v_cvt_pk_bf16_f32 v92, v120, v121
  v_exp_f32 v123, v123
  v_mfma_f32_32x32x16_bf16 v[160:175], v[76:79], v[84:87], v[160:175]
  v_exp_f32 v124, v124
  v_cvt_pk_bf16_f32 v93, v122, v123
  v_exp_f32 v125, v125
  v_exp_f32 v126, v126
  v_cvt_pk_bf16_f32 v94, v124, v125
  v_exp_f32 v127, v127
  s_cmp_lg_u32 s24, 0
  s_cbranch_scc1 L_at_nobar
  s_waitcnt vmcnt(0)
  s_barrier
L_at_nobar:
  s_cmp_lg_u32 s23, 0
  s_cbranch_scc1 L_at_loop
  v_cvt_pk_bf16_f32 v95, v126, v127
  v_mfma_f32_32x32x16_bf16 v[176:191], v[72:75], v[88:91], v[176:191]
  s_nop 0
  v_mfma_f32_32x32x16_bf16 v[176:191], v[76:79], v[92:95], v[176:191]
  s_cmp_lg_u32 s24, 0
  s_cbranch_scc1 L_at_out
  v_mov_b32 v5, 0
  v_mov_b32 v6, 0
  v_fma_f32 v5, v128, 0, v5
  v_fma_f32 v6, v129, 0, v6
  v_fma_f32 v5, v130, 0, v5
  v_fma_f32 v6, v131, 0, v6
  v_fma_f32 v5, v132, 0, v5
  v_fma_f32 v6, v133, 0, v6
  v_fma_f32 v5, v134, 0, v5
  v_fma_f32 v6, v135, 0, v6
  v_fma_f32 v5, v136, 0, v5
  v_fma_f32 v6, v137, 0, v6
  v_fma_f32 v5, v144, 0, v5
  v_fma_f32 v6, v145, 0, v6
  v_fma_f32 v5, v146, 0, v5
  v_fma_f32 v6, v147, 0, v6
  v_fma_f32 v5, v148, 0, v5
  v_fma_f32 v6, v149, 0, v6
  v_fma_f32 v5, v150, 0, v5
  v_fma_f32 v6, v151, 0, v6
  v_fma_f32 v5, v152, 0, v5
  v_fma_f32 v6, v153, 0, v6
  v_fma_f32 v5, v160, 0, v5
  v_fma_f32 v6, v161, 0, v6
  v_fma_f32 v5, v162, 0, v5
  v_fma_f32 v6, v163, 0, v6
  v_fma_f32 v5, v164, 0, v5
  v_fma_f32 v6, v165, 0, v6
  v_fma_f32 v5, v166, 0, v5
  v_fma_f32 v6, v167, 0, v6
  v_fma_f32 v5, v168, 0, v5
  v_fma_f32 v6, v169, 0, v6
  v_fma_f32 v5, v176, 0, v5
  v_fma_f32 v6, v177, 0, v6
  v_fma_f32 v5, v178, 0, v5
  v_fma_f32 v6, v179, 0, v6
  v_fma_f32 v5, v180, 0, v5
  v_fma_f32 v6, v181, 0, v6
  v_fma_f32 v5, v182, 0, v5
  v_fma_f32 v6, v183, 0, v6
  v_fma_f32 v5, v184, 0, v5
  v_fma_f32 v6, v185, 0, v6
  v_add_f32 v5, v5, v6
  v_max3_f32 v6, v138, v154, v170
  v_max_f32 v6, v6, v186
  v_add_f32 v5, v5, v6
  v_mov_b32 v7, 1602224128
  v_cmp_nlt_f32 vcc, v5, v7
  s_cmp_eq_u64 vcc, 0
  s_cbranch_scc1 L_at_out
  s_mov_b32 s24, 1
  s_mov_b32 s25, 64
  v_subrev_u32 v1, 163840, v1
  v_subrev_u32 v3, 163840, v3
  v_subrev_u32 v2, 163840, v2
  v_mov_b32 v128, 0
  v_mov_b32 v129, 0
  v_mov_b32 v130, 0
  v_mov_b32 v131, 0
  v_mov_b32 v132, 0
  v_mov_b32 v133, 0
  v_mov_b32 v134, 0
  v_mov_b32 v135, 0
  v_mov_b32 v136, 0
  v_mov_b32 v137, 0
  v_mov_b32 v138, 0
  v_mov_b32 v139, 0
  v_mov_b32 v140, 0
  v_mov_b32 v141, 0
  v_mov_b32 v142, 0
  v_mov_b32 v143, 0
  v_mov_b32 v144, 0
  v_mov_b32 v145, 0
  v_mov_b32 v146, 0
  v_mov_b32 v147, 0
  v_mov_b32 v148, 0
  v_mov_b32 v149, 0
  v_mov_b32 v150, 0
  v_mov_b32 v151, 0
  v_mov_b32 v152, 0
  v_mov_b32 v153, 0
  v_mov_b32 v154, 0
  v_mov_b32 v155, 0
  v_mov_b32 v156, 0
  v_mov_b32 v157, 0
  v_mov_b32 v158, 0
  v_mov_b32 v159, 0
  v_mov_b32 v88, 0
  v_mov_b32 v72, 0
  v_mov_b32 v89, 0
  v_mov_b32 v73, 0
  v_mov_b32 v90, 0
  v_mov_b32 v74, 0
  v_mov_b32 v91, 0
  v_mov_b32 v75, 0
  v_mov_b32 v92, 0
  v_mov_b32 v76, 0
  v_mov_b32 v93, 0
  v_mov_b32 v77, 0
  v_mov_b32 v94, 0
  v_mov_b32 v78, 0
  v_mov_b32 v95, 0
  v_mov_b32 v79, 0
  s_waitcnt vmcnt(0) lgkmcnt(0)
  s_nop 15
  s_branch L_at_max
L_at_out:
  s_nop 7
  v_rcp_f32 v8, v138
  v_rcp_f32 v9, v154
  v_rcp_f32 v10, v170
  v_rcp_f32 v11, v186
  v_mul_f32 v128, v128, v8
  v_mul_f32 v129, v129, v8
  v_mul_f32 v130, v130, v8
  v_mul_f32 v131, v131, v8
  v_mul_f32 v132, v132, v8
  v_mul_f32 v133, v133, v8
  v_mul_f32 v134, v134, v8
  v_mul_f32 v135, v135, v8
  v_mul_f32 v136, v136, v8
  v_mul_f32 v137, v137, v8
  v_cvt_pk_bf16_f32 v96, v128, v129
  v_cvt_pk_bf16_f32 v97, v130, v131
  v_cvt_pk_bf16_f32 v98, v132, v133
  v_cvt_pk_bf16_f32 v99, v134, v135
  v_cvt_pk_bf16_f32 v100, v136, v137
  buffer_store_dwordx4 v[96:99], v197, s[16:19], s30 offen sc1
  s_mov_b64 exec, s[28:29]
  buffer_store_dword v100, v206, s[16:19], s31 offen sc1
  s_mov_b64 exec, -1
  s_add_u32 s30, s30, 36864
  s_add_u32 s31, s31, 36864
  v_mul_f32 v144, v144, v9
  v_mul_f32 v145, v145, v9
  v_mul_f32 v146, v146, v9
  v_mul_f32 v147, v147, v9
  v_mul_f32 v148, v148, v9
  v_mul_f32 v149, v149, v9
  v_mul_f32 v150, v150, v9
  v_mul_f32 v151, v151, v9
  v_mul_f32 v152, v152, v9
  v_mul_f32 v153, v153, v9
  v_cvt_pk_bf16_f32 v112, v144, v145
  v_cvt_pk_bf16_f32 v113, v146, v147
  v_cvt_pk_bf16_f32 v114, v148, v149
  v_cvt_pk_bf16_f32 v115, v150, v151
  v_cvt_pk_bf16_f32 v116, v152, v153
  buffer_store_dwordx4 v[112:115], v197, s[16:19], s30 offen sc1
  s_mov_b64 exec, s[28:29]
  buffer_store_dword v116, v206, s[16:19], s31 offen sc1
  s_mov_b64 exec, -1
  s_add_u32 s30, s30, 36864
  s_add_u32 s31, s31, 36864
  v_mul_f32 v160, v160, v10
  v_mul_f32 v161, v161, v10
  v_mul_f32 v162, v162, v10
  v_mul_f32 v163, v163, v10
  v_mul_f32 v164, v164, v10
  v_mul_f32 v165, v165, v10
  v_mul_f32 v166, v166, v10
  v_mul_f32 v167, v167, v10
  v_mul_f32 v168, v168, v10
  v_mul_f32 v169, v169, v10
  v_cvt_pk_bf16_f32 v104, v160, v161
  v_cvt_pk_bf16_f32 v105, v162, v163
  v_cvt_pk_bf16_f32 v106, v164, v165
  v_cvt_pk_bf16_f32 v107, v166, v167
  v_cvt_pk_bf16_f32 v108, v168, v169
  buffer_store_dwordx4 v[104:107], v197, s[16:19], s30 offen sc1
  s_mov_b64 exec, s[28:29]
  buffer_store_dword v108, v206, s[16:19], s31 offen sc1
  s_mov_b64 exec, -1
  s_add_u32 s30, s30, 36864
  s_add_u32 s31, s31, 36864
  v_mul_f32 v176, v176, v11
  v_mul_f32 v177, v177, v11
  v_mul_f32 v178, v178, v11
  v_mul_f32 v179, v179, v11
  v_mul_f32 v180, v180, v11
  v_mul_f32 v181, v181, v11
  v_mul_f32 v182, v182, v11
  v_mul_f32 v183, v183, v11
  v_mul_f32 v184, v184, v11
  v_mul_f32 v185, v185, v11
  v_cvt_pk_bf16_f32 v120, v176, v177
  v_cvt_pk_bf16_f32 v121, v178, v179
  v_cvt_pk_bf16_f32 v122, v180, v181
  v_cvt_pk_bf16_f32 v123, v182, v183
  v_cvt_pk_bf16_f32 v124, v184, v185
  buffer_store_dwordx4 v[120:123], v197, s[16:19], s30 offen sc1
  s_mov_b64 exec, s[28:29]
  buffer_store_dword v124, v206, s[16:19], s31 offen sc1
  s_mov_b64 exec, -1
  s_lshl_b32 s53, s5, 5
  s_add_u32 s53, s53, s4
  s_lshl_b32 s53, s53, 7
  s_add_u32 s53, s53, 14417920
  s_mov_b32 s55, 1
  s_mov_b32 s43, s20
  s_mov_b32 s16, s8
  s_mov_b32 s17, s9
  s_mov_b32 s18, s10
  s_mov_b32 s19, 131072
  s_branch L_final
L_exit:
  s_endpgm

.section .rodata,"a"
.p2align 6
.amdhsa_kernel gated_mix__mha_block__mixer_s_mlp__prompt_kernel
  .amdhsa_next_free_vgpr 512
  .amdhsa_next_free_sgpr 102
  .amdhsa_accum_offset 256
  .amdhsa_group_segment_fixed_size 0
  .amdhsa_kernarg_size 96
  .amdhsa_user_sgpr_count 2
  .amdhsa_user_sgpr_kernarg_segment_ptr 1
  .amdhsa_system_sgpr_workgroup_id_x 1
  .amdhsa_float_denorm_mode_32 3
  .amdhsa_float_denorm_mode_16_64 3
.end_amdhsa_kernel
```
